```python
import torch

def _softmax(x, axis=-1):
    return torch.softmax(x, dim=axis)

def _gelu(x):
    return torch.nn.functional.gelu(x, approximate='tanh')

def _silu(x):
    return torch.nn.functional.silu(x)

def _sigmoid(x):
    return torch.sigmoid(x)

def _layernorm(x, axis=-1, eps=1e-05):
    m = x.mean(dim=axis, keepdim=True)
    v = x.var(dim=axis, keepdim=True, unbiased=False)
    return (x - m) / torch.sqrt(v + eps)

def _scatter_add(tgt, idx, src, axis=0):
    return tgt.clone().index_add_(axis, idx, src)

def _segment_sum(src, seg, n):
    out = torch.zeros((n,) + src.shape[1:], dtype=src.dtype)
    return out.index_add_(0, seg, src)

def _pad(x, pw):
    flat = tuple((v for pair in reversed(pw) for v in pair))
    return torch.nn.functional.pad(x, flat)
kernel_name = 'interleave_layers__memory_aug_recurrent_mem_tr__glu_gated_glu__prompt'

def setup_inputs():

    _w = lambda a: (lambda t: t.to(torch.bfloat16) if t.is_floating_point() else t)(torch.as_tensor(a))

    def _A_setup():
        B, S, Dm = (1, 2048, 512)
        H, Dh = (32, 128)
        M, seg = (8, 32)
        seg = min(seg, S)
        S = S // seg * seg
        return {'x': _w((lambda *s: torch.randn(*s, dtype=torch.bfloat16) * 0.05)(B, S, Dm)), 'mem0': _w((lambda *s: torch.randn(*s, dtype=torch.bfloat16) * 0.8)(B, M, Dm)), 'Wq': _w((lambda *s: torch.randn(*s, dtype=torch.bfloat16) * 0.8)(Dm, H, Dh) * Dm ** (-0.5)), 'Wk': _w((lambda *s: torch.randn(*s, dtype=torch.bfloat16) * 0.8)(Dm, H, Dh) * Dm ** (-0.5)), 'Wv': _w((lambda *s: torch.randn(*s, dtype=torch.bfloat16) * 0.8)(Dm, H, Dh) * Dm ** (-0.5)), 'Wo': _w((lambda *s: torch.randn(*s, dtype=torch.bfloat16) * 0.8)(H, Dh, Dm) * (H * Dh) ** (-0.5)), 'seg_len': seg}
    _A_in = _A_setup()

    def _B_setup():
        B, S, D, F = (1, 2048, 512, 1792)
        return {'x': _w((lambda *s: torch.randn(*s, dtype=torch.bfloat16) * 0.05)(B, S, D)), 'w_gate': _w((lambda *s: torch.randn(*s, dtype=torch.bfloat16) * 0.05)(D, F)), 'w_up': _w((lambda *s: torch.randn(*s, dtype=torch.bfloat16) * 0.05)(D, F)), 'w_down': _w((lambda *s: torch.randn(*s, dtype=torch.bfloat16) * 0.05)(F, D))}
    _B_in = _B_setup()
    return {'A_x': _A_in['x'], 'A_mem0': _A_in['mem0'], 'A_Wq': _A_in['Wq'], 'A_Wk': _A_in['Wk'], 'A_Wv': _A_in['Wv'], 'A_Wo': _A_in['Wo'], 'A_seg_len': _A_in['seg_len'], 'B_x': _B_in['x'], 'B_w_gate': _B_in['w_gate'], 'B_w_up': _B_in['w_up'], 'B_w_down': _B_in['w_down']}

def reference(A_x, A_mem0, A_Wq, A_Wk, A_Wv, A_Wo, A_seg_len, B_x, B_w_gate, B_w_up, B_w_down):

    def _A_ref(x, mem0, Wq, Wk, Wv, Wo, seg_len):
        B, S, Dm = x.shape
        H, Dh = (Wq.shape[1], Wq.shape[2])
        M = mem0.shape[1]
        scale = Dh ** (-0.5)
        n_seg = S // seg_len
        L = M + seg_len
        idx = torch.arange(L)
        mask = (idx[:, None] < M) | (idx[:, None] >= idx[None, :])
        mem = mem0
        outs = []
        for s in range(n_seg):
            xs = x[:, s * seg_len:(s + 1) * seg_len, :].clone()
            h = torch.concatenate([mem, xs], axis=1)
            q = torch.einsum('btd,dhe->bhte', h, Wq)
            k = torch.einsum('btd,dhe->bhte', h, Wk)
            v = torch.einsum('btd,dhe->bhte', h, Wv)
            scores = torch.einsum('bhqe,bhke->bhqk', q, k) * scale
            scores = torch.where(mask[None, None], scores, -1000000000.0)
            p = _softmax(scores, axis=-1)
            o = torch.einsum('bhqk,bhke->bhqe', p, v)
            o = torch.einsum('bhte,hed->btd', o, Wo)
            mem = o[:, :M, :].clone()
            outs.append(o[:, M:, :])
        return torch.concatenate(outs, axis=1)

    def _B_ref(x, w_gate, w_up, w_down):
        g = torch.einsum('bsd,df->bsf', x, w_gate)
        u = torch.einsum('bsd,df->bsf', x, w_up)
        h = _sigmoid(g) * u
        return torch.einsum('bsf,fd->bsd', h, w_down)
    x = A_x
    x = x + _A_ref(_layernorm(x, axis=-1), A_mem0, A_Wq, A_Wk, A_Wv, A_Wo, A_seg_len)
    x = x + _B_ref(_layernorm(x, axis=-1), B_w_gate, B_w_up, B_w_down)
    x = x + _A_ref(_layernorm(x, axis=-1), A_mem0, A_Wq, A_Wk, A_Wv, A_Wo, A_seg_len)
    x = x + _B_ref(_layernorm(x, axis=-1), B_w_gate, B_w_up, B_w_down)
    return x
```

```asm
; @launch grid=(256,1,1) block=(256,1,1) lds=163840
.amdgcn_target "amdgcn-amd-amdhsa--gfx950"
.text
.globl interleave_layers__memory_aug_recurrent_mem_tr__glu_gated_glu__prompt_kernel
.p2align 8
.type interleave_layers__memory_aug_recurrent_mem_tr__glu_gated_glu__prompt_kernel,@function
interleave_layers__memory_aug_recurrent_mem_tr__glu_gated_glu__prompt_kernel:
    s_cmp_ge_u32 s2, 256
    s_cbranch_scc1 L_end
    s_load_dwordx16 s[32:47], s[0:1], 0
    s_load_dwordx8 s[48:55], s[0:1], 64
    s_load_dwordx4 s[56:59], s[0:1], 96
    s_getreg_b32 s17, hwreg(HW_REG_XCC_ID, 0, 3)
    v_lshrrev_b32 v1, 6, v0
    v_and_b32 v0, 63, v0
    v_readfirstlane_b32 s16, v1
    s_mov_b32 s20, 0
    s_mov_b32 s3, 1
    s_waitcnt lgkmcnt(0)
    s_mov_b32 s4, s58
    s_and_b32 s5, s59, 0xffff
    s_mov_b32 s6, 268435456
    s_mov_b32 s7, 0x20000
    s_mov_b32 s60, s56
    s_and_b32 s61, s57, 0xffff
    s_mov_b32 s62, 256
    s_mov_b32 s63, 0x20000
    s_lshl_b32 s21, s17, 5
    v_mov_b32 v2, 1
    v_mov_b32 v1, s21
    s_cmp_eq_u32 s16, 0
    s_cbranch_scc0 L_pro1
    v_mov_b32 v12, 0
    s_mov_b64 exec, 1
    buffer_atomic_add v2, v1, s[60:63], 0 offen sc0
    s_waitcnt vmcnt(0)
    ds_write_b32 v12, v2
    s_mov_b64 exec, -1
L_pro1:
    v_lshlrev_b32 v3, 4, v0
    v_mov_b32 v4, -1
    v_mov_b32 v5, -1
    v_mov_b32 v6, -1
    v_mov_b32 v7, -1
    s_mul_i32 s22, s2, 3072
    s_add_u32 s22, s22, 2097152
    s_min_u32 s23, s16, 2
    s_lshl_b32 s23, s23, 10
    s_add_u32 s23, s23, s22
    buffer_store_dwordx4 v[4:7], v3, s[4:7], s23 offen sc1
    s_lshl_b32 s24, s2, 13
    s_lshl_b32 s23, s16, 11
    s_add_u32 s24, s24, s23
    v_mov_b32 v8, 0
    v_mov_b32 v9, 0
    v_mov_b32 v10, 0
    v_mov_b32 v11, 0
    buffer_store_dwordx4 v[8:11], v3, s[4:7], s24 offen sc1
    buffer_store_dwordx4 v[8:11], v3, s[4:7], s24 offen offset:1024 sc1
    s_waitcnt lgkmcnt(0)
    s_barrier
    v_mov_b32 v12, 0
    ds_read_b32 v2, v12
    s_waitcnt lgkmcnt(0)
    v_readfirstlane_b32 s18, v2
    s_mov_b32 s91, 0
    s_barrier
    s_lshl_b32 s21, s17, 2
    s_lshr_b32 s21, 0x76543210, s21
    s_and_b32 s21, s21, 7
    s_lshl_b32 s19, s21, 5
    s_add_u32 s19, s19, s18
    s_cmp_ge_u32 s18, 32
    s_cbranch_scc0 L_dispatch
    s_cmp_eq_u32 s91, 0
    s_cbranch_scc0 L_arr_4
    s_mov_b32 s91, 1
    s_waitcnt vmcnt(0)
    s_barrier
    s_cmp_eq_u32 s16, 0
    s_cbranch_scc0 L_arr_4
    s_lshl_b32 s21, s17, 5
    s_add_u32 s21, s21, 4
    s_atomic_add s3, s[56:57], s21
L_arr_4:
    s_cmp_eq_u32 s20, 0
    s_cbranch_scc0 L_rdv_done_2
    s_mov_b32 s27, 0
    v_lshlrev_b32 v1, 2, v0
L_rdv_1:
    buffer_load_dword v2, v1, s[60:63], 0 offen sc1
    s_add_u32 s27, s27, 1
    s_cmp_gt_u32 s27, 262144
    s_cbranch_scc1 L_end
L_rdv_1_p:
    s_waitcnt vmcnt(0)
    s_mov_b32 s21, 0
    v_readlane_b32 s22, v2, 1
    s_nop 0
    s_add_u32 s21, s21, s22
    v_readlane_b32 s22, v2, 9
    s_nop 0
    s_add_u32 s21, s21, s22
    v_readlane_b32 s22, v2, 17
    s_nop 0
    s_add_u32 s21, s21, s22
    v_readlane_b32 s22, v2, 25
    s_nop 0
    s_add_u32 s21, s21, s22
    v_readlane_b32 s22, v2, 33
    s_nop 0
    s_add_u32 s21, s21, s22
    v_readlane_b32 s22, v2, 41
    s_nop 0
    s_add_u32 s21, s21, s22
    v_readlane_b32 s22, v2, 49
    s_nop 0
    s_add_u32 s21, s21, s22
    v_readlane_b32 s22, v2, 57
    s_nop 0
    s_add_u32 s21, s21, s22
    s_cmp_eq_u32 s21, 256
    s_cbranch_scc1 L_rdv_l_3
    s_sleep 4
    s_branch L_rdv_1
L_rdv_l_3:
    s_mov_b32 s21, 0
    s_mov_b32 s23, 0
    v_readlane_b32 s22, v2, 0
    s_cmp_gt_u32 s17, 0
    s_cselect_b32 s24, s22, 0
    s_add_u32 s23, s23, s24
    s_xor_b32 s22, s22, 32
    s_or_b32 s21, s21, s22
    v_readlane_b32 s22, v2, 8
    s_cmp_gt_u32 s17, 1
    s_cselect_b32 s24, s22, 0
    s_add_u32 s23, s23, s24
    s_xor_b32 s22, s22, 32
    s_or_b32 s21, s21, s22
    v_readlane_b32 s22, v2, 16
    s_cmp_gt_u32 s17, 2
    s_cselect_b32 s24, s22, 0
    s_add_u32 s23, s23, s24
    s_xor_b32 s22, s22, 32
    s_or_b32 s21, s21, s22
    v_readlane_b32 s22, v2, 24
    s_cmp_gt_u32 s17, 3
    s_cselect_b32 s24, s22, 0
    s_add_u32 s23, s23, s24
    s_xor_b32 s22, s22, 32
    s_or_b32 s21, s21, s22
    v_readlane_b32 s22, v2, 32
    s_cmp_gt_u32 s17, 4
    s_cselect_b32 s24, s22, 0
    s_add_u32 s23, s23, s24
    s_xor_b32 s22, s22, 32
    s_or_b32 s21, s21, s22
    v_readlane_b32 s22, v2, 40
    s_cmp_gt_u32 s17, 5
    s_cselect_b32 s24, s22, 0
    s_add_u32 s23, s23, s24
    s_xor_b32 s22, s22, 32
    s_or_b32 s21, s21, s22
    v_readlane_b32 s22, v2, 48
    s_cmp_gt_u32 s17, 6
    s_cselect_b32 s24, s22, 0
    s_add_u32 s23, s23, s24
    s_xor_b32 s22, s22, 32
    s_or_b32 s21, s21, s22
    v_readlane_b32 s22, v2, 56
    s_cmp_gt_u32 s17, 7
    s_cselect_b32 s24, s22, 0
    s_add_u32 s23, s23, s24
    s_xor_b32 s22, s22, 32
    s_or_b32 s21, s21, s22
    s_mov_b32 s20, 1
    s_cmp_eq_u32 s21, 0
    s_cbranch_scc1 L_rdv_done_2
    s_mov_b32 s20, 2
    s_add_u32 s19, s23, s18
    s_waitcnt vmcnt(0) lgkmcnt(0)
    s_barrier
    s_branch L_dispatch
L_rdv_done_2:
L_dispatch:
    s_mov_b32 s89, 0
    s_cmp_lt_u32 s19, 64
    s_cbranch_scc1 L_role_CH
    s_mov_b32 s21, 2098176
    v_writelane_b32 v1, s21, 0
    s_mov_b32 s21, 5246979
    v_writelane_b32 v1, s21, 1
    s_mov_b32 s21, 8395782
    v_writelane_b32 v1, s21, 2
    s_mov_b32 s21, 11544585
    v_writelane_b32 v1, s21, 3
    s_mov_b32 s21, 67122188
    v_writelane_b32 v1, s21, 4
    s_mov_b32 s21, 70322241
    v_writelane_b32 v1, s21, 5
    s_mov_b32 s21, 73471044
    v_writelane_b32 v1, s21, 6
    s_mov_b32 s21, 135397447
    v_writelane_b32 v1, s21, 7
    s_mov_b32 s21, 138546306
    v_writelane_b32 v1, s21, 8
    s_mov_b32 s21, 141695109
    v_writelane_b32 v1, s21, 9
    s_mov_b32 s21, 14909576
    v_writelane_b32 v1, s21, 10
    s_mov_b32 s21, 17842191
    v_writelane_b32 v1, s21, 11
    s_mov_b32 s21, 20990994
    v_writelane_b32 v1, s21, 12
    s_mov_b32 s21, 24139797
    v_writelane_b32 v1, s21, 13
    s_mov_b32 s21, 27288600
    v_writelane_b32 v1, s21, 14
    s_mov_b32 s21, 76619803
    v_writelane_b32 v1, s21, 15
    s_mov_b32 s21, 79768650
    v_writelane_b32 v1, s21, 16
    s_mov_b32 s21, 82917453
    v_writelane_b32 v1, s21, 17
    s_mov_b32 s21, 143737936
    v_writelane_b32 v1, s21, 18
    s_mov_b32 s21, 146943114
    v_writelane_b32 v1, s21, 19
    s_mov_b32 s21, 150091917
    v_writelane_b32 v1, s21, 20
    s_mov_b32 s21, 30437520
    v_writelane_b32 v1, s21, 21
    s_mov_b32 s21, 33586206
    v_writelane_b32 v1, s21, 22
    s_mov_b32 s21, 36735009
    v_writelane_b32 v1, s21, 23
    s_mov_b32 s21, 39883812
    v_writelane_b32 v1, s21, 24
    s_mov_b32 s21, 87115815
    v_writelane_b32 v1, s21, 25
    s_mov_b32 s21, 90264660
    v_writelane_b32 v1, s21, 26
    s_mov_b32 s21, 93413463
    v_writelane_b32 v1, s21, 27
    s_mov_b32 s21, 152136794
    v_writelane_b32 v1, s21, 28
    s_mov_b32 s21, 155339922
    v_writelane_b32 v1, s21, 29
    s_mov_b32 s21, 158488725
    v_writelane_b32 v1, s21, 30
    s_mov_b32 s21, 236086424
    v_writelane_b32 v1, s21, 31
    s_mov_b32 s21, 44082216
    v_writelane_b32 v1, s21, 32
    s_mov_b32 s21, 47231019
    v_writelane_b32 v1, s21, 33
    s_mov_b32 s21, 50379822
    v_writelane_b32 v1, s21, 34
    s_mov_b32 s21, 53528625
    v_writelane_b32 v1, s21, 35
    s_mov_b32 s21, 98661468
    v_writelane_b32 v1, s21, 36
    s_mov_b32 s21, 101810271
    v_writelane_b32 v1, s21, 37
    s_mov_b32 s21, 104959074
    v_writelane_b32 v1, s21, 38
    s_mov_b32 s21, 162687077
    v_writelane_b32 v1, s21, 39
    s_mov_b32 s21, 165835932
    v_writelane_b32 v1, s21, 40
    s_mov_b32 s21, 168984735
    v_writelane_b32 v1, s21, 41
    s_mov_b32 s21, 54788322
    v_writelane_b32 v1, s21, 42
    s_mov_b32 s21, 57727029
    v_writelane_b32 v1, s21, 43
    s_mov_b32 s21, 60875832
    v_writelane_b32 v1, s21, 44
    s_mov_b32 s21, 64024635
    v_writelane_b32 v1, s21, 45
    s_mov_b32 s21, 107019326
    v_writelane_b32 v1, s21, 46
    s_mov_b32 s21, 110207079
    v_writelane_b32 v1, s21, 47
    s_mov_b32 s21, 113355882
    v_writelane_b32 v1, s21, 48
    s_mov_b32 s21, 116504685
    v_writelane_b32 v1, s21, 49
    s_mov_b32 s21, 172133538
    v_writelane_b32 v1, s21, 50
    s_mov_b32 s21, 175282341
    v_writelane_b32 v1, s21, 51
    s_mov_b32 s21, 238199976
    v_writelane_b32 v1, s21, 52
    s_mov_b32 s21, 202572032
    v_writelane_b32 v1, s21, 53
    s_mov_b32 s21, 205720770
    v_writelane_b32 v1, s21, 54
    s_mov_b32 s21, 208869573
    v_writelane_b32 v1, s21, 55
    s_mov_b32 s21, 212018376
    v_writelane_b32 v1, s21, 56
    s_mov_b32 s21, 215167179
    v_writelane_b32 v1, s21, 57
    s_mov_b32 s21, 218315982
    v_writelane_b32 v1, s21, 58
    s_mov_b32 s21, 221464785
    v_writelane_b32 v1, s21, 59
    s_mov_b32 s21, 224613588
    v_writelane_b32 v1, s21, 60
    s_mov_b32 s21, 227762391
    v_writelane_b32 v1, s21, 61
    s_mov_b32 s21, 230911194
    v_writelane_b32 v1, s21, 62
    s_mov_b32 s21, 234059997
    v_writelane_b32 v1, s21, 63
    s_sub_u32 s21, s19, 64
    s_mul_i32 s22, s21, 0x5556
    s_lshr_b32 s22, s22, 16
    s_mul_i32 s23, s22, 3
    s_sub_u32 s21, s21, s23
    s_mul_i32 s21, s21, 10
    v_readlane_b32 s22, v1, s22
    s_nop 0
    s_lshr_b32 s22, s22, s21
    s_and_b32 s25, s22, 63
    s_bfe_u32 s22, s22, 0x30006
    s_cmp_eq_u32 s22, 0
    s_cbranch_scc1 L_role_QKV
    s_cmp_eq_u32 s22, 3
    s_cbranch_scc1 L_role_R
    s_mov_b32 s90, s22
    s_lshr_b32 s21, s19, 5
    s_mov_b32 s64, 0
    s_mov_b32 s65, 0
    s_cmp_eq_u32 s21, 2
    s_cselect_b32 s64, 0, s64
    s_cselect_b32 s65, 7, s65
    s_cselect_b32 s70, 2147467264, s70
    s_cselect_b32 s71, 0, s71
    s_cmp_eq_u32 s21, 3
    s_cselect_b32 s64, 7, s64
    s_cselect_b32 s65, 7, s65
    s_cselect_b32 s70, 4294950912, s70
    s_cselect_b32 s71, 9, s71
    s_cmp_eq_u32 s21, 4
    s_cselect_b32 s64, 14, s64
    s_cselect_b32 s65, 6, s65
    s_cselect_b32 s70, 2147479552, s70
    s_cselect_b32 s71, 17, s71
    s_cmp_eq_u32 s21, 5
    s_cselect_b32 s64, 20, s64
    s_cselect_b32 s65, 6, s65
    s_cselect_b32 s70, 3221221376, s70
    s_cselect_b32 s71, 26, s71
    s_cmp_eq_u32 s21, 6
    s_cselect_b32 s64, 26, s64
    s_cselect_b32 s65, 6, s65
    s_cselect_b32 s70, 3221221376, s70
    s_cselect_b32 s71, 34, s71
    s_cmp_eq_u32 s65, 0
    s_cbranch_scc1 L_coop_done
    s_and_b32 s66, s19, 31
    s_bfm_b32 s66, s66, 0
    s_and_b32 s66, s66, s70
    s_bcnt1_i32_b32 s66, s66
    s_lshl_b32 s66, s66, 2
    s_add_u32 s66, s66, s16
    s_bcnt1_i32_b32 s67, s70
    s_lshl_b32 s67, s67, 2
    s_lshl_b32 s68, s65, 8
    s_sub_u32 s68, s68, 16
    v_lshlrev_b32 v2, 4, v0
    v_add_u32 v3, 1024, v2
    v_min_u32 v3, s68, v3
    s_lshl_b32 s64, s64, 8
    s_lshl_b32 m0, s16, 10
    s_cmp_eq_u32 s91, 0
    s_cbranch_scc0 L_arr_5
    s_mov_b32 s91, 1
    s_waitcnt vmcnt(0)
    s_barrier
    s_cmp_eq_u32 s16, 0
    s_cbranch_scc0 L_arr_5
    s_lshl_b32 s21, s17, 5
    s_add_u32 s21, s21, 4
    s_atomic_add s3, s[56:57], s21
L_arr_5:
    s_mov_b32 s8, s38
    s_and_b32 s9, s39, 0xffff
    s_mov_b32 s10, 4194304
    s_mov_b32 s11, 0x20000
L_coop_6:
    s_lshl_b32 s69, s66, 13
    s_add_u32 s69, s69, s64
    buffer_load_dwordx4 v2, s[8:11], s69 offen lds
    buffer_load_dwordx4 v3, s[8:11], s69 offen lds
    s_add_u32 s66, s66, s67
    s_waitcnt vmcnt(40)
    s_cmp_lt_u32 s66, 512
    s_cbranch_scc1 L_coop_6
    s_sub_u32 s66, s66, 512
    s_mov_b32 s8, s40
    s_and_b32 s9, s41, 0xffff
    s_mov_b32 s10, 4194304
    s_mov_b32 s11, 0x20000
L_coop_7:
    s_lshl_b32 s69, s66, 13
    s_add_u32 s69, s69, s64
    buffer_load_dwordx4 v2, s[8:11], s69 offen lds
    buffer_load_dwordx4 v3, s[8:11], s69 offen lds
    s_add_u32 s66, s66, s67
    s_waitcnt vmcnt(40)
    s_cmp_lt_u32 s66, 512
    s_cbranch_scc1 L_coop_7
    s_sub_u32 s66, s66, 512
    s_mov_b32 s8, s36
    s_and_b32 s9, s37, 0xffff
    s_mov_b32 s10, 4194304
    s_mov_b32 s11, 0x20000
L_coop_8:
    s_lshl_b32 s69, s66, 13
    s_add_u32 s69, s69, s64
    buffer_load_dwordx4 v2, s[8:11], s69 offen lds
    buffer_load_dwordx4 v3, s[8:11], s69 offen lds
    s_add_u32 s66, s66, s67
    s_waitcnt vmcnt(40)
    s_cmp_lt_u32 s66, 512
    s_cbranch_scc1 L_coop_8
    s_sub_u32 s66, s66, 512
    s_waitcnt vmcnt(0)
    s_barrier
L_coop_done:
    s_mov_b32 s22, s90
    s_cmp_eq_u32 s22, 1
    s_cbranch_scc1 L_role_AO
    s_cmp_eq_u32 s22, 2
    s_cbranch_scc1 L_role_F
    s_cmp_eq_u32 s22, 3
    s_cbranch_scc1 L_role_R
    s_cmp_eq_u32 s91, 0
    s_cbranch_scc0 L_arr_12
    s_mov_b32 s91, 1
    s_waitcnt vmcnt(0)
    s_barrier
    s_cmp_eq_u32 s16, 0
    s_cbranch_scc0 L_arr_12
    s_lshl_b32 s21, s17, 5
    s_add_u32 s21, s21, 4
    s_atomic_add s3, s[56:57], s21
L_arr_12:
    s_cmp_eq_u32 s20, 0
    s_cbranch_scc0 L_rdv_done_10
    s_mov_b32 s27, 0
    v_lshlrev_b32 v1, 2, v0
L_rdv_9:
    buffer_load_dword v2, v1, s[60:63], 0 offen sc1
    s_add_u32 s27, s27, 1
    s_cmp_gt_u32 s27, 262144
    s_cbranch_scc1 L_end
L_rdv_9_p:
    s_waitcnt vmcnt(0)
    s_mov_b32 s21, 0
    v_readlane_b32 s22, v2, 1
    s_nop 0
    s_add_u32 s21, s21, s22
    v_readlane_b32 s22, v2, 9
    s_nop 0
    s_add_u32 s21, s21, s22
    v_readlane_b32 s22, v2, 17
    s_nop 0
    s_add_u32 s21, s21, s22
    v_readlane_b32 s22, v2, 25
    s_nop 0
    s_add_u32 s21, s21, s22
    v_readlane_b32 s22, v2, 33
    s_nop 0
    s_add_u32 s21, s21, s22
    v_readlane_b32 s22, v2, 41
    s_nop 0
    s_add_u32 s21, s21, s22
    v_readlane_b32 s22, v2, 49
    s_nop 0
    s_add_u32 s21, s21, s22
    v_readlane_b32 s22, v2, 57
    s_nop 0
    s_add_u32 s21, s21, s22
    s_cmp_eq_u32 s21, 256
    s_cbranch_scc1 L_rdv_l_11
    s_sleep 4
    s_branch L_rdv_9
L_rdv_l_11:
    s_mov_b32 s21, 0
    s_mov_b32 s23, 0
    v_readlane_b32 s22, v2, 0
    s_cmp_gt_u32 s17, 0
    s_cselect_b32 s24, s22, 0
    s_add_u32 s23, s23, s24
    s_xor_b32 s22, s22, 32
    s_or_b32 s21, s21, s22
    v_readlane_b32 s22, v2, 8
    s_cmp_gt_u32 s17, 1
    s_cselect_b32 s24, s22, 0
    s_add_u32 s23, s23, s24
    s_xor_b32 s22, s22, 32
    s_or_b32 s21, s21, s22
    v_readlane_b32 s22, v2, 16
    s_cmp_gt_u32 s17, 2
    s_cselect_b32 s24, s22, 0
    s_add_u32 s23, s23, s24
    s_xor_b32 s22, s22, 32
    s_or_b32 s21, s21, s22
    v_readlane_b32 s22, v2, 24
    s_cmp_gt_u32 s17, 3
    s_cselect_b32 s24, s22, 0
    s_add_u32 s23, s23, s24
    s_xor_b32 s22, s22, 32
    s_or_b32 s21, s21, s22
    v_readlane_b32 s22, v2, 32
    s_cmp_gt_u32 s17, 4
    s_cselect_b32 s24, s22, 0
    s_add_u32 s23, s23, s24
    s_xor_b32 s22, s22, 32
    s_or_b32 s21, s21, s22
    v_readlane_b32 s22, v2, 40
    s_cmp_gt_u32 s17, 5
    s_cselect_b32 s24, s22, 0
    s_add_u32 s23, s23, s24
    s_xor_b32 s22, s22, 32
    s_or_b32 s21, s21, s22
    v_readlane_b32 s22, v2, 48
    s_cmp_gt_u32 s17, 6
    s_cselect_b32 s24, s22, 0
    s_add_u32 s23, s23, s24
    s_xor_b32 s22, s22, 32
    s_or_b32 s21, s21, s22
    v_readlane_b32 s22, v2, 56
    s_cmp_gt_u32 s17, 7
    s_cselect_b32 s24, s22, 0
    s_add_u32 s23, s23, s24
    s_xor_b32 s22, s22, 32
    s_or_b32 s21, s21, s22
    s_mov_b32 s20, 1
    s_cmp_eq_u32 s21, 0
    s_cbranch_scc1 L_rdv_done_10
    s_mov_b32 s20, 2
    s_add_u32 s19, s23, s18
    s_waitcnt vmcnt(0) lgkmcnt(0)
    s_barrier
    s_branch L_dispatch
L_rdv_done_10:
    s_branch L_end
L_role_CH:
    s_lshr_b32 s64, s19, 5
    s_and_b32 s65, s19, 31
    s_cmp_eq_u32 s64, 0
    s_cbranch_scc1 L_ch_nohelp
    s_cmp_eq_u32 s89, 0
    s_cbranch_scc0 L_ch_nohelp
    s_mov_b32 s89, 1
    s_mov_b32 s31, s65
    s_branch L_role_QKV
L_ch_nohelp:
    s_lshl_b32 s78, s65, 8
    v_lshrrev_b32 v94, 4, v0
    v_and_b32 v95, 15, v0
    v_lshlrev_b32 v90, 10, v94
    v_lshl_add_u32 v90, v95, 4, v90
    s_lshl_b32 s26, s16, 15
    v_lshlrev_b32 v98, 4, v0
    v_bfe_u32 v94, v0, 2, 1
    v_bfe_u32 v95, v0, 4, 1
    v_lshl_add_u32 v94, v95, 4, v94
    v_lshrrev_b32 v95, 5, v0
    v_lshl_add_u32 v94, v95, 2, v94
    v_lshlrev_b32 v94, 8, v94
    v_bfe_u32 v95, v0, 3, 1
    v_lshl_add_u32 v94, v95, 6, v94
    v_and_b32 v95, 3, v0
    v_lshl_add_u32 v94, v95, 3, v94
    v_add_u32 v91, s26, v94
    v_and_b32 v94, 1, v0
    v_lshlrev_b32 v92, 11, v94
    v_lshrrev_b32 v94, 4, v0
    v_lshl_add_u32 v92, v94, 8, v92
    v_bfe_u32 v94, v0, 1, 1
    v_lshl_add_u32 v92, v94, 6, v92
    v_bfe_u32 v94, v0, 2, 2
    v_lshl_add_u32 v92, v94, 4, v92
    v_add_u32 v92, s26, v92
    v_lshlrev_b32 v94, 4, v0
    s_lshl_b32 s21, s16, 15
    v_add_u32 v7, s21, v94
    s_cmp_eq_u32 s89, 2
    s_cbranch_scc0 L_ch_full
    s_lshl_b32 s26, s16, 13
    s_mov_b32 s8, s42
    s_and_b32 s9, s43, 0xffff
    s_mov_b32 s10, 4194304
    s_mov_b32 s11, 0x20000
    s_xor_b32 s23, s16, 0
    s_lshl_b32 s23, s23, 13
    s_lshl_b32 m0, s16, 15
    s_add_u32 m0, m0, s23
    s_lshl_b32 s22, s16, 8
    s_lshl_b32 s23, s65, 17
    s_add_u32 s22, s22, s23
    s_add_u32 s22, s22, 0
    buffer_load_dwordx4 v90, s[8:11], s22 offen lds
    s_add_u32 m0, m0, 1024
    s_add_u32 s22, s22, 4096
    buffer_load_dwordx4 v90, s[8:11], s22 offen lds
    s_add_u32 m0, m0, 1024
    s_add_u32 s22, s22, 4096
    buffer_load_dwordx4 v90, s[8:11], s22 offen lds
    s_add_u32 m0, m0, 1024
    s_add_u32 s22, s22, 4096
    buffer_load_dwordx4 v90, s[8:11], s22 offen lds
    s_add_u32 m0, m0, 1024
    s_add_u32 s22, s22, 4096
    buffer_load_dwordx4 v90, s[8:11], s22 offen lds
    s_add_u32 m0, m0, 1024
    s_add_u32 s22, s22, 4096
    buffer_load_dwordx4 v90, s[8:11], s22 offen lds
    s_add_u32 m0, m0, 1024
    s_add_u32 s22, s22, 4096
    buffer_load_dwordx4 v90, s[8:11], s22 offen lds
    s_add_u32 m0, m0, 1024
    s_add_u32 s22, s22, 4096
    buffer_load_dwordx4 v90, s[8:11], s22 offen lds
    s_cmp_eq_u32 s91, 0
    s_cbranch_scc0 L_arr_13
    s_mov_b32 s91, 1
    s_waitcnt vmcnt(8)
    s_barrier
    s_cmp_eq_u32 s16, 0
    s_cbranch_scc0 L_arr_13
    s_lshl_b32 s21, s17, 5
    s_add_u32 s21, s21, 4
    s_atomic_add s3, s[56:57], s21
L_arr_13:
    s_xor_b32 s23, s16, 1
    s_lshl_b32 s23, s23, 13
    s_lshl_b32 m0, s16, 15
    s_add_u32 m0, m0, s23
    s_lshl_b32 s22, s16, 8
    s_lshl_b32 s23, s65, 17
    s_add_u32 s22, s22, s23
    s_add_u32 s22, s22, 32768
    buffer_load_dwordx4 v90, s[8:11], s22 offen lds
    s_add_u32 m0, m0, 1024
    s_add_u32 s22, s22, 4096
    buffer_load_dwordx4 v90, s[8:11], s22 offen lds
    s_add_u32 m0, m0, 1024
    s_add_u32 s22, s22, 4096
    buffer_load_dwordx4 v90, s[8:11], s22 offen lds
    s_add_u32 m0, m0, 1024
    s_add_u32 s22, s22, 4096
    buffer_load_dwordx4 v90, s[8:11], s22 offen lds
    s_add_u32 m0, m0, 1024
    s_add_u32 s22, s22, 4096
    buffer_load_dwordx4 v90, s[8:11], s22 offen lds
    s_add_u32 m0, m0, 1024
    s_add_u32 s22, s22, 4096
    buffer_load_dwordx4 v90, s[8:11], s22 offen lds
    s_add_u32 m0, m0, 1024
    s_add_u32 s22, s22, 4096
    buffer_load_dwordx4 v90, s[8:11], s22 offen lds
    s_add_u32 m0, m0, 1024
    s_add_u32 s22, s22, 4096
    buffer_load_dwordx4 v90, s[8:11], s22 offen lds
    s_xor_b32 s23, s16, 2
    s_lshl_b32 s23, s23, 13
    s_lshl_b32 m0, s16, 15
    s_add_u32 m0, m0, s23
    s_lshl_b32 s22, s16, 8
    s_lshl_b32 s23, s65, 17
    s_add_u32 s22, s22, s23
    s_add_u32 s22, s22, 65536
    buffer_load_dwordx4 v90, s[8:11], s22 offen lds
    s_add_u32 m0, m0, 1024
    s_add_u32 s22, s22, 4096
    buffer_load_dwordx4 v90, s[8:11], s22 offen lds
    s_add_u32 m0, m0, 1024
    s_add_u32 s22, s22, 4096
    buffer_load_dwordx4 v90, s[8:11], s22 offen lds
    s_add_u32 m0, m0, 1024
    s_add_u32 s22, s22, 4096
    buffer_load_dwordx4 v90, s[8:11], s22 offen lds
    s_add_u32 m0, m0, 1024
    s_add_u32 s22, s22, 4096
    buffer_load_dwordx4 v90, s[8:11], s22 offen lds
    s_add_u32 m0, m0, 1024
    s_add_u32 s22, s22, 4096
    buffer_load_dwordx4 v90, s[8:11], s22 offen lds
    s_add_u32 m0, m0, 1024
    s_add_u32 s22, s22, 4096
    buffer_load_dwordx4 v90, s[8:11], s22 offen lds
    s_add_u32 m0, m0, 1024
    s_add_u32 s22, s22, 4096
    buffer_load_dwordx4 v90, s[8:11], s22 offen lds
    s_xor_b32 s23, s16, 3
    s_lshl_b32 s23, s23, 13
    s_lshl_b32 m0, s16, 15
    s_add_u32 m0, m0, s23
    s_lshl_b32 s22, s16, 8
    s_lshl_b32 s23, s65, 17
    s_add_u32 s22, s22, s23
    s_add_u32 s22, s22, 98304
    buffer_load_dwordx4 v90, s[8:11], s22 offen lds
    s_add_u32 m0, m0, 1024
    s_add_u32 s22, s22, 4096
    buffer_load_dwordx4 v90, s[8:11], s22 offen lds
    s_add_u32 m0, m0, 1024
    s_add_u32 s22, s22, 4096
    buffer_load_dwordx4 v90, s[8:11], s22 offen lds
    s_add_u32 m0, m0, 1024
    s_add_u32 s22, s22, 4096
    buffer_load_dwordx4 v90, s[8:11], s22 offen lds
    s_add_u32 m0, m0, 1024
    s_add_u32 s22, s22, 4096
    buffer_load_dwordx4 v90, s[8:11], s22 offen lds
    s_add_u32 m0, m0, 1024
    s_add_u32 s22, s22, 4096
    buffer_load_dwordx4 v90, s[8:11], s22 offen lds
    s_add_u32 m0, m0, 1024
    s_add_u32 s22, s22, 4096
    buffer_load_dwordx4 v90, s[8:11], s22 offen lds
    s_add_u32 m0, m0, 1024
    s_add_u32 s22, s22, 4096
    buffer_load_dwordx4 v90, s[8:11], s22 offen lds
    v_lshlrev_b32 v96, 2, v0
    buffer_load_dword v97, v96, s[60:63], 0 offen sc1
    v_lshlrev_b32 v1, 4, v0
    s_lshl_b32 s21, s16, 11
    s_add_u32 s21, s21, 131072
    v_add_u32 v2, s21, v1
    v_lshrrev_b32 v84, 5, v0
    v_and_b32 v85, 15, v0
    v_lshl_add_u32 v84, v84, 4, v85
    v_bfe_u32 v86, v0, 4, 1
    s_lshl_b32 s21, s16, 9
    s_add_u32 s82, s21, 2048
    s_add_u32 s21, s21, 139264
    v_lshlrev_b32 v3, 4, v84
    v_lshl_add_u32 v3, v86, 3, v3
    v_add_u32 v3, s21, v3
    s_lshl_b32 s22, s16, 8
    v_lshlrev_b32 v11, 10, v86
    v_lshl_add_u32 v11, v84, 3, v11
    v_add_u32 v11, s22, v11
    v_lshrrev_b32 v84, 4, v0
    v_bfe_u32 v86, v0, 2, 2
    v_lshl_add_u32 v86, v84, 2, v86
    v_lshlrev_b32 v86, 4, v86
    v_and_b32 v4, 1, v0
    v_lshl_add_u32 v4, v4, 3, v86
    v_add_u32 v4, 139264, v4
    v_lshlrev_b32 v86, 9, v84
    v_lshl_add_u32 v5, v85, 4, v86
    v_add_u32 v5, 147456, v5
    v_lshlrev_b32 v86, 11, v84
    v_lshl_add_u32 v10, v85, 4, v86
    s_lshl_b32 s21, s16, 9
    s_add_u32 s22, s21, 16384
    v_add_u32 v10, s22, v10
    v_and_b32 v85, 7, v0
    v_lshlrev_b32 v86, 7, v84
    v_lshl_add_u32 v6, v85, 4, v86
    s_add_u32 s21, s21, 143360
    v_add_u32 v6, s21, v6
    v_lshrrev_b32 v84, 5, v0
    v_lshlrev_b32 v12, 9, v84
    v_bfe_u32 v84, v0, 3, 1
    v_lshl_add_u32 v12, v84, 8, v12
    v_bfe_u32 v84, v0, 2, 1
    v_lshl_add_u32 v12, v84, 6, v12
    v_bfe_u32 v84, v0, 4, 1
    v_lshl_add_u32 v12, v84, 7, v12
    v_and_b32 v85, 3, v0
    v_lshl_add_u32 v12, v85, 4, v12
    s_lshl_b32 s21, s16, 11
    s_add_u32 s21, s21, 8192
    v_add_u32 v12, s21, v12
    v_lshrrev_b32 v84, 2, v0
    v_lshlrev_b32 v84, 11, v84
    v_lshl_add_u32 v9, v85, 4, v84
    s_lshl_b32 s21, s16, 16
    v_add_u32 v9, s21, v9
    v_lshrrev_b32 v84, 2, v0
    v_lshlrev_b32 v84, 1, v84
    v_and_b32 v84, 31, v84
    v_xor_b32 v84, s65, v84
    v_lshl_add_u32 v9, v84, 6, v9
    s_lshl_b32 s79, s65, 2
    s_add_u32 s79, s79, s16
    s_lshr_b32 s21, s79, 3
    s_lshl_b32 s21, s21, 2
    s_and_b32 s22, s79, 3
    s_add_u32 s21, s21, s22
    s_lshl_b32 s21, s21, 7
    s_bfe_u32 s22, s79, 0x10002
    s_lshl_b32 s22, s22, 6
    s_add_u32 s21, s21, s22
    v_lshrrev_b32 v84, 4, v0
    v_lshlrev_b32 v8, 4, v84
    v_lshl_add_u32 v8, v85, 2, v8
    v_add_u32 v8, s21, v8
    v_bfe_u32 v84, v0, 3, 1
    v_mul_u32_u24 v84, 0xaaaa, v84
    v_add_u32 v13, 0x4444, v84
    v_cmp_gt_u32 vcc, 32, v0
    v_mov_b32 v15, 0x3f803f80
    s_nop 0
    v_cndmask_b32 v14, 0, v15, vcc
    v_mov_b32 v15, v14
    v_mov_b32 v28, 0x3f803f80
    v_mov_b32 v29, 0x3f803f80
    v_bfe_u32 v84, v0, 3, 1
    v_lshl_add_u32 v84, v85, 1, v84
    v_bfe_u32 v86, v0, 2, 1
    v_lshlrev_b32 v86, 4, v86
    v_mov_b32 v85, 0x3f80
    v_lshlrev_b32 v85, v86, v85
    v_cmp_eq_u32 vcc, 0, v84
    s_nop 1
    v_cndmask_b32 v20, 0, v85, vcc
    v_cmp_eq_u32 vcc, 1, v84
    s_nop 1
    v_cndmask_b32 v21, 0, v85, vcc
    v_cmp_eq_u32 vcc, 2, v84
    s_nop 1
    v_cndmask_b32 v22, 0, v85, vcc
    v_cmp_eq_u32 vcc, 3, v84
    s_nop 1
    v_cndmask_b32 v23, 0, v85, vcc
    s_mov_b32 s84, 1040356334
    s_mov_b32 s85, 1040356334
    s_mul_i32 s66, s64, 393216
    s_add_u32 s66, s66, 2097152
    s_lshl_b32 s21, s16, 11
    s_add_u32 s80, s66, 262144
    s_add_u32 s68, s21, s80
    s_mov_b32 s69, 0
    s_mov_b32 s70, s66
    s_lshl_b32 s79, s79, 11
    s_add_u32 s81, s66, s79
    s_add_u32 s78, s70, 32768
    s_mov_b32 s66, 0
    s_mul_i32 s71, s64, 50331648
    s_mul_i32 s21, s65, 24576
    s_add_u32 s71, s71, s21
    s_add_u32 s71, s71, 127926272
    s_lshl_b32 s72, s64, 23
    s_lshl_b32 s21, s65, 12
    s_add_u32 s72, s72, s21
    s_add_u32 s72, s72, 18874368
    s_sub_u32 s83, s72, 143360
    s_lshl_b32 s73, s64, 20
    s_lshl_b32 s21, s65, 7
    s_add_u32 s73, s73, s21
    s_add_u32 s74, s73, 10240
    s_add_u32 s73, s73, 6144
    s_lshl_b32 s21, s16, 11
    s_add_u32 s75, s21, 147456
    s_mov_b32 s67, 0
    s_mov_b32 s12, s34
    s_and_b32 s13, s35, 0xffff
    s_mov_b32 s14, 8192
    s_mov_b32 s15, 0x20000
    v_and_b32 v84, 7, v0
    v_lshlrev_b32 v84, 10, v84
    v_lshrrev_b32 v85, 4, v0
    v_lshl_add_u32 v84, v85, 5, v84
    v_bfe_u32 v85, v0, 3, 1
    v_lshl_add_u32 v84, v85, 2, v84
    s_lshl_b32 s21, s16, 8
    buffer_load_dword v32, v84, s[12:15], s21 offen offset:0
    buffer_load_dword v33, v84, s[12:15], s21 offen offset:8
    buffer_load_dword v34, v84, s[12:15], s21 offen offset:16
    buffer_load_dword v35, v84, s[12:15], s21 offen offset:24
    buffer_load_dword v36, v84, s[12:15], s21 offen offset:128
    buffer_load_dword v37, v84, s[12:15], s21 offen offset:136
    buffer_load_dword v38, v84, s[12:15], s21 offen offset:144
    buffer_load_dword v39, v84, s[12:15], s21 offen offset:152
    s_waitcnt vmcnt(33)
    s_barrier
    s_xor_b32 s23, s16, 0
    s_lshl_b32 s23, s23, 13
    v_add_u32 v93, s23, v91
    ds_read_b64_tr_b16 v[40:41], v93 offset:0
    ds_read_b64_tr_b16 v[42:43], v93 offset:512
    ds_read_b64_tr_b16 v[44:45], v93 offset:2048
    ds_read_b64_tr_b16 v[46:47], v93 offset:2560
    ds_read_b64_tr_b16 v[48:49], v93 offset:32
    ds_read_b64_tr_b16 v[50:51], v93 offset:544
    ds_read_b64_tr_b16 v[52:53], v93 offset:2080
    ds_read_b64_tr_b16 v[54:55], v93 offset:2592
    s_waitcnt lgkmcnt(0)
    ds_read_b64_tr_b16 v[56:57], v93 offset:128
    ds_read_b64_tr_b16 v[58:59], v93 offset:640
    ds_read_b64_tr_b16 v[60:61], v93 offset:2176
    ds_read_b64_tr_b16 v[62:63], v93 offset:2688
    ds_read_b64_tr_b16 v[64:65], v93 offset:160
    ds_read_b64_tr_b16 v[66:67], v93 offset:672
    ds_read_b64_tr_b16 v[68:69], v93 offset:2208
    ds_read_b64_tr_b16 v[70:71], v93 offset:2720
    s_waitcnt lgkmcnt(0)
    v_add_u32 v93, s23, v92
    ds_write_b128 v93, v[40:43] offset:0
    ds_write_b128 v93, v[44:47] offset:1024
    ds_write_b128 v93, v[48:51] offset:128
    ds_write_b128 v93, v[52:55] offset:1152
    ds_write_b128 v93, v[56:59] offset:4096
    ds_write_b128 v93, v[60:63] offset:5120
    ds_write_b128 v93, v[64:67] offset:4224
    ds_write_b128 v93, v[68:71] offset:5248
    s_waitcnt lgkmcnt(0)
    s_waitcnt vmcnt(25)
    s_barrier
    s_xor_b32 s23, s16, 1
    s_lshl_b32 s23, s23, 13
    v_add_u32 v93, s23, v91
    ds_read_b64_tr_b16 v[40:41], v93 offset:0
    ds_read_b64_tr_b16 v[42:43], v93 offset:512
    ds_read_b64_tr_b16 v[44:45], v93 offset:2048
    ds_read_b64_tr_b16 v[46:47], v93 offset:2560
    ds_read_b64_tr_b16 v[48:49], v93 offset:32
    ds_read_b64_tr_b16 v[50:51], v93 offset:544
    ds_read_b64_tr_b16 v[52:53], v93 offset:2080
    ds_read_b64_tr_b16 v[54:55], v93 offset:2592
    s_waitcnt lgkmcnt(0)
    ds_read_b64_tr_b16 v[56:57], v93 offset:128
    ds_read_b64_tr_b16 v[58:59], v93 offset:640
    ds_read_b64_tr_b16 v[60:61], v93 offset:2176
    ds_read_b64_tr_b16 v[62:63], v93 offset:2688
    ds_read_b64_tr_b16 v[64:65], v93 offset:160
    ds_read_b64_tr_b16 v[66:67], v93 offset:672
    ds_read_b64_tr_b16 v[68:69], v93 offset:2208
    ds_read_b64_tr_b16 v[70:71], v93 offset:2720
    s_waitcnt lgkmcnt(0)
    v_add_u32 v93, s23, v92
    ds_write_b128 v93, v[40:43] offset:0
    ds_write_b128 v93, v[44:47] offset:1024
    ds_write_b128 v93, v[48:51] offset:128
    ds_write_b128 v93, v[52:55] offset:1152
    ds_write_b128 v93, v[56:59] offset:4096
    ds_write_b128 v93, v[60:63] offset:5120
    ds_write_b128 v93, v[64:67] offset:4224
    ds_write_b128 v93, v[68:71] offset:5248
    s_waitcnt lgkmcnt(0)
    s_waitcnt vmcnt(17)
    s_barrier
    s_xor_b32 s23, s16, 2
    s_lshl_b32 s23, s23, 13
    v_add_u32 v93, s23, v91
    ds_read_b64_tr_b16 v[40:41], v93 offset:0
    ds_read_b64_tr_b16 v[42:43], v93 offset:512
    ds_read_b64_tr_b16 v[44:45], v93 offset:2048
    ds_read_b64_tr_b16 v[46:47], v93 offset:2560
    ds_read_b64_tr_b16 v[48:49], v93 offset:32
    ds_read_b64_tr_b16 v[50:51], v93 offset:544
    ds_read_b64_tr_b16 v[52:53], v93 offset:2080
    ds_read_b64_tr_b16 v[54:55], v93 offset:2592
    s_waitcnt lgkmcnt(0)
    ds_read_b64_tr_b16 v[56:57], v93 offset:128
    ds_read_b64_tr_b16 v[58:59], v93 offset:640
    ds_read_b64_tr_b16 v[60:61], v93 offset:2176
    ds_read_b64_tr_b16 v[62:63], v93 offset:2688
    ds_read_b64_tr_b16 v[64:65], v93 offset:160
    ds_read_b64_tr_b16 v[66:67], v93 offset:672
    ds_read_b64_tr_b16 v[68:69], v93 offset:2208
    ds_read_b64_tr_b16 v[70:71], v93 offset:2720
    s_waitcnt lgkmcnt(0)
    v_add_u32 v93, s23, v92
    ds_write_b128 v93, v[40:43] offset:0
    ds_write_b128 v93, v[44:47] offset:1024
    ds_write_b128 v93, v[48:51] offset:128
    ds_write_b128 v93, v[52:55] offset:1152
    ds_write_b128 v93, v[56:59] offset:4096
    ds_write_b128 v93, v[60:63] offset:5120
    ds_write_b128 v93, v[64:67] offset:4224
    ds_write_b128 v93, v[68:71] offset:5248
    s_waitcnt lgkmcnt(0)
    s_waitcnt vmcnt(9)
    s_barrier
    s_xor_b32 s23, s16, 3
    s_lshl_b32 s23, s23, 13
    v_add_u32 v93, s23, v91
    ds_read_b64_tr_b16 v[40:41], v93 offset:0
    ds_read_b64_tr_b16 v[42:43], v93 offset:512
    ds_read_b64_tr_b16 v[44:45], v93 offset:2048
    ds_read_b64_tr_b16 v[46:47], v93 offset:2560
    ds_read_b64_tr_b16 v[48:49], v93 offset:32
    ds_read_b64_tr_b16 v[50:51], v93 offset:544
    ds_read_b64_tr_b16 v[52:53], v93 offset:2080
    ds_read_b64_tr_b16 v[54:55], v93 offset:2592
    s_waitcnt lgkmcnt(0)
    ds_read_b64_tr_b16 v[56:57], v93 offset:128
    ds_read_b64_tr_b16 v[58:59], v93 offset:640
    ds_read_b64_tr_b16 v[60:61], v93 offset:2176
    ds_read_b64_tr_b16 v[62:63], v93 offset:2688
    ds_read_b64_tr_b16 v[64:65], v93 offset:160
    ds_read_b64_tr_b16 v[66:67], v93 offset:672
    ds_read_b64_tr_b16 v[68:69], v93 offset:2208
    ds_read_b64_tr_b16 v[70:71], v93 offset:2720
    s_waitcnt lgkmcnt(0)
    v_add_u32 v93, s23, v92
    ds_write_b128 v93, v[40:43] offset:0
    ds_write_b128 v93, v[44:47] offset:1024
    ds_write_b128 v93, v[48:51] offset:128
    ds_write_b128 v93, v[52:55] offset:1152
    ds_write_b128 v93, v[56:59] offset:4096
    ds_write_b128 v93, v[60:63] offset:5120
    ds_write_b128 v93, v[64:67] offset:4224
    ds_write_b128 v93, v[68:71] offset:5248
    s_waitcnt lgkmcnt(0)
    s_branch L_ch_ldone
L_ch_full:
    v_lshrrev_b32 v109, 4, v0
    v_and_b32 v110, 15, v0
    v_lshlrev_b32 v111, 2, v109
    v_xor_b32 v110, v110, v111
    v_mul_u32_u24 v109, 8192, v109
    v_lshl_add_u32 v100, v110, 4, v109
    v_lshrrev_b32 v109, 4, v0
    v_lshlrev_b32 v109, 3, v109
    v_bfe_u32 v112, v0, 2, 2
    v_add_u32 v109, v109, v112
    v_mul_u32_u24 v109, 256, v109
    v_and_b32 v110, 3, v0
    v_lshl_add_u32 v109, v110, 3, v109
    s_mul_i32 s21, s16, 1
    s_add_u32 s21, s21, 0
    v_xor_b32 v110, s21, v112
    v_lshl_add_u32 v101, v110, 6, v109
    v_add_u32 v102, 0x10000, v101
    v_lshrrev_b32 v109, 4, v0
    v_lshlrev_b32 v109, 3, v109
    v_bfe_u32 v112, v0, 2, 2
    v_add_u32 v109, v109, v112
    v_mul_u32_u24 v109, 256, v109
    v_and_b32 v110, 3, v0
    v_lshl_add_u32 v109, v110, 4, v109
    s_mul_i32 s21, s16, 1
    s_add_u32 s21, s21, 0
    v_xor_b32 v110, s21, v112
    v_lshl_add_u32 v105, v110, 6, v109
    v_add_u32 v106, 0x10000, v105
    s_lshl_b32 s26, s16, 13
    s_mov_b32 s8, s38
    s_and_b32 s9, s39, 0xffff
    s_mov_b32 s10, 4194304
    s_mov_b32 s11, 0x20000
    s_mul_i32 s22, s16, 262144
    s_add_u32 s22, s22, s78
    s_xor_b32 s23, s16, 0
    s_lshl_b32 s23, s23, 13
    s_lshl_b32 m0, s16, 15
    s_add_u32 m0, m0, s23
    s_add_u32 s22, s22, 0
    buffer_load_dwordx4 v100, s[8:11], s22 offen lds
    s_add_u32 m0, m0, 1024
    s_add_u32 s22, s22, 32768
    buffer_load_dwordx4 v100, s[8:11], s22 offen lds
    s_add_u32 m0, m0, 1024
    s_add_u32 s22, s22, 32768
    buffer_load_dwordx4 v100, s[8:11], s22 offen lds
    s_add_u32 m0, m0, 1024
    s_add_u32 s22, s22, 32768
    buffer_load_dwordx4 v100, s[8:11], s22 offen lds
    s_add_u32 m0, m0, 1024
    s_add_u32 s22, s22, 32768
    buffer_load_dwordx4 v100, s[8:11], s22 offen lds
    s_add_u32 m0, m0, 1024
    s_add_u32 s22, s22, 32768
    buffer_load_dwordx4 v100, s[8:11], s22 offen lds
    s_add_u32 m0, m0, 1024
    s_add_u32 s22, s22, 32768
    buffer_load_dwordx4 v100, s[8:11], s22 offen lds
    s_add_u32 m0, m0, 1024
    s_add_u32 s22, s22, 32768
    buffer_load_dwordx4 v100, s[8:11], s22 offen lds
    s_cmp_eq_u32 s91, 0
    s_cbranch_scc0 L_arr_14
    s_mov_b32 s91, 1
    s_waitcnt vmcnt(8)
    s_barrier
    s_cmp_eq_u32 s16, 0
    s_cbranch_scc0 L_arr_14
    s_lshl_b32 s21, s17, 5
    s_add_u32 s21, s21, 4
    s_atomic_add s3, s[56:57], s21
L_arr_14:
    s_mul_i32 s22, s16, 262144
    s_add_u32 s22, s22, s78
    s_xor_b32 s23, s16, 1
    s_lshl_b32 s23, s23, 13
    s_lshl_b32 m0, s16, 15
    s_add_u32 m0, m0, s23
    s_add_u32 s22, s22, 1048576
    buffer_load_dwordx4 v100, s[8:11], s22 offen lds
    s_add_u32 m0, m0, 1024
    s_add_u32 s22, s22, 32768
    buffer_load_dwordx4 v100, s[8:11], s22 offen lds
    s_add_u32 m0, m0, 1024
    s_add_u32 s22, s22, 32768
    buffer_load_dwordx4 v100, s[8:11], s22 offen lds
    s_add_u32 m0, m0, 1024
    s_add_u32 s22, s22, 32768
    buffer_load_dwordx4 v100, s[8:11], s22 offen lds
    s_add_u32 m0, m0, 1024
    s_add_u32 s22, s22, 32768
    buffer_load_dwordx4 v100, s[8:11], s22 offen lds
    s_add_u32 m0, m0, 1024
    s_add_u32 s22, s22, 32768
    buffer_load_dwordx4 v100, s[8:11], s22 offen lds
    s_add_u32 m0, m0, 1024
    s_add_u32 s22, s22, 32768
    buffer_load_dwordx4 v100, s[8:11], s22 offen lds
    s_add_u32 m0, m0, 1024
    s_add_u32 s22, s22, 32768
    buffer_load_dwordx4 v100, s[8:11], s22 offen lds
    s_mul_i32 s22, s16, 262144
    s_add_u32 s22, s22, s78
    s_xor_b32 s23, s16, 2
    s_lshl_b32 s23, s23, 13
    s_lshl_b32 m0, s16, 15
    s_add_u32 m0, m0, s23
    s_add_u32 s22, s22, 2097152
    buffer_load_dwordx4 v100, s[8:11], s22 offen lds
    s_add_u32 m0, m0, 1024
    s_add_u32 s22, s22, 32768
    buffer_load_dwordx4 v100, s[8:11], s22 offen lds
    s_add_u32 m0, m0, 1024
    s_add_u32 s22, s22, 32768
    buffer_load_dwordx4 v100, s[8:11], s22 offen lds
    s_add_u32 m0, m0, 1024
    s_add_u32 s22, s22, 32768
    buffer_load_dwordx4 v100, s[8:11], s22 offen lds
    s_add_u32 m0, m0, 1024
    s_add_u32 s22, s22, 32768
    buffer_load_dwordx4 v100, s[8:11], s22 offen lds
    s_add_u32 m0, m0, 1024
    s_add_u32 s22, s22, 32768
    buffer_load_dwordx4 v100, s[8:11], s22 offen lds
    s_add_u32 m0, m0, 1024
    s_add_u32 s22, s22, 32768
    buffer_load_dwordx4 v100, s[8:11], s22 offen lds
    s_add_u32 m0, m0, 1024
    s_add_u32 s22, s22, 32768
    buffer_load_dwordx4 v100, s[8:11], s22 offen lds
    s_mul_i32 s22, s16, 262144
    s_add_u32 s22, s22, s78
    s_xor_b32 s23, s16, 3
    s_lshl_b32 s23, s23, 13
    s_lshl_b32 m0, s16, 15
    s_add_u32 m0, m0, s23
    s_add_u32 s22, s22, 3145728
    buffer_load_dwordx4 v100, s[8:11], s22 offen lds
    s_add_u32 m0, m0, 1024
    s_add_u32 s22, s22, 32768
    buffer_load_dwordx4 v100, s[8:11], s22 offen lds
    s_add_u32 m0, m0, 1024
    s_add_u32 s22, s22, 32768
    buffer_load_dwordx4 v100, s[8:11], s22 offen lds
    s_add_u32 m0, m0, 1024
    s_add_u32 s22, s22, 32768
    buffer_load_dwordx4 v100, s[8:11], s22 offen lds
    s_add_u32 m0, m0, 1024
    s_add_u32 s22, s22, 32768
    buffer_load_dwordx4 v100, s[8:11], s22 offen lds
    s_add_u32 m0, m0, 1024
    s_add_u32 s22, s22, 32768
    buffer_load_dwordx4 v100, s[8:11], s22 offen lds
    s_add_u32 m0, m0, 1024
    s_add_u32 s22, s22, 32768
    buffer_load_dwordx4 v100, s[8:11], s22 offen lds
    s_add_u32 m0, m0, 1024
    s_add_u32 s22, s22, 32768
    buffer_load_dwordx4 v100, s[8:11], s22 offen lds
    s_waitcnt vmcnt(24)
    s_barrier
    s_cmp_eq_u32 s16, 0
    s_cbranch_scc0 L_w_15_1
    ds_read_b64_tr_b16 a[128:129], v105 offset:0
    ds_read_b64_tr_b16 a[130:131], v105 offset:1024
    ds_read_b64_tr_b16 a[136:137], v105 offset:8
    ds_read_b64_tr_b16 a[138:139], v105 offset:1032
    ds_read_b64_tr_b16 a[132:133], v105 offset:40960
    ds_read_b64_tr_b16 a[134:135], v105 offset:41984
    ds_read_b64_tr_b16 a[140:141], v105 offset:40968
    ds_read_b64_tr_b16 a[142:143], v105 offset:41992
    s_waitcnt lgkmcnt(0)
    ds_read_b64_tr_b16 a[144:145], v106 offset:16384
    ds_read_b64_tr_b16 a[146:147], v106 offset:17408
    ds_read_b64_tr_b16 a[152:153], v106 offset:16392
    ds_read_b64_tr_b16 a[154:155], v106 offset:17416
    ds_read_b64_tr_b16 a[148:149], v106 offset:57344
    ds_read_b64_tr_b16 a[150:151], v106 offset:58368
    ds_read_b64_tr_b16 a[156:157], v106 offset:57352
    ds_read_b64_tr_b16 a[158:159], v106 offset:58376
    s_branch L_w_15
L_w_15_1:
    s_cmp_eq_u32 s16, 1
    s_cbranch_scc0 L_w_15_2
    ds_read_b64_tr_b16 a[160:161], v105 offset:0
    ds_read_b64_tr_b16 a[162:163], v105 offset:1024
    ds_read_b64_tr_b16 a[168:169], v105 offset:8
    ds_read_b64_tr_b16 a[170:171], v105 offset:1032
    ds_read_b64_tr_b16 a[164:165], v105 offset:40960
    ds_read_b64_tr_b16 a[166:167], v105 offset:41984
    ds_read_b64_tr_b16 a[172:173], v105 offset:40968
    ds_read_b64_tr_b16 a[174:175], v105 offset:41992
    s_waitcnt lgkmcnt(0)
    ds_read_b64_tr_b16 a[176:177], v106 offset:16384
    ds_read_b64_tr_b16 a[178:179], v106 offset:17408
    ds_read_b64_tr_b16 a[184:185], v106 offset:16392
    ds_read_b64_tr_b16 a[186:187], v106 offset:17416
    ds_read_b64_tr_b16 a[180:181], v106 offset:57344
    ds_read_b64_tr_b16 a[182:183], v106 offset:58368
    ds_read_b64_tr_b16 a[188:189], v106 offset:57352
    ds_read_b64_tr_b16 a[190:191], v106 offset:58376
    s_branch L_w_15
L_w_15_2:
    s_cmp_eq_u32 s16, 2
    s_cbranch_scc0 L_w_15_3
    ds_read_b64_tr_b16 a[192:193], v105 offset:0
    ds_read_b64_tr_b16 a[194:195], v105 offset:1024
    ds_read_b64_tr_b16 a[200:201], v105 offset:8
    ds_read_b64_tr_b16 a[202:203], v105 offset:1032
    ds_read_b64_tr_b16 a[196:197], v105 offset:40960
    ds_read_b64_tr_b16 a[198:199], v105 offset:41984
    ds_read_b64_tr_b16 a[204:205], v105 offset:40968
    ds_read_b64_tr_b16 a[206:207], v105 offset:41992
    s_waitcnt lgkmcnt(0)
    ds_read_b64_tr_b16 a[208:209], v106 offset:16384
    ds_read_b64_tr_b16 a[210:211], v106 offset:17408
    ds_read_b64_tr_b16 a[216:217], v106 offset:16392
    ds_read_b64_tr_b16 a[218:219], v106 offset:17416
    ds_read_b64_tr_b16 a[212:213], v106 offset:57344
    ds_read_b64_tr_b16 a[214:215], v106 offset:58368
    ds_read_b64_tr_b16 a[220:221], v106 offset:57352
    ds_read_b64_tr_b16 a[222:223], v106 offset:58376
    s_branch L_w_15
L_w_15_3:
    ds_read_b64_tr_b16 a[224:225], v105 offset:0
    ds_read_b64_tr_b16 a[226:227], v105 offset:1024
    ds_read_b64_tr_b16 a[232:233], v105 offset:8
    ds_read_b64_tr_b16 a[234:235], v105 offset:1032
    ds_read_b64_tr_b16 a[228:229], v105 offset:40960
    ds_read_b64_tr_b16 a[230:231], v105 offset:41984
    ds_read_b64_tr_b16 a[236:237], v105 offset:40968
    ds_read_b64_tr_b16 a[238:239], v105 offset:41992
    s_waitcnt lgkmcnt(0)
    ds_read_b64_tr_b16 a[240:241], v106 offset:16384
    ds_read_b64_tr_b16 a[242:243], v106 offset:17408
    ds_read_b64_tr_b16 a[248:249], v106 offset:16392
    ds_read_b64_tr_b16 a[250:251], v106 offset:17416
    ds_read_b64_tr_b16 a[244:245], v106 offset:57344
    ds_read_b64_tr_b16 a[246:247], v106 offset:58368
    ds_read_b64_tr_b16 a[252:253], v106 offset:57352
    ds_read_b64_tr_b16 a[254:255], v106 offset:58376
L_w_15:
    s_waitcnt lgkmcnt(0)
    s_waitcnt vmcnt(16)
    s_barrier
    s_mov_b32 s8, s40
    s_and_b32 s9, s41, 0xffff
    s_mov_b32 s10, 4194304
    s_mov_b32 s11, 0x20000
    s_mul_i32 s22, s16, 262144
    s_add_u32 s22, s22, s78
    s_xor_b32 s23, s16, 0
    s_lshl_b32 s23, s23, 13
    s_lshl_b32 m0, s16, 15
    s_add_u32 m0, m0, s23
    s_add_u32 s22, s22, 0
    buffer_load_dwordx4 v100, s[8:11], s22 offen lds
    s_add_u32 m0, m0, 1024
    s_add_u32 s22, s22, 32768
    buffer_load_dwordx4 v100, s[8:11], s22 offen lds
    s_add_u32 m0, m0, 1024
    s_add_u32 s22, s22, 32768
    buffer_load_dwordx4 v100, s[8:11], s22 offen lds
    s_add_u32 m0, m0, 1024
    s_add_u32 s22, s22, 32768
    buffer_load_dwordx4 v100, s[8:11], s22 offen lds
    s_add_u32 m0, m0, 1024
    s_add_u32 s22, s22, 32768
    buffer_load_dwordx4 v100, s[8:11], s22 offen lds
    s_add_u32 m0, m0, 1024
    s_add_u32 s22, s22, 32768
    buffer_load_dwordx4 v100, s[8:11], s22 offen lds
    s_add_u32 m0, m0, 1024
    s_add_u32 s22, s22, 32768
    buffer_load_dwordx4 v100, s[8:11], s22 offen lds
    s_add_u32 m0, m0, 1024
    s_add_u32 s22, s22, 32768
    buffer_load_dwordx4 v100, s[8:11], s22 offen lds
    s_cmp_eq_u32 s16, 0
    s_cbranch_scc0 L_w_16_1
    ds_read_b64_tr_b16 a[160:161], v105 offset:8192
    ds_read_b64_tr_b16 a[162:163], v105 offset:9216
    ds_read_b64_tr_b16 a[168:169], v105 offset:8200
    ds_read_b64_tr_b16 a[170:171], v105 offset:9224
    ds_read_b64_tr_b16 a[164:165], v105 offset:32768
    ds_read_b64_tr_b16 a[166:167], v105 offset:33792
    ds_read_b64_tr_b16 a[172:173], v105 offset:32776
    ds_read_b64_tr_b16 a[174:175], v105 offset:33800
    s_waitcnt lgkmcnt(0)
    ds_read_b64_tr_b16 a[176:177], v106 offset:24576
    ds_read_b64_tr_b16 a[178:179], v106 offset:25600
    ds_read_b64_tr_b16 a[184:185], v106 offset:24584
    ds_read_b64_tr_b16 a[186:187], v106 offset:25608
    ds_read_b64_tr_b16 a[180:181], v106 offset:49152
    ds_read_b64_tr_b16 a[182:183], v106 offset:50176
    ds_read_b64_tr_b16 a[188:189], v106 offset:49160
    ds_read_b64_tr_b16 a[190:191], v106 offset:50184
    s_branch L_w_16
L_w_16_1:
    s_cmp_eq_u32 s16, 1
    s_cbranch_scc0 L_w_16_2
    ds_read_b64_tr_b16 a[128:129], v105 offset:8192
    ds_read_b64_tr_b16 a[130:131], v105 offset:9216
    ds_read_b64_tr_b16 a[136:137], v105 offset:8200
    ds_read_b64_tr_b16 a[138:139], v105 offset:9224
    ds_read_b64_tr_b16 a[132:133], v105 offset:32768
    ds_read_b64_tr_b16 a[134:135], v105 offset:33792
    ds_read_b64_tr_b16 a[140:141], v105 offset:32776
    ds_read_b64_tr_b16 a[142:143], v105 offset:33800
    s_waitcnt lgkmcnt(0)
    ds_read_b64_tr_b16 a[144:145], v106 offset:24576
    ds_read_b64_tr_b16 a[146:147], v106 offset:25600
    ds_read_b64_tr_b16 a[152:153], v106 offset:24584
    ds_read_b64_tr_b16 a[154:155], v106 offset:25608
    ds_read_b64_tr_b16 a[148:149], v106 offset:49152
    ds_read_b64_tr_b16 a[150:151], v106 offset:50176
    ds_read_b64_tr_b16 a[156:157], v106 offset:49160
    ds_read_b64_tr_b16 a[158:159], v106 offset:50184
    s_branch L_w_16
L_w_16_2:
    s_cmp_eq_u32 s16, 2
    s_cbranch_scc0 L_w_16_3
    ds_read_b64_tr_b16 a[224:225], v105 offset:8192
    ds_read_b64_tr_b16 a[226:227], v105 offset:9216
    ds_read_b64_tr_b16 a[232:233], v105 offset:8200
    ds_read_b64_tr_b16 a[234:235], v105 offset:9224
    ds_read_b64_tr_b16 a[228:229], v105 offset:32768
    ds_read_b64_tr_b16 a[230:231], v105 offset:33792
    ds_read_b64_tr_b16 a[236:237], v105 offset:32776
    ds_read_b64_tr_b16 a[238:239], v105 offset:33800
    s_waitcnt lgkmcnt(0)
    ds_read_b64_tr_b16 a[240:241], v106 offset:24576
    ds_read_b64_tr_b16 a[242:243], v106 offset:25600
    ds_read_b64_tr_b16 a[248:249], v106 offset:24584
    ds_read_b64_tr_b16 a[250:251], v106 offset:25608
    ds_read_b64_tr_b16 a[244:245], v106 offset:49152
    ds_read_b64_tr_b16 a[246:247], v106 offset:50176
    ds_read_b64_tr_b16 a[252:253], v106 offset:49160
    ds_read_b64_tr_b16 a[254:255], v106 offset:50184
    s_branch L_w_16
L_w_16_3:
    ds_read_b64_tr_b16 a[192:193], v105 offset:8192
    ds_read_b64_tr_b16 a[194:195], v105 offset:9216
    ds_read_b64_tr_b16 a[200:201], v105 offset:8200
    ds_read_b64_tr_b16 a[202:203], v105 offset:9224
    ds_read_b64_tr_b16 a[196:197], v105 offset:32768
    ds_read_b64_tr_b16 a[198:199], v105 offset:33792
    ds_read_b64_tr_b16 a[204:205], v105 offset:32776
    ds_read_b64_tr_b16 a[206:207], v105 offset:33800
    s_waitcnt lgkmcnt(0)
    ds_read_b64_tr_b16 a[208:209], v106 offset:24576
    ds_read_b64_tr_b16 a[210:211], v106 offset:25600
    ds_read_b64_tr_b16 a[216:217], v106 offset:24584
    ds_read_b64_tr_b16 a[218:219], v106 offset:25608
    ds_read_b64_tr_b16 a[212:213], v106 offset:49152
    ds_read_b64_tr_b16 a[214:215], v106 offset:50176
    ds_read_b64_tr_b16 a[220:221], v106 offset:49160
    ds_read_b64_tr_b16 a[222:223], v106 offset:50184
L_w_16:
    s_waitcnt lgkmcnt(0)
    s_waitcnt vmcnt(16)
    s_barrier
    s_mul_i32 s22, s16, 262144
    s_add_u32 s22, s22, s78
    s_xor_b32 s23, s16, 1
    s_lshl_b32 s23, s23, 13
    s_lshl_b32 m0, s16, 15
    s_add_u32 m0, m0, s23
    s_add_u32 s22, s22, 1048576
    buffer_load_dwordx4 v100, s[8:11], s22 offen lds
    s_add_u32 m0, m0, 1024
    s_add_u32 s22, s22, 32768
    buffer_load_dwordx4 v100, s[8:11], s22 offen lds
    s_add_u32 m0, m0, 1024
    s_add_u32 s22, s22, 32768
    buffer_load_dwordx4 v100, s[8:11], s22 offen lds
    s_add_u32 m0, m0, 1024
    s_add_u32 s22, s22, 32768
    buffer_load_dwordx4 v100, s[8:11], s22 offen lds
    s_add_u32 m0, m0, 1024
    s_add_u32 s22, s22, 32768
    buffer_load_dwordx4 v100, s[8:11], s22 offen lds
    s_add_u32 m0, m0, 1024
    s_add_u32 s22, s22, 32768
    buffer_load_dwordx4 v100, s[8:11], s22 offen lds
    s_add_u32 m0, m0, 1024
    s_add_u32 s22, s22, 32768
    buffer_load_dwordx4 v100, s[8:11], s22 offen lds
    s_add_u32 m0, m0, 1024
    s_add_u32 s22, s22, 32768
    buffer_load_dwordx4 v100, s[8:11], s22 offen lds
    s_cmp_eq_u32 s16, 0
    s_cbranch_scc0 L_w_17_1
    ds_read_b64_tr_b16 a[192:193], v105 offset:16384
    ds_read_b64_tr_b16 a[194:195], v105 offset:17408
    ds_read_b64_tr_b16 a[200:201], v105 offset:16392
    ds_read_b64_tr_b16 a[202:203], v105 offset:17416
    ds_read_b64_tr_b16 a[196:197], v105 offset:57344
    ds_read_b64_tr_b16 a[198:199], v105 offset:58368
    ds_read_b64_tr_b16 a[204:205], v105 offset:57352
    ds_read_b64_tr_b16 a[206:207], v105 offset:58376
    s_waitcnt lgkmcnt(0)
    ds_read_b64_tr_b16 a[208:209], v106 offset:0
    ds_read_b64_tr_b16 a[210:211], v106 offset:1024
    ds_read_b64_tr_b16 a[216:217], v106 offset:8
    ds_read_b64_tr_b16 a[218:219], v106 offset:1032
    ds_read_b64_tr_b16 a[212:213], v106 offset:40960
    ds_read_b64_tr_b16 a[214:215], v106 offset:41984
    ds_read_b64_tr_b16 a[220:221], v106 offset:40968
    ds_read_b64_tr_b16 a[222:223], v106 offset:41992
    s_branch L_w_17
L_w_17_1:
    s_cmp_eq_u32 s16, 1
    s_cbranch_scc0 L_w_17_2
    ds_read_b64_tr_b16 a[224:225], v105 offset:16384
    ds_read_b64_tr_b16 a[226:227], v105 offset:17408
    ds_read_b64_tr_b16 a[232:233], v105 offset:16392
    ds_read_b64_tr_b16 a[234:235], v105 offset:17416
    ds_read_b64_tr_b16 a[228:229], v105 offset:57344
    ds_read_b64_tr_b16 a[230:231], v105 offset:58368
    ds_read_b64_tr_b16 a[236:237], v105 offset:57352
    ds_read_b64_tr_b16 a[238:239], v105 offset:58376
    s_waitcnt lgkmcnt(0)
    ds_read_b64_tr_b16 a[240:241], v106 offset:0
    ds_read_b64_tr_b16 a[242:243], v106 offset:1024
    ds_read_b64_tr_b16 a[248:249], v106 offset:8
    ds_read_b64_tr_b16 a[250:251], v106 offset:1032
    ds_read_b64_tr_b16 a[244:245], v106 offset:40960
    ds_read_b64_tr_b16 a[246:247], v106 offset:41984
    ds_read_b64_tr_b16 a[252:253], v106 offset:40968
    ds_read_b64_tr_b16 a[254:255], v106 offset:41992
    s_branch L_w_17
L_w_17_2:
    s_cmp_eq_u32 s16, 2
    s_cbranch_scc0 L_w_17_3
    ds_read_b64_tr_b16 a[128:129], v105 offset:16384
    ds_read_b64_tr_b16 a[130:131], v105 offset:17408
    ds_read_b64_tr_b16 a[136:137], v105 offset:16392
    ds_read_b64_tr_b16 a[138:139], v105 offset:17416
    ds_read_b64_tr_b16 a[132:133], v105 offset:57344
    ds_read_b64_tr_b16 a[134:135], v105 offset:58368
    ds_read_b64_tr_b16 a[140:141], v105 offset:57352
    ds_read_b64_tr_b16 a[142:143], v105 offset:58376
    s_waitcnt lgkmcnt(0)
    ds_read_b64_tr_b16 a[144:145], v106 offset:0
    ds_read_b64_tr_b16 a[146:147], v106 offset:1024
    ds_read_b64_tr_b16 a[152:153], v106 offset:8
    ds_read_b64_tr_b16 a[154:155], v106 offset:1032
    ds_read_b64_tr_b16 a[148:149], v106 offset:40960
    ds_read_b64_tr_b16 a[150:151], v106 offset:41984
    ds_read_b64_tr_b16 a[156:157], v106 offset:40968
    ds_read_b64_tr_b16 a[158:159], v106 offset:41992
    s_branch L_w_17
L_w_17_3:
    ds_read_b64_tr_b16 a[160:161], v105 offset:16384
    ds_read_b64_tr_b16 a[162:163], v105 offset:17408
    ds_read_b64_tr_b16 a[168:169], v105 offset:16392
    ds_read_b64_tr_b16 a[170:171], v105 offset:17416
    ds_read_b64_tr_b16 a[164:165], v105 offset:57344
    ds_read_b64_tr_b16 a[166:167], v105 offset:58368
    ds_read_b64_tr_b16 a[172:173], v105 offset:57352
    ds_read_b64_tr_b16 a[174:175], v105 offset:58376
    s_waitcnt lgkmcnt(0)
    ds_read_b64_tr_b16 a[176:177], v106 offset:0
    ds_read_b64_tr_b16 a[178:179], v106 offset:1024
    ds_read_b64_tr_b16 a[184:185], v106 offset:8
    ds_read_b64_tr_b16 a[186:187], v106 offset:1032
    ds_read_b64_tr_b16 a[180:181], v106 offset:40960
    ds_read_b64_tr_b16 a[182:183], v106 offset:41984
    ds_read_b64_tr_b16 a[188:189], v106 offset:40968
    ds_read_b64_tr_b16 a[190:191], v106 offset:41992
L_w_17:
    s_waitcnt lgkmcnt(0)
    s_waitcnt vmcnt(16)
    s_barrier
    s_mul_i32 s22, s16, 262144
    s_add_u32 s22, s22, s78
    s_xor_b32 s23, s16, 2
    s_lshl_b32 s23, s23, 13
    s_lshl_b32 m0, s16, 15
    s_add_u32 m0, m0, s23
    s_add_u32 s22, s22, 2097152
    buffer_load_dwordx4 v100, s[8:11], s22 offen lds
    s_add_u32 m0, m0, 1024
    s_add_u32 s22, s22, 32768
    buffer_load_dwordx4 v100, s[8:11], s22 offen lds
    s_add_u32 m0, m0, 1024
    s_add_u32 s22, s22, 32768
    buffer_load_dwordx4 v100, s[8:11], s22 offen lds
    s_add_u32 m0, m0, 1024
    s_add_u32 s22, s22, 32768
    buffer_load_dwordx4 v100, s[8:11], s22 offen lds
    s_add_u32 m0, m0, 1024
    s_add_u32 s22, s22, 32768
    buffer_load_dwordx4 v100, s[8:11], s22 offen lds
    s_add_u32 m0, m0, 1024
    s_add_u32 s22, s22, 32768
    buffer_load_dwordx4 v100, s[8:11], s22 offen lds
    s_add_u32 m0, m0, 1024
    s_add_u32 s22, s22, 32768
    buffer_load_dwordx4 v100, s[8:11], s22 offen lds
    s_add_u32 m0, m0, 1024
    s_add_u32 s22, s22, 32768
    buffer_load_dwordx4 v100, s[8:11], s22 offen lds
    s_cmp_eq_u32 s16, 0
    s_cbranch_scc0 L_w_18_1
    ds_read_b64_tr_b16 a[224:225], v105 offset:24576
    ds_read_b64_tr_b16 a[226:227], v105 offset:25600
    ds_read_b64_tr_b16 a[232:233], v105 offset:24584
    ds_read_b64_tr_b16 a[234:235], v105 offset:25608
    ds_read_b64_tr_b16 a[228:229], v105 offset:49152
    ds_read_b64_tr_b16 a[230:231], v105 offset:50176
    ds_read_b64_tr_b16 a[236:237], v105 offset:49160
    ds_read_b64_tr_b16 a[238:239], v105 offset:50184
    s_waitcnt lgkmcnt(0)
    ds_read_b64_tr_b16 a[240:241], v106 offset:8192
    ds_read_b64_tr_b16 a[242:243], v106 offset:9216
    ds_read_b64_tr_b16 a[248:249], v106 offset:8200
    ds_read_b64_tr_b16 a[250:251], v106 offset:9224
    ds_read_b64_tr_b16 a[244:245], v106 offset:32768
    ds_read_b64_tr_b16 a[246:247], v106 offset:33792
    ds_read_b64_tr_b16 a[252:253], v106 offset:32776
    ds_read_b64_tr_b16 a[254:255], v106 offset:33800
    s_branch L_w_18
L_w_18_1:
    s_cmp_eq_u32 s16, 1
    s_cbranch_scc0 L_w_18_2
    ds_read_b64_tr_b16 a[192:193], v105 offset:24576
    ds_read_b64_tr_b16 a[194:195], v105 offset:25600
    ds_read_b64_tr_b16 a[200:201], v105 offset:24584
    ds_read_b64_tr_b16 a[202:203], v105 offset:25608
    ds_read_b64_tr_b16 a[196:197], v105 offset:49152
    ds_read_b64_tr_b16 a[198:199], v105 offset:50176
    ds_read_b64_tr_b16 a[204:205], v105 offset:49160
    ds_read_b64_tr_b16 a[206:207], v105 offset:50184
    s_waitcnt lgkmcnt(0)
    ds_read_b64_tr_b16 a[208:209], v106 offset:8192
    ds_read_b64_tr_b16 a[210:211], v106 offset:9216
    ds_read_b64_tr_b16 a[216:217], v106 offset:8200
    ds_read_b64_tr_b16 a[218:219], v106 offset:9224
    ds_read_b64_tr_b16 a[212:213], v106 offset:32768
    ds_read_b64_tr_b16 a[214:215], v106 offset:33792
    ds_read_b64_tr_b16 a[220:221], v106 offset:32776
    ds_read_b64_tr_b16 a[222:223], v106 offset:33800
    s_branch L_w_18
L_w_18_2:
    s_cmp_eq_u32 s16, 2
    s_cbranch_scc0 L_w_18_3
    ds_read_b64_tr_b16 a[160:161], v105 offset:24576
    ds_read_b64_tr_b16 a[162:163], v105 offset:25600
    ds_read_b64_tr_b16 a[168:169], v105 offset:24584
    ds_read_b64_tr_b16 a[170:171], v105 offset:25608
    ds_read_b64_tr_b16 a[164:165], v105 offset:49152
    ds_read_b64_tr_b16 a[166:167], v105 offset:50176
    ds_read_b64_tr_b16 a[172:173], v105 offset:49160
    ds_read_b64_tr_b16 a[174:175], v105 offset:50184
    s_waitcnt lgkmcnt(0)
    ds_read_b64_tr_b16 a[176:177], v106 offset:8192
    ds_read_b64_tr_b16 a[178:179], v106 offset:9216
    ds_read_b64_tr_b16 a[184:185], v106 offset:8200
    ds_read_b64_tr_b16 a[186:187], v106 offset:9224
    ds_read_b64_tr_b16 a[180:181], v106 offset:32768
    ds_read_b64_tr_b16 a[182:183], v106 offset:33792
    ds_read_b64_tr_b16 a[188:189], v106 offset:32776
    ds_read_b64_tr_b16 a[190:191], v106 offset:33800
    s_branch L_w_18
L_w_18_3:
    ds_read_b64_tr_b16 a[128:129], v105 offset:24576
    ds_read_b64_tr_b16 a[130:131], v105 offset:25600
    ds_read_b64_tr_b16 a[136:137], v105 offset:24584
    ds_read_b64_tr_b16 a[138:139], v105 offset:25608
    ds_read_b64_tr_b16 a[132:133], v105 offset:49152
    ds_read_b64_tr_b16 a[134:135], v105 offset:50176
    ds_read_b64_tr_b16 a[140:141], v105 offset:49160
    ds_read_b64_tr_b16 a[142:143], v105 offset:50184
    s_waitcnt lgkmcnt(0)
    ds_read_b64_tr_b16 a[144:145], v106 offset:8192
    ds_read_b64_tr_b16 a[146:147], v106 offset:9216
    ds_read_b64_tr_b16 a[152:153], v106 offset:8200
    ds_read_b64_tr_b16 a[154:155], v106 offset:9224
    ds_read_b64_tr_b16 a[148:149], v106 offset:32768
    ds_read_b64_tr_b16 a[150:151], v106 offset:33792
    ds_read_b64_tr_b16 a[156:157], v106 offset:32776
    ds_read_b64_tr_b16 a[158:159], v106 offset:33800
L_w_18:
    s_waitcnt lgkmcnt(0)
    s_waitcnt vmcnt(16)
    s_barrier
    s_mul_i32 s22, s16, 262144
    s_add_u32 s22, s22, s78
    s_xor_b32 s23, s16, 3
    s_lshl_b32 s23, s23, 13
    s_lshl_b32 m0, s16, 15
    s_add_u32 m0, m0, s23
    s_add_u32 s22, s22, 3145728
    buffer_load_dwordx4 v100, s[8:11], s22 offen lds
    s_add_u32 m0, m0, 1024
    s_add_u32 s22, s22, 32768
    buffer_load_dwordx4 v100, s[8:11], s22 offen lds
    s_add_u32 m0, m0, 1024
    s_add_u32 s22, s22, 32768
    buffer_load_dwordx4 v100, s[8:11], s22 offen lds
    s_add_u32 m0, m0, 1024
    s_add_u32 s22, s22, 32768
    buffer_load_dwordx4 v100, s[8:11], s22 offen lds
    s_add_u32 m0, m0, 1024
    s_add_u32 s22, s22, 32768
    buffer_load_dwordx4 v100, s[8:11], s22 offen lds
    s_add_u32 m0, m0, 1024
    s_add_u32 s22, s22, 32768
    buffer_load_dwordx4 v100, s[8:11], s22 offen lds
    s_add_u32 m0, m0, 1024
    s_add_u32 s22, s22, 32768
    buffer_load_dwordx4 v100, s[8:11], s22 offen lds
    s_add_u32 m0, m0, 1024
    s_add_u32 s22, s22, 32768
    buffer_load_dwordx4 v100, s[8:11], s22 offen lds
    s_cmp_eq_u32 s16, 0
    s_cbranch_scc0 L_w_19_1
    ds_read_b64_tr_b16 v[128:129], v101 offset:0
    ds_read_b64_tr_b16 v[130:131], v101 offset:1024
    ds_read_b64_tr_b16 v[136:137], v101 offset:32
    ds_read_b64_tr_b16 v[138:139], v101 offset:1056
    ds_read_b64_tr_b16 v[132:133], v101 offset:40960
    ds_read_b64_tr_b16 v[134:135], v101 offset:41984
    ds_read_b64_tr_b16 v[140:141], v101 offset:40992
    ds_read_b64_tr_b16 v[142:143], v101 offset:42016
    s_waitcnt lgkmcnt(0)
    ds_read_b64_tr_b16 v[144:145], v102 offset:16384
    ds_read_b64_tr_b16 v[146:147], v102 offset:17408
    ds_read_b64_tr_b16 v[152:153], v102 offset:16416
    ds_read_b64_tr_b16 v[154:155], v102 offset:17440
    ds_read_b64_tr_b16 v[148:149], v102 offset:57344
    ds_read_b64_tr_b16 v[150:151], v102 offset:58368
    ds_read_b64_tr_b16 v[156:157], v102 offset:57376
    ds_read_b64_tr_b16 v[158:159], v102 offset:58400
    s_branch L_w_19
L_w_19_1:
    s_cmp_eq_u32 s16, 1
    s_cbranch_scc0 L_w_19_2
    ds_read_b64_tr_b16 v[160:161], v101 offset:0
    ds_read_b64_tr_b16 v[162:163], v101 offset:1024
    ds_read_b64_tr_b16 v[168:169], v101 offset:32
    ds_read_b64_tr_b16 v[170:171], v101 offset:1056
    ds_read_b64_tr_b16 v[164:165], v101 offset:40960
    ds_read_b64_tr_b16 v[166:167], v101 offset:41984
    ds_read_b64_tr_b16 v[172:173], v101 offset:40992
    ds_read_b64_tr_b16 v[174:175], v101 offset:42016
    s_waitcnt lgkmcnt(0)
    ds_read_b64_tr_b16 v[176:177], v102 offset:16384
    ds_read_b64_tr_b16 v[178:179], v102 offset:17408
    ds_read_b64_tr_b16 v[184:185], v102 offset:16416
    ds_read_b64_tr_b16 v[186:187], v102 offset:17440
    ds_read_b64_tr_b16 v[180:181], v102 offset:57344
    ds_read_b64_tr_b16 v[182:183], v102 offset:58368
    ds_read_b64_tr_b16 v[188:189], v102 offset:57376
    ds_read_b64_tr_b16 v[190:191], v102 offset:58400
    s_branch L_w_19
L_w_19_2:
    s_cmp_eq_u32 s16, 2
    s_cbranch_scc0 L_w_19_3
    ds_read_b64_tr_b16 v[192:193], v101 offset:0
    ds_read_b64_tr_b16 v[194:195], v101 offset:1024
    ds_read_b64_tr_b16 v[200:201], v101 offset:32
    ds_read_b64_tr_b16 v[202:203], v101 offset:1056
    ds_read_b64_tr_b16 v[196:197], v101 offset:40960
    ds_read_b64_tr_b16 v[198:199], v101 offset:41984
    ds_read_b64_tr_b16 v[204:205], v101 offset:40992
    ds_read_b64_tr_b16 v[206:207], v101 offset:42016
    s_waitcnt lgkmcnt(0)
    ds_read_b64_tr_b16 v[208:209], v102 offset:16384
    ds_read_b64_tr_b16 v[210:211], v102 offset:17408
    ds_read_b64_tr_b16 v[216:217], v102 offset:16416
    ds_read_b64_tr_b16 v[218:219], v102 offset:17440
    ds_read_b64_tr_b16 v[212:213], v102 offset:57344
    ds_read_b64_tr_b16 v[214:215], v102 offset:58368
    ds_read_b64_tr_b16 v[220:221], v102 offset:57376
    ds_read_b64_tr_b16 v[222:223], v102 offset:58400
    s_branch L_w_19
L_w_19_3:
    ds_read_b64_tr_b16 v[224:225], v101 offset:0
    ds_read_b64_tr_b16 v[226:227], v101 offset:1024
    ds_read_b64_tr_b16 v[232:233], v101 offset:32
    ds_read_b64_tr_b16 v[234:235], v101 offset:1056
    ds_read_b64_tr_b16 v[228:229], v101 offset:40960
    ds_read_b64_tr_b16 v[230:231], v101 offset:41984
    ds_read_b64_tr_b16 v[236:237], v101 offset:40992
    ds_read_b64_tr_b16 v[238:239], v101 offset:42016
    s_waitcnt lgkmcnt(0)
    ds_read_b64_tr_b16 v[240:241], v102 offset:16384
    ds_read_b64_tr_b16 v[242:243], v102 offset:17408
    ds_read_b64_tr_b16 v[248:249], v102 offset:16416
    ds_read_b64_tr_b16 v[250:251], v102 offset:17440
    ds_read_b64_tr_b16 v[244:245], v102 offset:57344
    ds_read_b64_tr_b16 v[246:247], v102 offset:58368
    ds_read_b64_tr_b16 v[252:253], v102 offset:57376
    ds_read_b64_tr_b16 v[254:255], v102 offset:58400
L_w_19:
    s_waitcnt lgkmcnt(0)
    s_waitcnt vmcnt(16)
    s_barrier
    s_mov_b32 s8, s36
    s_and_b32 s9, s37, 0xffff
    s_mov_b32 s10, 4194304
    s_mov_b32 s11, 0x20000
    s_mul_i32 s22, s16, 262144
    s_add_u32 s22, s22, s78
    s_xor_b32 s23, s16, 0
    s_lshl_b32 s23, s23, 13
    s_lshl_b32 m0, s16, 15
    s_add_u32 m0, m0, s23
    s_add_u32 s22, s22, 0
    buffer_load_dwordx4 v100, s[8:11], s22 offen lds
    s_add_u32 m0, m0, 1024
    s_add_u32 s22, s22, 32768
    buffer_load_dwordx4 v100, s[8:11], s22 offen lds
    s_add_u32 m0, m0, 1024
    s_add_u32 s22, s22, 32768
    buffer_load_dwordx4 v100, s[8:11], s22 offen lds
    s_add_u32 m0, m0, 1024
    s_add_u32 s22, s22, 32768
    buffer_load_dwordx4 v100, s[8:11], s22 offen lds
    s_add_u32 m0, m0, 1024
    s_add_u32 s22, s22, 32768
    buffer_load_dwordx4 v100, s[8:11], s22 offen lds
    s_add_u32 m0, m0, 1024
    s_add_u32 s22, s22, 32768
    buffer_load_dwordx4 v100, s[8:11], s22 offen lds
    s_add_u32 m0, m0, 1024
    s_add_u32 s22, s22, 32768
    buffer_load_dwordx4 v100, s[8:11], s22 offen lds
    s_add_u32 m0, m0, 1024
    s_add_u32 s22, s22, 32768
    buffer_load_dwordx4 v100, s[8:11], s22 offen lds
    v_lshlrev_b32 v96, 2, v0
    buffer_load_dword v97, v96, s[60:63], 0 offen sc1
    s_cmp_eq_u32 s16, 0
    s_cbranch_scc0 L_w_20_1
    ds_read_b64_tr_b16 v[160:161], v101 offset:8192
    ds_read_b64_tr_b16 v[162:163], v101 offset:9216
    ds_read_b64_tr_b16 v[168:169], v101 offset:8224
    ds_read_b64_tr_b16 v[170:171], v101 offset:9248
    ds_read_b64_tr_b16 v[164:165], v101 offset:32768
    ds_read_b64_tr_b16 v[166:167], v101 offset:33792
    ds_read_b64_tr_b16 v[172:173], v101 offset:32800
    ds_read_b64_tr_b16 v[174:175], v101 offset:33824
    s_waitcnt lgkmcnt(0)
    ds_read_b64_tr_b16 v[176:177], v102 offset:24576
    ds_read_b64_tr_b16 v[178:179], v102 offset:25600
    ds_read_b64_tr_b16 v[184:185], v102 offset:24608
    ds_read_b64_tr_b16 v[186:187], v102 offset:25632
    ds_read_b64_tr_b16 v[180:181], v102 offset:49152
    ds_read_b64_tr_b16 v[182:183], v102 offset:50176
    ds_read_b64_tr_b16 v[188:189], v102 offset:49184
    ds_read_b64_tr_b16 v[190:191], v102 offset:50208
    s_branch L_w_20
L_w_20_1:
    s_cmp_eq_u32 s16, 1
    s_cbranch_scc0 L_w_20_2
    ds_read_b64_tr_b16 v[128:129], v101 offset:8192
    ds_read_b64_tr_b16 v[130:131], v101 offset:9216
    ds_read_b64_tr_b16 v[136:137], v101 offset:8224
    ds_read_b64_tr_b16 v[138:139], v101 offset:9248
    ds_read_b64_tr_b16 v[132:133], v101 offset:32768
    ds_read_b64_tr_b16 v[134:135], v101 offset:33792
    ds_read_b64_tr_b16 v[140:141], v101 offset:32800
    ds_read_b64_tr_b16 v[142:143], v101 offset:33824
    s_waitcnt lgkmcnt(0)
    ds_read_b64_tr_b16 v[144:145], v102 offset:24576
    ds_read_b64_tr_b16 v[146:147], v102 offset:25600
    ds_read_b64_tr_b16 v[152:153], v102 offset:24608
    ds_read_b64_tr_b16 v[154:155], v102 offset:25632
    ds_read_b64_tr_b16 v[148:149], v102 offset:49152
    ds_read_b64_tr_b16 v[150:151], v102 offset:50176
    ds_read_b64_tr_b16 v[156:157], v102 offset:49184
    ds_read_b64_tr_b16 v[158:159], v102 offset:50208
    s_branch L_w_20
L_w_20_2:
    s_cmp_eq_u32 s16, 2
    s_cbranch_scc0 L_w_20_3
    ds_read_b64_tr_b16 v[224:225], v101 offset:8192
    ds_read_b64_tr_b16 v[226:227], v101 offset:9216
    ds_read_b64_tr_b16 v[232:233], v101 offset:8224
    ds_read_b64_tr_b16 v[234:235], v101 offset:9248
    ds_read_b64_tr_b16 v[228:229], v101 offset:32768
    ds_read_b64_tr_b16 v[230:231], v101 offset:33792
    ds_read_b64_tr_b16 v[236:237], v101 offset:32800
    ds_read_b64_tr_b16 v[238:239], v101 offset:33824
    s_waitcnt lgkmcnt(0)
    ds_read_b64_tr_b16 v[240:241], v102 offset:24576
    ds_read_b64_tr_b16 v[242:243], v102 offset:25600
    ds_read_b64_tr_b16 v[248:249], v102 offset:24608
    ds_read_b64_tr_b16 v[250:251], v102 offset:25632
    ds_read_b64_tr_b16 v[244:245], v102 offset:49152
    ds_read_b64_tr_b16 v[246:247], v102 offset:50176
    ds_read_b64_tr_b16 v[252:253], v102 offset:49184
    ds_read_b64_tr_b16 v[254:255], v102 offset:50208
    s_branch L_w_20
L_w_20_3:
    ds_read_b64_tr_b16 v[192:193], v101 offset:8192
    ds_read_b64_tr_b16 v[194:195], v101 offset:9216
    ds_read_b64_tr_b16 v[200:201], v101 offset:8224
    ds_read_b64_tr_b16 v[202:203], v101 offset:9248
    ds_read_b64_tr_b16 v[196:197], v101 offset:32768
    ds_read_b64_tr_b16 v[198:199], v101 offset:33792
    ds_read_b64_tr_b16 v[204:205], v101 offset:32800
    ds_read_b64_tr_b16 v[206:207], v101 offset:33824
    s_waitcnt lgkmcnt(0)
    ds_read_b64_tr_b16 v[208:209], v102 offset:24576
    ds_read_b64_tr_b16 v[210:211], v102 offset:25600
    ds_read_b64_tr_b16 v[216:217], v102 offset:24608
    ds_read_b64_tr_b16 v[218:219], v102 offset:25632
    ds_read_b64_tr_b16 v[212:213], v102 offset:49152
    ds_read_b64_tr_b16 v[214:215], v102 offset:50176
    ds_read_b64_tr_b16 v[220:221], v102 offset:49184
    ds_read_b64_tr_b16 v[222:223], v102 offset:50208
L_w_20:
    s_waitcnt lgkmcnt(0)
    s_waitcnt vmcnt(17)
    s_barrier
    s_mul_i32 s22, s16, 262144
    s_add_u32 s22, s22, s78
    s_xor_b32 s23, s16, 1
    s_lshl_b32 s23, s23, 13
    s_lshl_b32 m0, s16, 15
    s_add_u32 m0, m0, s23
    s_add_u32 s22, s22, 1048576
    buffer_load_dwordx4 v100, s[8:11], s22 offen lds
    s_add_u32 m0, m0, 1024
    s_add_u32 s22, s22, 32768
    buffer_load_dwordx4 v100, s[8:11], s22 offen lds
    s_add_u32 m0, m0, 1024
    s_add_u32 s22, s22, 32768
    buffer_load_dwordx4 v100, s[8:11], s22 offen lds
    s_add_u32 m0, m0, 1024
    s_add_u32 s22, s22, 32768
    buffer_load_dwordx4 v100, s[8:11], s22 offen lds
    s_add_u32 m0, m0, 1024
    s_add_u32 s22, s22, 32768
    buffer_load_dwordx4 v100, s[8:11], s22 offen lds
    s_add_u32 m0, m0, 1024
    s_add_u32 s22, s22, 32768
    buffer_load_dwordx4 v100, s[8:11], s22 offen lds
    s_add_u32 m0, m0, 1024
    s_add_u32 s22, s22, 32768
    buffer_load_dwordx4 v100, s[8:11], s22 offen lds
    s_add_u32 m0, m0, 1024
    s_add_u32 s22, s22, 32768
    buffer_load_dwordx4 v100, s[8:11], s22 offen lds
    s_cmp_eq_u32 s16, 0
    s_cbranch_scc0 L_w_21_1
    ds_read_b64_tr_b16 v[192:193], v101 offset:16384
    ds_read_b64_tr_b16 v[194:195], v101 offset:17408
    ds_read_b64_tr_b16 v[200:201], v101 offset:16416
    ds_read_b64_tr_b16 v[202:203], v101 offset:17440
    ds_read_b64_tr_b16 v[196:197], v101 offset:57344
    ds_read_b64_tr_b16 v[198:199], v101 offset:58368
    ds_read_b64_tr_b16 v[204:205], v101 offset:57376
    ds_read_b64_tr_b16 v[206:207], v101 offset:58400
    s_waitcnt lgkmcnt(0)
    ds_read_b64_tr_b16 v[208:209], v102 offset:0
    ds_read_b64_tr_b16 v[210:211], v102 offset:1024
    ds_read_b64_tr_b16 v[216:217], v102 offset:32
    ds_read_b64_tr_b16 v[218:219], v102 offset:1056
    ds_read_b64_tr_b16 v[212:213], v102 offset:40960
    ds_read_b64_tr_b16 v[214:215], v102 offset:41984
    ds_read_b64_tr_b16 v[220:221], v102 offset:40992
    ds_read_b64_tr_b16 v[222:223], v102 offset:42016
    s_branch L_w_21
L_w_21_1:
    s_cmp_eq_u32 s16, 1
    s_cbranch_scc0 L_w_21_2
    ds_read_b64_tr_b16 v[224:225], v101 offset:16384
    ds_read_b64_tr_b16 v[226:227], v101 offset:17408
    ds_read_b64_tr_b16 v[232:233], v101 offset:16416
    ds_read_b64_tr_b16 v[234:235], v101 offset:17440
    ds_read_b64_tr_b16 v[228:229], v101 offset:57344
    ds_read_b64_tr_b16 v[230:231], v101 offset:58368
    ds_read_b64_tr_b16 v[236:237], v101 offset:57376
    ds_read_b64_tr_b16 v[238:239], v101 offset:58400
    s_waitcnt lgkmcnt(0)
    ds_read_b64_tr_b16 v[240:241], v102 offset:0
    ds_read_b64_tr_b16 v[242:243], v102 offset:1024
    ds_read_b64_tr_b16 v[248:249], v102 offset:32
    ds_read_b64_tr_b16 v[250:251], v102 offset:1056
    ds_read_b64_tr_b16 v[244:245], v102 offset:40960
    ds_read_b64_tr_b16 v[246:247], v102 offset:41984
    ds_read_b64_tr_b16 v[252:253], v102 offset:40992
    ds_read_b64_tr_b16 v[254:255], v102 offset:42016
    s_branch L_w_21
L_w_21_2:
    s_cmp_eq_u32 s16, 2
    s_cbranch_scc0 L_w_21_3
    ds_read_b64_tr_b16 v[128:129], v101 offset:16384
    ds_read_b64_tr_b16 v[130:131], v101 offset:17408
    ds_read_b64_tr_b16 v[136:137], v101 offset:16416
    ds_read_b64_tr_b16 v[138:139], v101 offset:17440
    ds_read_b64_tr_b16 v[132:133], v101 offset:57344
    ds_read_b64_tr_b16 v[134:135], v101 offset:58368
    ds_read_b64_tr_b16 v[140:141], v101 offset:57376
    ds_read_b64_tr_b16 v[142:143], v101 offset:58400
    s_waitcnt lgkmcnt(0)
    ds_read_b64_tr_b16 v[144:145], v102 offset:0
    ds_read_b64_tr_b16 v[146:147], v102 offset:1024
    ds_read_b64_tr_b16 v[152:153], v102 offset:32
    ds_read_b64_tr_b16 v[154:155], v102 offset:1056
    ds_read_b64_tr_b16 v[148:149], v102 offset:40960
    ds_read_b64_tr_b16 v[150:151], v102 offset:41984
    ds_read_b64_tr_b16 v[156:157], v102 offset:40992
    ds_read_b64_tr_b16 v[158:159], v102 offset:42016
    s_branch L_w_21
L_w_21_3:
    ds_read_b64_tr_b16 v[160:161], v101 offset:16384
    ds_read_b64_tr_b16 v[162:163], v101 offset:17408
    ds_read_b64_tr_b16 v[168:169], v101 offset:16416
    ds_read_b64_tr_b16 v[170:171], v101 offset:17440
    ds_read_b64_tr_b16 v[164:165], v101 offset:57344
    ds_read_b64_tr_b16 v[166:167], v101 offset:58368
    ds_read_b64_tr_b16 v[172:173], v101 offset:57376
    ds_read_b64_tr_b16 v[174:175], v101 offset:58400
    s_waitcnt lgkmcnt(0)
    ds_read_b64_tr_b16 v[176:177], v102 offset:0
    ds_read_b64_tr_b16 v[178:179], v102 offset:1024
    ds_read_b64_tr_b16 v[184:185], v102 offset:32
    ds_read_b64_tr_b16 v[186:187], v102 offset:1056
    ds_read_b64_tr_b16 v[180:181], v102 offset:40960
    ds_read_b64_tr_b16 v[182:183], v102 offset:41984
    ds_read_b64_tr_b16 v[188:189], v102 offset:40992
    ds_read_b64_tr_b16 v[190:191], v102 offset:42016
L_w_21:
    s_waitcnt lgkmcnt(0)
    s_waitcnt vmcnt(17)
    s_barrier
    s_mul_i32 s22, s16, 262144
    s_add_u32 s22, s22, s78
    s_xor_b32 s23, s16, 2
    s_lshl_b32 s23, s23, 13
    s_lshl_b32 m0, s16, 15
    s_add_u32 m0, m0, s23
    s_add_u32 s22, s22, 2097152
    buffer_load_dwordx4 v100, s[8:11], s22 offen lds
    s_add_u32 m0, m0, 1024
    s_add_u32 s22, s22, 32768
    buffer_load_dwordx4 v100, s[8:11], s22 offen lds
    s_add_u32 m0, m0, 1024
    s_add_u32 s22, s22, 32768
    buffer_load_dwordx4 v100, s[8:11], s22 offen lds
    s_add_u32 m0, m0, 1024
    s_add_u32 s22, s22, 32768
    buffer_load_dwordx4 v100, s[8:11], s22 offen lds
    s_add_u32 m0, m0, 1024
    s_add_u32 s22, s22, 32768
    buffer_load_dwordx4 v100, s[8:11], s22 offen lds
    s_add_u32 m0, m0, 1024
    s_add_u32 s22, s22, 32768
    buffer_load_dwordx4 v100, s[8:11], s22 offen lds
    s_add_u32 m0, m0, 1024
    s_add_u32 s22, s22, 32768
    buffer_load_dwordx4 v100, s[8:11], s22 offen lds
    s_add_u32 m0, m0, 1024
    s_add_u32 s22, s22, 32768
    buffer_load_dwordx4 v100, s[8:11], s22 offen lds
    s_cmp_eq_u32 s16, 0
    s_cbranch_scc0 L_w_22_1
    ds_read_b64_tr_b16 v[224:225], v101 offset:24576
    ds_read_b64_tr_b16 v[226:227], v101 offset:25600
    ds_read_b64_tr_b16 v[232:233], v101 offset:24608
    ds_read_b64_tr_b16 v[234:235], v101 offset:25632
    ds_read_b64_tr_b16 v[228:229], v101 offset:49152
    ds_read_b64_tr_b16 v[230:231], v101 offset:50176
    ds_read_b64_tr_b16 v[236:237], v101 offset:49184
    ds_read_b64_tr_b16 v[238:239], v101 offset:50208
    s_waitcnt lgkmcnt(0)
    ds_read_b64_tr_b16 v[240:241], v102 offset:8192
    ds_read_b64_tr_b16 v[242:243], v102 offset:9216
    ds_read_b64_tr_b16 v[248:249], v102 offset:8224
    ds_read_b64_tr_b16 v[250:251], v102 offset:9248
    ds_read_b64_tr_b16 v[244:245], v102 offset:32768
    ds_read_b64_tr_b16 v[246:247], v102 offset:33792
    ds_read_b64_tr_b16 v[252:253], v102 offset:32800
    ds_read_b64_tr_b16 v[254:255], v102 offset:33824
    s_branch L_w_22
L_w_22_1:
    s_cmp_eq_u32 s16, 1
    s_cbranch_scc0 L_w_22_2
    ds_read_b64_tr_b16 v[192:193], v101 offset:24576
    ds_read_b64_tr_b16 v[194:195], v101 offset:25600
    ds_read_b64_tr_b16 v[200:201], v101 offset:24608
    ds_read_b64_tr_b16 v[202:203], v101 offset:25632
    ds_read_b64_tr_b16 v[196:197], v101 offset:49152
    ds_read_b64_tr_b16 v[198:199], v101 offset:50176
    ds_read_b64_tr_b16 v[204:205], v101 offset:49184
    ds_read_b64_tr_b16 v[206:207], v101 offset:50208
    s_waitcnt lgkmcnt(0)
    ds_read_b64_tr_b16 v[208:209], v102 offset:8192
    ds_read_b64_tr_b16 v[210:211], v102 offset:9216
    ds_read_b64_tr_b16 v[216:217], v102 offset:8224
    ds_read_b64_tr_b16 v[218:219], v102 offset:9248
    ds_read_b64_tr_b16 v[212:213], v102 offset:32768
    ds_read_b64_tr_b16 v[214:215], v102 offset:33792
    ds_read_b64_tr_b16 v[220:221], v102 offset:32800
    ds_read_b64_tr_b16 v[222:223], v102 offset:33824
    s_branch L_w_22
L_w_22_2:
    s_cmp_eq_u32 s16, 2
    s_cbranch_scc0 L_w_22_3
    ds_read_b64_tr_b16 v[160:161], v101 offset:24576
    ds_read_b64_tr_b16 v[162:163], v101 offset:25600
    ds_read_b64_tr_b16 v[168:169], v101 offset:24608
    ds_read_b64_tr_b16 v[170:171], v101 offset:25632
    ds_read_b64_tr_b16 v[164:165], v101 offset:49152
    ds_read_b64_tr_b16 v[166:167], v101 offset:50176
    ds_read_b64_tr_b16 v[172:173], v101 offset:49184
    ds_read_b64_tr_b16 v[174:175], v101 offset:50208
    s_waitcnt lgkmcnt(0)
    ds_read_b64_tr_b16 v[176:177], v102 offset:8192
    ds_read_b64_tr_b16 v[178:179], v102 offset:9216
    ds_read_b64_tr_b16 v[184:185], v102 offset:8224
    ds_read_b64_tr_b16 v[186:187], v102 offset:9248
    ds_read_b64_tr_b16 v[180:181], v102 offset:32768
    ds_read_b64_tr_b16 v[182:183], v102 offset:33792
    ds_read_b64_tr_b16 v[188:189], v102 offset:32800
    ds_read_b64_tr_b16 v[190:191], v102 offset:33824
    s_branch L_w_22
L_w_22_3:
    ds_read_b64_tr_b16 v[128:129], v101 offset:24576
    ds_read_b64_tr_b16 v[130:131], v101 offset:25600
    ds_read_b64_tr_b16 v[136:137], v101 offset:24608
    ds_read_b64_tr_b16 v[138:139], v101 offset:25632
    ds_read_b64_tr_b16 v[132:133], v101 offset:49152
    ds_read_b64_tr_b16 v[134:135], v101 offset:50176
    ds_read_b64_tr_b16 v[140:141], v101 offset:49184
    ds_read_b64_tr_b16 v[142:143], v101 offset:50208
    s_waitcnt lgkmcnt(0)
    ds_read_b64_tr_b16 v[144:145], v102 offset:8192
    ds_read_b64_tr_b16 v[146:147], v102 offset:9216
    ds_read_b64_tr_b16 v[152:153], v102 offset:8224
    ds_read_b64_tr_b16 v[154:155], v102 offset:9248
    ds_read_b64_tr_b16 v[148:149], v102 offset:32768
    ds_read_b64_tr_b16 v[150:151], v102 offset:33792
    ds_read_b64_tr_b16 v[156:157], v102 offset:32800
    ds_read_b64_tr_b16 v[158:159], v102 offset:33824
L_w_22:
    s_waitcnt lgkmcnt(0)
    s_waitcnt vmcnt(17)
    s_barrier
    s_mul_i32 s22, s16, 262144
    s_add_u32 s22, s22, s78
    s_xor_b32 s23, s16, 3
    s_lshl_b32 s23, s23, 13
    s_lshl_b32 m0, s16, 15
    s_add_u32 m0, m0, s23
    s_add_u32 s22, s22, 3145728
    buffer_load_dwordx4 v100, s[8:11], s22 offen lds
    s_add_u32 m0, m0, 1024
    s_add_u32 s22, s22, 32768
    buffer_load_dwordx4 v100, s[8:11], s22 offen lds
    s_add_u32 m0, m0, 1024
    s_add_u32 s22, s22, 32768
    buffer_load_dwordx4 v100, s[8:11], s22 offen lds
    s_add_u32 m0, m0, 1024
    s_add_u32 s22, s22, 32768
    buffer_load_dwordx4 v100, s[8:11], s22 offen lds
    s_add_u32 m0, m0, 1024
    s_add_u32 s22, s22, 32768
    buffer_load_dwordx4 v100, s[8:11], s22 offen lds
    s_add_u32 m0, m0, 1024
    s_add_u32 s22, s22, 32768
    buffer_load_dwordx4 v100, s[8:11], s22 offen lds
    s_add_u32 m0, m0, 1024
    s_add_u32 s22, s22, 32768
    buffer_load_dwordx4 v100, s[8:11], s22 offen lds
    s_add_u32 m0, m0, 1024
    s_add_u32 s22, s22, 32768
    buffer_load_dwordx4 v100, s[8:11], s22 offen lds
    s_cmp_eq_u32 s16, 0
    s_cbranch_scc0 L_w_23_1
    ds_read_b64_tr_b16 a[0:1], v105 offset:0
    ds_read_b64_tr_b16 a[2:3], v105 offset:1024
    ds_read_b64_tr_b16 a[8:9], v105 offset:8
    ds_read_b64_tr_b16 a[10:11], v105 offset:1032
    ds_read_b64_tr_b16 a[4:5], v105 offset:40960
    ds_read_b64_tr_b16 a[6:7], v105 offset:41984
    ds_read_b64_tr_b16 a[12:13], v105 offset:40968
    ds_read_b64_tr_b16 a[14:15], v105 offset:41992
    s_waitcnt lgkmcnt(0)
    ds_read_b64_tr_b16 a[16:17], v106 offset:16384
    ds_read_b64_tr_b16 a[18:19], v106 offset:17408
    ds_read_b64_tr_b16 a[24:25], v106 offset:16392
    ds_read_b64_tr_b16 a[26:27], v106 offset:17416
    ds_read_b64_tr_b16 a[20:21], v106 offset:57344
    ds_read_b64_tr_b16 a[22:23], v106 offset:58368
    ds_read_b64_tr_b16 a[28:29], v106 offset:57352
    ds_read_b64_tr_b16 a[30:31], v106 offset:58376
    s_branch L_w_23
L_w_23_1:
    s_cmp_eq_u32 s16, 1
    s_cbranch_scc0 L_w_23_2
    ds_read_b64_tr_b16 a[32:33], v105 offset:0
    ds_read_b64_tr_b16 a[34:35], v105 offset:1024
    ds_read_b64_tr_b16 a[40:41], v105 offset:8
    ds_read_b64_tr_b16 a[42:43], v105 offset:1032
    ds_read_b64_tr_b16 a[36:37], v105 offset:40960
    ds_read_b64_tr_b16 a[38:39], v105 offset:41984
    ds_read_b64_tr_b16 a[44:45], v105 offset:40968
    ds_read_b64_tr_b16 a[46:47], v105 offset:41992
    s_waitcnt lgkmcnt(0)
    ds_read_b64_tr_b16 a[48:49], v106 offset:16384
    ds_read_b64_tr_b16 a[50:51], v106 offset:17408
    ds_read_b64_tr_b16 a[56:57], v106 offset:16392
    ds_read_b64_tr_b16 a[58:59], v106 offset:17416
    ds_read_b64_tr_b16 a[52:53], v106 offset:57344
    ds_read_b64_tr_b16 a[54:55], v106 offset:58368
    ds_read_b64_tr_b16 a[60:61], v106 offset:57352
    ds_read_b64_tr_b16 a[62:63], v106 offset:58376
    s_branch L_w_23
L_w_23_2:
    s_cmp_eq_u32 s16, 2
    s_cbranch_scc0 L_w_23_3
    ds_read_b64_tr_b16 a[64:65], v105 offset:0
    ds_read_b64_tr_b16 a[66:67], v105 offset:1024
    ds_read_b64_tr_b16 a[72:73], v105 offset:8
    ds_read_b64_tr_b16 a[74:75], v105 offset:1032
    ds_read_b64_tr_b16 a[68:69], v105 offset:40960
    ds_read_b64_tr_b16 a[70:71], v105 offset:41984
    ds_read_b64_tr_b16 a[76:77], v105 offset:40968
    ds_read_b64_tr_b16 a[78:79], v105 offset:41992
    s_waitcnt lgkmcnt(0)
    ds_read_b64_tr_b16 a[80:81], v106 offset:16384
    ds_read_b64_tr_b16 a[82:83], v106 offset:17408
    ds_read_b64_tr_b16 a[88:89], v106 offset:16392
    ds_read_b64_tr_b16 a[90:91], v106 offset:17416
    ds_read_b64_tr_b16 a[84:85], v106 offset:57344
    ds_read_b64_tr_b16 a[86:87], v106 offset:58368
    ds_read_b64_tr_b16 a[92:93], v106 offset:57352
    ds_read_b64_tr_b16 a[94:95], v106 offset:58376
    s_branch L_w_23
L_w_23_3:
    ds_read_b64_tr_b16 a[96:97], v105 offset:0
    ds_read_b64_tr_b16 a[98:99], v105 offset:1024
    ds_read_b64_tr_b16 a[104:105], v105 offset:8
    ds_read_b64_tr_b16 a[106:107], v105 offset:1032
    ds_read_b64_tr_b16 a[100:101], v105 offset:40960
    ds_read_b64_tr_b16 a[102:103], v105 offset:41984
    ds_read_b64_tr_b16 a[108:109], v105 offset:40968
    ds_read_b64_tr_b16 a[110:111], v105 offset:41992
    s_waitcnt lgkmcnt(0)
    ds_read_b64_tr_b16 a[112:113], v106 offset:16384
    ds_read_b64_tr_b16 a[114:115], v106 offset:17408
    ds_read_b64_tr_b16 a[120:121], v106 offset:16392
    ds_read_b64_tr_b16 a[122:123], v106 offset:17416
    ds_read_b64_tr_b16 a[116:117], v106 offset:57344
    ds_read_b64_tr_b16 a[118:119], v106 offset:58368
    ds_read_b64_tr_b16 a[124:125], v106 offset:57352
    ds_read_b64_tr_b16 a[126:127], v106 offset:58376
L_w_23:
    s_waitcnt lgkmcnt(0)
    s_waitcnt vmcnt(16)
    s_barrier
    s_mov_b32 s8, s42
    s_and_b32 s9, s43, 0xffff
    s_mov_b32 s10, 4194304
    s_mov_b32 s11, 0x20000
    s_xor_b32 s23, s16, 0
    s_lshl_b32 s23, s23, 13
    s_lshl_b32 m0, s16, 15
    s_add_u32 m0, m0, s23
    s_lshl_b32 s22, s16, 8
    s_lshl_b32 s23, s65, 17
    s_add_u32 s22, s22, s23
    s_add_u32 s22, s22, 0
    buffer_load_dwordx4 v90, s[8:11], s22 offen lds
    s_add_u32 m0, m0, 1024
    s_add_u32 s22, s22, 4096
    buffer_load_dwordx4 v90, s[8:11], s22 offen lds
    s_add_u32 m0, m0, 1024
    s_add_u32 s22, s22, 4096
    buffer_load_dwordx4 v90, s[8:11], s22 offen lds
    s_add_u32 m0, m0, 1024
    s_add_u32 s22, s22, 4096
    buffer_load_dwordx4 v90, s[8:11], s22 offen lds
    s_add_u32 m0, m0, 1024
    s_add_u32 s22, s22, 4096
    buffer_load_dwordx4 v90, s[8:11], s22 offen lds
    s_add_u32 m0, m0, 1024
    s_add_u32 s22, s22, 4096
    buffer_load_dwordx4 v90, s[8:11], s22 offen lds
    s_add_u32 m0, m0, 1024
    s_add_u32 s22, s22, 4096
    buffer_load_dwordx4 v90, s[8:11], s22 offen lds
    s_add_u32 m0, m0, 1024
    s_add_u32 s22, s22, 4096
    buffer_load_dwordx4 v90, s[8:11], s22 offen lds
    s_cmp_eq_u32 s91, 0
    s_cbranch_scc0 L_arr_27
    s_mov_b32 s91, 1
    s_waitcnt vmcnt(0)
    s_barrier
    s_cmp_eq_u32 s16, 0
    s_cbranch_scc0 L_arr_27
    s_lshl_b32 s21, s17, 5
    s_add_u32 s21, s21, 4
    s_atomic_add s3, s[56:57], s21
L_arr_27:
    s_cmp_eq_u32 s20, 0
    s_cbranch_scc0 L_rdv_done_25
    s_mov_b32 s27, 0
    v_lshlrev_b32 v96, 2, v0
    s_branch L_rdv_24_p
L_rdv_24:
    buffer_load_dword v97, v96, s[60:63], 0 offen sc1
    s_add_u32 s27, s27, 1
    s_cmp_gt_u32 s27, 262144
    s_cbranch_scc1 L_end
    s_waitcnt vmcnt(0)
L_rdv_24_p:
    s_mov_b32 s21, 0
    v_readlane_b32 s22, v97, 1
    s_nop 0
    s_add_u32 s21, s21, s22
    v_readlane_b32 s22, v97, 9
    s_nop 0
    s_add_u32 s21, s21, s22
    v_readlane_b32 s22, v97, 17
    s_nop 0
    s_add_u32 s21, s21, s22
    v_readlane_b32 s22, v97, 25
    s_nop 0
    s_add_u32 s21, s21, s22
    v_readlane_b32 s22, v97, 33
    s_nop 0
    s_add_u32 s21, s21, s22
    v_readlane_b32 s22, v97, 41
    s_nop 0
    s_add_u32 s21, s21, s22
    v_readlane_b32 s22, v97, 49
    s_nop 0
    s_add_u32 s21, s21, s22
    v_readlane_b32 s22, v97, 57
    s_nop 0
    s_add_u32 s21, s21, s22
    s_cmp_eq_u32 s21, 256
    s_cbranch_scc1 L_rdv_l_26
    s_sleep 4
    s_branch L_rdv_24
L_rdv_l_26:
    s_mov_b32 s21, 0
    s_mov_b32 s23, 0
    v_readlane_b32 s22, v97, 0
    s_cmp_gt_u32 s17, 0
    s_cselect_b32 s24, s22, 0
    s_add_u32 s23, s23, s24
    s_xor_b32 s22, s22, 32
    s_or_b32 s21, s21, s22
    v_readlane_b32 s22, v97, 8
    s_cmp_gt_u32 s17, 1
    s_cselect_b32 s24, s22, 0
    s_add_u32 s23, s23, s24
    s_xor_b32 s22, s22, 32
    s_or_b32 s21, s21, s22
    v_readlane_b32 s22, v97, 16
    s_cmp_gt_u32 s17, 2
    s_cselect_b32 s24, s22, 0
    s_add_u32 s23, s23, s24
    s_xor_b32 s22, s22, 32
    s_or_b32 s21, s21, s22
    v_readlane_b32 s22, v97, 24
    s_cmp_gt_u32 s17, 3
    s_cselect_b32 s24, s22, 0
    s_add_u32 s23, s23, s24
    s_xor_b32 s22, s22, 32
    s_or_b32 s21, s21, s22
    v_readlane_b32 s22, v97, 32
    s_cmp_gt_u32 s17, 4
    s_cselect_b32 s24, s22, 0
    s_add_u32 s23, s23, s24
    s_xor_b32 s22, s22, 32
    s_or_b32 s21, s21, s22
    v_readlane_b32 s22, v97, 40
    s_cmp_gt_u32 s17, 5
    s_cselect_b32 s24, s22, 0
    s_add_u32 s23, s23, s24
    s_xor_b32 s22, s22, 32
    s_or_b32 s21, s21, s22
    v_readlane_b32 s22, v97, 48
    s_cmp_gt_u32 s17, 6
    s_cselect_b32 s24, s22, 0
    s_add_u32 s23, s23, s24
    s_xor_b32 s22, s22, 32
    s_or_b32 s21, s21, s22
    v_readlane_b32 s22, v97, 56
    s_cmp_gt_u32 s17, 7
    s_cselect_b32 s24, s22, 0
    s_add_u32 s23, s23, s24
    s_xor_b32 s22, s22, 32
    s_or_b32 s21, s21, s22
    s_mov_b32 s20, 1
    s_cmp_eq_u32 s21, 0
    s_cbranch_scc1 L_rdv_done_25
    s_mov_b32 s20, 2
    s_add_u32 s19, s23, s18
    s_waitcnt vmcnt(0) lgkmcnt(0)
    s_barrier
    s_branch L_dispatch
L_rdv_done_25:
    v_lshlrev_b32 v1, 4, v0
    s_lshl_b32 s21, s16, 11
    s_add_u32 s21, s21, 131072
    v_add_u32 v2, s21, v1
    v_lshrrev_b32 v84, 5, v0
    v_and_b32 v85, 15, v0
    v_lshl_add_u32 v84, v84, 4, v85
    v_bfe_u32 v86, v0, 4, 1
    s_lshl_b32 s21, s16, 9
    s_add_u32 s82, s21, 2048
    s_add_u32 s21, s21, 139264
    v_lshlrev_b32 v3, 4, v84
    v_lshl_add_u32 v3, v86, 3, v3
    v_add_u32 v3, s21, v3
    s_lshl_b32 s22, s16, 8
    v_lshlrev_b32 v11, 10, v86
    v_lshl_add_u32 v11, v84, 3, v11
    v_add_u32 v11, s22, v11
    v_lshrrev_b32 v84, 4, v0
    v_bfe_u32 v86, v0, 2, 2
    v_lshl_add_u32 v86, v84, 2, v86
    v_lshlrev_b32 v86, 4, v86
    v_and_b32 v4, 1, v0
    v_lshl_add_u32 v4, v4, 3, v86
    v_add_u32 v4, 139264, v4
    v_lshlrev_b32 v86, 9, v84
    v_lshl_add_u32 v5, v85, 4, v86
    v_add_u32 v5, 147456, v5
    v_lshlrev_b32 v86, 11, v84
    v_lshl_add_u32 v10, v85, 4, v86
    s_lshl_b32 s21, s16, 9
    s_add_u32 s22, s21, 16384
    v_add_u32 v10, s22, v10
    v_and_b32 v85, 7, v0
    v_lshlrev_b32 v86, 7, v84
    v_lshl_add_u32 v6, v85, 4, v86
    s_add_u32 s21, s21, 143360
    v_add_u32 v6, s21, v6
    v_lshrrev_b32 v84, 5, v0
    v_lshlrev_b32 v12, 9, v84
    v_bfe_u32 v84, v0, 3, 1
    v_lshl_add_u32 v12, v84, 8, v12
    v_bfe_u32 v84, v0, 2, 1
    v_lshl_add_u32 v12, v84, 6, v12
    v_bfe_u32 v84, v0, 4, 1
    v_lshl_add_u32 v12, v84, 7, v12
    v_and_b32 v85, 3, v0
    v_lshl_add_u32 v12, v85, 4, v12
    s_lshl_b32 s21, s16, 11
    s_add_u32 s21, s21, 8192
    v_add_u32 v12, s21, v12
    v_lshrrev_b32 v84, 2, v0
    v_lshlrev_b32 v84, 11, v84
    v_lshl_add_u32 v9, v85, 4, v84
    s_lshl_b32 s21, s16, 16
    v_add_u32 v9, s21, v9
    v_lshrrev_b32 v84, 2, v0
    v_lshlrev_b32 v84, 1, v84
    v_and_b32 v84, 31, v84
    v_xor_b32 v84, s65, v84
    v_lshl_add_u32 v9, v84, 6, v9
    s_lshl_b32 s79, s65, 2
    s_add_u32 s79, s79, s16
    s_lshr_b32 s21, s79, 3
    s_lshl_b32 s21, s21, 2
    s_and_b32 s22, s79, 3
    s_add_u32 s21, s21, s22
    s_lshl_b32 s21, s21, 7
    s_bfe_u32 s22, s79, 0x10002
    s_lshl_b32 s22, s22, 6
    s_add_u32 s21, s21, s22
    v_lshrrev_b32 v84, 4, v0
    v_lshlrev_b32 v8, 4, v84
    v_lshl_add_u32 v8, v85, 2, v8
    v_add_u32 v8, s21, v8
    v_bfe_u32 v84, v0, 3, 1
    v_mul_u32_u24 v84, 0xaaaa, v84
    v_add_u32 v13, 0x4444, v84
    v_cmp_gt_u32 vcc, 32, v0
    v_mov_b32 v15, 0x3f803f80
    s_nop 0
    v_cndmask_b32 v14, 0, v15, vcc
    v_mov_b32 v15, v14
    v_mov_b32 v28, 0x3f803f80
    v_mov_b32 v29, 0x3f803f80
    v_bfe_u32 v84, v0, 3, 1
    v_lshl_add_u32 v84, v85, 1, v84
    v_bfe_u32 v86, v0, 2, 1
    v_lshlrev_b32 v86, 4, v86
    v_mov_b32 v85, 0x3f80
    v_lshlrev_b32 v85, v86, v85
    v_cmp_eq_u32 vcc, 0, v84
    s_nop 1
    v_cndmask_b32 v20, 0, v85, vcc
    v_cmp_eq_u32 vcc, 1, v84
    s_nop 1
    v_cndmask_b32 v21, 0, v85, vcc
    v_cmp_eq_u32 vcc, 2, v84
    s_nop 1
    v_cndmask_b32 v22, 0, v85, vcc
    v_cmp_eq_u32 vcc, 3, v84
    s_nop 1
    v_cndmask_b32 v23, 0, v85, vcc
    s_mov_b32 s84, 1040356334
    s_mov_b32 s85, 1040356334
    s_mul_i32 s66, s64, 393216
    s_add_u32 s66, s66, 2097152
    s_lshl_b32 s21, s16, 11
    s_add_u32 s80, s66, 262144
    s_add_u32 s68, s21, s80
    s_mov_b32 s69, 0
    s_mov_b32 s70, s66
    s_lshl_b32 s79, s79, 11
    s_add_u32 s81, s66, s79
    s_add_u32 s78, s70, 32768
    s_mov_b32 s66, 0
    s_mul_i32 s71, s64, 50331648
    s_mul_i32 s21, s65, 24576
    s_add_u32 s71, s71, s21
    s_add_u32 s71, s71, 127926272
    s_lshl_b32 s72, s64, 23
    s_lshl_b32 s21, s65, 12
    s_add_u32 s72, s72, s21
    s_add_u32 s72, s72, 18874368
    s_sub_u32 s83, s72, 143360
    s_lshl_b32 s73, s64, 20
    s_lshl_b32 s21, s65, 7
    s_add_u32 s73, s73, s21
    s_add_u32 s74, s73, 10240
    s_add_u32 s73, s73, 6144
    s_lshl_b32 s21, s16, 11
    s_add_u32 s75, s21, 147456
    s_mov_b32 s67, 0
    s_mov_b32 s12, s34
    s_and_b32 s13, s35, 0xffff
    s_mov_b32 s14, 8192
    s_mov_b32 s15, 0x20000
    v_and_b32 v84, 7, v0
    v_lshlrev_b32 v84, 10, v84
    v_lshrrev_b32 v85, 4, v0
    v_lshl_add_u32 v84, v85, 5, v84
    v_bfe_u32 v85, v0, 3, 1
    v_lshl_add_u32 v84, v85, 2, v84
    s_lshl_b32 s21, s16, 8
    buffer_load_dword v32, v84, s[12:15], s21 offen offset:0
    buffer_load_dword v33, v84, s[12:15], s21 offen offset:8
    buffer_load_dword v34, v84, s[12:15], s21 offen offset:16
    buffer_load_dword v35, v84, s[12:15], s21 offen offset:24
    buffer_load_dword v36, v84, s[12:15], s21 offen offset:128
    buffer_load_dword v37, v84, s[12:15], s21 offen offset:136
    buffer_load_dword v38, v84, s[12:15], s21 offen offset:144
    buffer_load_dword v39, v84, s[12:15], s21 offen offset:152
    v_and_b32 v84, 3, v0
    v_lshlrev_b32 v84, 2, v84
    buffer_load_dword v87, v84, s[4:7], s73 offen sc1
    s_cmp_eq_u32 s16, 0
    s_cbranch_scc0 L_w_28_1
    ds_read_b64_tr_b16 a[32:33], v105 offset:8192
    ds_read_b64_tr_b16 a[34:35], v105 offset:9216
    ds_read_b64_tr_b16 a[40:41], v105 offset:8200
    ds_read_b64_tr_b16 a[42:43], v105 offset:9224
    ds_read_b64_tr_b16 a[36:37], v105 offset:32768
    ds_read_b64_tr_b16 a[38:39], v105 offset:33792
    ds_read_b64_tr_b16 a[44:45], v105 offset:32776
    ds_read_b64_tr_b16 a[46:47], v105 offset:33800
    s_waitcnt lgkmcnt(0)
    ds_read_b64_tr_b16 a[48:49], v106 offset:24576
    ds_read_b64_tr_b16 a[50:51], v106 offset:25600
    ds_read_b64_tr_b16 a[56:57], v106 offset:24584
    ds_read_b64_tr_b16 a[58:59], v106 offset:25608
    ds_read_b64_tr_b16 a[52:53], v106 offset:49152
    ds_read_b64_tr_b16 a[54:55], v106 offset:50176
    ds_read_b64_tr_b16 a[60:61], v106 offset:49160
    ds_read_b64_tr_b16 a[62:63], v106 offset:50184
    s_branch L_w_28
L_w_28_1:
    s_cmp_eq_u32 s16, 1
    s_cbranch_scc0 L_w_28_2
    ds_read_b64_tr_b16 a[0:1], v105 offset:8192
    ds_read_b64_tr_b16 a[2:3], v105 offset:9216
    ds_read_b64_tr_b16 a[8:9], v105 offset:8200
    ds_read_b64_tr_b16 a[10:11], v105 offset:9224
    ds_read_b64_tr_b16 a[4:5], v105 offset:32768
    ds_read_b64_tr_b16 a[6:7], v105 offset:33792
    ds_read_b64_tr_b16 a[12:13], v105 offset:32776
    ds_read_b64_tr_b16 a[14:15], v105 offset:33800
    s_waitcnt lgkmcnt(0)
    ds_read_b64_tr_b16 a[16:17], v106 offset:24576
    ds_read_b64_tr_b16 a[18:19], v106 offset:25600
    ds_read_b64_tr_b16 a[24:25], v106 offset:24584
    ds_read_b64_tr_b16 a[26:27], v106 offset:25608
    ds_read_b64_tr_b16 a[20:21], v106 offset:49152
    ds_read_b64_tr_b16 a[22:23], v106 offset:50176
    ds_read_b64_tr_b16 a[28:29], v106 offset:49160
    ds_read_b64_tr_b16 a[30:31], v106 offset:50184
    s_branch L_w_28
L_w_28_2:
    s_cmp_eq_u32 s16, 2
    s_cbranch_scc0 L_w_28_3
    ds_read_b64_tr_b16 a[96:97], v105 offset:8192
    ds_read_b64_tr_b16 a[98:99], v105 offset:9216
    ds_read_b64_tr_b16 a[104:105], v105 offset:8200
    ds_read_b64_tr_b16 a[106:107], v105 offset:9224
    ds_read_b64_tr_b16 a[100:101], v105 offset:32768
    ds_read_b64_tr_b16 a[102:103], v105 offset:33792
    ds_read_b64_tr_b16 a[108:109], v105 offset:32776
    ds_read_b64_tr_b16 a[110:111], v105 offset:33800
    s_waitcnt lgkmcnt(0)
    ds_read_b64_tr_b16 a[112:113], v106 offset:24576
    ds_read_b64_tr_b16 a[114:115], v106 offset:25600
    ds_read_b64_tr_b16 a[120:121], v106 offset:24584
    ds_read_b64_tr_b16 a[122:123], v106 offset:25608
    ds_read_b64_tr_b16 a[116:117], v106 offset:49152
    ds_read_b64_tr_b16 a[118:119], v106 offset:50176
    ds_read_b64_tr_b16 a[124:125], v106 offset:49160
    ds_read_b64_tr_b16 a[126:127], v106 offset:50184
    s_branch L_w_28
L_w_28_3:
    ds_read_b64_tr_b16 a[64:65], v105 offset:8192
    ds_read_b64_tr_b16 a[66:67], v105 offset:9216
    ds_read_b64_tr_b16 a[72:73], v105 offset:8200
    ds_read_b64_tr_b16 a[74:75], v105 offset:9224
    ds_read_b64_tr_b16 a[68:69], v105 offset:32768
    ds_read_b64_tr_b16 a[70:71], v105 offset:33792
    ds_read_b64_tr_b16 a[76:77], v105 offset:32776
    ds_read_b64_tr_b16 a[78:79], v105 offset:33800
    s_waitcnt lgkmcnt(0)
    ds_read_b64_tr_b16 a[80:81], v106 offset:24576
    ds_read_b64_tr_b16 a[82:83], v106 offset:25600
    ds_read_b64_tr_b16 a[88:89], v106 offset:24584
    ds_read_b64_tr_b16 a[90:91], v106 offset:25608
    ds_read_b64_tr_b16 a[84:85], v106 offset:49152
    ds_read_b64_tr_b16 a[86:87], v106 offset:50176
    ds_read_b64_tr_b16 a[92:93], v106 offset:49160
    ds_read_b64_tr_b16 a[94:95], v106 offset:50184
L_w_28:
    s_waitcnt lgkmcnt(0)
    s_waitcnt vmcnt(25)
    s_barrier
    s_xor_b32 s23, s16, 1
    s_lshl_b32 s23, s23, 13
    s_lshl_b32 m0, s16, 15
    s_add_u32 m0, m0, s23
    s_lshl_b32 s22, s16, 8
    s_lshl_b32 s23, s65, 17
    s_add_u32 s22, s22, s23
    s_add_u32 s22, s22, 32768
    buffer_load_dwordx4 v90, s[8:11], s22 offen lds
    s_add_u32 m0, m0, 1024
    s_add_u32 s22, s22, 4096
    buffer_load_dwordx4 v90, s[8:11], s22 offen lds
    s_add_u32 m0, m0, 1024
    s_add_u32 s22, s22, 4096
    buffer_load_dwordx4 v90, s[8:11], s22 offen lds
    s_add_u32 m0, m0, 1024
    s_add_u32 s22, s22, 4096
    buffer_load_dwordx4 v90, s[8:11], s22 offen lds
    s_add_u32 m0, m0, 1024
    s_add_u32 s22, s22, 4096
    buffer_load_dwordx4 v90, s[8:11], s22 offen lds
    s_add_u32 m0, m0, 1024
    s_add_u32 s22, s22, 4096
    buffer_load_dwordx4 v90, s[8:11], s22 offen lds
    s_add_u32 m0, m0, 1024
    s_add_u32 s22, s22, 4096
    buffer_load_dwordx4 v90, s[8:11], s22 offen lds
    s_add_u32 m0, m0, 1024
    s_add_u32 s22, s22, 4096
    buffer_load_dwordx4 v90, s[8:11], s22 offen lds
    s_cmp_eq_u32 s16, 0
    s_cbranch_scc0 L_w_29_1
    ds_read_b64_tr_b16 a[64:65], v105 offset:16384
    ds_read_b64_tr_b16 a[66:67], v105 offset:17408
    ds_read_b64_tr_b16 a[72:73], v105 offset:16392
    ds_read_b64_tr_b16 a[74:75], v105 offset:17416
    ds_read_b64_tr_b16 a[68:69], v105 offset:57344
    ds_read_b64_tr_b16 a[70:71], v105 offset:58368
    ds_read_b64_tr_b16 a[76:77], v105 offset:57352
    ds_read_b64_tr_b16 a[78:79], v105 offset:58376
    s_waitcnt lgkmcnt(0)
    ds_read_b64_tr_b16 a[80:81], v106 offset:0
    ds_read_b64_tr_b16 a[82:83], v106 offset:1024
    ds_read_b64_tr_b16 a[88:89], v106 offset:8
    ds_read_b64_tr_b16 a[90:91], v106 offset:1032
    ds_read_b64_tr_b16 a[84:85], v106 offset:40960
    ds_read_b64_tr_b16 a[86:87], v106 offset:41984
    ds_read_b64_tr_b16 a[92:93], v106 offset:40968
    ds_read_b64_tr_b16 a[94:95], v106 offset:41992
    s_branch L_w_29
L_w_29_1:
    s_cmp_eq_u32 s16, 1
    s_cbranch_scc0 L_w_29_2
    ds_read_b64_tr_b16 a[96:97], v105 offset:16384
    ds_read_b64_tr_b16 a[98:99], v105 offset:17408
    ds_read_b64_tr_b16 a[104:105], v105 offset:16392
    ds_read_b64_tr_b16 a[106:107], v105 offset:17416
    ds_read_b64_tr_b16 a[100:101], v105 offset:57344
    ds_read_b64_tr_b16 a[102:103], v105 offset:58368
    ds_read_b64_tr_b16 a[108:109], v105 offset:57352
    ds_read_b64_tr_b16 a[110:111], v105 offset:58376
    s_waitcnt lgkmcnt(0)
    ds_read_b64_tr_b16 a[112:113], v106 offset:0
    ds_read_b64_tr_b16 a[114:115], v106 offset:1024
    ds_read_b64_tr_b16 a[120:121], v106 offset:8
    ds_read_b64_tr_b16 a[122:123], v106 offset:1032
    ds_read_b64_tr_b16 a[116:117], v106 offset:40960
    ds_read_b64_tr_b16 a[118:119], v106 offset:41984
    ds_read_b64_tr_b16 a[124:125], v106 offset:40968
    ds_read_b64_tr_b16 a[126:127], v106 offset:41992
    s_branch L_w_29
L_w_29_2:
    s_cmp_eq_u32 s16, 2
    s_cbranch_scc0 L_w_29_3
    ds_read_b64_tr_b16 a[0:1], v105 offset:16384
    ds_read_b64_tr_b16 a[2:3], v105 offset:17408
    ds_read_b64_tr_b16 a[8:9], v105 offset:16392
    ds_read_b64_tr_b16 a[10:11], v105 offset:17416
    ds_read_b64_tr_b16 a[4:5], v105 offset:57344
    ds_read_b64_tr_b16 a[6:7], v105 offset:58368
    ds_read_b64_tr_b16 a[12:13], v105 offset:57352
    ds_read_b64_tr_b16 a[14:15], v105 offset:58376
    s_waitcnt lgkmcnt(0)
    ds_read_b64_tr_b16 a[16:17], v106 offset:0
    ds_read_b64_tr_b16 a[18:19], v106 offset:1024
    ds_read_b64_tr_b16 a[24:25], v106 offset:8
    ds_read_b64_tr_b16 a[26:27], v106 offset:1032
    ds_read_b64_tr_b16 a[20:21], v106 offset:40960
    ds_read_b64_tr_b16 a[22:23], v106 offset:41984
    ds_read_b64_tr_b16 a[28:29], v106 offset:40968
    ds_read_b64_tr_b16 a[30:31], v106 offset:41992
    s_branch L_w_29
L_w_29_3:
    ds_read_b64_tr_b16 a[32:33], v105 offset:16384
    ds_read_b64_tr_b16 a[34:35], v105 offset:17408
    ds_read_b64_tr_b16 a[40:41], v105 offset:16392
    ds_read_b64_tr_b16 a[42:43], v105 offset:17416
    ds_read_b64_tr_b16 a[36:37], v105 offset:57344
    ds_read_b64_tr_b16 a[38:39], v105 offset:58368
    ds_read_b64_tr_b16 a[44:45], v105 offset:57352
    ds_read_b64_tr_b16 a[46:47], v105 offset:58376
    s_waitcnt lgkmcnt(0)
    ds_read_b64_tr_b16 a[48:49], v106 offset:0
    ds_read_b64_tr_b16 a[50:51], v106 offset:1024
    ds_read_b64_tr_b16 a[56:57], v106 offset:8
    ds_read_b64_tr_b16 a[58:59], v106 offset:1032
    ds_read_b64_tr_b16 a[52:53], v106 offset:40960
    ds_read_b64_tr_b16 a[54:55], v106 offset:41984
    ds_read_b64_tr_b16 a[60:61], v106 offset:40968
    ds_read_b64_tr_b16 a[62:63], v106 offset:41992
L_w_29:
    s_waitcnt lgkmcnt(0)
    s_waitcnt vmcnt(25)
    s_barrier
    s_xor_b32 s23, s16, 2
    s_lshl_b32 s23, s23, 13
    s_lshl_b32 m0, s16, 15
    s_add_u32 m0, m0, s23
    s_lshl_b32 s22, s16, 8
    s_lshl_b32 s23, s65, 17
    s_add_u32 s22, s22, s23
    s_add_u32 s22, s22, 65536
    buffer_load_dwordx4 v90, s[8:11], s22 offen lds
    s_add_u32 m0, m0, 1024
    s_add_u32 s22, s22, 4096
    buffer_load_dwordx4 v90, s[8:11], s22 offen lds
    s_add_u32 m0, m0, 1024
    s_add_u32 s22, s22, 4096
    buffer_load_dwordx4 v90, s[8:11], s22 offen lds
    s_add_u32 m0, m0, 1024
    s_add_u32 s22, s22, 4096
    buffer_load_dwordx4 v90, s[8:11], s22 offen lds
    s_add_u32 m0, m0, 1024
    s_add_u32 s22, s22, 4096
    buffer_load_dwordx4 v90, s[8:11], s22 offen lds
    s_add_u32 m0, m0, 1024
    s_add_u32 s22, s22, 4096
    buffer_load_dwordx4 v90, s[8:11], s22 offen lds
    s_add_u32 m0, m0, 1024
    s_add_u32 s22, s22, 4096
    buffer_load_dwordx4 v90, s[8:11], s22 offen lds
    s_add_u32 m0, m0, 1024
    s_add_u32 s22, s22, 4096
    buffer_load_dwordx4 v90, s[8:11], s22 offen lds
    s_cmp_eq_u32 s16, 0
    s_cbranch_scc0 L_w_30_1
    ds_read_b64_tr_b16 a[96:97], v105 offset:24576
    ds_read_b64_tr_b16 a[98:99], v105 offset:25600
    ds_read_b64_tr_b16 a[104:105], v105 offset:24584
    ds_read_b64_tr_b16 a[106:107], v105 offset:25608
    ds_read_b64_tr_b16 a[100:101], v105 offset:49152
    ds_read_b64_tr_b16 a[102:103], v105 offset:50176
    ds_read_b64_tr_b16 a[108:109], v105 offset:49160
    ds_read_b64_tr_b16 a[110:111], v105 offset:50184
    s_waitcnt lgkmcnt(0)
    ds_read_b64_tr_b16 a[112:113], v106 offset:8192
    ds_read_b64_tr_b16 a[114:115], v106 offset:9216
    ds_read_b64_tr_b16 a[120:121], v106 offset:8200
    ds_read_b64_tr_b16 a[122:123], v106 offset:9224
    ds_read_b64_tr_b16 a[116:117], v106 offset:32768
    ds_read_b64_tr_b16 a[118:119], v106 offset:33792
    ds_read_b64_tr_b16 a[124:125], v106 offset:32776
    ds_read_b64_tr_b16 a[126:127], v106 offset:33800
    s_branch L_w_30
L_w_30_1:
    s_cmp_eq_u32 s16, 1
    s_cbranch_scc0 L_w_30_2
    ds_read_b64_tr_b16 a[64:65], v105 offset:24576
    ds_read_b64_tr_b16 a[66:67], v105 offset:25600
    ds_read_b64_tr_b16 a[72:73], v105 offset:24584
    ds_read_b64_tr_b16 a[74:75], v105 offset:25608
    ds_read_b64_tr_b16 a[68:69], v105 offset:49152
    ds_read_b64_tr_b16 a[70:71], v105 offset:50176
    ds_read_b64_tr_b16 a[76:77], v105 offset:49160
    ds_read_b64_tr_b16 a[78:79], v105 offset:50184
    s_waitcnt lgkmcnt(0)
    ds_read_b64_tr_b16 a[80:81], v106 offset:8192
    ds_read_b64_tr_b16 a[82:83], v106 offset:9216
    ds_read_b64_tr_b16 a[88:89], v106 offset:8200
    ds_read_b64_tr_b16 a[90:91], v106 offset:9224
    ds_read_b64_tr_b16 a[84:85], v106 offset:32768
    ds_read_b64_tr_b16 a[86:87], v106 offset:33792
    ds_read_b64_tr_b16 a[92:93], v106 offset:32776
    ds_read_b64_tr_b16 a[94:95], v106 offset:33800
    s_branch L_w_30
L_w_30_2:
    s_cmp_eq_u32 s16, 2
    s_cbranch_scc0 L_w_30_3
    ds_read_b64_tr_b16 a[32:33], v105 offset:24576
    ds_read_b64_tr_b16 a[34:35], v105 offset:25600
    ds_read_b64_tr_b16 a[40:41], v105 offset:24584
    ds_read_b64_tr_b16 a[42:43], v105 offset:25608
    ds_read_b64_tr_b16 a[36:37], v105 offset:49152
    ds_read_b64_tr_b16 a[38:39], v105 offset:50176
    ds_read_b64_tr_b16 a[44:45], v105 offset:49160
    ds_read_b64_tr_b16 a[46:47], v105 offset:50184
    s_waitcnt lgkmcnt(0)
    ds_read_b64_tr_b16 a[48:49], v106 offset:8192
    ds_read_b64_tr_b16 a[50:51], v106 offset:9216
    ds_read_b64_tr_b16 a[56:57], v106 offset:8200
    ds_read_b64_tr_b16 a[58:59], v106 offset:9224
    ds_read_b64_tr_b16 a[52:53], v106 offset:32768
    ds_read_b64_tr_b16 a[54:55], v106 offset:33792
    ds_read_b64_tr_b16 a[60:61], v106 offset:32776
    ds_read_b64_tr_b16 a[62:63], v106 offset:33800
    s_branch L_w_30
L_w_30_3:
    ds_read_b64_tr_b16 a[0:1], v105 offset:24576
    ds_read_b64_tr_b16 a[2:3], v105 offset:25600
    ds_read_b64_tr_b16 a[8:9], v105 offset:24584
    ds_read_b64_tr_b16 a[10:11], v105 offset:25608
    ds_read_b64_tr_b16 a[4:5], v105 offset:49152
    ds_read_b64_tr_b16 a[6:7], v105 offset:50176
    ds_read_b64_tr_b16 a[12:13], v105 offset:49160
    ds_read_b64_tr_b16 a[14:15], v105 offset:50184
    s_waitcnt lgkmcnt(0)
    ds_read_b64_tr_b16 a[16:17], v106 offset:8192
    ds_read_b64_tr_b16 a[18:19], v106 offset:9216
    ds_read_b64_tr_b16 a[24:25], v106 offset:8200
    ds_read_b64_tr_b16 a[26:27], v106 offset:9224
    ds_read_b64_tr_b16 a[20:21], v106 offset:32768
    ds_read_b64_tr_b16 a[22:23], v106 offset:33792
    ds_read_b64_tr_b16 a[28:29], v106 offset:32776
    ds_read_b64_tr_b16 a[30:31], v106 offset:33800
L_w_30:
    s_waitcnt lgkmcnt(0)
    s_waitcnt vmcnt(25)
    s_barrier
    s_xor_b32 s23, s16, 3
    s_lshl_b32 s23, s23, 13
    s_lshl_b32 m0, s16, 15
    s_add_u32 m0, m0, s23
    s_lshl_b32 s22, s16, 8
    s_lshl_b32 s23, s65, 17
    s_add_u32 s22, s22, s23
    s_add_u32 s22, s22, 98304
    buffer_load_dwordx4 v90, s[8:11], s22 offen lds
    s_add_u32 m0, m0, 1024
    s_add_u32 s22, s22, 4096
    buffer_load_dwordx4 v90, s[8:11], s22 offen lds
    s_add_u32 m0, m0, 1024
    s_add_u32 s22, s22, 4096
    buffer_load_dwordx4 v90, s[8:11], s22 offen lds
    s_add_u32 m0, m0, 1024
    s_add_u32 s22, s22, 4096
    buffer_load_dwordx4 v90, s[8:11], s22 offen lds
    s_add_u32 m0, m0, 1024
    s_add_u32 s22, s22, 4096
    buffer_load_dwordx4 v90, s[8:11], s22 offen lds
    s_add_u32 m0, m0, 1024
    s_add_u32 s22, s22, 4096
    buffer_load_dwordx4 v90, s[8:11], s22 offen lds
    s_add_u32 m0, m0, 1024
    s_add_u32 s22, s22, 4096
    buffer_load_dwordx4 v90, s[8:11], s22 offen lds
    s_add_u32 m0, m0, 1024
    s_add_u32 s22, s22, 4096
    buffer_load_dwordx4 v90, s[8:11], s22 offen lds
    s_xor_b32 s23, s16, 0
    s_lshl_b32 s23, s23, 13
    v_add_u32 v93, s23, v91
    ds_read_b64_tr_b16 v[40:41], v93 offset:0
    ds_read_b64_tr_b16 v[42:43], v93 offset:512
    ds_read_b64_tr_b16 v[44:45], v93 offset:2048
    ds_read_b64_tr_b16 v[46:47], v93 offset:2560
    ds_read_b64_tr_b16 v[48:49], v93 offset:32
    ds_read_b64_tr_b16 v[50:51], v93 offset:544
    ds_read_b64_tr_b16 v[52:53], v93 offset:2080
    ds_read_b64_tr_b16 v[54:55], v93 offset:2592
    s_waitcnt lgkmcnt(0)
    ds_read_b64_tr_b16 v[56:57], v93 offset:128
    ds_read_b64_tr_b16 v[58:59], v93 offset:640
    ds_read_b64_tr_b16 v[60:61], v93 offset:2176
    ds_read_b64_tr_b16 v[62:63], v93 offset:2688
    ds_read_b64_tr_b16 v[64:65], v93 offset:160
    ds_read_b64_tr_b16 v[66:67], v93 offset:672
    ds_read_b64_tr_b16 v[68:69], v93 offset:2208
    ds_read_b64_tr_b16 v[70:71], v93 offset:2720
    s_waitcnt lgkmcnt(0)
    v_add_u32 v93, s23, v92
    ds_write_b128 v93, v[40:43] offset:0
    ds_write_b128 v93, v[44:47] offset:1024
    ds_write_b128 v93, v[48:51] offset:128
    ds_write_b128 v93, v[52:55] offset:1152
    ds_write_b128 v93, v[56:59] offset:4096
    ds_write_b128 v93, v[60:63] offset:5120
    ds_write_b128 v93, v[64:67] offset:4224
    ds_write_b128 v93, v[68:71] offset:5248
    s_waitcnt lgkmcnt(0)
    s_waitcnt vmcnt(16)
    s_barrier
    v_cmp_gt_u32 vcc, 1, v87
    s_mov_b32 s31, 0
    s_cbranch_vccnz L_ch_nk
    s_mov_b32 m0, s75
    s_xor_b32 s75, s75, 8192
    buffer_load_dwordx4 v12, s[4:7], s71 offen sc1 lds
    buffer_load_dwordx4 v12, s[4:7], s71 offen offset:1024 sc1 lds
    s_mov_b32 s31, 1
L_ch_nk:
    s_xor_b32 s23, s16, 1
    s_lshl_b32 s23, s23, 13
    v_add_u32 v93, s23, v91
    ds_read_b64_tr_b16 v[40:41], v93 offset:0
    ds_read_b64_tr_b16 v[42:43], v93 offset:512
    ds_read_b64_tr_b16 v[44:45], v93 offset:2048
    ds_read_b64_tr_b16 v[46:47], v93 offset:2560
    ds_read_b64_tr_b16 v[48:49], v93 offset:32
    ds_read_b64_tr_b16 v[50:51], v93 offset:544
    ds_read_b64_tr_b16 v[52:53], v93 offset:2080
    ds_read_b64_tr_b16 v[54:55], v93 offset:2592
    s_waitcnt lgkmcnt(0)
    ds_read_b64_tr_b16 v[56:57], v93 offset:128
    ds_read_b64_tr_b16 v[58:59], v93 offset:640
    ds_read_b64_tr_b16 v[60:61], v93 offset:2176
    ds_read_b64_tr_b16 v[62:63], v93 offset:2688
    ds_read_b64_tr_b16 v[64:65], v93 offset:160
    ds_read_b64_tr_b16 v[66:67], v93 offset:672
    ds_read_b64_tr_b16 v[68:69], v93 offset:2208
    ds_read_b64_tr_b16 v[70:71], v93 offset:2720
    s_waitcnt lgkmcnt(0)
    v_add_u32 v93, s23, v92
    ds_write_b128 v93, v[40:43] offset:0
    ds_write_b128 v93, v[44:47] offset:1024
    ds_write_b128 v93, v[48:51] offset:128
    ds_write_b128 v93, v[52:55] offset:1152
    ds_write_b128 v93, v[56:59] offset:4096
    ds_write_b128 v93, v[60:63] offset:5120
    ds_write_b128 v93, v[64:67] offset:4224
    ds_write_b128 v93, v[68:71] offset:5248
    s_waitcnt lgkmcnt(0)
    s_waitcnt vmcnt(8)
    s_barrier
    s_xor_b32 s23, s16, 2
    s_lshl_b32 s23, s23, 13
    v_add_u32 v93, s23, v91
    ds_read_b64_tr_b16 v[40:41], v93 offset:0
    ds_read_b64_tr_b16 v[42:43], v93 offset:512
    ds_read_b64_tr_b16 v[44:45], v93 offset:2048
    ds_read_b64_tr_b16 v[46:47], v93 offset:2560
    ds_read_b64_tr_b16 v[48:49], v93 offset:32
    ds_read_b64_tr_b16 v[50:51], v93 offset:544
    ds_read_b64_tr_b16 v[52:53], v93 offset:2080
    ds_read_b64_tr_b16 v[54:55], v93 offset:2592
    s_waitcnt lgkmcnt(0)
    ds_read_b64_tr_b16 v[56:57], v93 offset:128
    ds_read_b64_tr_b16 v[58:59], v93 offset:640
    ds_read_b64_tr_b16 v[60:61], v93 offset:2176
    ds_read_b64_tr_b16 v[62:63], v93 offset:2688
    ds_read_b64_tr_b16 v[64:65], v93 offset:160
    ds_read_b64_tr_b16 v[66:67], v93 offset:672
    ds_read_b64_tr_b16 v[68:69], v93 offset:2208
    ds_read_b64_tr_b16 v[70:71], v93 offset:2720
    s_waitcnt lgkmcnt(0)
    v_add_u32 v93, s23, v92
    ds_write_b128 v93, v[40:43] offset:0
    ds_write_b128 v93, v[44:47] offset:1024
    ds_write_b128 v93, v[48:51] offset:128
    ds_write_b128 v93, v[52:55] offset:1152
    ds_write_b128 v93, v[56:59] offset:4096
    ds_write_b128 v93, v[60:63] offset:5120
    ds_write_b128 v93, v[64:67] offset:4224
    ds_write_b128 v93, v[68:71] offset:5248
    s_waitcnt lgkmcnt(0)
    s_waitcnt vmcnt(0)
    s_barrier
    s_xor_b32 s23, s16, 3
    s_lshl_b32 s23, s23, 13
    v_add_u32 v93, s23, v91
    ds_read_b64_tr_b16 v[40:41], v93 offset:0
    ds_read_b64_tr_b16 v[42:43], v93 offset:512
    ds_read_b64_tr_b16 v[44:45], v93 offset:2048
    ds_read_b64_tr_b16 v[46:47], v93 offset:2560
    ds_read_b64_tr_b16 v[48:49], v93 offset:32
    ds_read_b64_tr_b16 v[50:51], v93 offset:544
    ds_read_b64_tr_b16 v[52:53], v93 offset:2080
    ds_read_b64_tr_b16 v[54:55], v93 offset:2592
    s_waitcnt lgkmcnt(0)
    ds_read_b64_tr_b16 v[56:57], v93 offset:128
    ds_read_b64_tr_b16 v[58:59], v93 offset:640
    ds_read_b64_tr_b16 v[60:61], v93 offset:2176
    ds_read_b64_tr_b16 v[62:63], v93 offset:2688
    ds_read_b64_tr_b16 v[64:65], v93 offset:160
    ds_read_b64_tr_b16 v[66:67], v93 offset:672
    ds_read_b64_tr_b16 v[68:69], v93 offset:2208
    ds_read_b64_tr_b16 v[70:71], v93 offset:2720
    s_waitcnt lgkmcnt(0)
    v_add_u32 v93, s23, v92
    ds_write_b128 v93, v[40:43] offset:0
    ds_write_b128 v93, v[44:47] offset:1024
    ds_write_b128 v93, v[48:51] offset:128
    ds_write_b128 v93, v[52:55] offset:1152
    ds_write_b128 v93, v[56:59] offset:4096
    ds_write_b128 v93, v[60:63] offset:5120
    ds_write_b128 v93, v[64:67] offset:4224
    ds_write_b128 v93, v[68:71] offset:5248
    s_waitcnt lgkmcnt(0)
    s_cmp_eq_u32 s31, 1
    s_cbranch_scc1 L_ch_k0
L_ch_ldone:
    s_cmp_eq_u32 s91, 0
    s_cbranch_scc0 L_arr_34
    s_mov_b32 s91, 1
    s_waitcnt vmcnt(0)
    s_barrier
    s_cmp_eq_u32 s16, 0
    s_cbranch_scc0 L_arr_34
    s_lshl_b32 s21, s17, 5
    s_add_u32 s21, s21, 4
    s_atomic_add s3, s[56:57], s21
L_arr_34:
    s_cmp_eq_u32 s20, 0
    s_cbranch_scc0 L_rdv_done_32
    s_mov_b32 s27, 0
    v_lshlrev_b32 v96, 2, v0
    s_branch L_rdv_31_p
L_rdv_31:
    buffer_load_dword v97, v96, s[60:63], 0 offen sc1
    s_add_u32 s27, s27, 1
    s_cmp_gt_u32 s27, 262144
    s_cbranch_scc1 L_end
L_rdv_31_p:
    s_waitcnt vmcnt(0)
    s_mov_b32 s21, 0
    v_readlane_b32 s22, v97, 1
    s_nop 0
    s_add_u32 s21, s21, s22
    v_readlane_b32 s22, v97, 9
    s_nop 0
    s_add_u32 s21, s21, s22
    v_readlane_b32 s22, v97, 17
    s_nop 0
    s_add_u32 s21, s21, s22
    v_readlane_b32 s22, v97, 25
    s_nop 0
    s_add_u32 s21, s21, s22
    v_readlane_b32 s22, v97, 33
    s_nop 0
    s_add_u32 s21, s21, s22
    v_readlane_b32 s22, v97, 41
    s_nop 0
    s_add_u32 s21, s21, s22
    v_readlane_b32 s22, v97, 49
    s_nop 0
    s_add_u32 s21, s21, s22
    v_readlane_b32 s22, v97, 57
    s_nop 0
    s_add_u32 s21, s21, s22
    s_cmp_eq_u32 s21, 256
    s_cbranch_scc1 L_rdv_l_33
    s_sleep 4
    s_branch L_rdv_31
L_rdv_l_33:
    s_mov_b32 s21, 0
    s_mov_b32 s23, 0
    v_readlane_b32 s22, v97, 0
    s_cmp_gt_u32 s17, 0
    s_cselect_b32 s24, s22, 0
    s_add_u32 s23, s23, s24
    s_xor_b32 s22, s22, 32
    s_or_b32 s21, s21, s22
    v_readlane_b32 s22, v97, 8
    s_cmp_gt_u32 s17, 1
    s_cselect_b32 s24, s22, 0
    s_add_u32 s23, s23, s24
    s_xor_b32 s22, s22, 32
    s_or_b32 s21, s21, s22
    v_readlane_b32 s22, v97, 16
    s_cmp_gt_u32 s17, 2
    s_cselect_b32 s24, s22, 0
    s_add_u32 s23, s23, s24
    s_xor_b32 s22, s22, 32
    s_or_b32 s21, s21, s22
    v_readlane_b32 s22, v97, 24
    s_cmp_gt_u32 s17, 3
    s_cselect_b32 s24, s22, 0
    s_add_u32 s23, s23, s24
    s_xor_b32 s22, s22, 32
    s_or_b32 s21, s21, s22
    v_readlane_b32 s22, v97, 32
    s_cmp_gt_u32 s17, 4
    s_cselect_b32 s24, s22, 0
    s_add_u32 s23, s23, s24
    s_xor_b32 s22, s22, 32
    s_or_b32 s21, s21, s22
    v_readlane_b32 s22, v97, 40
    s_cmp_gt_u32 s17, 5
    s_cselect_b32 s24, s22, 0
    s_add_u32 s23, s23, s24
    s_xor_b32 s22, s22, 32
    s_or_b32 s21, s21, s22
    v_readlane_b32 s22, v97, 48
    s_cmp_gt_u32 s17, 6
    s_cselect_b32 s24, s22, 0
    s_add_u32 s23, s23, s24
    s_xor_b32 s22, s22, 32
    s_or_b32 s21, s21, s22
    v_readlane_b32 s22, v97, 56
    s_cmp_gt_u32 s17, 7
    s_cselect_b32 s24, s22, 0
    s_add_u32 s23, s23, s24
    s_xor_b32 s22, s22, 32
    s_or_b32 s21, s21, s22
    s_mov_b32 s20, 1
    s_cmp_eq_u32 s21, 0
    s_cbranch_scc1 L_rdv_done_32
    s_mov_b32 s20, 2
    s_add_u32 s19, s23, s18
    s_waitcnt vmcnt(0) lgkmcnt(0)
    s_barrier
    s_branch L_dispatch
L_rdv_done_32:
    s_mov_b32 s27, 0
L_q0_35:
    s_load_dwordx4 s[8:11], s[58:59], s73 glc
    s_add_u32 s27, s27, 1
    s_cmp_gt_u32 s27, 262144
    s_cbranch_scc1 L_end
    s_waitcnt lgkmcnt(0)
    s_and_b32 s8, s8, s9
    s_and_b32 s10, s10, s11
    s_and_b32 s8, s8, s10
    s_cbranch_scc1 L_q0_35_ok
    s_sleep 4
    s_branch L_q0_35
L_q0_35_ok:
    s_mov_b32 m0, s75
    s_xor_b32 s75, s75, 8192
    buffer_load_dwordx4 v12, s[4:7], s71 offen sc1 lds
    buffer_load_dwordx4 v12, s[4:7], s71 offen offset:1024 sc1 lds
L_ch_k0:
    s_add_u32 s73, s73, 16384
    s_load_dwordx4 s[8:11], s[58:59], s73 glc
    v_mov_b64 v[64:65], 0
    v_mov_b64 v[66:67], 0
    v_mov_b64 v[68:69], 0
    v_mov_b64 v[70:71], 0
    v_mov_b64 v[72:73], 0
    v_mov_b64 v[74:75], 0
    v_mov_b64 v[76:77], 0
    v_mov_b64 v[78:79], 0
    v_mov_b64 v[80:81], 0
    v_mov_b64 v[82:83], 0
    v_mov_b64 v[84:85], 0
    v_mov_b64 v[86:87], 0
    v_xor_b32 v26, 2048, v2
    v_xor_b32 v27, 4096, v2
    v_xor_b32 v30, 6144, v2
    s_waitcnt vmcnt(0) lgkmcnt(0)
    s_barrier
    s_cmp_eq_u32 s20, 2
    s_cbranch_scc1 L_ch_entry_slow
    s_branch L_ch_entry_fast
L_ch_loop_fast:
    s_mov_b32 s27, 0
    s_nop 15
    s_nop 15
    s_nop 15
    s_nop 1
    buffer_load_dwordx4 v[32:35], v1, s[4:7], s76 offen sc1
    buffer_load_dwordx4 v[36:39], v1, s[4:7], s76 offen offset:1024 sc1
    s_nop 15
    s_nop 15
    s_nop 7
L_ch_p2_fast:
    buffer_load_dwordx4 v[96:99], v1, s[4:7], s76 offen sc1
    buffer_load_dwordx4 v[100:103], v1, s[4:7], s76 offen offset:1024 sc1
    s_waitcnt vmcnt(3)
    v_max3_u32 v40, v32, v33, v34
    s_waitcnt vmcnt(2)
    v_max3_u32 v41, v35, v36, v37
    v_max3_u32 v40, v40, v38, v39
    v_max_u32 v40, v40, v41
    v_cmp_eq_u32 vcc, -1, v40
    s_cbranch_vccnz L_ch_p2b_fast
L_ch_entry_fast:
    ds_write_b128 v2, v[32:35]
    ds_write_b128 v2, v[36:39] offset:1024
    v_smfmac_f32_16x16x64_bf16 v[64:67], v[32:35], a[0:7], v13
    v_smfmac_f32_16x16x64_bf16 v[68:71], v[32:35], a[8:15], v13
    v_smfmac_f32_16x16x64_bf16 v[72:75], v[32:35], a[128:135], v13
    buffer_load_dwordx4 v[112:115], v10, s[4:7], s71 offen sc1
    v_smfmac_f32_16x16x64_bf16 v[76:79], v[32:35], a[136:143], v13
    buffer_load_dwordx4 v[116:119], v10, s[4:7], s71 offen offset:256 sc1
    v_smfmac_f32_16x16x64_bf16 v[80:83], v[32:35], v[128:135], v13
    v_smfmac_f32_16x16x64_bf16 v[84:87], v[32:35], v[136:143], v13
    s_waitcnt lgkmcnt(0)
    s_barrier
L_ch_b1_fast:
    v_smfmac_f32_16x16x64_bf16 v[64:67], v[36:39], a[16:23], v13
    ds_read_b128 v[40:43], v26 offset:0
    v_smfmac_f32_16x16x64_bf16 v[68:71], v[36:39], a[24:31], v13
    ds_read_b128 v[44:47], v26 offset:1024
    v_smfmac_f32_16x16x64_bf16 v[72:75], v[36:39], a[144:151], v13
    ds_read_b128 v[48:51], v27 offset:0
    v_smfmac_f32_16x16x64_bf16 v[76:79], v[36:39], a[152:159], v13
    ds_read_b128 v[52:55], v27 offset:1024
    v_smfmac_f32_16x16x64_bf16 v[80:83], v[36:39], v[144:151], v13
    ds_read_b128 v[56:59], v30 offset:0
    v_smfmac_f32_16x16x64_bf16 v[84:87], v[36:39], v[152:159], v13
    ds_read_b128 v[60:63], v30 offset:1024
L_ch_q_fast:
    s_waitcnt lgkmcnt(5)
    v_smfmac_f32_16x16x64_bf16 v[64:67], v[40:43], a[32:39], v13
    s_add_u32 s71, s71, 786432
    v_smfmac_f32_16x16x64_bf16 v[68:71], v[40:43], a[40:47], v13
    s_and_b32 s8, s8, s9
    s_and_b32 s10, s10, s11
    s_waitcnt lgkmcnt(4)
    v_smfmac_f32_16x16x64_bf16 v[64:67], v[44:47], a[48:55], v13
    s_and_b32 s8, s8, s10
    s_cbranch_scc0 L_ch_kvwait_fast
L_ch_kvok_fast:
    v_smfmac_f32_16x16x64_bf16 v[68:71], v[44:47], a[56:63], v13
    s_mov_b32 m0, s75
    s_xor_b32 s75, s75, 8192
    buffer_load_dwordx4 v12, s[4:7], s71 offen sc1 lds
    s_waitcnt lgkmcnt(3)
    v_smfmac_f32_16x16x64_bf16 v[64:67], v[48:51], a[64:71], v13
    buffer_load_dwordx4 v12, s[4:7], s71 offen offset:1024 sc1 lds
    v_smfmac_f32_16x16x64_bf16 v[68:71], v[48:51], a[72:79], v13
    s_waitcnt lgkmcnt(2)
    v_smfmac_f32_16x16x64_bf16 v[64:67], v[52:55], a[80:87], v13
    v_smfmac_f32_16x16x64_bf16 v[68:71], v[52:55], a[88:95], v13
    s_waitcnt lgkmcnt(0)
    v_smfmac_f32_16x16x64_bf16 v[64:67], v[56:59], a[96:103], v13
    ds_read_b128 v[88:91], v5 offset:0
    v_smfmac_f32_16x16x64_bf16 v[68:71], v[56:59], a[104:111], v13
    ds_read_b128 v[92:95], v5 offset:256
    v_smfmac_f32_16x16x64_bf16 v[64:67], v[60:63], a[112:119], v13
    ds_read_b128 v[120:123], v5 offset:2048
    v_smfmac_f32_16x16x64_bf16 v[68:71], v[60:63], a[120:127], v13
    ds_read_b128 v[124:127], v5 offset:2304
    v_smfmac_f32_16x16x64_bf16 v[72:75], v[40:43], a[160:167], v13
    s_nop 1
    v_smfmac_f32_16x16x64_bf16 v[76:79], v[40:43], a[168:175], v13
    s_nop 1
    v_smfmac_f32_16x16x64_bf16 v[72:75], v[44:47], a[176:183], v13
    s_waitcnt vmcnt(4)
    v_smfmac_f32_16x16x64_bf16 v[76:79], v[44:47], a[184:191], v13
    v_permlane32_swap_b32 v64, v68
    v_smfmac_f32_16x16x64_bf16 v[72:75], v[48:51], a[192:199], v13
    v_permlane32_swap_b32 v65, v69
    v_smfmac_f32_16x16x64_bf16 v[76:79], v[48:51], a[200:207], v13
    v_permlane32_swap_b32 v66, v70
    v_smfmac_f32_16x16x64_bf16 v[72:75], v[52:55], a[208:215], v13
    v_permlane32_swap_b32 v67, v71
    v_smfmac_f32_16x16x64_bf16 v[76:79], v[52:55], a[216:223], v13
    v_add_f32 v64, v64, v68
    v_smfmac_f32_16x16x64_bf16 v[72:75], v[56:59], a[224:231], v13
    v_add_f32 v65, v65, v69
    v_smfmac_f32_16x16x64_bf16 v[76:79], v[56:59], a[232:239], v13
    v_add_f32 v66, v66, v70
    v_smfmac_f32_16x16x64_bf16 v[72:75], v[60:63], a[240:247], v13
    v_add_f32 v67, v67, v71
    v_smfmac_f32_16x16x64_bf16 v[76:79], v[60:63], a[248:255], v13
    v_cvt_pk_bf16_f32 v108, v64, v65
    v_smfmac_f32_16x16x64_bf16 v[80:83], v[40:43], v[160:167], v13
    v_cvt_pk_bf16_f32 v109, v66, v67
    s_nop 0
    v_smfmac_f32_16x16x64_bf16 v[84:87], v[40:43], v[168:175], v13
    ds_write_b64 v3, v[108:109]
    s_nop 0
    v_smfmac_f32_16x16x64_bf16 v[80:83], v[44:47], v[176:183], v13
    s_nop 0
    v_permlane32_swap_b32 v72, v76
    v_permlane32_swap_b32 v73, v77
    v_permlane32_swap_b32 v74, v78
    v_permlane32_swap_b32 v75, v79
    v_add_f32 v72, v72, v76
    v_add_f32 v73, v73, v77
    v_add_f32 v74, v74, v78
    v_add_f32 v75, v75, v79
    v_cvt_pk_bf16_f32 v110, v72, v73
    v_cvt_pk_bf16_f32 v111, v74, v75
    ds_write_b64 v3, v[110:111] offset:2048
    v_smfmac_f32_16x16x64_bf16 v[84:87], v[44:47], v[184:191], v13
    v_smfmac_f32_16x16x64_bf16 v[80:83], v[48:51], v[192:199], v13
    ds_read_b128 v[40:43], v5 offset:4096
    v_smfmac_f32_16x16x64_bf16 v[84:87], v[48:51], v[200:207], v13
    ds_read_b128 v[44:47], v5 offset:4352
    v_smfmac_f32_16x16x64_bf16 v[80:83], v[52:55], v[208:215], v13
    s_waitcnt lgkmcnt(2)
    s_barrier
    v_smfmac_f32_16x16x64_bf16 v[84:87], v[52:55], v[216:223], v13
    ds_read_b64_tr_b16 v[64:65], v4 offset:0
    ds_read_b64_tr_b16 v[66:67], v4 offset:256
    v_smfmac_f32_16x16x64_bf16 v[80:83], v[56:59], v[224:231], v13
    ds_read_b64_tr_b16 v[68:69], v4 offset:2048
    ds_read_b64_tr_b16 v[70:71], v4 offset:2304
    v_smfmac_f32_16x16x64_bf16 v[84:87], v[56:59], v[232:239], v13
    ds_read_b64_tr_b16 v[72:73], v4 offset:512
    ds_read_b64_tr_b16 v[74:75], v4 offset:768
    v_smfmac_f32_16x16x64_bf16 v[80:83], v[60:63], v[240:247], v13
    ds_read_b64_tr_b16 v[76:77], v4 offset:2560
    ds_read_b64_tr_b16 v[78:79], v4 offset:2816
    v_smfmac_f32_16x16x64_bf16 v[84:87], v[60:63], v[248:255], v13
    ds_read_b64_tr_b16 v[32:33], v4 offset:1024
    ds_read_b64_tr_b16 v[34:35], v4 offset:1280
    s_waitcnt lgkmcnt(6)
    v_mfma_f32_16x16x32_bf16 v[100:103], v[88:91], v[64:67], 0
    ds_read_b64_tr_b16 v[36:37], v4 offset:3072
    ds_read_b64_tr_b16 v[38:39], v4 offset:3328
    v_mfma_f32_16x16x32_bf16 v[104:107], v[92:95], v[64:67], 0
    ds_read_b128 v[48:51], v5 offset:6144
    v_add_u32 v26, s82, v4
    v_mfma_f32_16x16x32_bf16 v[96:99], v[68:71], v[64:67], 0
    ds_read_b128 v[52:55], v5 offset:6400
    s_waitcnt lgkmcnt(6)
    v_mfma_f32_16x16x32_bf16 v[100:103], v[120:123], v[72:75], v[100:103]
    ds_read_b64_tr_b16 v[56:57], v4 offset:1536
    ds_read_b64_tr_b16 v[58:59], v4 offset:1792
    v_mfma_f32_16x16x32_bf16 v[104:107], v[124:127], v[72:75], v[104:107]
    ds_read_b64_tr_b16 v[60:61], v4 offset:3584
    ds_read_b64_tr_b16 v[62:63], v4 offset:3840
    v_mfma_f32_16x16x32_bf16 v[96:99], v[76:79], v[72:75], v[96:99]
    v_cvt_pk_bf16_f32 v88, v80, v81
    v_cvt_pk_bf16_f32 v89, v82, v83
    s_waitcnt lgkmcnt(6)
    v_mfma_f32_16x16x32_bf16 v[100:103], v[40:43], v[32:35], v[100:103]
    ds_read_b64_tr_b16 v[16:17], v26 offset:0
    ds_read_b64_tr_b16 v[18:19], v26 offset:256
    v_cvt_pk_bf16_f32 v90, v84, v85
    v_cvt_pk_bf16_f32 v91, v86, v87
    v_mfma_f32_16x16x32_bf16 v[104:107], v[44:47], v[32:35], v[104:107]
    v_permlane32_swap_b32 v80, v84
    v_mfma_f32_16x16x32_bf16 v[96:99], v[36:39], v[32:35], v[96:99]
    v_permlane32_swap_b32 v81, v85
    s_waitcnt lgkmcnt(2)
    v_mfma_f32_16x16x32_bf16 v[100:103], v[48:51], v[56:59], v[100:103]
    v_permlane32_swap_b32 v82, v86
    v_mfma_f32_16x16x32_bf16 v[104:107], v[52:55], v[56:59], v[104:107]
    v_permlane32_swap_b32 v83, v87
    v_mfma_f32_16x16x32_bf16 v[96:99], v[60:63], v[56:59], v[96:99]
    v_add_f32 v80, v80, v84
    v_add_f32 v81, v81, v85
    v_add_f32 v82, v82, v86
    v_add_f32 v83, v83, v87
    v_cvt_pk_bf16_f32 v24, v80, v81
    v_cvt_pk_bf16_f32 v25, v82, v83
    s_waitcnt lgkmcnt(0)
    buffer_store_dwordx2 v[24:25], v11, s[4:7], s72 offen offset:2048 sc1
    buffer_store_dwordx4 v[16:19], v6, s[4:7], s83 offen sc1
    s_cmp_eq_u32 s67, 63
    s_cbranch_scc1 L_ch_fin
    ds_read_b128 v[64:67], v7 offset:8192
    ds_read_b128 v[68:71], v7 offset:9216
    v_max3_f32 v30, v100, v101, v102
    v_max3_f32 v27, v103, v104, v105
    v_max3_f32 v30, v30, v106, v107
    v_max3_f32 v27, v27, v96, v97
    v_max3_f32 v30, v30, v98, v99
    v_max_f32 v30, v30, v27
    v_mov_b32 v27, v30
    ds_read_b128 v[32:35], v7 offset:0
    ds_read_b128 v[36:39], v7 offset:1024
    v_permlane32_swap_b32 v27, v30
    v_max_f32 v30, v30, v27
    v_mov_b32 v27, v30
    ds_read_b128 v[40:43], v7 offset:2048
    ds_read_b128 v[44:47], v7 offset:3072
    v_permlane16_swap_b32 v27, v30
    v_max_f32 v30, v30, v27
    v_mul_f32 v30, s84, v30
    v_pk_fma_f32 v[100:101], v[100:101], s[84:85], v[30:31] op_sel_hi:[1,1,0] neg_lo:[0,0,1] neg_hi:[0,0,1]
    v_pk_fma_f32 v[102:103], v[102:103], s[84:85], v[30:31] op_sel_hi:[1,1,0] neg_lo:[0,0,1] neg_hi:[0,0,1]
    v_pk_fma_f32 v[104:105], v[104:105], s[84:85], v[30:31] op_sel_hi:[1,1,0] neg_lo:[0,0,1] neg_hi:[0,0,1]
    v_pk_fma_f32 v[106:107], v[106:107], s[84:85], v[30:31] op_sel_hi:[1,1,0] neg_lo:[0,0,1] neg_hi:[0,0,1]
    v_exp_f32 v100, v100
    v_exp_f32 v101, v101
    v_exp_f32 v102, v102
    v_exp_f32 v103, v103
    v_exp_f32 v104, v104
    v_exp_f32 v105, v105
    v_exp_f32 v106, v106
    v_exp_f32 v107, v107
    v_pk_fma_f32 v[96:97], v[96:97], s[84:85], v[30:31] op_sel_hi:[1,1,0] neg_lo:[0,0,1] neg_hi:[0,0,1]
    v_pk_fma_f32 v[98:99], v[98:99], s[84:85], v[30:31] op_sel_hi:[1,1,0] neg_lo:[0,0,1] neg_hi:[0,0,1]
    v_cvt_pk_bf16_f32 v108, v100, v101
    v_cvt_pk_bf16_f32 v109, v102, v103
    v_cvt_pk_bf16_f32 v110, v104, v105
    v_cvt_pk_bf16_f32 v111, v106, v107
    v_exp_f32 v96, v96
    s_waitcnt vmcnt(4)
    v_mfma_f32_16x16x32_bf16 v[120:123], v[112:115], v[108:111], 0
    ds_read_b128 v[48:51], v7 offset:4096
    v_exp_f32 v97, v97
    v_mfma_f32_16x16x32_bf16 v[124:127], v[116:119], v[108:111], 0
    ds_read_b128 v[52:55], v7 offset:5120
    v_exp_f32 v98, v98
    v_mfma_f32_16x16x16_bf16 v[100:103], v[28:29], v[108:109], 0
    ds_read_b128 v[56:59], v7 offset:6144
    v_exp_f32 v99, v99
    v_mfma_f32_16x16x16_bf16 v[100:103], v[28:29], v[110:111], v[100:103]
    ds_read_b128 v[60:63], v7 offset:7168
    v_cvt_pk_bf16_f32 v96, v96, v97
    v_cvt_pk_bf16_f32 v97, v98, v99
    s_nop 1
    v_mfma_f32_16x16x16_bf16 v[100:103], v[14:15], v[96:97], v[100:103]
    ds_read_b128 v[72:75], v7 offset:10240
    v_mfma_f32_16x16x16_bf16 v[120:123], v[88:89], v[96:97], v[120:123]
    ds_read_b128 v[76:79], v7 offset:11264
    v_mfma_f32_16x16x16_bf16 v[124:127], v[90:91], v[96:97], v[124:127]
    ds_read_b128 v[80:83], v7 offset:16384
    ds_read_b128 v[84:87], v7 offset:17408
    v_mov_b64 v[96:97], 0
    v_mov_b64 v[98:99], 0
    v_mov_b64 v[104:105], 0
    v_rcp_f32 v26, v100
    v_mov_b64 v[106:107], 0
    v_mov_b64 v[108:109], 0
    v_mov_b64 v[110:111], 0
    v_pk_mul_f32 v[120:121], v[120:121], v[26:27] op_sel_hi:[1,0]
    v_pk_mul_f32 v[122:123], v[122:123], v[26:27] op_sel_hi:[1,0]
    v_pk_mul_f32 v[124:125], v[124:125], v[26:27] op_sel_hi:[1,0]
    v_pk_mul_f32 v[126:127], v[126:127], v[26:27] op_sel_hi:[1,0]
    v_cvt_pk_bf16_f32 v120, v120, v121
    v_cvt_pk_bf16_f32 v121, v122, v123
    v_cvt_pk_bf16_f32 v122, v124, v125
    v_cvt_pk_bf16_f32 v123, v126, v127
    ds_write_b128 v6, v[120:123]
    ds_read_b128 v[88:91], v7 offset:18432
    ds_read_b128 v[92:95], v7 offset:19456
    v_mov_b64 v[100:101], 0
    v_mov_b64 v[102:103], 0
    s_waitcnt lgkmcnt(7)
    v_smfmac_f32_16x16x64_bf16 v[96:99], v[120:123], v[32:39], v13
    ds_read_b128 v[32:35], v7 offset:24576
    ds_read_b128 v[36:39], v7 offset:25600
    v_xor_b32 v26, 512, v6
    v_smfmac_f32_16x16x64_bf16 v[100:103], v[120:123], v[40:47], v13
    ds_read_b128 v[40:43], v7 offset:26624
    ds_read_b128 v[44:47], v7 offset:27648
    v_xor_b32 v27, 1024, v6
    v_smfmac_f32_16x16x64_bf16 v[104:107], v[120:123], v[48:55], v13
    v_xor_b32 v30, 1536, v6
    v_smfmac_f32_16x16x64_bf16 v[108:111], v[120:123], v[56:63], v13
    s_waitcnt lgkmcnt(6)
    s_barrier
    ds_read_b128 v[112:115], v26
    ds_read_b128 v[116:119], v27
    ds_read_b128 v[124:127], v30
    ds_read_b128 v[48:51], v7 offset:12288
    ds_read_b128 v[52:55], v7 offset:13312
    ds_read_b128 v[56:59], v7 offset:14336
    ds_read_b128 v[60:63], v7 offset:15360
    s_add_u32 s73, s73, 16384
    s_waitcnt lgkmcnt(6)
    v_smfmac_f32_16x16x64_bf16 v[96:99], v[112:115], v[64:71], v13
    ds_read_b128 v[64:67], v7 offset:20480
    s_waitcnt lgkmcnt(7)
    v_smfmac_f32_16x16x64_bf16 v[100:103], v[112:115], v[72:79], v13
    ds_read_b128 v[68:71], v7 offset:21504
    s_waitcnt lgkmcnt(7)
    v_smfmac_f32_16x16x64_bf16 v[96:99], v[116:119], v[80:87], v13
    ds_read_b128 v[72:75], v7 offset:22528
    s_waitcnt lgkmcnt(8)
    v_smfmac_f32_16x16x64_bf16 v[100:103], v[116:119], v[88:95], v13
    ds_read_b128 v[76:79], v7 offset:23552
    ds_read_b128 v[80:83], v7 offset:28672
    s_waitcnt lgkmcnt(9)
    v_smfmac_f32_16x16x64_bf16 v[96:99], v[124:127], v[32:39], v13
    ds_read_b128 v[84:87], v7 offset:29696
    s_waitcnt lgkmcnt(10)
    v_smfmac_f32_16x16x64_bf16 v[100:103], v[124:127], v[40:47], v13
    ds_read_b128 v[88:91], v7 offset:30720
    s_waitcnt lgkmcnt(9)
    v_smfmac_f32_16x16x64_bf16 v[104:107], v[112:115], v[48:55], v13
    ds_read_b128 v[92:95], v7 offset:31744
    s_waitcnt lgkmcnt(8)
    v_smfmac_f32_16x16x64_bf16 v[108:111], v[112:115], v[56:63], v13
    s_waitcnt lgkmcnt(6)
    v_smfmac_f32_16x16x64_bf16 v[104:107], v[116:119], v[64:71], v13
    v_cvt_pk_bf16_f32 v96, v96, v97
    v_cvt_pk_bf16_f32 v97, v98, v99
    v_cvt_pk_bf16_f32 v98, v100, v101
    s_waitcnt lgkmcnt(4)
    v_smfmac_f32_16x16x64_bf16 v[108:111], v[116:119], v[72:79], v13
    v_cvt_pk_bf16_f32 v99, v102, v103
    v_bfi_b32 v96, 1, s66, v96
    v_bfi_b32 v97, 1, s66, v97
    s_waitcnt lgkmcnt(2)
    v_smfmac_f32_16x16x64_bf16 v[104:107], v[124:127], v[80:87], v13
    v_bfi_b32 v98, 1, s66, v98
    v_bfi_b32 v99, 1, s66, v99
    buffer_store_dwordx4 v[96:99], v9, s[4:7], s70 offen
    s_waitcnt lgkmcnt(0)
    v_smfmac_f32_16x16x64_bf16 v[108:111], v[124:127], v[88:95], v13
    s_nop 2
    v_cvt_pk_bf16_f32 v104, v104, v105
    v_cvt_pk_bf16_f32 v105, v106, v107
    s_nop 2
    v_cvt_pk_bf16_f32 v106, v108, v109
    v_cvt_pk_bf16_f32 v107, v110, v111
    v_bfi_b32 v104, 1, s66, v104
    v_bfi_b32 v105, 1, s66, v105
    v_bfi_b32 v106, 1, s66, v106
    v_bfi_b32 v107, 1, s66, v107
    buffer_store_dwordx4 v[104:107], v9, s[4:7], s78 offen
    s_add_u32 s77, s80, s69
    s_add_u32 s69, s69, 8192
    s_cmp_eq_u32 s69, 24576
    s_cselect_b32 s69, 0, s69
    s_add_u32 s76, s68, s69
    s_add_u32 s23, s80, s69
    s_add_u32 s67, s67, 1
    s_add_u32 s72, s72, 131072
    s_add_u32 s83, s83, 131072
    v_xor_b32 v5, 8192, v5
    v_mov_b32 v96, -1
    v_mov_b64 v[64:65], 0
    v_mov_b64 v[66:67], 0
    v_mov_b64 v[68:69], 0
    v_mov_b64 v[70:71], 0
    v_mov_b64 v[72:73], 0
    v_mov_b64 v[74:75], 0
    v_mov_b64 v[76:77], 0
    v_mov_b64 v[78:79], 0
    v_mov_b64 v[80:81], 0
    v_mov_b64 v[82:83], 0
    v_mov_b64 v[84:85], 0
    v_mov_b64 v[86:87], 0
    v_xor_b32 v26, 2048, v2
    v_xor_b32 v27, 4096, v2
    v_xor_b32 v30, 6144, v2
    s_mov_b32 s27, 0
    s_nop 15
    s_nop 15
    s_nop 15
    s_nop 7
    buffer_load_dwordx4 v[48:51], v1, s[4:7], s81 offen sc1
    buffer_load_dwordx4 v[52:55], v1, s[4:7], s81 offen offset:1024 sc1
    s_waitcnt vmcnt(4)
    s_atomic_add s3, s[58:59], s74
    s_add_u32 s74, s74, 16384
    s_nop 15
    s_nop 15
    s_nop 7
L_ch_p1_fast:
    buffer_load_dwordx4 v[56:59], v1, s[4:7], s81 offen sc1
    buffer_load_dwordx4 v[60:63], v1, s[4:7], s81 offen offset:1024 sc1
    s_waitcnt vmcnt(3)
    v_mfma_f32_16x16x32_bf16 v[40:43], v[20:23], v[48:51], 0
    s_waitcnt vmcnt(2)
    v_mfma_f32_16x16x32_bf16 v[40:43], v[20:23], v[52:55], v[40:43]
    v_bitop3_b32 v44, v48, v49, s66 bitop3:0x7e
    v_bitop3_b32 v45, v50, v51, s66 bitop3:0x7e
    v_bitop3_b32 v46, v52, v53, s66 bitop3:0x7e
    v_bitop3_b32 v47, v54, v55, s66 bitop3:0x7e
    v_or3_b32 v44, v44, v45, v46
    v_bitop3_b32 v44, v44, v47, 1 bitop3:0xa8
    v_cmp_ne_u32 vcc, 0, v44
    s_cbranch_vccnz L_ch_nan_fast
L_ch_pub_fast:
    s_load_dwordx4 s[8:11], s[58:59], s73 glc
    v_add_f32_dpp v42, v40, v40 row_ror:8 row_mask:0xf bank_mask:0xf
    v_add_f32_dpp v43, v41, v41 row_ror:8 row_mask:0xf bank_mask:0xf
    s_nop 0
    v_add_f32_dpp v40, v42, v42 row_ror:4 row_mask:0xf bank_mask:0xf
    v_add_f32_dpp v41, v43, v43 row_ror:4 row_mask:0xf bank_mask:0xf
    v_cvt_pk_bf16_f32 v40, v40, v41
    s_mov_b32 exec_lo, 0x000f000f
    s_mov_b32 exec_hi, 0x000f000f
    buffer_store_dword v40, v8, s[4:7], s23 offen
    buffer_store_dword v96, v8, s[4:7], s77 offen
    s_mov_b64 exec, -1
    s_xor_b32 s66, s66, 1
    s_branch L_ch_loop_fast
L_ch_nan_fast:
    buffer_load_dwordx4 v[48:51], v1, s[4:7], s81 offen sc1
    buffer_load_dwordx4 v[52:55], v1, s[4:7], s81 offen offset:1024 sc1
    s_add_u32 s27, s27, 1
    s_cmp_gt_u32 s27, 262144
    s_cbranch_scc1 L_end
    s_waitcnt vmcnt(3)
    v_mfma_f32_16x16x32_bf16 v[40:43], v[20:23], v[56:59], 0
    s_waitcnt vmcnt(2)
    v_mfma_f32_16x16x32_bf16 v[40:43], v[20:23], v[60:63], v[40:43]
    v_bitop3_b32 v44, v56, v57, s66 bitop3:0x7e
    v_bitop3_b32 v45, v58, v59, s66 bitop3:0x7e
    v_bitop3_b32 v46, v60, v61, s66 bitop3:0x7e
    v_bitop3_b32 v47, v62, v63, s66 bitop3:0x7e
    v_or3_b32 v44, v44, v45, v46
    v_bitop3_b32 v44, v44, v47, 1 bitop3:0xa8
    v_cmp_ne_u32 vcc, 0, v44
    s_cbranch_vccnz L_ch_p1_fast
    s_branch L_ch_pub_fast
L_ch_nan_fastr:
    s_add_u32 s27, s27, 1
    s_cmp_gt_u32 s27, 262144
    s_cbranch_scc1 L_end
    s_branch L_ch_p1_fast
L_ch_nan_fasts:
    buffer_load_dwordx4 v[48:51], v1, s[4:7], s81 offen sc1
    buffer_load_dwordx4 v[52:55], v1, s[4:7], s81 offen offset:1024 sc1
    s_add_u32 s27, s27, 1
    s_cmp_gt_u32 s27, 262144
    s_cbranch_scc1 L_end
    s_branch L_ch_p1_fast
L_ch_p2s_fast:
    buffer_load_dwordx4 v[32:35], v1, s[4:7], s76 offen sc1
    buffer_load_dwordx4 v[36:39], v1, s[4:7], s76 offen offset:1024 sc1
    s_add_u32 s27, s27, 1
    s_cmp_gt_u32 s27, 262144
    s_cbranch_scc1 L_end
    s_branch L_ch_p2_fast
L_ch_p2z_fast:
    v_mov_b64 v[64:65], 0
    v_mov_b64 v[66:67], 0
    v_mov_b64 v[68:69], 0
    v_mov_b64 v[70:71], 0
    v_mov_b64 v[72:73], 0
    v_mov_b64 v[74:75], 0
    v_mov_b64 v[76:77], 0
    v_mov_b64 v[78:79], 0
    v_mov_b64 v[80:81], 0
    v_mov_b64 v[82:83], 0
    v_mov_b64 v[84:85], 0
    v_mov_b64 v[86:87], 0
L_ch_p2b_fast:
    buffer_load_dwordx4 v[104:107], v1, s[4:7], s76 offen sc1
    buffer_load_dwordx4 v[108:111], v1, s[4:7], s76 offen offset:1024 sc1
    s_add_u32 s27, s27, 1
    s_cmp_gt_u32 s27, 262144
    s_cbranch_scc1 L_end
    s_waitcnt vmcnt(3)
    v_max3_u32 v40, v96, v97, v98
    s_waitcnt vmcnt(2)
    v_max3_u32 v41, v99, v100, v101
    v_max3_u32 v40, v40, v102, v103
    v_max_u32 v40, v40, v41
    v_cmp_eq_u32 vcc, -1, v40
    s_cbranch_vccnz L_ch_p2c_fast
    v_mov_b64 v[32:33], v[96:97]
    v_mov_b64 v[34:35], v[98:99]
    v_mov_b64 v[36:37], v[100:101]
    v_mov_b64 v[38:39], v[102:103]
    s_branch L_ch_entry_fast
L_ch_p2c_fast:
    buffer_load_dwordx4 v[96:99], v1, s[4:7], s76 offen sc1
    buffer_load_dwordx4 v[100:103], v1, s[4:7], s76 offen offset:1024 sc1
    s_waitcnt vmcnt(3)
    v_max3_u32 v40, v104, v105, v106
    s_waitcnt vmcnt(2)
    v_max3_u32 v41, v107, v108, v109
    v_max3_u32 v40, v40, v110, v111
    v_max_u32 v40, v40, v41
    v_cmp_eq_u32 vcc, -1, v40
    s_cbranch_vccnz L_ch_p2b_fast
    v_mov_b64 v[32:33], v[104:105]
    v_mov_b64 v[34:35], v[106:107]
    v_mov_b64 v[36:37], v[108:109]
    v_mov_b64 v[38:39], v[110:111]
    s_branch L_ch_entry_fast
L_ch_kvwait_fast:
    s_cmp_ge_u32 s67, 62
    s_cbranch_scc1 L_ch_kvok_fast
    s_waitcnt vmcnt(0)
    v_bfe_u32 v109, v1, 2, 4
    v_and_b32 v109, 12, v109
    s_mov_b32 s27, 0
L_poll_36:
    buffer_load_dword v108, v109, s[4:7], s73 offen sc1
    s_add_u32 s27, s27, 1
    s_cmp_gt_u32 s27, 262144
    s_cbranch_scc1 L_end
    s_waitcnt vmcnt(0)
    v_cmp_gt_u32 vcc, 1, v108
    s_cbranch_vccz L_poll_36_ok
    s_sleep 4
    s_branch L_poll_36
L_poll_36_ok:
    s_branch L_ch_kvok_fast
L_ch_loop_slow:
    s_mov_b32 s27, 0
    s_nop 15
    s_nop 15
    s_nop 15
    s_nop 1
    buffer_load_dwordx4 v[32:35], v1, s[4:7], s76 offen sc1
    buffer_load_dwordx4 v[36:39], v1, s[4:7], s76 offen offset:1024 sc1
    s_nop 15
    s_nop 15
    s_nop 7
L_ch_p2_slow:
    buffer_load_dwordx4 v[96:99], v1, s[4:7], s76 offen sc1
    buffer_load_dwordx4 v[100:103], v1, s[4:7], s76 offen offset:1024 sc1
    s_waitcnt vmcnt(3)
    v_max3_u32 v40, v32, v33, v34
    s_waitcnt vmcnt(2)
    v_max3_u32 v41, v35, v36, v37
    v_max3_u32 v40, v40, v38, v39
    v_max_u32 v40, v40, v41
    v_cmp_eq_u32 vcc, -1, v40
    s_cbranch_vccnz L_ch_p2b_slow
L_ch_entry_slow:
    ds_write_b128 v2, v[32:35]
    ds_write_b128 v2, v[36:39] offset:1024
    v_smfmac_f32_16x16x64_bf16 v[64:67], v[32:35], a[0:7], v13
    v_smfmac_f32_16x16x64_bf16 v[68:71], v[32:35], a[8:15], v13
    v_smfmac_f32_16x16x64_bf16 v[72:75], v[32:35], a[128:135], v13
    buffer_load_dwordx4 v[112:115], v10, s[4:7], s71 offen sc1
    v_smfmac_f32_16x16x64_bf16 v[76:79], v[32:35], a[136:143], v13
    buffer_load_dwordx4 v[116:119], v10, s[4:7], s71 offen offset:256 sc1
    v_smfmac_f32_16x16x64_bf16 v[80:83], v[32:35], v[128:135], v13
    v_smfmac_f32_16x16x64_bf16 v[84:87], v[32:35], v[136:143], v13
    s_waitcnt lgkmcnt(0)
    s_barrier
L_ch_b1_slow:
    v_smfmac_f32_16x16x64_bf16 v[64:67], v[36:39], a[16:23], v13
    ds_read_b128 v[40:43], v26 offset:0
    v_smfmac_f32_16x16x64_bf16 v[68:71], v[36:39], a[24:31], v13
    ds_read_b128 v[44:47], v26 offset:1024
    v_smfmac_f32_16x16x64_bf16 v[72:75], v[36:39], a[144:151], v13
    ds_read_b128 v[48:51], v27 offset:0
    v_smfmac_f32_16x16x64_bf16 v[76:79], v[36:39], a[152:159], v13
    ds_read_b128 v[52:55], v27 offset:1024
    v_smfmac_f32_16x16x64_bf16 v[80:83], v[36:39], v[144:151], v13
    ds_read_b128 v[56:59], v30 offset:0
    v_smfmac_f32_16x16x64_bf16 v[84:87], v[36:39], v[152:159], v13
    ds_read_b128 v[60:63], v30 offset:1024
L_ch_q_slow:
    s_waitcnt lgkmcnt(5)
    v_smfmac_f32_16x16x64_bf16 v[64:67], v[40:43], a[32:39], v13
    s_add_u32 s71, s71, 786432
    v_smfmac_f32_16x16x64_bf16 v[68:71], v[40:43], a[40:47], v13
    s_and_b32 s8, s8, s9
    s_and_b32 s10, s10, s11
    s_waitcnt lgkmcnt(4)
    v_smfmac_f32_16x16x64_bf16 v[64:67], v[44:47], a[48:55], v13
    s_and_b32 s8, s8, s10
    s_cbranch_scc0 L_ch_kvwait_slow
L_ch_kvok_slow:
    v_smfmac_f32_16x16x64_bf16 v[68:71], v[44:47], a[56:63], v13
    s_mov_b32 m0, s75
    s_xor_b32 s75, s75, 8192
    buffer_load_dwordx4 v12, s[4:7], s71 offen sc1 lds
    s_waitcnt lgkmcnt(3)
    v_smfmac_f32_16x16x64_bf16 v[64:67], v[48:51], a[64:71], v13
    buffer_load_dwordx4 v12, s[4:7], s71 offen offset:1024 sc1 lds
    v_smfmac_f32_16x16x64_bf16 v[68:71], v[48:51], a[72:79], v13
    s_waitcnt lgkmcnt(2)
    v_smfmac_f32_16x16x64_bf16 v[64:67], v[52:55], a[80:87], v13
    v_smfmac_f32_16x16x64_bf16 v[68:71], v[52:55], a[88:95], v13
    s_waitcnt lgkmcnt(0)
    v_smfmac_f32_16x16x64_bf16 v[64:67], v[56:59], a[96:103], v13
    ds_read_b128 v[88:91], v5 offset:0
    v_smfmac_f32_16x16x64_bf16 v[68:71], v[56:59], a[104:111], v13
    ds_read_b128 v[92:95], v5 offset:256
    v_smfmac_f32_16x16x64_bf16 v[64:67], v[60:63], a[112:119], v13
    ds_read_b128 v[120:123], v5 offset:2048
    v_smfmac_f32_16x16x64_bf16 v[68:71], v[60:63], a[120:127], v13
    ds_read_b128 v[124:127], v5 offset:2304
    v_smfmac_f32_16x16x64_bf16 v[72:75], v[40:43], a[160:167], v13
    s_nop 1
    v_smfmac_f32_16x16x64_bf16 v[76:79], v[40:43], a[168:175], v13
    s_nop 1
    v_smfmac_f32_16x16x64_bf16 v[72:75], v[44:47], a[176:183], v13
    s_waitcnt vmcnt(4)
    v_smfmac_f32_16x16x64_bf16 v[76:79], v[44:47], a[184:191], v13
    v_permlane32_swap_b32 v64, v68
    v_smfmac_f32_16x16x64_bf16 v[72:75], v[48:51], a[192:199], v13
    v_permlane32_swap_b32 v65, v69
    v_smfmac_f32_16x16x64_bf16 v[76:79], v[48:51], a[200:207], v13
    v_permlane32_swap_b32 v66, v70
    v_smfmac_f32_16x16x64_bf16 v[72:75], v[52:55], a[208:215], v13
    v_permlane32_swap_b32 v67, v71
    v_smfmac_f32_16x16x64_bf16 v[76:79], v[52:55], a[216:223], v13
    v_add_f32 v64, v64, v68
    v_smfmac_f32_16x16x64_bf16 v[72:75], v[56:59], a[224:231], v13
    v_add_f32 v65, v65, v69
    v_smfmac_f32_16x16x64_bf16 v[76:79], v[56:59], a[232:239], v13
    v_add_f32 v66, v66, v70
    v_smfmac_f32_16x16x64_bf16 v[72:75], v[60:63], a[240:247], v13
    v_add_f32 v67, v67, v71
    v_smfmac_f32_16x16x64_bf16 v[76:79], v[60:63], a[248:255], v13
    v_cvt_pk_bf16_f32 v108, v64, v65
    v_smfmac_f32_16x16x64_bf16 v[80:83], v[40:43], v[160:167], v13
    v_cvt_pk_bf16_f32 v109, v66, v67
    s_nop 0
    v_smfmac_f32_16x16x64_bf16 v[84:87], v[40:43], v[168:175], v13
    ds_write_b64 v3, v[108:109]
    s_nop 0
    v_smfmac_f32_16x16x64_bf16 v[80:83], v[44:47], v[176:183], v13
    s_nop 0
    v_permlane32_swap_b32 v72, v76
    v_permlane32_swap_b32 v73, v77
    v_permlane32_swap_b32 v74, v78
    v_permlane32_swap_b32 v75, v79
    v_add_f32 v72, v72, v76
    v_add_f32 v73, v73, v77
    v_add_f32 v74, v74, v78
    v_add_f32 v75, v75, v79
    v_cvt_pk_bf16_f32 v110, v72, v73
    v_cvt_pk_bf16_f32 v111, v74, v75
    ds_write_b64 v3, v[110:111] offset:2048
    v_smfmac_f32_16x16x64_bf16 v[84:87], v[44:47], v[184:191], v13
    v_smfmac_f32_16x16x64_bf16 v[80:83], v[48:51], v[192:199], v13
    ds_read_b128 v[40:43], v5 offset:4096
    v_smfmac_f32_16x16x64_bf16 v[84:87], v[48:51], v[200:207], v13
    ds_read_b128 v[44:47], v5 offset:4352
    v_smfmac_f32_16x16x64_bf16 v[80:83], v[52:55], v[208:215], v13
    s_waitcnt lgkmcnt(2)
    s_barrier
    v_smfmac_f32_16x16x64_bf16 v[84:87], v[52:55], v[216:223], v13
    ds_read_b64_tr_b16 v[64:65], v4 offset:0
    ds_read_b64_tr_b16 v[66:67], v4 offset:256
    v_smfmac_f32_16x16x64_bf16 v[80:83], v[56:59], v[224:231], v13
    ds_read_b64_tr_b16 v[68:69], v4 offset:2048
    ds_read_b64_tr_b16 v[70:71], v4 offset:2304
    v_smfmac_f32_16x16x64_bf16 v[84:87], v[56:59], v[232:239], v13
    ds_read_b64_tr_b16 v[72:73], v4 offset:512
    ds_read_b64_tr_b16 v[74:75], v4 offset:768
    v_smfmac_f32_16x16x64_bf16 v[80:83], v[60:63], v[240:247], v13
    ds_read_b64_tr_b16 v[76:77], v4 offset:2560
    ds_read_b64_tr_b16 v[78:79], v4 offset:2816
    v_smfmac_f32_16x16x64_bf16 v[84:87], v[60:63], v[248:255], v13
    ds_read_b64_tr_b16 v[32:33], v4 offset:1024
    ds_read_b64_tr_b16 v[34:35], v4 offset:1280
    s_waitcnt lgkmcnt(6)
    v_mfma_f32_16x16x32_bf16 v[100:103], v[88:91], v[64:67], 0
    ds_read_b64_tr_b16 v[36:37], v4 offset:3072
    ds_read_b64_tr_b16 v[38:39], v4 offset:3328
    v_mfma_f32_16x16x32_bf16 v[104:107], v[92:95], v[64:67], 0
    ds_read_b128 v[48:51], v5 offset:6144
    v_add_u32 v26, s82, v4
    v_mfma_f32_16x16x32_bf16 v[96:99], v[68:71], v[64:67], 0
    ds_read_b128 v[52:55], v5 offset:6400
    s_waitcnt lgkmcnt(6)
    v_mfma_f32_16x16x32_bf16 v[100:103], v[120:123], v[72:75], v[100:103]
    ds_read_b64_tr_b16 v[56:57], v4 offset:1536
    ds_read_b64_tr_b16 v[58:59], v4 offset:1792
    v_mfma_f32_16x16x32_bf16 v[104:107], v[124:127], v[72:75], v[104:107]
    ds_read_b64_tr_b16 v[60:61], v4 offset:3584
    ds_read_b64_tr_b16 v[62:63], v4 offset:3840
    v_mfma_f32_16x16x32_bf16 v[96:99], v[76:79], v[72:75], v[96:99]
    v_cvt_pk_bf16_f32 v88, v80, v81
    v_cvt_pk_bf16_f32 v89, v82, v83
    s_waitcnt lgkmcnt(6)
    v_mfma_f32_16x16x32_bf16 v[100:103], v[40:43], v[32:35], v[100:103]
    ds_read_b64_tr_b16 v[16:17], v26 offset:0
    ds_read_b64_tr_b16 v[18:19], v26 offset:256
    v_cvt_pk_bf16_f32 v90, v84, v85
    v_cvt_pk_bf16_f32 v91, v86, v87
    v_mfma_f32_16x16x32_bf16 v[104:107], v[44:47], v[32:35], v[104:107]
    v_permlane32_swap_b32 v80, v84
    v_mfma_f32_16x16x32_bf16 v[96:99], v[36:39], v[32:35], v[96:99]
    v_permlane32_swap_b32 v81, v85
    s_waitcnt lgkmcnt(2)
    v_mfma_f32_16x16x32_bf16 v[100:103], v[48:51], v[56:59], v[100:103]
    v_permlane32_swap_b32 v82, v86
    v_mfma_f32_16x16x32_bf16 v[104:107], v[52:55], v[56:59], v[104:107]
    v_permlane32_swap_b32 v83, v87
    v_mfma_f32_16x16x32_bf16 v[96:99], v[60:63], v[56:59], v[96:99]
    v_add_f32 v80, v80, v84
    v_add_f32 v81, v81, v85
    v_add_f32 v82, v82, v86
    v_add_f32 v83, v83, v87
    v_cvt_pk_bf16_f32 v24, v80, v81
    v_cvt_pk_bf16_f32 v25, v82, v83
    s_waitcnt lgkmcnt(0)
    buffer_store_dwordx2 v[24:25], v11, s[4:7], s72 offen offset:2048 sc1
    buffer_store_dwordx4 v[16:19], v6, s[4:7], s83 offen sc1
    s_cmp_eq_u32 s67, 63
    s_cbranch_scc1 L_ch_fin
    ds_read_b128 v[64:67], v7 offset:8192
    ds_read_b128 v[68:71], v7 offset:9216
    v_max3_f32 v30, v100, v101, v102
    v_max3_f32 v27, v103, v104, v105
    v_max3_f32 v30, v30, v106, v107
    v_max3_f32 v27, v27, v96, v97
    v_max3_f32 v30, v30, v98, v99
    v_max_f32 v30, v30, v27
    v_mov_b32 v27, v30
    ds_read_b128 v[32:35], v7 offset:0
    ds_read_b128 v[36:39], v7 offset:1024
    v_permlane32_swap_b32 v27, v30
    v_max_f32 v30, v30, v27
    v_mov_b32 v27, v30
    ds_read_b128 v[40:43], v7 offset:2048
    ds_read_b128 v[44:47], v7 offset:3072
    v_permlane16_swap_b32 v27, v30
    v_max_f32 v30, v30, v27
    v_mul_f32 v30, s84, v30
    v_pk_fma_f32 v[100:101], v[100:101], s[84:85], v[30:31] op_sel_hi:[1,1,0] neg_lo:[0,0,1] neg_hi:[0,0,1]
    v_pk_fma_f32 v[102:103], v[102:103], s[84:85], v[30:31] op_sel_hi:[1,1,0] neg_lo:[0,0,1] neg_hi:[0,0,1]
    v_pk_fma_f32 v[104:105], v[104:105], s[84:85], v[30:31] op_sel_hi:[1,1,0] neg_lo:[0,0,1] neg_hi:[0,0,1]
    v_pk_fma_f32 v[106:107], v[106:107], s[84:85], v[30:31] op_sel_hi:[1,1,0] neg_lo:[0,0,1] neg_hi:[0,0,1]
    v_exp_f32 v100, v100
    v_exp_f32 v101, v101
    v_exp_f32 v102, v102
    v_exp_f32 v103, v103
    v_exp_f32 v104, v104
    v_exp_f32 v105, v105
    v_exp_f32 v106, v106
    v_exp_f32 v107, v107
    v_pk_fma_f32 v[96:97], v[96:97], s[84:85], v[30:31] op_sel_hi:[1,1,0] neg_lo:[0,0,1] neg_hi:[0,0,1]
    v_pk_fma_f32 v[98:99], v[98:99], s[84:85], v[30:31] op_sel_hi:[1,1,0] neg_lo:[0,0,1] neg_hi:[0,0,1]
    v_cvt_pk_bf16_f32 v108, v100, v101
    v_cvt_pk_bf16_f32 v109, v102, v103
    v_cvt_pk_bf16_f32 v110, v104, v105
    v_cvt_pk_bf16_f32 v111, v106, v107
    v_exp_f32 v96, v96
    s_waitcnt vmcnt(4)
    v_mfma_f32_16x16x32_bf16 v[120:123], v[112:115], v[108:111], 0
    ds_read_b128 v[48:51], v7 offset:4096
    v_exp_f32 v97, v97
    v_mfma_f32_16x16x32_bf16 v[124:127], v[116:119], v[108:111], 0
    ds_read_b128 v[52:55], v7 offset:5120
    v_exp_f32 v98, v98
    v_mfma_f32_16x16x16_bf16 v[100:103], v[28:29], v[108:109], 0
    ds_read_b128 v[56:59], v7 offset:6144
    v_exp_f32 v99, v99
    v_mfma_f32_16x16x16_bf16 v[100:103], v[28:29], v[110:111], v[100:103]
    ds_read_b128 v[60:63], v7 offset:7168
    v_cvt_pk_bf16_f32 v96, v96, v97
    v_cvt_pk_bf16_f32 v97, v98, v99
    s_nop 1
    v_mfma_f32_16x16x16_bf16 v[100:103], v[14:15], v[96:97], v[100:103]
    ds_read_b128 v[72:75], v7 offset:10240
    v_mfma_f32_16x16x16_bf16 v[120:123], v[88:89], v[96:97], v[120:123]
    ds_read_b128 v[76:79], v7 offset:11264
    v_mfma_f32_16x16x16_bf16 v[124:127], v[90:91], v[96:97], v[124:127]
    ds_read_b128 v[80:83], v7 offset:16384
    ds_read_b128 v[84:87], v7 offset:17408
    v_mov_b64 v[96:97], 0
    v_mov_b64 v[98:99], 0
    v_mov_b64 v[104:105], 0
    v_rcp_f32 v26, v100
    v_mov_b64 v[106:107], 0
    v_mov_b64 v[108:109], 0
    v_mov_b64 v[110:111], 0
    v_pk_mul_f32 v[120:121], v[120:121], v[26:27] op_sel_hi:[1,0]
    v_pk_mul_f32 v[122:123], v[122:123], v[26:27] op_sel_hi:[1,0]
    v_pk_mul_f32 v[124:125], v[124:125], v[26:27] op_sel_hi:[1,0]
    v_pk_mul_f32 v[126:127], v[126:127], v[26:27] op_sel_hi:[1,0]
    v_cvt_pk_bf16_f32 v120, v120, v121
    v_cvt_pk_bf16_f32 v121, v122, v123
    v_cvt_pk_bf16_f32 v122, v124, v125
    v_cvt_pk_bf16_f32 v123, v126, v127
    ds_write_b128 v6, v[120:123]
    ds_read_b128 v[88:91], v7 offset:18432
    ds_read_b128 v[92:95], v7 offset:19456
    v_mov_b64 v[100:101], 0
    v_mov_b64 v[102:103], 0
    s_waitcnt lgkmcnt(7)
    v_smfmac_f32_16x16x64_bf16 v[96:99], v[120:123], v[32:39], v13
    ds_read_b128 v[32:35], v7 offset:24576
    ds_read_b128 v[36:39], v7 offset:25600
    v_xor_b32 v26, 512, v6
    v_smfmac_f32_16x16x64_bf16 v[100:103], v[120:123], v[40:47], v13
    ds_read_b128 v[40:43], v7 offset:26624
    ds_read_b128 v[44:47], v7 offset:27648
    v_xor_b32 v27, 1024, v6
    v_smfmac_f32_16x16x64_bf16 v[104:107], v[120:123], v[48:55], v13
    v_xor_b32 v30, 1536, v6
    v_smfmac_f32_16x16x64_bf16 v[108:111], v[120:123], v[56:63], v13
    s_waitcnt lgkmcnt(6)
    s_barrier
    ds_read_b128 v[112:115], v26
    ds_read_b128 v[116:119], v27
    ds_read_b128 v[124:127], v30
    ds_read_b128 v[48:51], v7 offset:12288
    ds_read_b128 v[52:55], v7 offset:13312
    ds_read_b128 v[56:59], v7 offset:14336
    ds_read_b128 v[60:63], v7 offset:15360
    s_add_u32 s73, s73, 16384
    s_waitcnt lgkmcnt(6)
    v_smfmac_f32_16x16x64_bf16 v[96:99], v[112:115], v[64:71], v13
    ds_read_b128 v[64:67], v7 offset:20480
    s_waitcnt lgkmcnt(7)
    v_smfmac_f32_16x16x64_bf16 v[100:103], v[112:115], v[72:79], v13
    ds_read_b128 v[68:71], v7 offset:21504
    s_waitcnt lgkmcnt(7)
    v_smfmac_f32_16x16x64_bf16 v[96:99], v[116:119], v[80:87], v13
    ds_read_b128 v[72:75], v7 offset:22528
    s_waitcnt lgkmcnt(8)
    v_smfmac_f32_16x16x64_bf16 v[100:103], v[116:119], v[88:95], v13
    ds_read_b128 v[76:79], v7 offset:23552
    ds_read_b128 v[80:83], v7 offset:28672
    s_waitcnt lgkmcnt(9)
    v_smfmac_f32_16x16x64_bf16 v[96:99], v[124:127], v[32:39], v13
    ds_read_b128 v[84:87], v7 offset:29696
    s_waitcnt lgkmcnt(10)
    v_smfmac_f32_16x16x64_bf16 v[100:103], v[124:127], v[40:47], v13
    ds_read_b128 v[88:91], v7 offset:30720
    s_waitcnt lgkmcnt(9)
    v_smfmac_f32_16x16x64_bf16 v[104:107], v[112:115], v[48:55], v13
    ds_read_b128 v[92:95], v7 offset:31744
    s_waitcnt lgkmcnt(8)
    v_smfmac_f32_16x16x64_bf16 v[108:111], v[112:115], v[56:63], v13
    s_waitcnt lgkmcnt(6)
    v_smfmac_f32_16x16x64_bf16 v[104:107], v[116:119], v[64:71], v13
    v_cvt_pk_bf16_f32 v96, v96, v97
    v_cvt_pk_bf16_f32 v97, v98, v99
    v_cvt_pk_bf16_f32 v98, v100, v101
    s_waitcnt lgkmcnt(4)
    v_smfmac_f32_16x16x64_bf16 v[108:111], v[116:119], v[72:79], v13
    v_cvt_pk_bf16_f32 v99, v102, v103
    v_bfi_b32 v96, 1, s66, v96
    v_bfi_b32 v97, 1, s66, v97
    s_waitcnt lgkmcnt(2)
    v_smfmac_f32_16x16x64_bf16 v[104:107], v[124:127], v[80:87], v13
    v_bfi_b32 v98, 1, s66, v98
    v_bfi_b32 v99, 1, s66, v99
    buffer_store_dwordx4 v[96:99], v9, s[4:7], s70 offen sc1
    s_waitcnt lgkmcnt(0)
    v_smfmac_f32_16x16x64_bf16 v[108:111], v[124:127], v[88:95], v13
    s_nop 2
    v_cvt_pk_bf16_f32 v104, v104, v105
    v_cvt_pk_bf16_f32 v105, v106, v107
    s_nop 2
    v_cvt_pk_bf16_f32 v106, v108, v109
    v_cvt_pk_bf16_f32 v107, v110, v111
    v_bfi_b32 v104, 1, s66, v104
    v_bfi_b32 v105, 1, s66, v105
    v_bfi_b32 v106, 1, s66, v106
    v_bfi_b32 v107, 1, s66, v107
    buffer_store_dwordx4 v[104:107], v9, s[4:7], s78 offen sc1
    s_add_u32 s77, s80, s69
    s_add_u32 s69, s69, 8192
    s_cmp_eq_u32 s69, 24576
    s_cselect_b32 s69, 0, s69
    s_add_u32 s76, s68, s69
    s_add_u32 s23, s80, s69
    s_add_u32 s67, s67, 1
    s_add_u32 s72, s72, 131072
    s_add_u32 s83, s83, 131072
    v_xor_b32 v5, 8192, v5
    v_mov_b32 v96, -1
    v_mov_b64 v[64:65], 0
    v_mov_b64 v[66:67], 0
    v_mov_b64 v[68:69], 0
    v_mov_b64 v[70:71], 0
    v_mov_b64 v[72:73], 0
    v_mov_b64 v[74:75], 0
    v_mov_b64 v[76:77], 0
    v_mov_b64 v[78:79], 0
    v_mov_b64 v[80:81], 0
    v_mov_b64 v[82:83], 0
    v_mov_b64 v[84:85], 0
    v_mov_b64 v[86:87], 0
    v_xor_b32 v26, 2048, v2
    v_xor_b32 v27, 4096, v2
    v_xor_b32 v30, 6144, v2
    s_mov_b32 s27, 0
    s_nop 15
    s_nop 15
    s_nop 15
    s_nop 7
    buffer_load_dwordx4 v[48:51], v1, s[4:7], s81 offen sc1
    buffer_load_dwordx4 v[52:55], v1, s[4:7], s81 offen offset:1024 sc1
    s_waitcnt vmcnt(4)
    s_atomic_add s3, s[58:59], s74
    s_add_u32 s74, s74, 16384
    s_nop 15
    s_nop 15
    s_nop 7
L_ch_p1_slow:
    buffer_load_dwordx4 v[56:59], v1, s[4:7], s81 offen sc1
    buffer_load_dwordx4 v[60:63], v1, s[4:7], s81 offen offset:1024 sc1
    s_waitcnt vmcnt(3)
    v_mfma_f32_16x16x32_bf16 v[40:43], v[20:23], v[48:51], 0
    s_waitcnt vmcnt(2)
    v_mfma_f32_16x16x32_bf16 v[40:43], v[20:23], v[52:55], v[40:43]
    v_bitop3_b32 v44, v48, v49, s66 bitop3:0x7e
    v_bitop3_b32 v45, v50, v51, s66 bitop3:0x7e
    v_bitop3_b32 v46, v52, v53, s66 bitop3:0x7e
    v_bitop3_b32 v47, v54, v55, s66 bitop3:0x7e
    v_or3_b32 v44, v44, v45, v46
    v_bitop3_b32 v44, v44, v47, 1 bitop3:0xa8
    v_cmp_ne_u32 vcc, 0, v44
    s_cbranch_vccnz L_ch_nan_slow
L_ch_pub_slow:
    s_load_dwordx4 s[8:11], s[58:59], s73 glc
    v_add_f32_dpp v42, v40, v40 row_ror:8 row_mask:0xf bank_mask:0xf
    v_add_f32_dpp v43, v41, v41 row_ror:8 row_mask:0xf bank_mask:0xf
    s_nop 0
    v_add_f32_dpp v40, v42, v42 row_ror:4 row_mask:0xf bank_mask:0xf
    v_add_f32_dpp v41, v43, v43 row_ror:4 row_mask:0xf bank_mask:0xf
    v_cvt_pk_bf16_f32 v40, v40, v41
    s_mov_b32 exec_lo, 0x000f000f
    s_mov_b32 exec_hi, 0x000f000f
    buffer_store_dword v40, v8, s[4:7], s23 offen sc1
    buffer_store_dword v96, v8, s[4:7], s77 offen sc1
    s_mov_b64 exec, -1
    s_xor_b32 s66, s66, 1
    s_branch L_ch_loop_slow
L_ch_nan_slow:
    buffer_load_dwordx4 v[48:51], v1, s[4:7], s81 offen sc1
    buffer_load_dwordx4 v[52:55], v1, s[4:7], s81 offen offset:1024 sc1
    s_add_u32 s27, s27, 1
    s_cmp_gt_u32 s27, 262144
    s_cbranch_scc1 L_end
    s_waitcnt vmcnt(3)
    v_mfma_f32_16x16x32_bf16 v[40:43], v[20:23], v[56:59], 0
    s_waitcnt vmcnt(2)
    v_mfma_f32_16x16x32_bf16 v[40:43], v[20:23], v[60:63], v[40:43]
    v_bitop3_b32 v44, v56, v57, s66 bitop3:0x7e
    v_bitop3_b32 v45, v58, v59, s66 bitop3:0x7e
    v_bitop3_b32 v46, v60, v61, s66 bitop3:0x7e
    v_bitop3_b32 v47, v62, v63, s66 bitop3:0x7e
    v_or3_b32 v44, v44, v45, v46
    v_bitop3_b32 v44, v44, v47, 1 bitop3:0xa8
    v_cmp_ne_u32 vcc, 0, v44
    s_cbranch_vccnz L_ch_p1_slow
    s_branch L_ch_pub_slow
L_ch_nan_slowr:
    s_add_u32 s27, s27, 1
    s_cmp_gt_u32 s27, 262144
    s_cbranch_scc1 L_end
    s_branch L_ch_p1_slow
L_ch_nan_slows:
    buffer_load_dwordx4 v[48:51], v1, s[4:7], s81 offen sc1
    buffer_load_dwordx4 v[52:55], v1, s[4:7], s81 offen offset:1024 sc1
    s_add_u32 s27, s27, 1
    s_cmp_gt_u32 s27, 262144
    s_cbranch_scc1 L_end
    s_branch L_ch_p1_slow
L_ch_p2s_slow:
    buffer_load_dwordx4 v[32:35], v1, s[4:7], s76 offen sc1
    buffer_load_dwordx4 v[36:39], v1, s[4:7], s76 offen offset:1024 sc1
    s_add_u32 s27, s27, 1
    s_cmp_gt_u32 s27, 262144
    s_cbranch_scc1 L_end
    s_branch L_ch_p2_slow
L_ch_p2z_slow:
    v_mov_b64 v[64:65], 0
    v_mov_b64 v[66:67], 0
    v_mov_b64 v[68:69], 0
    v_mov_b64 v[70:71], 0
    v_mov_b64 v[72:73], 0
    v_mov_b64 v[74:75], 0
    v_mov_b64 v[76:77], 0
    v_mov_b64 v[78:79], 0
    v_mov_b64 v[80:81], 0
    v_mov_b64 v[82:83], 0
    v_mov_b64 v[84:85], 0
    v_mov_b64 v[86:87], 0
L_ch_p2b_slow:
    buffer_load_dwordx4 v[104:107], v1, s[4:7], s76 offen sc1
    buffer_load_dwordx4 v[108:111], v1, s[4:7], s76 offen offset:1024 sc1
    s_add_u32 s27, s27, 1
    s_cmp_gt_u32 s27, 262144
    s_cbranch_scc1 L_end
    s_waitcnt vmcnt(3)
    v_max3_u32 v40, v96, v97, v98
    s_waitcnt vmcnt(2)
    v_max3_u32 v41, v99, v100, v101
    v_max3_u32 v40, v40, v102, v103
    v_max_u32 v40, v40, v41
    v_cmp_eq_u32 vcc, -1, v40
    s_cbranch_vccnz L_ch_p2c_slow
    v_mov_b64 v[32:33], v[96:97]
    v_mov_b64 v[34:35], v[98:99]
    v_mov_b64 v[36:37], v[100:101]
    v_mov_b64 v[38:39], v[102:103]
    s_branch L_ch_entry_slow
L_ch_p2c_slow:
    buffer_load_dwordx4 v[96:99], v1, s[4:7], s76 offen sc1
    buffer_load_dwordx4 v[100:103], v1, s[4:7], s76 offen offset:1024 sc1
    s_waitcnt vmcnt(3)
    v_max3_u32 v40, v104, v105, v106
    s_waitcnt vmcnt(2)
    v_max3_u32 v41, v107, v108, v109
    v_max3_u32 v40, v40, v110, v111
    v_max_u32 v40, v40, v41
    v_cmp_eq_u32 vcc, -1, v40
    s_cbranch_vccnz L_ch_p2b_slow
    v_mov_b64 v[32:33], v[104:105]
    v_mov_b64 v[34:35], v[106:107]
    v_mov_b64 v[36:37], v[108:109]
    v_mov_b64 v[38:39], v[110:111]
    s_branch L_ch_entry_slow
L_ch_kvwait_slow:
    s_cmp_ge_u32 s67, 62
    s_cbranch_scc1 L_ch_kvok_slow
    s_waitcnt vmcnt(0)
    v_bfe_u32 v109, v1, 2, 4
    v_and_b32 v109, 12, v109
    s_mov_b32 s27, 0
L_poll_37:
    buffer_load_dword v108, v109, s[4:7], s73 offen sc1
    s_add_u32 s27, s27, 1
    s_cmp_gt_u32 s27, 262144
    s_cbranch_scc1 L_end
    s_waitcnt vmcnt(0)
    v_cmp_gt_u32 vcc, 1, v108
    s_cbranch_vccz L_poll_37_ok
    s_sleep 4
    s_branch L_poll_37
L_poll_37_ok:
    s_branch L_ch_kvok_slow
L_ch_fin:
    s_waitcnt vmcnt(0)
    s_atomic_add s3, s[58:59], s74
    s_branch L_end
L_role_QKV:
    s_lshr_b32 s64, s25, 1
    s_and_b32 s67, s25, 1
    s_add_u32 s68, s67, 64
    s_mov_b32 s65, 2
    s_mov_b32 s88, 59
    s_mov_b32 s84, 2863312895
    s_mov_b32 s85, 682
    s_cmp_eq_u32 s89, 0
    s_cbranch_scc1 L_qkv_par
    s_mov_b32 s64, s31
    s_cmp_eq_u32 s89, 1
    s_cselect_b32 s67, 24, 34
    s_cselect_b32 s88, 10, 0
    s_mov_b32 s65, 1
    s_mov_b64 s[84:85], -1
L_qkv_par:
    s_lshl_b32 s66, s64, 8
    v_lshrrev_b32 v109, 4, v0
    v_and_b32 v110, 15, v0
    v_lshlrev_b32 v111, 2, v109
    v_xor_b32 v110, v110, v111
    v_mul_u32_u24 v109, 8192, v109
    v_lshl_add_u32 v100, v110, 4, v109
    v_lshrrev_b32 v109, 4, v0
    v_lshlrev_b32 v109, 3, v109
    v_bfe_u32 v112, v0, 2, 2
    v_add_u32 v109, v109, v112
    v_mul_u32_u24 v109, 256, v109
    v_and_b32 v110, 3, v0
    v_lshl_add_u32 v109, v110, 3, v109
    s_mul_i32 s21, s16, 1
    s_add_u32 s21, s21, 0
    v_xor_b32 v110, s21, v112
    v_lshl_add_u32 v101, v110, 6, v109
    v_lshrrev_b32 v109, 4, v0
    v_lshlrev_b32 v109, 3, v109
    v_bfe_u32 v112, v0, 2, 2
    v_add_u32 v109, v109, v112
    v_mul_u32_u24 v109, 256, v109
    v_and_b32 v110, 3, v0
    v_lshl_add_u32 v109, v110, 4, v109
    s_mul_i32 s21, s16, 1
    s_add_u32 s21, s21, 0
    v_xor_b32 v110, s21, v112
    v_lshl_add_u32 v105, v110, 6, v109
    s_lshl_b32 s26, s16, 13
    s_mov_b32 s8, s38
    s_and_b32 s9, s39, 0xffff
    s_mov_b32 s10, 4194304
    s_mov_b32 s11, 0x20000
    s_mul_i32 s22, s16, 262144
    s_add_u32 s22, s22, s66
    s_add_u32 m0, s26, 0
    s_add_u32 s22, s22, 0
    buffer_load_dwordx4 v100, s[8:11], s22 offen lds
    s_add_u32 m0, m0, 1024
    s_add_u32 s22, s22, 32768
    buffer_load_dwordx4 v100, s[8:11], s22 offen lds
    s_add_u32 m0, m0, 1024
    s_add_u32 s22, s22, 32768
    buffer_load_dwordx4 v100, s[8:11], s22 offen lds
    s_add_u32 m0, m0, 1024
    s_add_u32 s22, s22, 32768
    buffer_load_dwordx4 v100, s[8:11], s22 offen lds
    s_add_u32 m0, m0, 1024
    s_add_u32 s22, s22, 32768
    buffer_load_dwordx4 v100, s[8:11], s22 offen lds
    s_add_u32 m0, m0, 1024
    s_add_u32 s22, s22, 32768
    buffer_load_dwordx4 v100, s[8:11], s22 offen lds
    s_add_u32 m0, m0, 1024
    s_add_u32 s22, s22, 32768
    buffer_load_dwordx4 v100, s[8:11], s22 offen lds
    s_add_u32 m0, m0, 1024
    s_add_u32 s22, s22, 32768
    buffer_load_dwordx4 v100, s[8:11], s22 offen lds
    s_cmp_eq_u32 s91, 0
    s_cbranch_scc0 L_arr_38
    s_mov_b32 s91, 1
    s_waitcnt vmcnt(8)
    s_barrier
    s_cmp_eq_u32 s16, 0
    s_cbranch_scc0 L_arr_38
    s_lshl_b32 s21, s17, 5
    s_add_u32 s21, s21, 4
    s_atomic_add s3, s[56:57], s21
L_arr_38:
    s_mul_i32 s22, s16, 262144
    s_add_u32 s22, s22, s66
    s_add_u32 m0, s26, 32768
    s_add_u32 s22, s22, 1048576
    buffer_load_dwordx4 v100, s[8:11], s22 offen lds
    s_add_u32 m0, m0, 1024
    s_add_u32 s22, s22, 32768
    buffer_load_dwordx4 v100, s[8:11], s22 offen lds
    s_add_u32 m0, m0, 1024
    s_add_u32 s22, s22, 32768
    buffer_load_dwordx4 v100, s[8:11], s22 offen lds
    s_add_u32 m0, m0, 1024
    s_add_u32 s22, s22, 32768
    buffer_load_dwordx4 v100, s[8:11], s22 offen lds
    s_add_u32 m0, m0, 1024
    s_add_u32 s22, s22, 32768
    buffer_load_dwordx4 v100, s[8:11], s22 offen lds
    s_add_u32 m0, m0, 1024
    s_add_u32 s22, s22, 32768
    buffer_load_dwordx4 v100, s[8:11], s22 offen lds
    s_add_u32 m0, m0, 1024
    s_add_u32 s22, s22, 32768
    buffer_load_dwordx4 v100, s[8:11], s22 offen lds
    s_add_u32 m0, m0, 1024
    s_add_u32 s22, s22, 32768
    buffer_load_dwordx4 v100, s[8:11], s22 offen lds
    s_mul_i32 s22, s16, 262144
    s_add_u32 s22, s22, s66
    s_add_u32 m0, s26, 65536
    s_add_u32 s22, s22, 2097152
    buffer_load_dwordx4 v100, s[8:11], s22 offen lds
    s_add_u32 m0, m0, 1024
    s_add_u32 s22, s22, 32768
    buffer_load_dwordx4 v100, s[8:11], s22 offen lds
    s_add_u32 m0, m0, 1024
    s_add_u32 s22, s22, 32768
    buffer_load_dwordx4 v100, s[8:11], s22 offen lds
    s_add_u32 m0, m0, 1024
    s_add_u32 s22, s22, 32768
    buffer_load_dwordx4 v100, s[8:11], s22 offen lds
    s_add_u32 m0, m0, 1024
    s_add_u32 s22, s22, 32768
    buffer_load_dwordx4 v100, s[8:11], s22 offen lds
    s_add_u32 m0, m0, 1024
    s_add_u32 s22, s22, 32768
    buffer_load_dwordx4 v100, s[8:11], s22 offen lds
    s_add_u32 m0, m0, 1024
    s_add_u32 s22, s22, 32768
    buffer_load_dwordx4 v100, s[8:11], s22 offen lds
    s_add_u32 m0, m0, 1024
    s_add_u32 s22, s22, 32768
    buffer_load_dwordx4 v100, s[8:11], s22 offen lds
    s_mul_i32 s22, s16, 262144
    s_add_u32 s22, s22, s66
    s_add_u32 m0, s26, 98304
    s_add_u32 s22, s22, 3145728
    buffer_load_dwordx4 v100, s[8:11], s22 offen lds
    s_add_u32 m0, m0, 1024
    s_add_u32 s22, s22, 32768
    buffer_load_dwordx4 v100, s[8:11], s22 offen lds
    s_add_u32 m0, m0, 1024
    s_add_u32 s22, s22, 32768
    buffer_load_dwordx4 v100, s[8:11], s22 offen lds
    s_add_u32 m0, m0, 1024
    s_add_u32 s22, s22, 32768
    buffer_load_dwordx4 v100, s[8:11], s22 offen lds
    s_add_u32 m0, m0, 1024
    s_add_u32 s22, s22, 32768
    buffer_load_dwordx4 v100, s[8:11], s22 offen lds
    s_add_u32 m0, m0, 1024
    s_add_u32 s22, s22, 32768
    buffer_load_dwordx4 v100, s[8:11], s22 offen lds
    s_add_u32 m0, m0, 1024
    s_add_u32 s22, s22, 32768
    buffer_load_dwordx4 v100, s[8:11], s22 offen lds
    s_add_u32 m0, m0, 1024
    s_add_u32 s22, s22, 32768
    buffer_load_dwordx4 v100, s[8:11], s22 offen lds
    s_waitcnt vmcnt(24)
    s_barrier
    s_cmp_eq_u32 s16, 0
    s_cbranch_scc0 L_w_39_1
    ds_read_b64_tr_b16 a[128:129], v105 offset:0
    ds_read_b64_tr_b16 a[130:131], v105 offset:1024
    ds_read_b64_tr_b16 a[136:137], v105 offset:8
    ds_read_b64_tr_b16 a[138:139], v105 offset:1032
    ds_read_b64_tr_b16 a[132:133], v105 offset:8192
    ds_read_b64_tr_b16 a[134:135], v105 offset:9216
    ds_read_b64_tr_b16 a[140:141], v105 offset:8200
    ds_read_b64_tr_b16 a[142:143], v105 offset:9224
    s_waitcnt lgkmcnt(0)
    ds_read_b64_tr_b16 a[144:145], v105 offset:16384
    ds_read_b64_tr_b16 a[146:147], v105 offset:17408
    ds_read_b64_tr_b16 a[152:153], v105 offset:16392
    ds_read_b64_tr_b16 a[154:155], v105 offset:17416
    ds_read_b64_tr_b16 a[148:149], v105 offset:24576
    ds_read_b64_tr_b16 a[150:151], v105 offset:25600
    ds_read_b64_tr_b16 a[156:157], v105 offset:24584
    ds_read_b64_tr_b16 a[158:159], v105 offset:25608
    s_branch L_w_39
L_w_39_1:
    s_cmp_eq_u32 s16, 1
    s_cbranch_scc0 L_w_39_2
    ds_read_b64_tr_b16 a[160:161], v105 offset:0
    ds_read_b64_tr_b16 a[162:163], v105 offset:1024
    ds_read_b64_tr_b16 a[168:169], v105 offset:8
    ds_read_b64_tr_b16 a[170:171], v105 offset:1032
    ds_read_b64_tr_b16 a[164:165], v105 offset:8192
    ds_read_b64_tr_b16 a[166:167], v105 offset:9216
    ds_read_b64_tr_b16 a[172:173], v105 offset:8200
    ds_read_b64_tr_b16 a[174:175], v105 offset:9224
    s_waitcnt lgkmcnt(0)
    ds_read_b64_tr_b16 a[176:177], v105 offset:16384
    ds_read_b64_tr_b16 a[178:179], v105 offset:17408
    ds_read_b64_tr_b16 a[184:185], v105 offset:16392
    ds_read_b64_tr_b16 a[186:187], v105 offset:17416
    ds_read_b64_tr_b16 a[180:181], v105 offset:24576
    ds_read_b64_tr_b16 a[182:183], v105 offset:25600
    ds_read_b64_tr_b16 a[188:189], v105 offset:24584
    ds_read_b64_tr_b16 a[190:191], v105 offset:25608
    s_branch L_w_39
L_w_39_2:
    s_cmp_eq_u32 s16, 2
    s_cbranch_scc0 L_w_39_3
    ds_read_b64_tr_b16 a[192:193], v105 offset:0
    ds_read_b64_tr_b16 a[194:195], v105 offset:1024
    ds_read_b64_tr_b16 a[200:201], v105 offset:8
    ds_read_b64_tr_b16 a[202:203], v105 offset:1032
    ds_read_b64_tr_b16 a[196:197], v105 offset:8192
    ds_read_b64_tr_b16 a[198:199], v105 offset:9216
    ds_read_b64_tr_b16 a[204:205], v105 offset:8200
    ds_read_b64_tr_b16 a[206:207], v105 offset:9224
    s_waitcnt lgkmcnt(0)
    ds_read_b64_tr_b16 a[208:209], v105 offset:16384
    ds_read_b64_tr_b16 a[210:211], v105 offset:17408
    ds_read_b64_tr_b16 a[216:217], v105 offset:16392
    ds_read_b64_tr_b16 a[218:219], v105 offset:17416
    ds_read_b64_tr_b16 a[212:213], v105 offset:24576
    ds_read_b64_tr_b16 a[214:215], v105 offset:25600
    ds_read_b64_tr_b16 a[220:221], v105 offset:24584
    ds_read_b64_tr_b16 a[222:223], v105 offset:25608
    s_branch L_w_39
L_w_39_3:
    ds_read_b64_tr_b16 a[224:225], v105 offset:0
    ds_read_b64_tr_b16 a[226:227], v105 offset:1024
    ds_read_b64_tr_b16 a[232:233], v105 offset:8
    ds_read_b64_tr_b16 a[234:235], v105 offset:1032
    ds_read_b64_tr_b16 a[228:229], v105 offset:8192
    ds_read_b64_tr_b16 a[230:231], v105 offset:9216
    ds_read_b64_tr_b16 a[236:237], v105 offset:8200
    ds_read_b64_tr_b16 a[238:239], v105 offset:9224
    s_waitcnt lgkmcnt(0)
    ds_read_b64_tr_b16 a[240:241], v105 offset:16384
    ds_read_b64_tr_b16 a[242:243], v105 offset:17408
    ds_read_b64_tr_b16 a[248:249], v105 offset:16392
    ds_read_b64_tr_b16 a[250:251], v105 offset:17416
    ds_read_b64_tr_b16 a[244:245], v105 offset:24576
    ds_read_b64_tr_b16 a[246:247], v105 offset:25600
    ds_read_b64_tr_b16 a[252:253], v105 offset:24584
    ds_read_b64_tr_b16 a[254:255], v105 offset:25608
L_w_39:
    s_waitcnt lgkmcnt(0)
    s_waitcnt vmcnt(16)
    s_barrier
    s_mov_b32 s8, s40
    s_and_b32 s9, s41, 0xffff
    s_mov_b32 s10, 4194304
    s_mov_b32 s11, 0x20000
    s_mul_i32 s22, s16, 262144
    s_add_u32 s22, s22, s66
    s_add_u32 m0, s26, 0
    s_add_u32 s22, s22, 0
    buffer_load_dwordx4 v100, s[8:11], s22 offen lds
    s_add_u32 m0, m0, 1024
    s_add_u32 s22, s22, 32768
    buffer_load_dwordx4 v100, s[8:11], s22 offen lds
    s_add_u32 m0, m0, 1024
    s_add_u32 s22, s22, 32768
    buffer_load_dwordx4 v100, s[8:11], s22 offen lds
    s_add_u32 m0, m0, 1024
    s_add_u32 s22, s22, 32768
    buffer_load_dwordx4 v100, s[8:11], s22 offen lds
    s_add_u32 m0, m0, 1024
    s_add_u32 s22, s22, 32768
    buffer_load_dwordx4 v100, s[8:11], s22 offen lds
    s_add_u32 m0, m0, 1024
    s_add_u32 s22, s22, 32768
    buffer_load_dwordx4 v100, s[8:11], s22 offen lds
    s_add_u32 m0, m0, 1024
    s_add_u32 s22, s22, 32768
    buffer_load_dwordx4 v100, s[8:11], s22 offen lds
    s_add_u32 m0, m0, 1024
    s_add_u32 s22, s22, 32768
    buffer_load_dwordx4 v100, s[8:11], s22 offen lds
    s_cmp_eq_u32 s16, 0
    s_cbranch_scc0 L_w_40_1
    ds_read_b64_tr_b16 a[160:161], v105 offset:32768
    ds_read_b64_tr_b16 a[162:163], v105 offset:33792
    ds_read_b64_tr_b16 a[168:169], v105 offset:32776
    ds_read_b64_tr_b16 a[170:171], v105 offset:33800
    ds_read_b64_tr_b16 a[164:165], v105 offset:40960
    ds_read_b64_tr_b16 a[166:167], v105 offset:41984
    ds_read_b64_tr_b16 a[172:173], v105 offset:40968
    ds_read_b64_tr_b16 a[174:175], v105 offset:41992
    s_waitcnt lgkmcnt(0)
    ds_read_b64_tr_b16 a[176:177], v105 offset:49152
    ds_read_b64_tr_b16 a[178:179], v105 offset:50176
    ds_read_b64_tr_b16 a[184:185], v105 offset:49160
    ds_read_b64_tr_b16 a[186:187], v105 offset:50184
    ds_read_b64_tr_b16 a[180:181], v105 offset:57344
    ds_read_b64_tr_b16 a[182:183], v105 offset:58368
    ds_read_b64_tr_b16 a[188:189], v105 offset:57352
    ds_read_b64_tr_b16 a[190:191], v105 offset:58376
    s_branch L_w_40
L_w_40_1:
    s_cmp_eq_u32 s16, 1
    s_cbranch_scc0 L_w_40_2
    ds_read_b64_tr_b16 a[128:129], v105 offset:32768
    ds_read_b64_tr_b16 a[130:131], v105 offset:33792
    ds_read_b64_tr_b16 a[136:137], v105 offset:32776
    ds_read_b64_tr_b16 a[138:139], v105 offset:33800
    ds_read_b64_tr_b16 a[132:133], v105 offset:40960
    ds_read_b64_tr_b16 a[134:135], v105 offset:41984
    ds_read_b64_tr_b16 a[140:141], v105 offset:40968
    ds_read_b64_tr_b16 a[142:143], v105 offset:41992
    s_waitcnt lgkmcnt(0)
    ds_read_b64_tr_b16 a[144:145], v105 offset:49152
    ds_read_b64_tr_b16 a[146:147], v105 offset:50176
    ds_read_b64_tr_b16 a[152:153], v105 offset:49160
    ds_read_b64_tr_b16 a[154:155], v105 offset:50184
    ds_read_b64_tr_b16 a[148:149], v105 offset:57344
    ds_read_b64_tr_b16 a[150:151], v105 offset:58368
    ds_read_b64_tr_b16 a[156:157], v105 offset:57352
    ds_read_b64_tr_b16 a[158:159], v105 offset:58376
    s_branch L_w_40
L_w_40_2:
    s_cmp_eq_u32 s16, 2
    s_cbranch_scc0 L_w_40_3
    ds_read_b64_tr_b16 a[224:225], v105 offset:32768
    ds_read_b64_tr_b16 a[226:227], v105 offset:33792
    ds_read_b64_tr_b16 a[232:233], v105 offset:32776
    ds_read_b64_tr_b16 a[234:235], v105 offset:33800
    ds_read_b64_tr_b16 a[228:229], v105 offset:40960
    ds_read_b64_tr_b16 a[230:231], v105 offset:41984
    ds_read_b64_tr_b16 a[236:237], v105 offset:40968
    ds_read_b64_tr_b16 a[238:239], v105 offset:41992
    s_waitcnt lgkmcnt(0)
    ds_read_b64_tr_b16 a[240:241], v105 offset:49152
    ds_read_b64_tr_b16 a[242:243], v105 offset:50176
    ds_read_b64_tr_b16 a[248:249], v105 offset:49160
    ds_read_b64_tr_b16 a[250:251], v105 offset:50184
    ds_read_b64_tr_b16 a[244:245], v105 offset:57344
    ds_read_b64_tr_b16 a[246:247], v105 offset:58368
    ds_read_b64_tr_b16 a[252:253], v105 offset:57352
    ds_read_b64_tr_b16 a[254:255], v105 offset:58376
    s_branch L_w_40
L_w_40_3:
    ds_read_b64_tr_b16 a[192:193], v105 offset:32768
    ds_read_b64_tr_b16 a[194:195], v105 offset:33792
    ds_read_b64_tr_b16 a[200:201], v105 offset:32776
    ds_read_b64_tr_b16 a[202:203], v105 offset:33800
    ds_read_b64_tr_b16 a[196:197], v105 offset:40960
    ds_read_b64_tr_b16 a[198:199], v105 offset:41984
    ds_read_b64_tr_b16 a[204:205], v105 offset:40968
    ds_read_b64_tr_b16 a[206:207], v105 offset:41992
    s_waitcnt lgkmcnt(0)
    ds_read_b64_tr_b16 a[208:209], v105 offset:49152
    ds_read_b64_tr_b16 a[210:211], v105 offset:50176
    ds_read_b64_tr_b16 a[216:217], v105 offset:49160
    ds_read_b64_tr_b16 a[218:219], v105 offset:50184
    ds_read_b64_tr_b16 a[212:213], v105 offset:57344
    ds_read_b64_tr_b16 a[214:215], v105 offset:58368
    ds_read_b64_tr_b16 a[220:221], v105 offset:57352
    ds_read_b64_tr_b16 a[222:223], v105 offset:58376
L_w_40:
    s_waitcnt lgkmcnt(0)
    s_waitcnt vmcnt(16)
    s_barrier
    s_mul_i32 s22, s16, 262144
    s_add_u32 s22, s22, s66
    s_add_u32 m0, s26, 32768
    s_add_u32 s22, s22, 1048576
    buffer_load_dwordx4 v100, s[8:11], s22 offen lds
    s_add_u32 m0, m0, 1024
    s_add_u32 s22, s22, 32768
    buffer_load_dwordx4 v100, s[8:11], s22 offen lds
    s_add_u32 m0, m0, 1024
    s_add_u32 s22, s22, 32768
    buffer_load_dwordx4 v100, s[8:11], s22 offen lds
    s_add_u32 m0, m0, 1024
    s_add_u32 s22, s22, 32768
    buffer_load_dwordx4 v100, s[8:11], s22 offen lds
    s_add_u32 m0, m0, 1024
    s_add_u32 s22, s22, 32768
    buffer_load_dwordx4 v100, s[8:11], s22 offen lds
    s_add_u32 m0, m0, 1024
    s_add_u32 s22, s22, 32768
    buffer_load_dwordx4 v100, s[8:11], s22 offen lds
    s_add_u32 m0, m0, 1024
    s_add_u32 s22, s22, 32768
    buffer_load_dwordx4 v100, s[8:11], s22 offen lds
    s_add_u32 m0, m0, 1024
    s_add_u32 s22, s22, 32768
    buffer_load_dwordx4 v100, s[8:11], s22 offen lds
    v_xor_b32 v101, 0x10000, v101
    v_xor_b32 v102, 0x10000, v102
    v_xor_b32 v103, 0x10000, v103
    v_xor_b32 v104, 0x10000, v104
    v_xor_b32 v105, 0x10000, v105
    v_xor_b32 v106, 0x10000, v106
    v_xor_b32 v107, 0x10000, v107
    v_xor_b32 v108, 0x10000, v108
    s_cmp_eq_u32 s16, 0
    s_cbranch_scc0 L_w_41_1
    ds_read_b64_tr_b16 a[192:193], v105 offset:0
    ds_read_b64_tr_b16 a[194:195], v105 offset:1024
    ds_read_b64_tr_b16 a[200:201], v105 offset:8
    ds_read_b64_tr_b16 a[202:203], v105 offset:1032
    ds_read_b64_tr_b16 a[196:197], v105 offset:8192
    ds_read_b64_tr_b16 a[198:199], v105 offset:9216
    ds_read_b64_tr_b16 a[204:205], v105 offset:8200
    ds_read_b64_tr_b16 a[206:207], v105 offset:9224
    s_waitcnt lgkmcnt(0)
    ds_read_b64_tr_b16 a[208:209], v105 offset:16384
    ds_read_b64_tr_b16 a[210:211], v105 offset:17408
    ds_read_b64_tr_b16 a[216:217], v105 offset:16392
    ds_read_b64_tr_b16 a[218:219], v105 offset:17416
    ds_read_b64_tr_b16 a[212:213], v105 offset:24576
    ds_read_b64_tr_b16 a[214:215], v105 offset:25600
    ds_read_b64_tr_b16 a[220:221], v105 offset:24584
    ds_read_b64_tr_b16 a[222:223], v105 offset:25608
    s_branch L_w_41
L_w_41_1:
    s_cmp_eq_u32 s16, 1
    s_cbranch_scc0 L_w_41_2
    ds_read_b64_tr_b16 a[224:225], v105 offset:0
    ds_read_b64_tr_b16 a[226:227], v105 offset:1024
    ds_read_b64_tr_b16 a[232:233], v105 offset:8
    ds_read_b64_tr_b16 a[234:235], v105 offset:1032
    ds_read_b64_tr_b16 a[228:229], v105 offset:8192
    ds_read_b64_tr_b16 a[230:231], v105 offset:9216
    ds_read_b64_tr_b16 a[236:237], v105 offset:8200
    ds_read_b64_tr_b16 a[238:239], v105 offset:9224
    s_waitcnt lgkmcnt(0)
    ds_read_b64_tr_b16 a[240:241], v105 offset:16384
    ds_read_b64_tr_b16 a[242:243], v105 offset:17408
    ds_read_b64_tr_b16 a[248:249], v105 offset:16392
    ds_read_b64_tr_b16 a[250:251], v105 offset:17416
    ds_read_b64_tr_b16 a[244:245], v105 offset:24576
    ds_read_b64_tr_b16 a[246:247], v105 offset:25600
    ds_read_b64_tr_b16 a[252:253], v105 offset:24584
    ds_read_b64_tr_b16 a[254:255], v105 offset:25608
    s_branch L_w_41
L_w_41_2:
    s_cmp_eq_u32 s16, 2
    s_cbranch_scc0 L_w_41_3
    ds_read_b64_tr_b16 a[128:129], v105 offset:0
    ds_read_b64_tr_b16 a[130:131], v105 offset:1024
    ds_read_b64_tr_b16 a[136:137], v105 offset:8
    ds_read_b64_tr_b16 a[138:139], v105 offset:1032
    ds_read_b64_tr_b16 a[132:133], v105 offset:8192
    ds_read_b64_tr_b16 a[134:135], v105 offset:9216
    ds_read_b64_tr_b16 a[140:141], v105 offset:8200
    ds_read_b64_tr_b16 a[142:143], v105 offset:9224
    s_waitcnt lgkmcnt(0)
    ds_read_b64_tr_b16 a[144:145], v105 offset:16384
    ds_read_b64_tr_b16 a[146:147], v105 offset:17408
    ds_read_b64_tr_b16 a[152:153], v105 offset:16392
    ds_read_b64_tr_b16 a[154:155], v105 offset:17416
    ds_read_b64_tr_b16 a[148:149], v105 offset:24576
    ds_read_b64_tr_b16 a[150:151], v105 offset:25600
    ds_read_b64_tr_b16 a[156:157], v105 offset:24584
    ds_read_b64_tr_b16 a[158:159], v105 offset:25608
    s_branch L_w_41
L_w_41_3:
    ds_read_b64_tr_b16 a[160:161], v105 offset:0
    ds_read_b64_tr_b16 a[162:163], v105 offset:1024
    ds_read_b64_tr_b16 a[168:169], v105 offset:8
    ds_read_b64_tr_b16 a[170:171], v105 offset:1032
    ds_read_b64_tr_b16 a[164:165], v105 offset:8192
    ds_read_b64_tr_b16 a[166:167], v105 offset:9216
    ds_read_b64_tr_b16 a[172:173], v105 offset:8200
    ds_read_b64_tr_b16 a[174:175], v105 offset:9224
    s_waitcnt lgkmcnt(0)
    ds_read_b64_tr_b16 a[176:177], v105 offset:16384
    ds_read_b64_tr_b16 a[178:179], v105 offset:17408
    ds_read_b64_tr_b16 a[184:185], v105 offset:16392
    ds_read_b64_tr_b16 a[186:187], v105 offset:17416
    ds_read_b64_tr_b16 a[180:181], v105 offset:24576
    ds_read_b64_tr_b16 a[182:183], v105 offset:25600
    ds_read_b64_tr_b16 a[188:189], v105 offset:24584
    ds_read_b64_tr_b16 a[190:191], v105 offset:25608
L_w_41:
    s_waitcnt lgkmcnt(0)
    s_waitcnt vmcnt(16)
    s_barrier
    s_mul_i32 s22, s16, 262144
    s_add_u32 s22, s22, s66
    s_add_u32 m0, s26, 65536
    s_add_u32 s22, s22, 2097152
    buffer_load_dwordx4 v100, s[8:11], s22 offen lds
    s_add_u32 m0, m0, 1024
    s_add_u32 s22, s22, 32768
    buffer_load_dwordx4 v100, s[8:11], s22 offen lds
    s_add_u32 m0, m0, 1024
    s_add_u32 s22, s22, 32768
    buffer_load_dwordx4 v100, s[8:11], s22 offen lds
    s_add_u32 m0, m0, 1024
    s_add_u32 s22, s22, 32768
    buffer_load_dwordx4 v100, s[8:11], s22 offen lds
    s_add_u32 m0, m0, 1024
    s_add_u32 s22, s22, 32768
    buffer_load_dwordx4 v100, s[8:11], s22 offen lds
    s_add_u32 m0, m0, 1024
    s_add_u32 s22, s22, 32768
    buffer_load_dwordx4 v100, s[8:11], s22 offen lds
    s_add_u32 m0, m0, 1024
    s_add_u32 s22, s22, 32768
    buffer_load_dwordx4 v100, s[8:11], s22 offen lds
    s_add_u32 m0, m0, 1024
    s_add_u32 s22, s22, 32768
    buffer_load_dwordx4 v100, s[8:11], s22 offen lds
    s_cmp_eq_u32 s16, 0
    s_cbranch_scc0 L_w_42_1
    ds_read_b64_tr_b16 a[224:225], v105 offset:32768
    ds_read_b64_tr_b16 a[226:227], v105 offset:33792
    ds_read_b64_tr_b16 a[232:233], v105 offset:32776
    ds_read_b64_tr_b16 a[234:235], v105 offset:33800
    ds_read_b64_tr_b16 a[228:229], v105 offset:40960
    ds_read_b64_tr_b16 a[230:231], v105 offset:41984
    ds_read_b64_tr_b16 a[236:237], v105 offset:40968
    ds_read_b64_tr_b16 a[238:239], v105 offset:41992
    s_waitcnt lgkmcnt(0)
    ds_read_b64_tr_b16 a[240:241], v105 offset:49152
    ds_read_b64_tr_b16 a[242:243], v105 offset:50176
    ds_read_b64_tr_b16 a[248:249], v105 offset:49160
    ds_read_b64_tr_b16 a[250:251], v105 offset:50184
    ds_read_b64_tr_b16 a[244:245], v105 offset:57344
    ds_read_b64_tr_b16 a[246:247], v105 offset:58368
    ds_read_b64_tr_b16 a[252:253], v105 offset:57352
    ds_read_b64_tr_b16 a[254:255], v105 offset:58376
    s_branch L_w_42
L_w_42_1:
    s_cmp_eq_u32 s16, 1
    s_cbranch_scc0 L_w_42_2
    ds_read_b64_tr_b16 a[192:193], v105 offset:32768
    ds_read_b64_tr_b16 a[194:195], v105 offset:33792
    ds_read_b64_tr_b16 a[200:201], v105 offset:32776
    ds_read_b64_tr_b16 a[202:203], v105 offset:33800
    ds_read_b64_tr_b16 a[196:197], v105 offset:40960
    ds_read_b64_tr_b16 a[198:199], v105 offset:41984
    ds_read_b64_tr_b16 a[204:205], v105 offset:40968
    ds_read_b64_tr_b16 a[206:207], v105 offset:41992
    s_waitcnt lgkmcnt(0)
    ds_read_b64_tr_b16 a[208:209], v105 offset:49152
    ds_read_b64_tr_b16 a[210:211], v105 offset:50176
    ds_read_b64_tr_b16 a[216:217], v105 offset:49160
    ds_read_b64_tr_b16 a[218:219], v105 offset:50184
    ds_read_b64_tr_b16 a[212:213], v105 offset:57344
    ds_read_b64_tr_b16 a[214:215], v105 offset:58368
    ds_read_b64_tr_b16 a[220:221], v105 offset:57352
    ds_read_b64_tr_b16 a[222:223], v105 offset:58376
    s_branch L_w_42
L_w_42_2:
    s_cmp_eq_u32 s16, 2
    s_cbranch_scc0 L_w_42_3
    ds_read_b64_tr_b16 a[160:161], v105 offset:32768
    ds_read_b64_tr_b16 a[162:163], v105 offset:33792
    ds_read_b64_tr_b16 a[168:169], v105 offset:32776
    ds_read_b64_tr_b16 a[170:171], v105 offset:33800
    ds_read_b64_tr_b16 a[164:165], v105 offset:40960
    ds_read_b64_tr_b16 a[166:167], v105 offset:41984
    ds_read_b64_tr_b16 a[172:173], v105 offset:40968
    ds_read_b64_tr_b16 a[174:175], v105 offset:41992
    s_waitcnt lgkmcnt(0)
    ds_read_b64_tr_b16 a[176:177], v105 offset:49152
    ds_read_b64_tr_b16 a[178:179], v105 offset:50176
    ds_read_b64_tr_b16 a[184:185], v105 offset:49160
    ds_read_b64_tr_b16 a[186:187], v105 offset:50184
    ds_read_b64_tr_b16 a[180:181], v105 offset:57344
    ds_read_b64_tr_b16 a[182:183], v105 offset:58368
    ds_read_b64_tr_b16 a[188:189], v105 offset:57352
    ds_read_b64_tr_b16 a[190:191], v105 offset:58376
    s_branch L_w_42
L_w_42_3:
    ds_read_b64_tr_b16 a[128:129], v105 offset:32768
    ds_read_b64_tr_b16 a[130:131], v105 offset:33792
    ds_read_b64_tr_b16 a[136:137], v105 offset:32776
    ds_read_b64_tr_b16 a[138:139], v105 offset:33800
    ds_read_b64_tr_b16 a[132:133], v105 offset:40960
    ds_read_b64_tr_b16 a[134:135], v105 offset:41984
    ds_read_b64_tr_b16 a[140:141], v105 offset:40968
    ds_read_b64_tr_b16 a[142:143], v105 offset:41992
    s_waitcnt lgkmcnt(0)
    ds_read_b64_tr_b16 a[144:145], v105 offset:49152
    ds_read_b64_tr_b16 a[146:147], v105 offset:50176
    ds_read_b64_tr_b16 a[152:153], v105 offset:49160
    ds_read_b64_tr_b16 a[154:155], v105 offset:50184
    ds_read_b64_tr_b16 a[148:149], v105 offset:57344
    ds_read_b64_tr_b16 a[150:151], v105 offset:58368
    ds_read_b64_tr_b16 a[156:157], v105 offset:57352
    ds_read_b64_tr_b16 a[158:159], v105 offset:58376
L_w_42:
    s_waitcnt lgkmcnt(0)
    s_waitcnt vmcnt(16)
    s_barrier
    s_mul_i32 s22, s16, 262144
    s_add_u32 s22, s22, s66
    s_add_u32 m0, s26, 98304
    s_add_u32 s22, s22, 3145728
    buffer_load_dwordx4 v100, s[8:11], s22 offen lds
    s_add_u32 m0, m0, 1024
    s_add_u32 s22, s22, 32768
    buffer_load_dwordx4 v100, s[8:11], s22 offen lds
    s_add_u32 m0, m0, 1024
    s_add_u32 s22, s22, 32768
    buffer_load_dwordx4 v100, s[8:11], s22 offen lds
    s_add_u32 m0, m0, 1024
    s_add_u32 s22, s22, 32768
    buffer_load_dwordx4 v100, s[8:11], s22 offen lds
    s_add_u32 m0, m0, 1024
    s_add_u32 s22, s22, 32768
    buffer_load_dwordx4 v100, s[8:11], s22 offen lds
    s_add_u32 m0, m0, 1024
    s_add_u32 s22, s22, 32768
    buffer_load_dwordx4 v100, s[8:11], s22 offen lds
    s_add_u32 m0, m0, 1024
    s_add_u32 s22, s22, 32768
    buffer_load_dwordx4 v100, s[8:11], s22 offen lds
    s_add_u32 m0, m0, 1024
    s_add_u32 s22, s22, 32768
    buffer_load_dwordx4 v100, s[8:11], s22 offen lds
    v_xor_b32 v101, 0x10000, v101
    v_xor_b32 v102, 0x10000, v102
    v_xor_b32 v103, 0x10000, v103
    v_xor_b32 v104, 0x10000, v104
    v_xor_b32 v105, 0x10000, v105
    v_xor_b32 v106, 0x10000, v106
    v_xor_b32 v107, 0x10000, v107
    v_xor_b32 v108, 0x10000, v108
    s_cmp_eq_u32 s16, 0
    s_cbranch_scc0 L_w_43_1
    ds_read_b64_tr_b16 v[128:129], v101 offset:0
    ds_read_b64_tr_b16 v[130:131], v101 offset:1024
    ds_read_b64_tr_b16 v[136:137], v101 offset:32
    ds_read_b64_tr_b16 v[138:139], v101 offset:1056
    ds_read_b64_tr_b16 v[132:133], v101 offset:8192
    ds_read_b64_tr_b16 v[134:135], v101 offset:9216
    ds_read_b64_tr_b16 v[140:141], v101 offset:8224
    ds_read_b64_tr_b16 v[142:143], v101 offset:9248
    s_waitcnt lgkmcnt(0)
    ds_read_b64_tr_b16 v[144:145], v101 offset:16384
    ds_read_b64_tr_b16 v[146:147], v101 offset:17408
    ds_read_b64_tr_b16 v[152:153], v101 offset:16416
    ds_read_b64_tr_b16 v[154:155], v101 offset:17440
    ds_read_b64_tr_b16 v[148:149], v101 offset:24576
    ds_read_b64_tr_b16 v[150:151], v101 offset:25600
    ds_read_b64_tr_b16 v[156:157], v101 offset:24608
    ds_read_b64_tr_b16 v[158:159], v101 offset:25632
    s_branch L_w_43
L_w_43_1:
    s_cmp_eq_u32 s16, 1
    s_cbranch_scc0 L_w_43_2
    ds_read_b64_tr_b16 v[160:161], v101 offset:0
    ds_read_b64_tr_b16 v[162:163], v101 offset:1024
    ds_read_b64_tr_b16 v[168:169], v101 offset:32
    ds_read_b64_tr_b16 v[170:171], v101 offset:1056
    ds_read_b64_tr_b16 v[164:165], v101 offset:8192
    ds_read_b64_tr_b16 v[166:167], v101 offset:9216
    ds_read_b64_tr_b16 v[172:173], v101 offset:8224
    ds_read_b64_tr_b16 v[174:175], v101 offset:9248
    s_waitcnt lgkmcnt(0)
    ds_read_b64_tr_b16 v[176:177], v101 offset:16384
    ds_read_b64_tr_b16 v[178:179], v101 offset:17408
    ds_read_b64_tr_b16 v[184:185], v101 offset:16416
    ds_read_b64_tr_b16 v[186:187], v101 offset:17440
    ds_read_b64_tr_b16 v[180:181], v101 offset:24576
    ds_read_b64_tr_b16 v[182:183], v101 offset:25600
    ds_read_b64_tr_b16 v[188:189], v101 offset:24608
    ds_read_b64_tr_b16 v[190:191], v101 offset:25632
    s_branch L_w_43
L_w_43_2:
    s_cmp_eq_u32 s16, 2
    s_cbranch_scc0 L_w_43_3
    ds_read_b64_tr_b16 v[192:193], v101 offset:0
    ds_read_b64_tr_b16 v[194:195], v101 offset:1024
    ds_read_b64_tr_b16 v[200:201], v101 offset:32
    ds_read_b64_tr_b16 v[202:203], v101 offset:1056
    ds_read_b64_tr_b16 v[196:197], v101 offset:8192
    ds_read_b64_tr_b16 v[198:199], v101 offset:9216
    ds_read_b64_tr_b16 v[204:205], v101 offset:8224
    ds_read_b64_tr_b16 v[206:207], v101 offset:9248
    s_waitcnt lgkmcnt(0)
    ds_read_b64_tr_b16 v[208:209], v101 offset:16384
    ds_read_b64_tr_b16 v[210:211], v101 offset:17408
    ds_read_b64_tr_b16 v[216:217], v101 offset:16416
    ds_read_b64_tr_b16 v[218:219], v101 offset:17440
    ds_read_b64_tr_b16 v[212:213], v101 offset:24576
    ds_read_b64_tr_b16 v[214:215], v101 offset:25600
    ds_read_b64_tr_b16 v[220:221], v101 offset:24608
    ds_read_b64_tr_b16 v[222:223], v101 offset:25632
    s_branch L_w_43
L_w_43_3:
    ds_read_b64_tr_b16 v[224:225], v101 offset:0
    ds_read_b64_tr_b16 v[226:227], v101 offset:1024
    ds_read_b64_tr_b16 v[232:233], v101 offset:32
    ds_read_b64_tr_b16 v[234:235], v101 offset:1056
    ds_read_b64_tr_b16 v[228:229], v101 offset:8192
    ds_read_b64_tr_b16 v[230:231], v101 offset:9216
    ds_read_b64_tr_b16 v[236:237], v101 offset:8224
    ds_read_b64_tr_b16 v[238:239], v101 offset:9248
    s_waitcnt lgkmcnt(0)
    ds_read_b64_tr_b16 v[240:241], v101 offset:16384
    ds_read_b64_tr_b16 v[242:243], v101 offset:17408
    ds_read_b64_tr_b16 v[248:249], v101 offset:16416
    ds_read_b64_tr_b16 v[250:251], v101 offset:17440
    ds_read_b64_tr_b16 v[244:245], v101 offset:24576
    ds_read_b64_tr_b16 v[246:247], v101 offset:25600
    ds_read_b64_tr_b16 v[252:253], v101 offset:24608
    ds_read_b64_tr_b16 v[254:255], v101 offset:25632
L_w_43:
    s_waitcnt lgkmcnt(0)
    s_waitcnt vmcnt(16)
    s_barrier
    s_mov_b32 s8, s36
    s_and_b32 s9, s37, 0xffff
    s_mov_b32 s10, 4194304
    s_mov_b32 s11, 0x20000
    s_mul_i32 s22, s16, 262144
    s_add_u32 s22, s22, s66
    s_add_u32 m0, s26, 0
    s_add_u32 s22, s22, 0
    buffer_load_dwordx4 v100, s[8:11], s22 offen lds
    s_add_u32 m0, m0, 1024
    s_add_u32 s22, s22, 32768
    buffer_load_dwordx4 v100, s[8:11], s22 offen lds
    s_add_u32 m0, m0, 1024
    s_add_u32 s22, s22, 32768
    buffer_load_dwordx4 v100, s[8:11], s22 offen lds
    s_add_u32 m0, m0, 1024
    s_add_u32 s22, s22, 32768
    buffer_load_dwordx4 v100, s[8:11], s22 offen lds
    s_add_u32 m0, m0, 1024
    s_add_u32 s22, s22, 32768
    buffer_load_dwordx4 v100, s[8:11], s22 offen lds
    s_add_u32 m0, m0, 1024
    s_add_u32 s22, s22, 32768
    buffer_load_dwordx4 v100, s[8:11], s22 offen lds
    s_add_u32 m0, m0, 1024
    s_add_u32 s22, s22, 32768
    buffer_load_dwordx4 v100, s[8:11], s22 offen lds
    s_add_u32 m0, m0, 1024
    s_add_u32 s22, s22, 32768
    buffer_load_dwordx4 v100, s[8:11], s22 offen lds
    s_cmp_eq_u32 s16, 0
    s_cbranch_scc0 L_w_44_1
    ds_read_b64_tr_b16 v[160:161], v101 offset:32768
    ds_read_b64_tr_b16 v[162:163], v101 offset:33792
    ds_read_b64_tr_b16 v[168:169], v101 offset:32800
    ds_read_b64_tr_b16 v[170:171], v101 offset:33824
    ds_read_b64_tr_b16 v[164:165], v101 offset:40960
    ds_read_b64_tr_b16 v[166:167], v101 offset:41984
    ds_read_b64_tr_b16 v[172:173], v101 offset:40992
    ds_read_b64_tr_b16 v[174:175], v101 offset:42016
    s_waitcnt lgkmcnt(0)
    ds_read_b64_tr_b16 v[176:177], v101 offset:49152
    ds_read_b64_tr_b16 v[178:179], v101 offset:50176
    ds_read_b64_tr_b16 v[184:185], v101 offset:49184
    ds_read_b64_tr_b16 v[186:187], v101 offset:50208
    ds_read_b64_tr_b16 v[180:181], v101 offset:57344
    ds_read_b64_tr_b16 v[182:183], v101 offset:58368
    ds_read_b64_tr_b16 v[188:189], v101 offset:57376
    ds_read_b64_tr_b16 v[190:191], v101 offset:58400
    s_branch L_w_44
L_w_44_1:
    s_cmp_eq_u32 s16, 1
    s_cbranch_scc0 L_w_44_2
    ds_read_b64_tr_b16 v[128:129], v101 offset:32768
    ds_read_b64_tr_b16 v[130:131], v101 offset:33792
    ds_read_b64_tr_b16 v[136:137], v101 offset:32800
    ds_read_b64_tr_b16 v[138:139], v101 offset:33824
    ds_read_b64_tr_b16 v[132:133], v101 offset:40960
    ds_read_b64_tr_b16 v[134:135], v101 offset:41984
    ds_read_b64_tr_b16 v[140:141], v101 offset:40992
    ds_read_b64_tr_b16 v[142:143], v101 offset:42016
    s_waitcnt lgkmcnt(0)
    ds_read_b64_tr_b16 v[144:145], v101 offset:49152
    ds_read_b64_tr_b16 v[146:147], v101 offset:50176
    ds_read_b64_tr_b16 v[152:153], v101 offset:49184
    ds_read_b64_tr_b16 v[154:155], v101 offset:50208
    ds_read_b64_tr_b16 v[148:149], v101 offset:57344
    ds_read_b64_tr_b16 v[150:151], v101 offset:58368
    ds_read_b64_tr_b16 v[156:157], v101 offset:57376
    ds_read_b64_tr_b16 v[158:159], v101 offset:58400
    s_branch L_w_44
L_w_44_2:
    s_cmp_eq_u32 s16, 2
    s_cbranch_scc0 L_w_44_3
    ds_read_b64_tr_b16 v[224:225], v101 offset:32768
    ds_read_b64_tr_b16 v[226:227], v101 offset:33792
    ds_read_b64_tr_b16 v[232:233], v101 offset:32800
    ds_read_b64_tr_b16 v[234:235], v101 offset:33824
    ds_read_b64_tr_b16 v[228:229], v101 offset:40960
    ds_read_b64_tr_b16 v[230:231], v101 offset:41984
    ds_read_b64_tr_b16 v[236:237], v101 offset:40992
    ds_read_b64_tr_b16 v[238:239], v101 offset:42016
    s_waitcnt lgkmcnt(0)
    ds_read_b64_tr_b16 v[240:241], v101 offset:49152
    ds_read_b64_tr_b16 v[242:243], v101 offset:50176
    ds_read_b64_tr_b16 v[248:249], v101 offset:49184
    ds_read_b64_tr_b16 v[250:251], v101 offset:50208
    ds_read_b64_tr_b16 v[244:245], v101 offset:57344
    ds_read_b64_tr_b16 v[246:247], v101 offset:58368
    ds_read_b64_tr_b16 v[252:253], v101 offset:57376
    ds_read_b64_tr_b16 v[254:255], v101 offset:58400
    s_branch L_w_44
L_w_44_3:
    ds_read_b64_tr_b16 v[192:193], v101 offset:32768
    ds_read_b64_tr_b16 v[194:195], v101 offset:33792
    ds_read_b64_tr_b16 v[200:201], v101 offset:32800
    ds_read_b64_tr_b16 v[202:203], v101 offset:33824
    ds_read_b64_tr_b16 v[196:197], v101 offset:40960
    ds_read_b64_tr_b16 v[198:199], v101 offset:41984
    ds_read_b64_tr_b16 v[204:205], v101 offset:40992
    ds_read_b64_tr_b16 v[206:207], v101 offset:42016
    s_waitcnt lgkmcnt(0)
    ds_read_b64_tr_b16 v[208:209], v101 offset:49152
    ds_read_b64_tr_b16 v[210:211], v101 offset:50176
    ds_read_b64_tr_b16 v[216:217], v101 offset:49184
    ds_read_b64_tr_b16 v[218:219], v101 offset:50208
    ds_read_b64_tr_b16 v[212:213], v101 offset:57344
    ds_read_b64_tr_b16 v[214:215], v101 offset:58368
    ds_read_b64_tr_b16 v[220:221], v101 offset:57376
    ds_read_b64_tr_b16 v[222:223], v101 offset:58400
L_w_44:
    s_waitcnt lgkmcnt(0)
    s_waitcnt vmcnt(16)
    s_barrier
    s_mul_i32 s22, s16, 262144
    s_add_u32 s22, s22, s66
    s_add_u32 m0, s26, 32768
    s_add_u32 s22, s22, 1048576
    buffer_load_dwordx4 v100, s[8:11], s22 offen lds
    s_add_u32 m0, m0, 1024
    s_add_u32 s22, s22, 32768
    buffer_load_dwordx4 v100, s[8:11], s22 offen lds
    s_add_u32 m0, m0, 1024
    s_add_u32 s22, s22, 32768
    buffer_load_dwordx4 v100, s[8:11], s22 offen lds
    s_add_u32 m0, m0, 1024
    s_add_u32 s22, s22, 32768
    buffer_load_dwordx4 v100, s[8:11], s22 offen lds
    s_add_u32 m0, m0, 1024
    s_add_u32 s22, s22, 32768
    buffer_load_dwordx4 v100, s[8:11], s22 offen lds
    s_add_u32 m0, m0, 1024
    s_add_u32 s22, s22, 32768
    buffer_load_dwordx4 v100, s[8:11], s22 offen lds
    s_add_u32 m0, m0, 1024
    s_add_u32 s22, s22, 32768
    buffer_load_dwordx4 v100, s[8:11], s22 offen lds
    s_add_u32 m0, m0, 1024
    s_add_u32 s22, s22, 32768
    buffer_load_dwordx4 v100, s[8:11], s22 offen lds
    v_xor_b32 v101, 0x10000, v101
    v_xor_b32 v102, 0x10000, v102
    v_xor_b32 v103, 0x10000, v103
    v_xor_b32 v104, 0x10000, v104
    v_xor_b32 v105, 0x10000, v105
    v_xor_b32 v106, 0x10000, v106
    v_xor_b32 v107, 0x10000, v107
    v_xor_b32 v108, 0x10000, v108
    s_cmp_eq_u32 s16, 0
    s_cbranch_scc0 L_w_45_1
    ds_read_b64_tr_b16 v[192:193], v101 offset:0
    ds_read_b64_tr_b16 v[194:195], v101 offset:1024
    ds_read_b64_tr_b16 v[200:201], v101 offset:32
    ds_read_b64_tr_b16 v[202:203], v101 offset:1056
    ds_read_b64_tr_b16 v[196:197], v101 offset:8192
    ds_read_b64_tr_b16 v[198:199], v101 offset:9216
    ds_read_b64_tr_b16 v[204:205], v101 offset:8224
    ds_read_b64_tr_b16 v[206:207], v101 offset:9248
    s_waitcnt lgkmcnt(0)
    ds_read_b64_tr_b16 v[208:209], v101 offset:16384
    ds_read_b64_tr_b16 v[210:211], v101 offset:17408
    ds_read_b64_tr_b16 v[216:217], v101 offset:16416
    ds_read_b64_tr_b16 v[218:219], v101 offset:17440
    ds_read_b64_tr_b16 v[212:213], v101 offset:24576
    ds_read_b64_tr_b16 v[214:215], v101 offset:25600
    ds_read_b64_tr_b16 v[220:221], v101 offset:24608
    ds_read_b64_tr_b16 v[222:223], v101 offset:25632
    s_branch L_w_45
L_w_45_1:
    s_cmp_eq_u32 s16, 1
    s_cbranch_scc0 L_w_45_2
    ds_read_b64_tr_b16 v[224:225], v101 offset:0
    ds_read_b64_tr_b16 v[226:227], v101 offset:1024
    ds_read_b64_tr_b16 v[232:233], v101 offset:32
    ds_read_b64_tr_b16 v[234:235], v101 offset:1056
    ds_read_b64_tr_b16 v[228:229], v101 offset:8192
    ds_read_b64_tr_b16 v[230:231], v101 offset:9216
    ds_read_b64_tr_b16 v[236:237], v101 offset:8224
    ds_read_b64_tr_b16 v[238:239], v101 offset:9248
    s_waitcnt lgkmcnt(0)
    ds_read_b64_tr_b16 v[240:241], v101 offset:16384
    ds_read_b64_tr_b16 v[242:243], v101 offset:17408
    ds_read_b64_tr_b16 v[248:249], v101 offset:16416
    ds_read_b64_tr_b16 v[250:251], v101 offset:17440
    ds_read_b64_tr_b16 v[244:245], v101 offset:24576
    ds_read_b64_tr_b16 v[246:247], v101 offset:25600
    ds_read_b64_tr_b16 v[252:253], v101 offset:24608
    ds_read_b64_tr_b16 v[254:255], v101 offset:25632
    s_branch L_w_45
L_w_45_2:
    s_cmp_eq_u32 s16, 2
    s_cbranch_scc0 L_w_45_3
    ds_read_b64_tr_b16 v[128:129], v101 offset:0
    ds_read_b64_tr_b16 v[130:131], v101 offset:1024
    ds_read_b64_tr_b16 v[136:137], v101 offset:32
    ds_read_b64_tr_b16 v[138:139], v101 offset:1056
    ds_read_b64_tr_b16 v[132:133], v101 offset:8192
    ds_read_b64_tr_b16 v[134:135], v101 offset:9216
    ds_read_b64_tr_b16 v[140:141], v101 offset:8224
    ds_read_b64_tr_b16 v[142:143], v101 offset:9248
    s_waitcnt lgkmcnt(0)
    ds_read_b64_tr_b16 v[144:145], v101 offset:16384
    ds_read_b64_tr_b16 v[146:147], v101 offset:17408
    ds_read_b64_tr_b16 v[152:153], v101 offset:16416
    ds_read_b64_tr_b16 v[154:155], v101 offset:17440
    ds_read_b64_tr_b16 v[148:149], v101 offset:24576
    ds_read_b64_tr_b16 v[150:151], v101 offset:25600
    ds_read_b64_tr_b16 v[156:157], v101 offset:24608
    ds_read_b64_tr_b16 v[158:159], v101 offset:25632
    s_branch L_w_45
L_w_45_3:
    ds_read_b64_tr_b16 v[160:161], v101 offset:0
    ds_read_b64_tr_b16 v[162:163], v101 offset:1024
    ds_read_b64_tr_b16 v[168:169], v101 offset:32
    ds_read_b64_tr_b16 v[170:171], v101 offset:1056
    ds_read_b64_tr_b16 v[164:165], v101 offset:8192
    ds_read_b64_tr_b16 v[166:167], v101 offset:9216
    ds_read_b64_tr_b16 v[172:173], v101 offset:8224
    ds_read_b64_tr_b16 v[174:175], v101 offset:9248
    s_waitcnt lgkmcnt(0)
    ds_read_b64_tr_b16 v[176:177], v101 offset:16384
    ds_read_b64_tr_b16 v[178:179], v101 offset:17408
    ds_read_b64_tr_b16 v[184:185], v101 offset:16416
    ds_read_b64_tr_b16 v[186:187], v101 offset:17440
    ds_read_b64_tr_b16 v[180:181], v101 offset:24576
    ds_read_b64_tr_b16 v[182:183], v101 offset:25600
    ds_read_b64_tr_b16 v[188:189], v101 offset:24608
    ds_read_b64_tr_b16 v[190:191], v101 offset:25632
L_w_45:
    s_waitcnt lgkmcnt(0)
    s_waitcnt vmcnt(16)
    s_barrier
    s_mul_i32 s22, s16, 262144
    s_add_u32 s22, s22, s66
    s_add_u32 m0, s26, 65536
    s_add_u32 s22, s22, 2097152
    buffer_load_dwordx4 v100, s[8:11], s22 offen lds
    s_add_u32 m0, m0, 1024
    s_add_u32 s22, s22, 32768
    buffer_load_dwordx4 v100, s[8:11], s22 offen lds
    s_add_u32 m0, m0, 1024
    s_add_u32 s22, s22, 32768
    buffer_load_dwordx4 v100, s[8:11], s22 offen lds
    s_add_u32 m0, m0, 1024
    s_add_u32 s22, s22, 32768
    buffer_load_dwordx4 v100, s[8:11], s22 offen lds
    s_add_u32 m0, m0, 1024
    s_add_u32 s22, s22, 32768
    buffer_load_dwordx4 v100, s[8:11], s22 offen lds
    s_add_u32 m0, m0, 1024
    s_add_u32 s22, s22, 32768
    buffer_load_dwordx4 v100, s[8:11], s22 offen lds
    s_add_u32 m0, m0, 1024
    s_add_u32 s22, s22, 32768
    buffer_load_dwordx4 v100, s[8:11], s22 offen lds
    s_add_u32 m0, m0, 1024
    s_add_u32 s22, s22, 32768
    buffer_load_dwordx4 v100, s[8:11], s22 offen lds
    s_cmp_eq_u32 s16, 0
    s_cbranch_scc0 L_w_46_1
    ds_read_b64_tr_b16 v[224:225], v101 offset:32768
    ds_read_b64_tr_b16 v[226:227], v101 offset:33792
    ds_read_b64_tr_b16 v[232:233], v101 offset:32800
    ds_read_b64_tr_b16 v[234:235], v101 offset:33824
    ds_read_b64_tr_b16 v[228:229], v101 offset:40960
    ds_read_b64_tr_b16 v[230:231], v101 offset:41984
    ds_read_b64_tr_b16 v[236:237], v101 offset:40992
    ds_read_b64_tr_b16 v[238:239], v101 offset:42016
    s_waitcnt lgkmcnt(0)
    ds_read_b64_tr_b16 v[240:241], v101 offset:49152
    ds_read_b64_tr_b16 v[242:243], v101 offset:50176
    ds_read_b64_tr_b16 v[248:249], v101 offset:49184
    ds_read_b64_tr_b16 v[250:251], v101 offset:50208
    ds_read_b64_tr_b16 v[244:245], v101 offset:57344
    ds_read_b64_tr_b16 v[246:247], v101 offset:58368
    ds_read_b64_tr_b16 v[252:253], v101 offset:57376
    ds_read_b64_tr_b16 v[254:255], v101 offset:58400
    s_branch L_w_46
L_w_46_1:
    s_cmp_eq_u32 s16, 1
    s_cbranch_scc0 L_w_46_2
    ds_read_b64_tr_b16 v[192:193], v101 offset:32768
    ds_read_b64_tr_b16 v[194:195], v101 offset:33792
    ds_read_b64_tr_b16 v[200:201], v101 offset:32800
    ds_read_b64_tr_b16 v[202:203], v101 offset:33824
    ds_read_b64_tr_b16 v[196:197], v101 offset:40960
    ds_read_b64_tr_b16 v[198:199], v101 offset:41984
    ds_read_b64_tr_b16 v[204:205], v101 offset:40992
    ds_read_b64_tr_b16 v[206:207], v101 offset:42016
    s_waitcnt lgkmcnt(0)
    ds_read_b64_tr_b16 v[208:209], v101 offset:49152
    ds_read_b64_tr_b16 v[210:211], v101 offset:50176
    ds_read_b64_tr_b16 v[216:217], v101 offset:49184
    ds_read_b64_tr_b16 v[218:219], v101 offset:50208
    ds_read_b64_tr_b16 v[212:213], v101 offset:57344
    ds_read_b64_tr_b16 v[214:215], v101 offset:58368
    ds_read_b64_tr_b16 v[220:221], v101 offset:57376
    ds_read_b64_tr_b16 v[222:223], v101 offset:58400
    s_branch L_w_46
L_w_46_2:
    s_cmp_eq_u32 s16, 2
    s_cbranch_scc0 L_w_46_3
    ds_read_b64_tr_b16 v[160:161], v101 offset:32768
    ds_read_b64_tr_b16 v[162:163], v101 offset:33792
    ds_read_b64_tr_b16 v[168:169], v101 offset:32800
    ds_read_b64_tr_b16 v[170:171], v101 offset:33824
    ds_read_b64_tr_b16 v[164:165], v101 offset:40960
    ds_read_b64_tr_b16 v[166:167], v101 offset:41984
    ds_read_b64_tr_b16 v[172:173], v101 offset:40992
    ds_read_b64_tr_b16 v[174:175], v101 offset:42016
    s_waitcnt lgkmcnt(0)
    ds_read_b64_tr_b16 v[176:177], v101 offset:49152
    ds_read_b64_tr_b16 v[178:179], v101 offset:50176
    ds_read_b64_tr_b16 v[184:185], v101 offset:49184
    ds_read_b64_tr_b16 v[186:187], v101 offset:50208
    ds_read_b64_tr_b16 v[180:181], v101 offset:57344
    ds_read_b64_tr_b16 v[182:183], v101 offset:58368
    ds_read_b64_tr_b16 v[188:189], v101 offset:57376
    ds_read_b64_tr_b16 v[190:191], v101 offset:58400
    s_branch L_w_46
L_w_46_3:
    ds_read_b64_tr_b16 v[128:129], v101 offset:32768
    ds_read_b64_tr_b16 v[130:131], v101 offset:33792
    ds_read_b64_tr_b16 v[136:137], v101 offset:32800
    ds_read_b64_tr_b16 v[138:139], v101 offset:33824
    ds_read_b64_tr_b16 v[132:133], v101 offset:40960
    ds_read_b64_tr_b16 v[134:135], v101 offset:41984
    ds_read_b64_tr_b16 v[140:141], v101 offset:40992
    ds_read_b64_tr_b16 v[142:143], v101 offset:42016
    s_waitcnt lgkmcnt(0)
    ds_read_b64_tr_b16 v[144:145], v101 offset:49152
    ds_read_b64_tr_b16 v[146:147], v101 offset:50176
    ds_read_b64_tr_b16 v[152:153], v101 offset:49184
    ds_read_b64_tr_b16 v[154:155], v101 offset:50208
    ds_read_b64_tr_b16 v[148:149], v101 offset:57344
    ds_read_b64_tr_b16 v[150:151], v101 offset:58368
    ds_read_b64_tr_b16 v[156:157], v101 offset:57376
    ds_read_b64_tr_b16 v[158:159], v101 offset:58400
L_w_46:
    s_waitcnt lgkmcnt(0)
    s_waitcnt vmcnt(16)
    s_barrier
    s_mul_i32 s22, s16, 262144
    s_add_u32 s22, s22, s66
    s_add_u32 m0, s26, 98304
    s_add_u32 s22, s22, 3145728
    buffer_load_dwordx4 v100, s[8:11], s22 offen lds
    s_add_u32 m0, m0, 1024
    s_add_u32 s22, s22, 32768
    buffer_load_dwordx4 v100, s[8:11], s22 offen lds
    s_add_u32 m0, m0, 1024
    s_add_u32 s22, s22, 32768
    buffer_load_dwordx4 v100, s[8:11], s22 offen lds
    s_add_u32 m0, m0, 1024
    s_add_u32 s22, s22, 32768
    buffer_load_dwordx4 v100, s[8:11], s22 offen lds
    s_add_u32 m0, m0, 1024
    s_add_u32 s22, s22, 32768
    buffer_load_dwordx4 v100, s[8:11], s22 offen lds
    s_add_u32 m0, m0, 1024
    s_add_u32 s22, s22, 32768
    buffer_load_dwordx4 v100, s[8:11], s22 offen lds
    s_add_u32 m0, m0, 1024
    s_add_u32 s22, s22, 32768
    buffer_load_dwordx4 v100, s[8:11], s22 offen lds
    s_add_u32 m0, m0, 1024
    s_add_u32 s22, s22, 32768
    buffer_load_dwordx4 v100, s[8:11], s22 offen lds
    v_xor_b32 v101, 0x10000, v101
    v_xor_b32 v102, 0x10000, v102
    v_xor_b32 v103, 0x10000, v103
    v_xor_b32 v104, 0x10000, v104
    v_xor_b32 v105, 0x10000, v105
    v_xor_b32 v106, 0x10000, v106
    v_xor_b32 v107, 0x10000, v107
    v_xor_b32 v108, 0x10000, v108
    s_cmp_eq_u32 s16, 0
    s_cbranch_scc0 L_w_47_1
    ds_read_b64_tr_b16 a[0:1], v105 offset:0
    ds_read_b64_tr_b16 a[2:3], v105 offset:1024
    ds_read_b64_tr_b16 a[8:9], v105 offset:8
    ds_read_b64_tr_b16 a[10:11], v105 offset:1032
    ds_read_b64_tr_b16 a[4:5], v105 offset:8192
    ds_read_b64_tr_b16 a[6:7], v105 offset:9216
    ds_read_b64_tr_b16 a[12:13], v105 offset:8200
    ds_read_b64_tr_b16 a[14:15], v105 offset:9224
    s_waitcnt lgkmcnt(0)
    ds_read_b64_tr_b16 a[16:17], v105 offset:16384
    ds_read_b64_tr_b16 a[18:19], v105 offset:17408
    ds_read_b64_tr_b16 a[24:25], v105 offset:16392
    ds_read_b64_tr_b16 a[26:27], v105 offset:17416
    ds_read_b64_tr_b16 a[20:21], v105 offset:24576
    ds_read_b64_tr_b16 a[22:23], v105 offset:25600
    ds_read_b64_tr_b16 a[28:29], v105 offset:24584
    ds_read_b64_tr_b16 a[30:31], v105 offset:25608
    s_branch L_w_47
L_w_47_1:
    s_cmp_eq_u32 s16, 1
    s_cbranch_scc0 L_w_47_2
    ds_read_b64_tr_b16 a[32:33], v105 offset:0
    ds_read_b64_tr_b16 a[34:35], v105 offset:1024
    ds_read_b64_tr_b16 a[40:41], v105 offset:8
    ds_read_b64_tr_b16 a[42:43], v105 offset:1032
    ds_read_b64_tr_b16 a[36:37], v105 offset:8192
    ds_read_b64_tr_b16 a[38:39], v105 offset:9216
    ds_read_b64_tr_b16 a[44:45], v105 offset:8200
    ds_read_b64_tr_b16 a[46:47], v105 offset:9224
    s_waitcnt lgkmcnt(0)
    ds_read_b64_tr_b16 a[48:49], v105 offset:16384
    ds_read_b64_tr_b16 a[50:51], v105 offset:17408
    ds_read_b64_tr_b16 a[56:57], v105 offset:16392
    ds_read_b64_tr_b16 a[58:59], v105 offset:17416
    ds_read_b64_tr_b16 a[52:53], v105 offset:24576
    ds_read_b64_tr_b16 a[54:55], v105 offset:25600
    ds_read_b64_tr_b16 a[60:61], v105 offset:24584
    ds_read_b64_tr_b16 a[62:63], v105 offset:25608
    s_branch L_w_47
L_w_47_2:
    s_cmp_eq_u32 s16, 2
    s_cbranch_scc0 L_w_47_3
    ds_read_b64_tr_b16 a[64:65], v105 offset:0
    ds_read_b64_tr_b16 a[66:67], v105 offset:1024
    ds_read_b64_tr_b16 a[72:73], v105 offset:8
    ds_read_b64_tr_b16 a[74:75], v105 offset:1032
    ds_read_b64_tr_b16 a[68:69], v105 offset:8192
    ds_read_b64_tr_b16 a[70:71], v105 offset:9216
    ds_read_b64_tr_b16 a[76:77], v105 offset:8200
    ds_read_b64_tr_b16 a[78:79], v105 offset:9224
    s_waitcnt lgkmcnt(0)
    ds_read_b64_tr_b16 a[80:81], v105 offset:16384
    ds_read_b64_tr_b16 a[82:83], v105 offset:17408
    ds_read_b64_tr_b16 a[88:89], v105 offset:16392
    ds_read_b64_tr_b16 a[90:91], v105 offset:17416
    ds_read_b64_tr_b16 a[84:85], v105 offset:24576
    ds_read_b64_tr_b16 a[86:87], v105 offset:25600
    ds_read_b64_tr_b16 a[92:93], v105 offset:24584
    ds_read_b64_tr_b16 a[94:95], v105 offset:25608
    s_branch L_w_47
L_w_47_3:
    ds_read_b64_tr_b16 a[96:97], v105 offset:0
    ds_read_b64_tr_b16 a[98:99], v105 offset:1024
    ds_read_b64_tr_b16 a[104:105], v105 offset:8
    ds_read_b64_tr_b16 a[106:107], v105 offset:1032
    ds_read_b64_tr_b16 a[100:101], v105 offset:8192
    ds_read_b64_tr_b16 a[102:103], v105 offset:9216
    ds_read_b64_tr_b16 a[108:109], v105 offset:8200
    ds_read_b64_tr_b16 a[110:111], v105 offset:9224
    s_waitcnt lgkmcnt(0)
    ds_read_b64_tr_b16 a[112:113], v105 offset:16384
    ds_read_b64_tr_b16 a[114:115], v105 offset:17408
    ds_read_b64_tr_b16 a[120:121], v105 offset:16392
    ds_read_b64_tr_b16 a[122:123], v105 offset:17416
    ds_read_b64_tr_b16 a[116:117], v105 offset:24576
    ds_read_b64_tr_b16 a[118:119], v105 offset:25600
    ds_read_b64_tr_b16 a[124:125], v105 offset:24584
    ds_read_b64_tr_b16 a[126:127], v105 offset:25608
L_w_47:
    s_waitcnt lgkmcnt(0)
    s_waitcnt vmcnt(16)
    s_barrier
    s_cmp_eq_u32 s16, 0
    s_cbranch_scc0 L_w_48_1
    ds_read_b64_tr_b16 a[32:33], v105 offset:32768
    ds_read_b64_tr_b16 a[34:35], v105 offset:33792
    ds_read_b64_tr_b16 a[40:41], v105 offset:32776
    ds_read_b64_tr_b16 a[42:43], v105 offset:33800
    ds_read_b64_tr_b16 a[36:37], v105 offset:40960
    ds_read_b64_tr_b16 a[38:39], v105 offset:41984
    ds_read_b64_tr_b16 a[44:45], v105 offset:40968
    ds_read_b64_tr_b16 a[46:47], v105 offset:41992
    s_waitcnt lgkmcnt(0)
    ds_read_b64_tr_b16 a[48:49], v105 offset:49152
    ds_read_b64_tr_b16 a[50:51], v105 offset:50176
    ds_read_b64_tr_b16 a[56:57], v105 offset:49160
    ds_read_b64_tr_b16 a[58:59], v105 offset:50184
    ds_read_b64_tr_b16 a[52:53], v105 offset:57344
    ds_read_b64_tr_b16 a[54:55], v105 offset:58368
    ds_read_b64_tr_b16 a[60:61], v105 offset:57352
    ds_read_b64_tr_b16 a[62:63], v105 offset:58376
    s_branch L_w_48
L_w_48_1:
    s_cmp_eq_u32 s16, 1
    s_cbranch_scc0 L_w_48_2
    ds_read_b64_tr_b16 a[0:1], v105 offset:32768
    ds_read_b64_tr_b16 a[2:3], v105 offset:33792
    ds_read_b64_tr_b16 a[8:9], v105 offset:32776
    ds_read_b64_tr_b16 a[10:11], v105 offset:33800
    ds_read_b64_tr_b16 a[4:5], v105 offset:40960
    ds_read_b64_tr_b16 a[6:7], v105 offset:41984
    ds_read_b64_tr_b16 a[12:13], v105 offset:40968
    ds_read_b64_tr_b16 a[14:15], v105 offset:41992
    s_waitcnt lgkmcnt(0)
    ds_read_b64_tr_b16 a[16:17], v105 offset:49152
    ds_read_b64_tr_b16 a[18:19], v105 offset:50176
    ds_read_b64_tr_b16 a[24:25], v105 offset:49160
    ds_read_b64_tr_b16 a[26:27], v105 offset:50184
    ds_read_b64_tr_b16 a[20:21], v105 offset:57344
    ds_read_b64_tr_b16 a[22:23], v105 offset:58368
    ds_read_b64_tr_b16 a[28:29], v105 offset:57352
    ds_read_b64_tr_b16 a[30:31], v105 offset:58376
    s_branch L_w_48
L_w_48_2:
    s_cmp_eq_u32 s16, 2
    s_cbranch_scc0 L_w_48_3
    ds_read_b64_tr_b16 a[96:97], v105 offset:32768
    ds_read_b64_tr_b16 a[98:99], v105 offset:33792
    ds_read_b64_tr_b16 a[104:105], v105 offset:32776
    ds_read_b64_tr_b16 a[106:107], v105 offset:33800
    ds_read_b64_tr_b16 a[100:101], v105 offset:40960
    ds_read_b64_tr_b16 a[102:103], v105 offset:41984
    ds_read_b64_tr_b16 a[108:109], v105 offset:40968
    ds_read_b64_tr_b16 a[110:111], v105 offset:41992
    s_waitcnt lgkmcnt(0)
    ds_read_b64_tr_b16 a[112:113], v105 offset:49152
    ds_read_b64_tr_b16 a[114:115], v105 offset:50176
    ds_read_b64_tr_b16 a[120:121], v105 offset:49160
    ds_read_b64_tr_b16 a[122:123], v105 offset:50184
    ds_read_b64_tr_b16 a[116:117], v105 offset:57344
    ds_read_b64_tr_b16 a[118:119], v105 offset:58368
    ds_read_b64_tr_b16 a[124:125], v105 offset:57352
    ds_read_b64_tr_b16 a[126:127], v105 offset:58376
    s_branch L_w_48
L_w_48_3:
    ds_read_b64_tr_b16 a[64:65], v105 offset:32768
    ds_read_b64_tr_b16 a[66:67], v105 offset:33792
    ds_read_b64_tr_b16 a[72:73], v105 offset:32776
    ds_read_b64_tr_b16 a[74:75], v105 offset:33800
    ds_read_b64_tr_b16 a[68:69], v105 offset:40960
    ds_read_b64_tr_b16 a[70:71], v105 offset:41984
    ds_read_b64_tr_b16 a[76:77], v105 offset:40968
    ds_read_b64_tr_b16 a[78:79], v105 offset:41992
    s_waitcnt lgkmcnt(0)
    ds_read_b64_tr_b16 a[80:81], v105 offset:49152
    ds_read_b64_tr_b16 a[82:83], v105 offset:50176
    ds_read_b64_tr_b16 a[88:89], v105 offset:49160
    ds_read_b64_tr_b16 a[90:91], v105 offset:50184
    ds_read_b64_tr_b16 a[84:85], v105 offset:57344
    ds_read_b64_tr_b16 a[86:87], v105 offset:58368
    ds_read_b64_tr_b16 a[92:93], v105 offset:57352
    ds_read_b64_tr_b16 a[94:95], v105 offset:58376
L_w_48:
    s_waitcnt lgkmcnt(0)
    s_waitcnt vmcnt(8)
    s_barrier
    v_xor_b32 v101, 0x10000, v101
    v_xor_b32 v102, 0x10000, v102
    v_xor_b32 v103, 0x10000, v103
    v_xor_b32 v104, 0x10000, v104
    v_xor_b32 v105, 0x10000, v105
    v_xor_b32 v106, 0x10000, v106
    v_xor_b32 v107, 0x10000, v107
    v_xor_b32 v108, 0x10000, v108
    s_cmp_eq_u32 s16, 0
    s_cbranch_scc0 L_w_49_1
    ds_read_b64_tr_b16 a[64:65], v105 offset:0
    ds_read_b64_tr_b16 a[66:67], v105 offset:1024
    ds_read_b64_tr_b16 a[72:73], v105 offset:8
    ds_read_b64_tr_b16 a[74:75], v105 offset:1032
    ds_read_b64_tr_b16 a[68:69], v105 offset:8192
    ds_read_b64_tr_b16 a[70:71], v105 offset:9216
    ds_read_b64_tr_b16 a[76:77], v105 offset:8200
    ds_read_b64_tr_b16 a[78:79], v105 offset:9224
    s_waitcnt lgkmcnt(0)
    ds_read_b64_tr_b16 a[80:81], v105 offset:16384
    ds_read_b64_tr_b16 a[82:83], v105 offset:17408
    ds_read_b64_tr_b16 a[88:89], v105 offset:16392
    ds_read_b64_tr_b16 a[90:91], v105 offset:17416
    ds_read_b64_tr_b16 a[84:85], v105 offset:24576
    ds_read_b64_tr_b16 a[86:87], v105 offset:25600
    ds_read_b64_tr_b16 a[92:93], v105 offset:24584
    ds_read_b64_tr_b16 a[94:95], v105 offset:25608
    s_branch L_w_49
L_w_49_1:
    s_cmp_eq_u32 s16, 1
    s_cbranch_scc0 L_w_49_2
    ds_read_b64_tr_b16 a[96:97], v105 offset:0
    ds_read_b64_tr_b16 a[98:99], v105 offset:1024
    ds_read_b64_tr_b16 a[104:105], v105 offset:8
    ds_read_b64_tr_b16 a[106:107], v105 offset:1032
    ds_read_b64_tr_b16 a[100:101], v105 offset:8192
    ds_read_b64_tr_b16 a[102:103], v105 offset:9216
    ds_read_b64_tr_b16 a[108:109], v105 offset:8200
    ds_read_b64_tr_b16 a[110:111], v105 offset:9224
    s_waitcnt lgkmcnt(0)
    ds_read_b64_tr_b16 a[112:113], v105 offset:16384
    ds_read_b64_tr_b16 a[114:115], v105 offset:17408
    ds_read_b64_tr_b16 a[120:121], v105 offset:16392
    ds_read_b64_tr_b16 a[122:123], v105 offset:17416
    ds_read_b64_tr_b16 a[116:117], v105 offset:24576
    ds_read_b64_tr_b16 a[118:119], v105 offset:25600
    ds_read_b64_tr_b16 a[124:125], v105 offset:24584
    ds_read_b64_tr_b16 a[126:127], v105 offset:25608
    s_branch L_w_49
L_w_49_2:
    s_cmp_eq_u32 s16, 2
    s_cbranch_scc0 L_w_49_3
    ds_read_b64_tr_b16 a[0:1], v105 offset:0
    ds_read_b64_tr_b16 a[2:3], v105 offset:1024
    ds_read_b64_tr_b16 a[8:9], v105 offset:8
    ds_read_b64_tr_b16 a[10:11], v105 offset:1032
    ds_read_b64_tr_b16 a[4:5], v105 offset:8192
    ds_read_b64_tr_b16 a[6:7], v105 offset:9216
    ds_read_b64_tr_b16 a[12:13], v105 offset:8200
    ds_read_b64_tr_b16 a[14:15], v105 offset:9224
    s_waitcnt lgkmcnt(0)
    ds_read_b64_tr_b16 a[16:17], v105 offset:16384
    ds_read_b64_tr_b16 a[18:19], v105 offset:17408
    ds_read_b64_tr_b16 a[24:25], v105 offset:16392
    ds_read_b64_tr_b16 a[26:27], v105 offset:17416
    ds_read_b64_tr_b16 a[20:21], v105 offset:24576
    ds_read_b64_tr_b16 a[22:23], v105 offset:25600
    ds_read_b64_tr_b16 a[28:29], v105 offset:24584
    ds_read_b64_tr_b16 a[30:31], v105 offset:25608
    s_branch L_w_49
L_w_49_3:
    ds_read_b64_tr_b16 a[32:33], v105 offset:0
    ds_read_b64_tr_b16 a[34:35], v105 offset:1024
    ds_read_b64_tr_b16 a[40:41], v105 offset:8
    ds_read_b64_tr_b16 a[42:43], v105 offset:1032
    ds_read_b64_tr_b16 a[36:37], v105 offset:8192
    ds_read_b64_tr_b16 a[38:39], v105 offset:9216
    ds_read_b64_tr_b16 a[44:45], v105 offset:8200
    ds_read_b64_tr_b16 a[46:47], v105 offset:9224
    s_waitcnt lgkmcnt(0)
    ds_read_b64_tr_b16 a[48:49], v105 offset:16384
    ds_read_b64_tr_b16 a[50:51], v105 offset:17408
    ds_read_b64_tr_b16 a[56:57], v105 offset:16392
    ds_read_b64_tr_b16 a[58:59], v105 offset:17416
    ds_read_b64_tr_b16 a[52:53], v105 offset:24576
    ds_read_b64_tr_b16 a[54:55], v105 offset:25600
    ds_read_b64_tr_b16 a[60:61], v105 offset:24584
    ds_read_b64_tr_b16 a[62:63], v105 offset:25608
L_w_49:
    s_waitcnt lgkmcnt(0)
    s_waitcnt vmcnt(0)
    s_barrier
    s_cmp_eq_u32 s16, 0
    s_cbranch_scc0 L_w_50_1
    ds_read_b64_tr_b16 a[96:97], v105 offset:32768
    ds_read_b64_tr_b16 a[98:99], v105 offset:33792
    ds_read_b64_tr_b16 a[104:105], v105 offset:32776
    ds_read_b64_tr_b16 a[106:107], v105 offset:33800
    ds_read_b64_tr_b16 a[100:101], v105 offset:40960
    ds_read_b64_tr_b16 a[102:103], v105 offset:41984
    ds_read_b64_tr_b16 a[108:109], v105 offset:40968
    ds_read_b64_tr_b16 a[110:111], v105 offset:41992
    s_waitcnt lgkmcnt(0)
    ds_read_b64_tr_b16 a[112:113], v105 offset:49152
    ds_read_b64_tr_b16 a[114:115], v105 offset:50176
    ds_read_b64_tr_b16 a[120:121], v105 offset:49160
    ds_read_b64_tr_b16 a[122:123], v105 offset:50184
    ds_read_b64_tr_b16 a[116:117], v105 offset:57344
    ds_read_b64_tr_b16 a[118:119], v105 offset:58368
    ds_read_b64_tr_b16 a[124:125], v105 offset:57352
    ds_read_b64_tr_b16 a[126:127], v105 offset:58376
    s_branch L_w_50
L_w_50_1:
    s_cmp_eq_u32 s16, 1
    s_cbranch_scc0 L_w_50_2
    ds_read_b64_tr_b16 a[64:65], v105 offset:32768
    ds_read_b64_tr_b16 a[66:67], v105 offset:33792
    ds_read_b64_tr_b16 a[72:73], v105 offset:32776
    ds_read_b64_tr_b16 a[74:75], v105 offset:33800
    ds_read_b64_tr_b16 a[68:69], v105 offset:40960
    ds_read_b64_tr_b16 a[70:71], v105 offset:41984
    ds_read_b64_tr_b16 a[76:77], v105 offset:40968
    ds_read_b64_tr_b16 a[78:79], v105 offset:41992
    s_waitcnt lgkmcnt(0)
    ds_read_b64_tr_b16 a[80:81], v105 offset:49152
    ds_read_b64_tr_b16 a[82:83], v105 offset:50176
    ds_read_b64_tr_b16 a[88:89], v105 offset:49160
    ds_read_b64_tr_b16 a[90:91], v105 offset:50184
    ds_read_b64_tr_b16 a[84:85], v105 offset:57344
    ds_read_b64_tr_b16 a[86:87], v105 offset:58368
    ds_read_b64_tr_b16 a[92:93], v105 offset:57352
    ds_read_b64_tr_b16 a[94:95], v105 offset:58376
    s_branch L_w_50
L_w_50_2:
    s_cmp_eq_u32 s16, 2
    s_cbranch_scc0 L_w_50_3
    ds_read_b64_tr_b16 a[32:33], v105 offset:32768
    ds_read_b64_tr_b16 a[34:35], v105 offset:33792
    ds_read_b64_tr_b16 a[40:41], v105 offset:32776
    ds_read_b64_tr_b16 a[42:43], v105 offset:33800
    ds_read_b64_tr_b16 a[36:37], v105 offset:40960
    ds_read_b64_tr_b16 a[38:39], v105 offset:41984
    ds_read_b64_tr_b16 a[44:45], v105 offset:40968
    ds_read_b64_tr_b16 a[46:47], v105 offset:41992
    s_waitcnt lgkmcnt(0)
    ds_read_b64_tr_b16 a[48:49], v105 offset:49152
    ds_read_b64_tr_b16 a[50:51], v105 offset:50176
    ds_read_b64_tr_b16 a[56:57], v105 offset:49160
    ds_read_b64_tr_b16 a[58:59], v105 offset:50184
    ds_read_b64_tr_b16 a[52:53], v105 offset:57344
    ds_read_b64_tr_b16 a[54:55], v105 offset:58368
    ds_read_b64_tr_b16 a[60:61], v105 offset:57352
    ds_read_b64_tr_b16 a[62:63], v105 offset:58376
    s_branch L_w_50
L_w_50_3:
    ds_read_b64_tr_b16 a[0:1], v105 offset:32768
    ds_read_b64_tr_b16 a[2:3], v105 offset:33792
    ds_read_b64_tr_b16 a[8:9], v105 offset:32776
    ds_read_b64_tr_b16 a[10:11], v105 offset:33800
    ds_read_b64_tr_b16 a[4:5], v105 offset:40960
    ds_read_b64_tr_b16 a[6:7], v105 offset:41984
    ds_read_b64_tr_b16 a[12:13], v105 offset:40968
    ds_read_b64_tr_b16 a[14:15], v105 offset:41992
    s_waitcnt lgkmcnt(0)
    ds_read_b64_tr_b16 a[16:17], v105 offset:49152
    ds_read_b64_tr_b16 a[18:19], v105 offset:50176
    ds_read_b64_tr_b16 a[24:25], v105 offset:49160
    ds_read_b64_tr_b16 a[26:27], v105 offset:50184
    ds_read_b64_tr_b16 a[20:21], v105 offset:57344
    ds_read_b64_tr_b16 a[22:23], v105 offset:58368
    ds_read_b64_tr_b16 a[28:29], v105 offset:57352
    ds_read_b64_tr_b16 a[30:31], v105 offset:58376
L_w_50:
    s_waitcnt lgkmcnt(0)
    s_cmp_eq_u32 s91, 0
    s_cbranch_scc0 L_arr_54
    s_mov_b32 s91, 1
    s_waitcnt vmcnt(0)
    s_barrier
    s_cmp_eq_u32 s16, 0
    s_cbranch_scc0 L_arr_54
    s_lshl_b32 s21, s17, 5
    s_add_u32 s21, s21, 4
    s_atomic_add s3, s[56:57], s21
L_arr_54:
    s_cmp_eq_u32 s20, 0
    s_cbranch_scc0 L_rdv_done_52
    s_mov_b32 s27, 0
    v_lshlrev_b32 v1, 2, v0
L_rdv_51:
    buffer_load_dword v2, v1, s[60:63], 0 offen sc1
    s_add_u32 s27, s27, 1
    s_cmp_gt_u32 s27, 262144
    s_cbranch_scc1 L_end
L_rdv_51_p:
    s_waitcnt vmcnt(0)
    s_mov_b32 s21, 0
    v_readlane_b32 s22, v2, 1
    s_nop 0
    s_add_u32 s21, s21, s22
    v_readlane_b32 s22, v2, 9
    s_nop 0
    s_add_u32 s21, s21, s22
    v_readlane_b32 s22, v2, 17
    s_nop 0
    s_add_u32 s21, s21, s22
    v_readlane_b32 s22, v2, 25
    s_nop 0
    s_add_u32 s21, s21, s22
    v_readlane_b32 s22, v2, 33
    s_nop 0
    s_add_u32 s21, s21, s22
    v_readlane_b32 s22, v2, 41
    s_nop 0
    s_add_u32 s21, s21, s22
    v_readlane_b32 s22, v2, 49
    s_nop 0
    s_add_u32 s21, s21, s22
    v_readlane_b32 s22, v2, 57
    s_nop 0
    s_add_u32 s21, s21, s22
    s_cmp_eq_u32 s21, 256
    s_cbranch_scc1 L_rdv_l_53
    s_sleep 4
    s_branch L_rdv_51
L_rdv_l_53:
    s_mov_b32 s21, 0
    s_mov_b32 s23, 0
    v_readlane_b32 s22, v2, 0
    s_cmp_gt_u32 s17, 0
    s_cselect_b32 s24, s22, 0
    s_add_u32 s23, s23, s24
    s_xor_b32 s22, s22, 32
    s_or_b32 s21, s21, s22
    v_readlane_b32 s22, v2, 8
    s_cmp_gt_u32 s17, 1
    s_cselect_b32 s24, s22, 0
    s_add_u32 s23, s23, s24
    s_xor_b32 s22, s22, 32
    s_or_b32 s21, s21, s22
    v_readlane_b32 s22, v2, 16
    s_cmp_gt_u32 s17, 2
    s_cselect_b32 s24, s22, 0
    s_add_u32 s23, s23, s24
    s_xor_b32 s22, s22, 32
    s_or_b32 s21, s21, s22
    v_readlane_b32 s22, v2, 24
    s_cmp_gt_u32 s17, 3
    s_cselect_b32 s24, s22, 0
    s_add_u32 s23, s23, s24
    s_xor_b32 s22, s22, 32
    s_or_b32 s21, s21, s22
    v_readlane_b32 s22, v2, 32
    s_cmp_gt_u32 s17, 4
    s_cselect_b32 s24, s22, 0
    s_add_u32 s23, s23, s24
    s_xor_b32 s22, s22, 32
    s_or_b32 s21, s21, s22
    v_readlane_b32 s22, v2, 40
    s_cmp_gt_u32 s17, 5
    s_cselect_b32 s24, s22, 0
    s_add_u32 s23, s23, s24
    s_xor_b32 s22, s22, 32
    s_or_b32 s21, s21, s22
    v_readlane_b32 s22, v2, 48
    s_cmp_gt_u32 s17, 6
    s_cselect_b32 s24, s22, 0
    s_add_u32 s23, s23, s24
    s_xor_b32 s22, s22, 32
    s_or_b32 s21, s21, s22
    v_readlane_b32 s22, v2, 56
    s_cmp_gt_u32 s17, 7
    s_cselect_b32 s24, s22, 0
    s_add_u32 s23, s23, s24
    s_xor_b32 s22, s22, 32
    s_or_b32 s21, s21, s22
    s_mov_b32 s20, 1
    s_cmp_eq_u32 s21, 0
    s_cbranch_scc1 L_rdv_done_52
    s_mov_b32 s20, 2
    s_add_u32 s19, s23, s18
    s_waitcnt vmcnt(0) lgkmcnt(0)
    s_barrier
    s_branch L_dispatch
L_rdv_done_52:
    v_lshrrev_b32 v14, 4, v0
    v_and_b32 v15, 15, v0
    v_lshlrev_b32 v14, 9, v14
    v_lshl_add_u32 v14, v15, 4, v14
    s_xor_b32 s21, s16, 0
    s_lshl_b32 s21, s21, 13
    s_add_u32 s21, s21, 0
    v_add_u32 v10, s21, v14
    s_xor_b32 s21, s16, 1
    s_lshl_b32 s21, s21, 13
    s_add_u32 s21, s21, 0
    v_add_u32 v11, s21, v14
    s_xor_b32 s21, s16, 2
    s_lshl_b32 s21, s21, 13
    s_add_u32 s21, s21, 0
    v_add_u32 v12, s21, v14
    s_xor_b32 s21, s16, 3
    s_lshl_b32 s21, s21, 13
    s_add_u32 s21, s21, 0
    v_add_u32 v13, s21, v14
    s_barrier
    v_bfe_u32 v14, v0, 3, 1
    v_lshlrev_b32 v1, 9, v14
    v_bfe_u32 v15, v0, 4, 1
    v_lshl_add_u32 v1, v15, 8, v1
    v_bfe_u32 v15, v0, 2, 1
    v_lshl_add_u32 v1, v15, 7, v1
    v_lshlrev_b32 v4, 8, v14
    v_lshl_add_u32 v4, v15, 6, v4
    v_and_b32 v14, 3, v0
    v_lshl_add_u32 v1, v14, 5, v1
    v_lshl_add_u32 v4, v14, 4, v4
    v_lshrrev_b32 v14, 5, v0
    v_lshl_add_u32 v1, v14, 4, v1
    v_lshrrev_b32 v14, 4, v0
    v_lshl_add_u32 v4, v14, 9, v4
    v_and_b32 v15, 15, v0
    v_lshlrev_b32 v3, 11, v14
    v_lshl_add_u32 v3, v15, 4, v3
    v_mov_b32 v5, 1
    s_lshl_b32 s80, s16, 13
    s_mov_b32 s69, 0
    s_mov_b32 s72, 0
    s_mul_i32 s82, s64, 24576
    s_add_u32 s82, s82, 127926272
    s_lshl_b32 s83, s64, 7
    s_lshl_b32 s86, s16, 2
    s_add_u32 s83, s83, s86
    v_and_b32 v9, 7, v0
    v_lshlrev_b32 v2, 7, v9
    s_add_u32 s83, s83, 6144
    s_mov_b32 s73, 0
    v_xor_b32 v120, 0, v1
    v_xor_b32 v121, 128, v1
    v_xor_b32 v122, 256, v1
    v_xor_b32 v123, 384, v1
    v_xor_b32 v124, 512, v1
    v_xor_b32 v125, 640, v1
    v_xor_b32 v126, 768, v1
    v_xor_b32 v127, 896, v1
    s_bitcmp1_b64 s[84:85], s69
    s_cselect_b32 s71, s67, s68
    s_cselect_b32 s21, s65, 0
    s_cselect_b32 s22, 0, 2
    s_add_u32 s67, s67, s21
    s_add_u32 s68, s68, s22
    s_lshr_b32 s22, s67, 1
    s_cmp_eq_u32 s22, 12
    s_cselect_b32 s21, s21, 0
    s_lshr_b32 s21, s21, 1
    s_mul_i32 s21, s21, 10
    s_add_u32 s67, s67, s21
    s_add_u32 s69, s69, 1
    s_lshl_b32 s74, s71, 14
    s_add_u32 s74, s74, s86
    s_cmp_le_u32 s69, s88
    s_cselect_b32 s74, s74, 14336
    s_lshl_b32 s75, s71, 15
    s_add_u32 s75, s75, s80
    s_add_u32 s75, s75, 4194304
    s_xor_b32 s81, s72, 0x8000
    s_add_u32 s81, s81, s80
L_qkv_block:
    s_mov_b32 s27, 0
L_poll_55:
    buffer_load_dword v8, v2, s[4:7], s74 offen sc1
    s_add_u32 s27, s27, 1
    s_cmp_gt_u32 s27, 262144
    s_cbranch_scc1 L_end
    s_waitcnt vmcnt(0)
    v_cmp_gt_u32 vcc, 1, v8
    s_cbranch_vccz L_poll_55_ok
    s_sleep 4
    s_branch L_poll_55
L_poll_55_ok:
    s_mov_b32 m0, s81
    s_add_u32 s23, s75, 4096
    buffer_load_dwordx4 v120, s[4:7], s75 offen offset:0 sc1 lds
    buffer_load_dwordx4 v121, s[4:7], s75 offen offset:1024 sc1 lds
    buffer_load_dwordx4 v122, s[4:7], s75 offen offset:2048 sc1 lds
    buffer_load_dwordx4 v123, s[4:7], s75 offen offset:3072 sc1 lds
    s_add_u32 m0, m0, 4096
    s_nop 0
    buffer_load_dwordx4 v124, s[4:7], s23 offen offset:0 sc1 lds
    buffer_load_dwordx4 v125, s[4:7], s23 offen offset:1024 sc1 lds
    buffer_load_dwordx4 v126, s[4:7], s23 offen offset:2048 sc1 lds
    buffer_load_dwordx4 v127, s[4:7], s23 offen offset:3072 sc1 lds
    v_xor_b32 v10, 0x8000, v10
    v_xor_b32 v11, 0x8000, v11
    v_xor_b32 v12, 0x8000, v12
    v_xor_b32 v13, 0x8000, v13
    s_xor_b32 s72, s72, 0x8000
    s_mov_b32 s70, s71
    s_waitcnt vmcnt(6)
    ds_read_b128 v[64:67], v10 offset:0
    ds_read_b128 v[68:71], v10 offset:256
    s_waitcnt vmcnt(4)
    ds_read_b128 v[72:75], v10 offset:2048
    s_waitcnt lgkmcnt(2)
    v_mfma_f32_16x16x32_bf16 v[32:35], a[128:131], v[64:67], 0
    s_waitcnt vmcnt(4)
    ds_read_b128 v[76:79], v10 offset:2304
    v_mfma_f32_16x16x32_bf16 v[36:39], a[136:139], v[64:67], 0
    s_bitcmp1_b64 s[84:85], s69
    v_mfma_f32_16x16x32_bf16 v[48:51], v[64:67], v[128:131], 0
    s_cselect_b32 s71, s67, s68
    v_mfma_f32_16x16x32_bf16 v[56:59], v[64:67], v[136:139], 0
    s_cselect_b32 s21, s65, 0
    v_mfma_f32_16x16x32_bf16 v[16:19], a[0:3], v[64:67], 0
    s_cselect_b32 s22, 0, 2
    v_mfma_f32_16x16x32_bf16 v[20:23], a[8:11], v[64:67], 0
    s_add_u32 s67, s67, s21
    s_waitcnt lgkmcnt(2)
    v_mfma_f32_16x16x32_bf16 v[40:43], a[128:131], v[68:71], 0
    s_waitcnt vmcnt(2)
    ds_read_b128 v[80:83], v10 offset:4096
    v_mfma_f32_16x16x32_bf16 v[44:47], a[136:139], v[68:71], 0
    s_add_u32 s68, s68, s22
    v_mfma_f32_16x16x32_bf16 v[52:55], v[68:71], v[128:131], 0
    s_lshr_b32 s22, s67, 1
    v_mfma_f32_16x16x32_bf16 v[60:63], v[68:71], v[136:139], 0
    s_cmp_eq_u32 s22, 12
    v_mfma_f32_16x16x32_bf16 v[24:27], a[0:3], v[68:71], 0
    s_cselect_b32 s21, s21, 0
    v_mfma_f32_16x16x32_bf16 v[28:31], a[8:11], v[68:71], 0
    s_lshr_b32 s21, s21, 1
    s_waitcnt lgkmcnt(2)
    v_mfma_f32_16x16x32_bf16 v[32:35], a[132:135], v[72:75], v[32:35]
    ds_read_b128 v[84:87], v10 offset:4352
    v_mfma_f32_16x16x32_bf16 v[36:39], a[140:143], v[72:75], v[36:39]
    s_mul_i32 s21, s21, 10
    v_mfma_f32_16x16x32_bf16 v[48:51], v[72:75], v[132:135], v[48:51]
    s_add_u32 s67, s67, s21
    v_mfma_f32_16x16x32_bf16 v[56:59], v[72:75], v[140:143], v[56:59]
    s_add_u32 s69, s69, 1
    v_mfma_f32_16x16x32_bf16 v[16:19], a[4:7], v[72:75], v[16:19]
    s_lshl_b32 s74, s71, 14
    v_mfma_f32_16x16x32_bf16 v[20:23], a[12:15], v[72:75], v[20:23]
    s_add_u32 s74, s74, s86
    s_waitcnt lgkmcnt(2)
    v_mfma_f32_16x16x32_bf16 v[40:43], a[132:135], v[76:79], v[40:43]
    s_waitcnt vmcnt(0)
    ds_read_b128 v[88:91], v10 offset:6144
    v_mfma_f32_16x16x32_bf16 v[44:47], a[140:143], v[76:79], v[44:47]
    s_cmp_le_u32 s69, s88
    v_mfma_f32_16x16x32_bf16 v[52:55], v[76:79], v[132:135], v[52:55]
    s_cselect_b32 s74, s74, 14336
    v_mfma_f32_16x16x32_bf16 v[60:63], v[76:79], v[140:143], v[60:63]
    s_lshl_b32 s75, s71, 15
    v_mfma_f32_16x16x32_bf16 v[24:27], a[4:7], v[76:79], v[24:27]
    s_add_u32 s75, s75, s80
    v_mfma_f32_16x16x32_bf16 v[28:31], a[12:15], v[76:79], v[28:31]
    s_add_u32 s75, s75, 4194304
    s_waitcnt lgkmcnt(2)
    v_mfma_f32_16x16x32_bf16 v[32:35], a[144:147], v[80:83], v[32:35]
    ds_read_b128 v[92:95], v10 offset:6400
    v_mfma_f32_16x16x32_bf16 v[36:39], a[152:155], v[80:83], v[36:39]
    s_xor_b32 s81, s72, 0x8000
    v_mfma_f32_16x16x32_bf16 v[48:51], v[80:83], v[144:147], v[48:51]
    s_add_u32 s81, s81, s80
    v_mfma_f32_16x16x32_bf16 v[56:59], v[80:83], v[152:155], v[56:59]
    s_mov_b32 s87, s70
    v_mfma_f32_16x16x32_bf16 v[16:19], a[16:19], v[80:83], v[16:19]
    s_mul_i32 s76, s70, 786432
    v_mfma_f32_16x16x32_bf16 v[20:23], a[24:27], v[80:83], v[20:23]
    s_add_u32 s76, s76, s82
    s_waitcnt lgkmcnt(2)
    v_mfma_f32_16x16x32_bf16 v[40:43], a[144:147], v[84:87], v[40:43]
    s_barrier
    ds_read_b128 v[64:67], v11 offset:0
    v_mfma_f32_16x16x32_bf16 v[44:47], a[152:155], v[84:87], v[44:47]
    s_lshl_b32 s21, s16, 11
    v_mfma_f32_16x16x32_bf16 v[52:55], v[84:87], v[144:147], v[52:55]
    s_add_u32 s77, s76, s21
    v_mfma_f32_16x16x32_bf16 v[60:63], v[84:87], v[152:155], v[60:63]
    s_add_u32 s78, s77, 8192
    v_mfma_f32_16x16x32_bf16 v[24:27], a[16:19], v[84:87], v[24:27]
    s_lshl_b32 s21, s16, 9
    v_mfma_f32_16x16x32_bf16 v[28:31], a[24:27], v[84:87], v[28:31]
    s_add_u32 s76, s76, s21
    s_waitcnt lgkmcnt(2)
    v_mfma_f32_16x16x32_bf16 v[32:35], a[148:151], v[88:91], v[32:35]
    ds_read_b128 v[68:71], v11 offset:256
    v_mfma_f32_16x16x32_bf16 v[36:39], a[156:159], v[88:91], v[36:39]
    s_add_u32 s76, s76, 16384
    v_mfma_f32_16x16x32_bf16 v[48:51], v[88:91], v[148:151], v[48:51]
    v_mfma_f32_16x16x32_bf16 v[56:59], v[88:91], v[156:159], v[56:59]
    v_mfma_f32_16x16x32_bf16 v[16:19], a[20:23], v[88:91], v[16:19]
    v_mfma_f32_16x16x32_bf16 v[20:23], a[28:31], v[88:91], v[20:23]
    s_waitcnt lgkmcnt(2)
    v_mfma_f32_16x16x32_bf16 v[40:43], a[148:151], v[92:95], v[40:43]
    ds_read_b128 v[72:75], v11 offset:2048
    v_mfma_f32_16x16x32_bf16 v[44:47], a[156:159], v[92:95], v[44:47]
    v_mfma_f32_16x16x32_bf16 v[52:55], v[92:95], v[148:151], v[52:55]
    v_mfma_f32_16x16x32_bf16 v[60:63], v[92:95], v[156:159], v[60:63]
    v_mfma_f32_16x16x32_bf16 v[24:27], a[20:23], v[92:95], v[24:27]
    v_mfma_f32_16x16x32_bf16 v[28:31], a[28:31], v[92:95], v[28:31]
    s_waitcnt lgkmcnt(2)
    v_mfma_f32_16x16x32_bf16 v[32:35], a[160:163], v[64:67], v[32:35]
    ds_read_b128 v[76:79], v11 offset:2304
    v_mfma_f32_16x16x32_bf16 v[36:39], a[168:171], v[64:67], v[36:39]
    v_mfma_f32_16x16x32_bf16 v[48:51], v[64:67], v[160:163], v[48:51]
    v_mfma_f32_16x16x32_bf16 v[56:59], v[64:67], v[168:171], v[56:59]
    v_mfma_f32_16x16x32_bf16 v[16:19], a[32:35], v[64:67], v[16:19]
    v_mfma_f32_16x16x32_bf16 v[20:23], a[40:43], v[64:67], v[20:23]
    s_waitcnt lgkmcnt(2)
    v_mfma_f32_16x16x32_bf16 v[40:43], a[160:163], v[68:71], v[40:43]
    ds_read_b128 v[80:83], v11 offset:4096
    v_mfma_f32_16x16x32_bf16 v[44:47], a[168:171], v[68:71], v[44:47]
    v_mfma_f32_16x16x32_bf16 v[52:55], v[68:71], v[160:163], v[52:55]
    v_mfma_f32_16x16x32_bf16 v[60:63], v[68:71], v[168:171], v[60:63]
    v_mfma_f32_16x16x32_bf16 v[24:27], a[32:35], v[68:71], v[24:27]
    v_mfma_f32_16x16x32_bf16 v[28:31], a[40:43], v[68:71], v[28:31]
    s_waitcnt lgkmcnt(2)
    v_mfma_f32_16x16x32_bf16 v[32:35], a[164:167], v[72:75], v[32:35]
    ds_read_b128 v[84:87], v11 offset:4352
    v_mfma_f32_16x16x32_bf16 v[36:39], a[172:175], v[72:75], v[36:39]
    buffer_load_dword v8, v2, s[4:7], s74 offen sc1
    v_mfma_f32_16x16x32_bf16 v[48:51], v[72:75], v[164:167], v[48:51]
    v_mfma_f32_16x16x32_bf16 v[56:59], v[72:75], v[172:175], v[56:59]
    v_mfma_f32_16x16x32_bf16 v[16:19], a[36:39], v[72:75], v[16:19]
    v_mfma_f32_16x16x32_bf16 v[20:23], a[44:47], v[72:75], v[20:23]
    s_waitcnt lgkmcnt(2)
    v_mfma_f32_16x16x32_bf16 v[40:43], a[164:167], v[76:79], v[40:43]
    ds_read_b128 v[88:91], v11 offset:6144
    v_mfma_f32_16x16x32_bf16 v[44:47], a[172:175], v[76:79], v[44:47]
    v_mfma_f32_16x16x32_bf16 v[52:55], v[76:79], v[164:167], v[52:55]
    v_mfma_f32_16x16x32_bf16 v[60:63], v[76:79], v[172:175], v[60:63]
    v_mfma_f32_16x16x32_bf16 v[24:27], a[36:39], v[76:79], v[24:27]
    v_mfma_f32_16x16x32_bf16 v[28:31], a[44:47], v[76:79], v[28:31]
    s_waitcnt lgkmcnt(2)
    v_mfma_f32_16x16x32_bf16 v[32:35], a[176:179], v[80:83], v[32:35]
    ds_read_b128 v[92:95], v11 offset:6400
    v_mfma_f32_16x16x32_bf16 v[36:39], a[184:187], v[80:83], v[36:39]
    v_mfma_f32_16x16x32_bf16 v[48:51], v[80:83], v[176:179], v[48:51]
    v_mfma_f32_16x16x32_bf16 v[56:59], v[80:83], v[184:187], v[56:59]
    v_mfma_f32_16x16x32_bf16 v[16:19], a[48:51], v[80:83], v[16:19]
    v_mfma_f32_16x16x32_bf16 v[20:23], a[56:59], v[80:83], v[20:23]
    s_waitcnt lgkmcnt(2)
    v_mfma_f32_16x16x32_bf16 v[40:43], a[176:179], v[84:87], v[40:43]
    ds_read_b128 v[64:67], v12 offset:0
    v_mfma_f32_16x16x32_bf16 v[44:47], a[184:187], v[84:87], v[44:47]
    v_mfma_f32_16x16x32_bf16 v[52:55], v[84:87], v[176:179], v[52:55]
    v_mfma_f32_16x16x32_bf16 v[60:63], v[84:87], v[184:187], v[60:63]
    v_mfma_f32_16x16x32_bf16 v[24:27], a[48:51], v[84:87], v[24:27]
    v_mfma_f32_16x16x32_bf16 v[28:31], a[56:59], v[84:87], v[28:31]
    s_waitcnt lgkmcnt(2)
    v_mfma_f32_16x16x32_bf16 v[32:35], a[180:183], v[88:91], v[32:35]
    ds_read_b128 v[68:71], v12 offset:256
    v_mfma_f32_16x16x32_bf16 v[36:39], a[188:191], v[88:91], v[36:39]
    v_mfma_f32_16x16x32_bf16 v[48:51], v[88:91], v[180:183], v[48:51]
    v_mfma_f32_16x16x32_bf16 v[56:59], v[88:91], v[188:191], v[56:59]
    v_mfma_f32_16x16x32_bf16 v[16:19], a[52:55], v[88:91], v[16:19]
    v_mfma_f32_16x16x32_bf16 v[20:23], a[60:63], v[88:91], v[20:23]
    s_waitcnt lgkmcnt(2)
    v_mfma_f32_16x16x32_bf16 v[40:43], a[180:183], v[92:95], v[40:43]
    ds_read_b128 v[72:75], v12 offset:2048
    v_mfma_f32_16x16x32_bf16 v[44:47], a[188:191], v[92:95], v[44:47]
    v_mfma_f32_16x16x32_bf16 v[52:55], v[92:95], v[180:183], v[52:55]
    s_lshl_b32 s73, s70, 14
    v_mfma_f32_16x16x32_bf16 v[60:63], v[92:95], v[188:191], v[60:63]
    s_add_u32 s73, s73, s83
    v_mfma_f32_16x16x32_bf16 v[24:27], a[52:55], v[92:95], v[24:27]
    v_mfma_f32_16x16x32_bf16 v[28:31], a[60:63], v[92:95], v[28:31]
    s_waitcnt lgkmcnt(2)
    v_mfma_f32_16x16x32_bf16 v[32:35], a[192:195], v[64:67], v[32:35]
    ds_read_b128 v[76:79], v12 offset:2304
    v_mfma_f32_16x16x32_bf16 v[36:39], a[200:203], v[64:67], v[36:39]
    v_mfma_f32_16x16x32_bf16 v[48:51], v[64:67], v[192:195], v[48:51]
    v_mfma_f32_16x16x32_bf16 v[56:59], v[64:67], v[200:203], v[56:59]
    v_mfma_f32_16x16x32_bf16 v[16:19], a[64:67], v[64:67], v[16:19]
    v_mfma_f32_16x16x32_bf16 v[20:23], a[72:75], v[64:67], v[20:23]
    s_waitcnt lgkmcnt(2)
    v_mfma_f32_16x16x32_bf16 v[40:43], a[192:195], v[68:71], v[40:43]
    ds_read_b128 v[80:83], v12 offset:4096
    v_mfma_f32_16x16x32_bf16 v[44:47], a[200:203], v[68:71], v[44:47]
    v_mfma_f32_16x16x32_bf16 v[52:55], v[68:71], v[192:195], v[52:55]
    v_mfma_f32_16x16x32_bf16 v[60:63], v[68:71], v[200:203], v[60:63]
    v_mfma_f32_16x16x32_bf16 v[24:27], a[64:67], v[68:71], v[24:27]
    v_mfma_f32_16x16x32_bf16 v[28:31], a[72:75], v[68:71], v[28:31]
    s_waitcnt vmcnt(0)
    s_branch L_qkv_ck
L_qkv_loop1:
    s_waitcnt lgkmcnt(2)
    v_mfma_f32_16x16x32_bf16 v[32:35], a[128:131], v[64:67], 0
    ds_read_b128 v[76:79], v10 offset:2304
    v_mfma_f32_16x16x32_bf16 v[36:39], a[136:139], v[64:67], 0
    v_cvt_pk_bf16_f32 v104, v16, v17
    v_cvt_pk_bf16_f32 v105, v18, v19
    v_mfma_f32_16x16x32_bf16 v[48:51], v[64:67], v[128:131], 0
    v_cvt_pk_bf16_f32 v106, v20, v21
    v_cvt_pk_bf16_f32 v107, v22, v23
    v_mfma_f32_16x16x32_bf16 v[56:59], v[64:67], v[136:139], 0
    buffer_store_dwordx4 v[96:99], v3, s[4:7], s76 offen sc1
    s_waitcnt lgkmcnt(2)
    v_mfma_f32_16x16x32_bf16 v[40:43], a[128:131], v[68:71], 0
    ds_read_b128 v[80:83], v10 offset:4096
    v_mfma_f32_16x16x32_bf16 v[44:47], a[136:139], v[68:71], 0
    v_cvt_pk_bf16_f32 v108, v24, v25
    v_cvt_pk_bf16_f32 v109, v26, v27
    v_mfma_f32_16x16x32_bf16 v[52:55], v[68:71], v[128:131], 0
    v_cvt_pk_bf16_f32 v110, v28, v29
    v_cvt_pk_bf16_f32 v111, v30, v31
    v_mfma_f32_16x16x32_bf16 v[60:63], v[68:71], v[136:139], 0
    v_mfma_f32_16x16x32_bf16 v[16:19], a[0:3], v[64:67], 0
    buffer_store_dwordx4 v[100:103], v3, s[4:7], s76 offen offset:256 sc1
    v_mfma_f32_16x16x32_bf16 v[20:23], a[8:11], v[64:67], 0
    v_mfma_f32_16x16x32_bf16 v[24:27], a[0:3], v[68:71], 0
    v_mfma_f32_16x16x32_bf16 v[28:31], a[8:11], v[68:71], 0
    s_waitcnt lgkmcnt(2)
    v_mfma_f32_16x16x32_bf16 v[32:35], a[132:135], v[72:75], v[32:35]
    ds_read_b128 v[84:87], v10 offset:4352
    v_mfma_f32_16x16x32_bf16 v[36:39], a[140:143], v[72:75], v[36:39]
    v_mfma_f32_16x16x32_bf16 v[48:51], v[72:75], v[132:135], v[48:51]
    buffer_store_dwordx4 v[104:107], v4, s[4:7], s77 offen sc1
    v_mfma_f32_16x16x32_bf16 v[56:59], v[72:75], v[140:143], v[56:59]
    v_mfma_f32_16x16x32_bf16 v[16:19], a[4:7], v[72:75], v[16:19]
    v_mfma_f32_16x16x32_bf16 v[20:23], a[12:15], v[72:75], v[20:23]
    s_waitcnt lgkmcnt(2)
    v_mfma_f32_16x16x32_bf16 v[40:43], a[132:135], v[76:79], v[40:43]
    ds_read_b128 v[88:91], v10 offset:6144
    v_mfma_f32_16x16x32_bf16 v[44:47], a[140:143], v[76:79], v[44:47]
    v_mfma_f32_16x16x32_bf16 v[52:55], v[76:79], v[132:135], v[52:55]
    buffer_store_dwordx4 v[108:111], v4, s[4:7], s77 offen offset:128 sc1
    v_mfma_f32_16x16x32_bf16 v[60:63], v[76:79], v[140:143], v[60:63]
    v_mfma_f32_16x16x32_bf16 v[24:27], a[4:7], v[76:79], v[24:27]
    v_mfma_f32_16x16x32_bf16 v[28:31], a[12:15], v[76:79], v[28:31]
    s_waitcnt lgkmcnt(2)
    v_mfma_f32_16x16x32_bf16 v[32:35], a[144:147], v[80:83], v[32:35]
    ds_read_b128 v[92:95], v10 offset:6400
    v_mfma_f32_16x16x32_bf16 v[36:39], a[152:155], v[80:83], v[36:39]
    s_bitcmp1_b64 s[84:85], s69
    v_mfma_f32_16x16x32_bf16 v[48:51], v[80:83], v[144:147], v[48:51]
    s_cselect_b32 s71, s67, s68
    v_mfma_f32_16x16x32_bf16 v[56:59], v[80:83], v[152:155], v[56:59]
    s_cselect_b32 s21, s65, 0
    v_mfma_f32_16x16x32_bf16 v[16:19], a[16:19], v[80:83], v[16:19]
    s_cselect_b32 s22, 0, 2
    v_mfma_f32_16x16x32_bf16 v[20:23], a[24:27], v[80:83], v[20:23]
    s_add_u32 s67, s67, s21
    s_waitcnt lgkmcnt(2)
    v_mfma_f32_16x16x32_bf16 v[40:43], a[144:147], v[84:87], v[40:43]
    s_barrier
    ds_read_b128 v[64:67], v11 offset:0
    v_mfma_f32_16x16x32_bf16 v[44:47], a[152:155], v[84:87], v[44:47]
    s_add_u32 s68, s68, s22
    v_mfma_f32_16x16x32_bf16 v[52:55], v[84:87], v[144:147], v[52:55]
    s_lshr_b32 s22, s67, 1
    v_mfma_f32_16x16x32_bf16 v[60:63], v[84:87], v[152:155], v[60:63]
    s_cmp_eq_u32 s22, 12
    v_mfma_f32_16x16x32_bf16 v[24:27], a[16:19], v[84:87], v[24:27]
    s_cselect_b32 s21, s21, 0
    v_mfma_f32_16x16x32_bf16 v[28:31], a[24:27], v[84:87], v[28:31]
    s_lshr_b32 s21, s21, 1
    s_waitcnt lgkmcnt(2)
    v_mfma_f32_16x16x32_bf16 v[32:35], a[148:151], v[88:91], v[32:35]
    ds_read_b128 v[68:71], v11 offset:256
    v_mfma_f32_16x16x32_bf16 v[36:39], a[156:159], v[88:91], v[36:39]
    s_mul_i32 s21, s21, 10
    v_mfma_f32_16x16x32_bf16 v[48:51], v[88:91], v[148:151], v[48:51]
    s_add_u32 s67, s67, s21
    v_mfma_f32_16x16x32_bf16 v[56:59], v[88:91], v[156:159], v[56:59]
    s_add_u32 s69, s69, 1
    v_mfma_f32_16x16x32_bf16 v[16:19], a[20:23], v[88:91], v[16:19]
    s_lshl_b32 s74, s71, 14
    v_mfma_f32_16x16x32_bf16 v[20:23], a[28:31], v[88:91], v[20:23]
    s_add_u32 s74, s74, s86
    s_waitcnt lgkmcnt(2)
    v_mfma_f32_16x16x32_bf16 v[40:43], a[148:151], v[92:95], v[40:43]
    ds_read_b128 v[72:75], v11 offset:2048
    v_mfma_f32_16x16x32_bf16 v[44:47], a[156:159], v[92:95], v[44:47]
    s_cmp_le_u32 s69, s88
    v_mfma_f32_16x16x32_bf16 v[52:55], v[92:95], v[148:151], v[52:55]
    s_cselect_b32 s74, s74, 14336
    v_mfma_f32_16x16x32_bf16 v[60:63], v[92:95], v[156:159], v[60:63]
    s_lshl_b32 s75, s71, 15
    v_mfma_f32_16x16x32_bf16 v[24:27], a[20:23], v[92:95], v[24:27]
    s_add_u32 s75, s75, s80
    v_mfma_f32_16x16x32_bf16 v[28:31], a[28:31], v[92:95], v[28:31]
    s_add_u32 s75, s75, 4194304
    s_waitcnt lgkmcnt(2)
    v_mfma_f32_16x16x32_bf16 v[32:35], a[160:163], v[64:67], v[32:35]
    ds_read_b128 v[76:79], v11 offset:2304
    v_mfma_f32_16x16x32_bf16 v[36:39], a[168:171], v[64:67], v[36:39]
    s_xor_b32 s81, s72, 0x8000
    v_mfma_f32_16x16x32_bf16 v[48:51], v[64:67], v[160:163], v[48:51]
    s_add_u32 s81, s81, s80
    v_mfma_f32_16x16x32_bf16 v[56:59], v[64:67], v[168:171], v[56:59]
    s_mov_b32 s87, s70
    v_mfma_f32_16x16x32_bf16 v[16:19], a[32:35], v[64:67], v[16:19]
    s_mul_i32 s76, s70, 786432
    v_mfma_f32_16x16x32_bf16 v[20:23], a[40:43], v[64:67], v[20:23]
    s_add_u32 s76, s76, s82
    s_waitcnt lgkmcnt(2)
    v_mfma_f32_16x16x32_bf16 v[40:43], a[160:163], v[68:71], v[40:43]
    ds_read_b128 v[80:83], v11 offset:4096
    v_mfma_f32_16x16x32_bf16 v[44:47], a[168:171], v[68:71], v[44:47]
    s_lshl_b32 s21, s16, 11
    v_mfma_f32_16x16x32_bf16 v[52:55], v[68:71], v[160:163], v[52:55]
    s_add_u32 s77, s76, s21
    v_mfma_f32_16x16x32_bf16 v[60:63], v[68:71], v[168:171], v[60:63]
    s_add_u32 s78, s77, 8192
    v_mfma_f32_16x16x32_bf16 v[24:27], a[32:35], v[68:71], v[24:27]
    s_lshl_b32 s21, s16, 9
    v_mfma_f32_16x16x32_bf16 v[28:31], a[40:43], v[68:71], v[28:31]
    s_add_u32 s76, s76, s21
    s_waitcnt lgkmcnt(2)
    v_mfma_f32_16x16x32_bf16 v[32:35], a[164:167], v[72:75], v[32:35]
    ds_read_b128 v[84:87], v11 offset:4352
    v_mfma_f32_16x16x32_bf16 v[36:39], a[172:175], v[72:75], v[36:39]
    s_add_u32 s76, s76, 16384
    v_mfma_f32_16x16x32_bf16 v[48:51], v[72:75], v[164:167], v[48:51]
    buffer_load_dword v8, v2, s[4:7], s74 offen sc1
    v_mfma_f32_16x16x32_bf16 v[56:59], v[72:75], v[172:175], v[56:59]
    v_mfma_f32_16x16x32_bf16 v[16:19], a[36:39], v[72:75], v[16:19]
    v_mfma_f32_16x16x32_bf16 v[20:23], a[44:47], v[72:75], v[20:23]
    s_waitcnt lgkmcnt(2)
    v_mfma_f32_16x16x32_bf16 v[40:43], a[164:167], v[76:79], v[40:43]
    ds_read_b128 v[88:91], v11 offset:6144
    v_mfma_f32_16x16x32_bf16 v[44:47], a[172:175], v[76:79], v[44:47]
    v_mfma_f32_16x16x32_bf16 v[52:55], v[76:79], v[164:167], v[52:55]
    v_mfma_f32_16x16x32_bf16 v[60:63], v[76:79], v[172:175], v[60:63]
    v_mfma_f32_16x16x32_bf16 v[24:27], a[36:39], v[76:79], v[24:27]
    v_mfma_f32_16x16x32_bf16 v[28:31], a[44:47], v[76:79], v[28:31]
    s_waitcnt lgkmcnt(2)
    v_mfma_f32_16x16x32_bf16 v[32:35], a[176:179], v[80:83], v[32:35]
    ds_read_b128 v[92:95], v11 offset:6400
    v_mfma_f32_16x16x32_bf16 v[36:39], a[184:187], v[80:83], v[36:39]
    v_mfma_f32_16x16x32_bf16 v[48:51], v[80:83], v[176:179], v[48:51]
    v_mfma_f32_16x16x32_bf16 v[56:59], v[80:83], v[184:187], v[56:59]
    v_mfma_f32_16x16x32_bf16 v[16:19], a[48:51], v[80:83], v[16:19]
    v_mfma_f32_16x16x32_bf16 v[20:23], a[56:59], v[80:83], v[20:23]
    s_waitcnt lgkmcnt(2)
    v_mfma_f32_16x16x32_bf16 v[40:43], a[176:179], v[84:87], v[40:43]
    ds_read_b128 v[64:67], v12 offset:0
    v_mfma_f32_16x16x32_bf16 v[44:47], a[184:187], v[84:87], v[44:47]
    v_mfma_f32_16x16x32_bf16 v[52:55], v[84:87], v[176:179], v[52:55]
    v_mfma_f32_16x16x32_bf16 v[60:63], v[84:87], v[184:187], v[60:63]
    v_mfma_f32_16x16x32_bf16 v[24:27], a[48:51], v[84:87], v[24:27]
    v_mfma_f32_16x16x32_bf16 v[28:31], a[56:59], v[84:87], v[28:31]
    s_waitcnt lgkmcnt(2)
    v_mfma_f32_16x16x32_bf16 v[32:35], a[180:183], v[88:91], v[32:35]
    ds_read_b128 v[68:71], v12 offset:256
    v_mfma_f32_16x16x32_bf16 v[36:39], a[188:191], v[88:91], v[36:39]
    v_mfma_f32_16x16x32_bf16 v[48:51], v[88:91], v[180:183], v[48:51]
    v_mfma_f32_16x16x32_bf16 v[56:59], v[88:91], v[188:191], v[56:59]
    v_mfma_f32_16x16x32_bf16 v[16:19], a[52:55], v[88:91], v[16:19]
    v_mfma_f32_16x16x32_bf16 v[20:23], a[60:63], v[88:91], v[20:23]
    s_waitcnt lgkmcnt(2)
    v_mfma_f32_16x16x32_bf16 v[40:43], a[180:183], v[92:95], v[40:43]
    ds_read_b128 v[72:75], v12 offset:2048
    v_mfma_f32_16x16x32_bf16 v[44:47], a[188:191], v[92:95], v[44:47]
    s_waitcnt vmcnt(1)
    s_mov_b64 exec, 1
    buffer_store_dword v5, off, s[4:7], s73 sc1
    s_mov_b64 exec, -1
    v_mfma_f32_16x16x32_bf16 v[52:55], v[92:95], v[180:183], v[52:55]
    s_lshl_b32 s73, s70, 14
    v_mfma_f32_16x16x32_bf16 v[60:63], v[92:95], v[188:191], v[60:63]
    s_add_u32 s73, s73, s83
    v_mfma_f32_16x16x32_bf16 v[24:27], a[52:55], v[92:95], v[24:27]
    v_mfma_f32_16x16x32_bf16 v[28:31], a[60:63], v[92:95], v[28:31]
    s_waitcnt lgkmcnt(2)
    v_mfma_f32_16x16x32_bf16 v[32:35], a[192:195], v[64:67], v[32:35]
    ds_read_b128 v[76:79], v12 offset:2304
    v_mfma_f32_16x16x32_bf16 v[36:39], a[200:203], v[64:67], v[36:39]
    v_mfma_f32_16x16x32_bf16 v[48:51], v[64:67], v[192:195], v[48:51]
    v_mfma_f32_16x16x32_bf16 v[56:59], v[64:67], v[200:203], v[56:59]
    v_mfma_f32_16x16x32_bf16 v[16:19], a[64:67], v[64:67], v[16:19]
    v_mfma_f32_16x16x32_bf16 v[20:23], a[72:75], v[64:67], v[20:23]
    s_waitcnt lgkmcnt(2)
    v_mfma_f32_16x16x32_bf16 v[40:43], a[192:195], v[68:71], v[40:43]
    ds_read_b128 v[80:83], v12 offset:4096
    v_mfma_f32_16x16x32_bf16 v[44:47], a[200:203], v[68:71], v[44:47]
    v_mfma_f32_16x16x32_bf16 v[52:55], v[68:71], v[192:195], v[52:55]
    v_mfma_f32_16x16x32_bf16 v[60:63], v[68:71], v[200:203], v[60:63]
    v_mfma_f32_16x16x32_bf16 v[24:27], a[64:67], v[68:71], v[24:27]
    v_mfma_f32_16x16x32_bf16 v[28:31], a[72:75], v[68:71], v[28:31]
    s_waitcnt vmcnt(1)
L_qkv_ck:
    v_cmp_gt_u32 vcc, 1, v8
    s_cbranch_vccnz L_qkv_b0
    s_waitcnt lgkmcnt(2)
    v_mfma_f32_16x16x32_bf16 v[32:35], a[196:199], v[72:75], v[32:35]
    ds_read_b128 v[84:87], v12 offset:4352
    v_mfma_f32_16x16x32_bf16 v[36:39], a[204:207], v[72:75], v[36:39]
    v_mfma_f32_16x16x32_bf16 v[48:51], v[72:75], v[196:199], v[48:51]
    s_mov_b32 m0, s81
    s_add_u32 s23, s75, 4096
    v_mfma_f32_16x16x32_bf16 v[56:59], v[72:75], v[204:207], v[56:59]
    v_mfma_f32_16x16x32_bf16 v[16:19], a[68:71], v[72:75], v[16:19]
    v_mfma_f32_16x16x32_bf16 v[20:23], a[76:79], v[72:75], v[20:23]
    s_waitcnt lgkmcnt(2)
    v_mfma_f32_16x16x32_bf16 v[40:43], a[196:199], v[76:79], v[40:43]
    ds_read_b128 v[88:91], v12 offset:6144
    v_mfma_f32_16x16x32_bf16 v[44:47], a[204:207], v[76:79], v[44:47]
    v_mfma_f32_16x16x32_bf16 v[52:55], v[76:79], v[196:199], v[52:55]
    buffer_load_dwordx4 v120, s[4:7], s75 offen offset:0 sc1 lds
    v_mfma_f32_16x16x32_bf16 v[60:63], v[76:79], v[204:207], v[60:63]
    v_mfma_f32_16x16x32_bf16 v[24:27], a[68:71], v[76:79], v[24:27]
    v_mfma_f32_16x16x32_bf16 v[28:31], a[76:79], v[76:79], v[28:31]
    s_waitcnt lgkmcnt(2)
    v_mfma_f32_16x16x32_bf16 v[32:35], a[208:211], v[80:83], v[32:35]
    ds_read_b128 v[92:95], v12 offset:6400
    v_mfma_f32_16x16x32_bf16 v[36:39], a[216:219], v[80:83], v[36:39]
    v_mfma_f32_16x16x32_bf16 v[48:51], v[80:83], v[208:211], v[48:51]
    buffer_load_dwordx4 v121, s[4:7], s75 offen offset:1024 sc1 lds
    v_mfma_f32_16x16x32_bf16 v[56:59], v[80:83], v[216:219], v[56:59]
    v_mfma_f32_16x16x32_bf16 v[16:19], a[80:83], v[80:83], v[16:19]
    v_mfma_f32_16x16x32_bf16 v[20:23], a[88:91], v[80:83], v[20:23]
    s_waitcnt lgkmcnt(2)
    v_mfma_f32_16x16x32_bf16 v[40:43], a[208:211], v[84:87], v[40:43]
    ds_read_b128 v[64:67], v13 offset:0
    v_mfma_f32_16x16x32_bf16 v[44:47], a[216:219], v[84:87], v[44:47]
    v_mfma_f32_16x16x32_bf16 v[52:55], v[84:87], v[208:211], v[52:55]
    buffer_load_dwordx4 v122, s[4:7], s75 offen offset:2048 sc1 lds
    v_mfma_f32_16x16x32_bf16 v[60:63], v[84:87], v[216:219], v[60:63]
    v_mfma_f32_16x16x32_bf16 v[24:27], a[80:83], v[84:87], v[24:27]
    v_mfma_f32_16x16x32_bf16 v[28:31], a[88:91], v[84:87], v[28:31]
    s_waitcnt lgkmcnt(2)
    v_mfma_f32_16x16x32_bf16 v[32:35], a[212:215], v[88:91], v[32:35]
    ds_read_b128 v[68:71], v13 offset:256
    v_mfma_f32_16x16x32_bf16 v[36:39], a[220:223], v[88:91], v[36:39]
    v_mfma_f32_16x16x32_bf16 v[48:51], v[88:91], v[212:215], v[48:51]
    buffer_load_dwordx4 v123, s[4:7], s75 offen offset:3072 sc1 lds
    v_mfma_f32_16x16x32_bf16 v[56:59], v[88:91], v[220:223], v[56:59]
    v_mfma_f32_16x16x32_bf16 v[16:19], a[84:87], v[88:91], v[16:19]
    v_mfma_f32_16x16x32_bf16 v[20:23], a[92:95], v[88:91], v[20:23]
    s_waitcnt lgkmcnt(2)
    v_mfma_f32_16x16x32_bf16 v[40:43], a[212:215], v[92:95], v[40:43]
    ds_read_b128 v[72:75], v13 offset:2048
    v_mfma_f32_16x16x32_bf16 v[44:47], a[220:223], v[92:95], v[44:47]
    v_mfma_f32_16x16x32_bf16 v[52:55], v[92:95], v[212:215], v[52:55]
    s_add_u32 m0, m0, 4096
    v_mfma_f32_16x16x32_bf16 v[60:63], v[92:95], v[220:223], v[60:63]
    v_mfma_f32_16x16x32_bf16 v[24:27], a[84:87], v[92:95], v[24:27]
    v_mfma_f32_16x16x32_bf16 v[28:31], a[92:95], v[92:95], v[28:31]
    s_waitcnt lgkmcnt(2)
    v_mfma_f32_16x16x32_bf16 v[32:35], a[224:227], v[64:67], v[32:35]
    ds_read_b128 v[76:79], v13 offset:2304
    v_mfma_f32_16x16x32_bf16 v[36:39], a[232:235], v[64:67], v[36:39]
    v_mfma_f32_16x16x32_bf16 v[48:51], v[64:67], v[224:227], v[48:51]
    buffer_load_dwordx4 v124, s[4:7], s23 offen offset:0 sc1 lds
    v_mfma_f32_16x16x32_bf16 v[56:59], v[64:67], v[232:235], v[56:59]
    v_mfma_f32_16x16x32_bf16 v[16:19], a[96:99], v[64:67], v[16:19]
    v_mfma_f32_16x16x32_bf16 v[20:23], a[104:107], v[64:67], v[20:23]
    s_waitcnt lgkmcnt(2)
    v_mfma_f32_16x16x32_bf16 v[40:43], a[224:227], v[68:71], v[40:43]
    ds_read_b128 v[80:83], v13 offset:4096
    v_mfma_f32_16x16x32_bf16 v[44:47], a[232:235], v[68:71], v[44:47]
    v_mfma_f32_16x16x32_bf16 v[52:55], v[68:71], v[224:227], v[52:55]
    buffer_load_dwordx4 v125, s[4:7], s23 offen offset:1024 sc1 lds
    v_mfma_f32_16x16x32_bf16 v[60:63], v[68:71], v[232:235], v[60:63]
    v_mfma_f32_16x16x32_bf16 v[24:27], a[96:99], v[68:71], v[24:27]
    v_mfma_f32_16x16x32_bf16 v[28:31], a[104:107], v[68:71], v[28:31]
    s_waitcnt lgkmcnt(2)
    v_mfma_f32_16x16x32_bf16 v[32:35], a[228:231], v[72:75], v[32:35]
    ds_read_b128 v[84:87], v13 offset:4352
    v_mfma_f32_16x16x32_bf16 v[36:39], a[236:239], v[72:75], v[36:39]
    v_mfma_f32_16x16x32_bf16 v[48:51], v[72:75], v[228:231], v[48:51]
    buffer_load_dwordx4 v126, s[4:7], s23 offen offset:2048 sc1 lds
    v_mfma_f32_16x16x32_bf16 v[56:59], v[72:75], v[236:239], v[56:59]
    v_mfma_f32_16x16x32_bf16 v[16:19], a[100:103], v[72:75], v[16:19]
    v_mfma_f32_16x16x32_bf16 v[20:23], a[108:111], v[72:75], v[20:23]
    s_waitcnt lgkmcnt(2)
    v_mfma_f32_16x16x32_bf16 v[40:43], a[228:231], v[76:79], v[40:43]
    ds_read_b128 v[88:91], v13 offset:6144
    v_mfma_f32_16x16x32_bf16 v[44:47], a[236:239], v[76:79], v[44:47]
    v_mfma_f32_16x16x32_bf16 v[52:55], v[76:79], v[228:231], v[52:55]
    buffer_load_dwordx4 v127, s[4:7], s23 offen offset:3072 sc1 lds
    v_mfma_f32_16x16x32_bf16 v[60:63], v[76:79], v[236:239], v[60:63]
    v_mfma_f32_16x16x32_bf16 v[24:27], a[100:103], v[76:79], v[24:27]
    v_mfma_f32_16x16x32_bf16 v[28:31], a[108:111], v[76:79], v[28:31]
    s_waitcnt lgkmcnt(2)
    v_mfma_f32_16x16x32_bf16 v[32:35], a[240:243], v[80:83], v[32:35]
    ds_read_b128 v[92:95], v13 offset:6400
    v_mfma_f32_16x16x32_bf16 v[36:39], a[248:251], v[80:83], v[36:39]
    v_mfma_f32_16x16x32_bf16 v[48:51], v[80:83], v[240:243], v[48:51]
    v_mfma_f32_16x16x32_bf16 v[56:59], v[80:83], v[248:251], v[56:59]
    v_mfma_f32_16x16x32_bf16 v[16:19], a[112:115], v[80:83], v[16:19]
    v_mfma_f32_16x16x32_bf16 v[20:23], a[120:123], v[80:83], v[20:23]
    s_waitcnt lgkmcnt(0)
    v_mfma_f32_16x16x32_bf16 v[40:43], a[240:243], v[84:87], v[40:43]
    v_xor_b32 v10, 0x8000, v10
    v_mfma_f32_16x16x32_bf16 v[44:47], a[248:251], v[84:87], v[44:47]
    v_xor_b32 v11, 0x8000, v11
    v_mfma_f32_16x16x32_bf16 v[32:35], a[244:247], v[88:91], v[32:35]
    v_xor_b32 v12, 0x8000, v12
    v_mfma_f32_16x16x32_bf16 v[36:39], a[252:255], v[88:91], v[36:39]
    v_xor_b32 v13, 0x8000, v13
    v_mfma_f32_16x16x32_bf16 v[40:43], a[244:247], v[92:95], v[40:43]
    v_mfma_f32_16x16x32_bf16 v[44:47], a[252:255], v[92:95], v[44:47]
    v_mfma_f32_16x16x32_bf16 v[52:55], v[84:87], v[240:243], v[52:55]
    s_nop 1
    v_mfma_f32_16x16x32_bf16 v[60:63], v[84:87], v[248:251], v[60:63]
    s_nop 1
    v_mfma_f32_16x16x32_bf16 v[48:51], v[88:91], v[244:247], v[48:51]
    s_nop 0
    v_mfma_f32_16x16x32_bf16 v[56:59], v[88:91], v[252:255], v[56:59]
    v_cvt_pk_bf16_f32 v32, v32, v33
    v_cvt_pk_bf16_f32 v33, v34, v35
    v_mfma_f32_16x16x32_bf16 v[52:55], v[92:95], v[244:247], v[52:55]
    v_cvt_pk_bf16_f32 v34, v36, v37
    v_cvt_pk_bf16_f32 v35, v38, v39
    v_mfma_f32_16x16x32_bf16 v[60:63], v[92:95], v[252:255], v[60:63]
    v_cvt_pk_bf16_f32 v36, v40, v41
    v_cvt_pk_bf16_f32 v37, v42, v43
    v_mfma_f32_16x16x32_bf16 v[24:27], a[112:115], v[84:87], v[24:27]
    v_cvt_pk_bf16_f32 v38, v44, v45
    v_cvt_pk_bf16_f32 v39, v46, v47
    v_mfma_f32_16x16x32_bf16 v[28:31], a[120:123], v[84:87], v[28:31]
    buffer_store_dwordx4 v[32:35], v4, s[4:7], s78 offen sc1
    v_mfma_f32_16x16x32_bf16 v[16:19], a[116:119], v[88:91], v[16:19]
    buffer_store_dwordx4 v[36:39], v4, s[4:7], s78 offen offset:128 sc1
    v_mfma_f32_16x16x32_bf16 v[20:23], a[124:127], v[88:91], v[20:23]
    v_cvt_pk_bf16_f32 v96, v48, v49
    v_cvt_pk_bf16_f32 v97, v50, v51
    v_mfma_f32_16x16x32_bf16 v[24:27], a[116:119], v[92:95], v[24:27]
    v_cvt_pk_bf16_f32 v98, v52, v53
    v_cvt_pk_bf16_f32 v99, v54, v55
    v_mfma_f32_16x16x32_bf16 v[28:31], a[124:127], v[92:95], v[28:31]
    v_cvt_pk_bf16_f32 v100, v56, v57
    v_cvt_pk_bf16_f32 v101, v58, v59
    s_waitcnt vmcnt(2)
    ds_read_b128 v[64:67], v10 offset:0
    ds_read_b128 v[68:71], v10 offset:256
    ds_read_b128 v[72:75], v10 offset:2048
    s_xor_b32 s72, s72, 0x8000
    s_mov_b32 s70, s71
    v_cvt_pk_bf16_f32 v102, v60, v61
    v_cvt_pk_bf16_f32 v103, v62, v63
    s_cmp_le_u32 s69, s88
    s_cbranch_scc1 L_qkv_loop1
    v_cvt_pk_bf16_f32 v104, v16, v17
    v_cvt_pk_bf16_f32 v105, v18, v19
    v_cvt_pk_bf16_f32 v106, v20, v21
    v_cvt_pk_bf16_f32 v107, v22, v23
    v_cvt_pk_bf16_f32 v108, v24, v25
    v_cvt_pk_bf16_f32 v109, v26, v27
    v_cvt_pk_bf16_f32 v110, v28, v29
    v_cvt_pk_bf16_f32 v111, v30, v31
    buffer_store_dwordx4 v[96:99], v3, s[4:7], s76 offen sc1
    buffer_store_dwordx4 v[100:103], v3, s[4:7], s76 offen offset:256 sc1
    buffer_store_dwordx4 v[104:107], v4, s[4:7], s77 offen sc1
    buffer_store_dwordx4 v[108:111], v4, s[4:7], s77 offen offset:128 sc1
    s_branch L_qkv_done
L_qkv_b0:
    s_waitcnt lgkmcnt(2)
    v_mfma_f32_16x16x32_bf16 v[32:35], a[196:199], v[72:75], v[32:35]
    ds_read_b128 v[84:87], v12 offset:4352
    v_mfma_f32_16x16x32_bf16 v[36:39], a[204:207], v[72:75], v[36:39]
    v_mfma_f32_16x16x32_bf16 v[48:51], v[72:75], v[196:199], v[48:51]
    v_mfma_f32_16x16x32_bf16 v[56:59], v[72:75], v[204:207], v[56:59]
    v_mfma_f32_16x16x32_bf16 v[16:19], a[68:71], v[72:75], v[16:19]
    v_mfma_f32_16x16x32_bf16 v[20:23], a[76:79], v[72:75], v[20:23]
    s_waitcnt lgkmcnt(2)
    v_mfma_f32_16x16x32_bf16 v[40:43], a[196:199], v[76:79], v[40:43]
    ds_read_b128 v[88:91], v12 offset:6144
    v_mfma_f32_16x16x32_bf16 v[44:47], a[204:207], v[76:79], v[44:47]
    v_mfma_f32_16x16x32_bf16 v[52:55], v[76:79], v[196:199], v[52:55]
    v_mfma_f32_16x16x32_bf16 v[60:63], v[76:79], v[204:207], v[60:63]
    v_mfma_f32_16x16x32_bf16 v[24:27], a[68:71], v[76:79], v[24:27]
    v_mfma_f32_16x16x32_bf16 v[28:31], a[76:79], v[76:79], v[28:31]
    s_waitcnt lgkmcnt(2)
    v_mfma_f32_16x16x32_bf16 v[32:35], a[208:211], v[80:83], v[32:35]
    ds_read_b128 v[92:95], v12 offset:6400
    v_mfma_f32_16x16x32_bf16 v[36:39], a[216:219], v[80:83], v[36:39]
    v_mfma_f32_16x16x32_bf16 v[48:51], v[80:83], v[208:211], v[48:51]
    v_mfma_f32_16x16x32_bf16 v[56:59], v[80:83], v[216:219], v[56:59]
    v_mfma_f32_16x16x32_bf16 v[16:19], a[80:83], v[80:83], v[16:19]
    v_mfma_f32_16x16x32_bf16 v[20:23], a[88:91], v[80:83], v[20:23]
    s_waitcnt lgkmcnt(2)
    v_mfma_f32_16x16x32_bf16 v[40:43], a[208:211], v[84:87], v[40:43]
    ds_read_b128 v[64:67], v13 offset:0
    v_mfma_f32_16x16x32_bf16 v[44:47], a[216:219], v[84:87], v[44:47]
    v_mfma_f32_16x16x32_bf16 v[52:55], v[84:87], v[208:211], v[52:55]
    v_mfma_f32_16x16x32_bf16 v[60:63], v[84:87], v[216:219], v[60:63]
    v_mfma_f32_16x16x32_bf16 v[24:27], a[80:83], v[84:87], v[24:27]
    v_mfma_f32_16x16x32_bf16 v[28:31], a[88:91], v[84:87], v[28:31]
    s_waitcnt lgkmcnt(2)
    v_mfma_f32_16x16x32_bf16 v[32:35], a[212:215], v[88:91], v[32:35]
    ds_read_b128 v[68:71], v13 offset:256
    v_mfma_f32_16x16x32_bf16 v[36:39], a[220:223], v[88:91], v[36:39]
    v_mfma_f32_16x16x32_bf16 v[48:51], v[88:91], v[212:215], v[48:51]
    v_mfma_f32_16x16x32_bf16 v[56:59], v[88:91], v[220:223], v[56:59]
    v_mfma_f32_16x16x32_bf16 v[16:19], a[84:87], v[88:91], v[16:19]
    v_mfma_f32_16x16x32_bf16 v[20:23], a[92:95], v[88:91], v[20:23]
    s_waitcnt lgkmcnt(2)
    v_mfma_f32_16x16x32_bf16 v[40:43], a[212:215], v[92:95], v[40:43]
    ds_read_b128 v[72:75], v13 offset:2048
    v_mfma_f32_16x16x32_bf16 v[44:47], a[220:223], v[92:95], v[44:47]
    v_mfma_f32_16x16x32_bf16 v[52:55], v[92:95], v[212:215], v[52:55]
    v_mfma_f32_16x16x32_bf16 v[60:63], v[92:95], v[220:223], v[60:63]
    v_mfma_f32_16x16x32_bf16 v[24:27], a[84:87], v[92:95], v[24:27]
    v_mfma_f32_16x16x32_bf16 v[28:31], a[92:95], v[92:95], v[28:31]
    s_waitcnt lgkmcnt(2)
    v_mfma_f32_16x16x32_bf16 v[32:35], a[224:227], v[64:67], v[32:35]
    ds_read_b128 v[76:79], v13 offset:2304
    v_mfma_f32_16x16x32_bf16 v[36:39], a[232:235], v[64:67], v[36:39]
    v_mfma_f32_16x16x32_bf16 v[48:51], v[64:67], v[224:227], v[48:51]
    v_mfma_f32_16x16x32_bf16 v[56:59], v[64:67], v[232:235], v[56:59]
    v_mfma_f32_16x16x32_bf16 v[16:19], a[96:99], v[64:67], v[16:19]
    v_mfma_f32_16x16x32_bf16 v[20:23], a[104:107], v[64:67], v[20:23]
    s_waitcnt lgkmcnt(2)
    v_mfma_f32_16x16x32_bf16 v[40:43], a[224:227], v[68:71], v[40:43]
    ds_read_b128 v[80:83], v13 offset:4096
    v_mfma_f32_16x16x32_bf16 v[44:47], a[232:235], v[68:71], v[44:47]
    v_mfma_f32_16x16x32_bf16 v[52:55], v[68:71], v[224:227], v[52:55]
    v_mfma_f32_16x16x32_bf16 v[60:63], v[68:71], v[232:235], v[60:63]
    v_mfma_f32_16x16x32_bf16 v[24:27], a[96:99], v[68:71], v[24:27]
    v_mfma_f32_16x16x32_bf16 v[28:31], a[104:107], v[68:71], v[28:31]
    s_waitcnt lgkmcnt(2)
    v_mfma_f32_16x16x32_bf16 v[32:35], a[228:231], v[72:75], v[32:35]
    ds_read_b128 v[84:87], v13 offset:4352
    v_mfma_f32_16x16x32_bf16 v[36:39], a[236:239], v[72:75], v[36:39]
    v_mfma_f32_16x16x32_bf16 v[48:51], v[72:75], v[228:231], v[48:51]
    v_mfma_f32_16x16x32_bf16 v[56:59], v[72:75], v[236:239], v[56:59]
    v_mfma_f32_16x16x32_bf16 v[16:19], a[100:103], v[72:75], v[16:19]
    v_mfma_f32_16x16x32_bf16 v[20:23], a[108:111], v[72:75], v[20:23]
    s_waitcnt lgkmcnt(2)
    v_mfma_f32_16x16x32_bf16 v[40:43], a[228:231], v[76:79], v[40:43]
    ds_read_b128 v[88:91], v13 offset:6144
    v_mfma_f32_16x16x32_bf16 v[44:47], a[236:239], v[76:79], v[44:47]
    v_mfma_f32_16x16x32_bf16 v[52:55], v[76:79], v[228:231], v[52:55]
    v_mfma_f32_16x16x32_bf16 v[60:63], v[76:79], v[236:239], v[60:63]
    v_mfma_f32_16x16x32_bf16 v[24:27], a[100:103], v[76:79], v[24:27]
    v_mfma_f32_16x16x32_bf16 v[28:31], a[108:111], v[76:79], v[28:31]
    s_waitcnt lgkmcnt(2)
    v_mfma_f32_16x16x32_bf16 v[32:35], a[240:243], v[80:83], v[32:35]
    ds_read_b128 v[92:95], v13 offset:6400
    v_mfma_f32_16x16x32_bf16 v[36:39], a[248:251], v[80:83], v[36:39]
    v_mfma_f32_16x16x32_bf16 v[48:51], v[80:83], v[240:243], v[48:51]
    v_mfma_f32_16x16x32_bf16 v[56:59], v[80:83], v[248:251], v[56:59]
    v_mfma_f32_16x16x32_bf16 v[16:19], a[112:115], v[80:83], v[16:19]
    v_mfma_f32_16x16x32_bf16 v[20:23], a[120:123], v[80:83], v[20:23]
    s_waitcnt lgkmcnt(0)
    v_mfma_f32_16x16x32_bf16 v[40:43], a[240:243], v[84:87], v[40:43]
    v_mfma_f32_16x16x32_bf16 v[44:47], a[248:251], v[84:87], v[44:47]
    v_mfma_f32_16x16x32_bf16 v[32:35], a[244:247], v[88:91], v[32:35]
    v_mfma_f32_16x16x32_bf16 v[36:39], a[252:255], v[88:91], v[36:39]
    v_mfma_f32_16x16x32_bf16 v[40:43], a[244:247], v[92:95], v[40:43]
    v_mfma_f32_16x16x32_bf16 v[44:47], a[252:255], v[92:95], v[44:47]
    v_mfma_f32_16x16x32_bf16 v[52:55], v[84:87], v[240:243], v[52:55]
    s_nop 1
    v_mfma_f32_16x16x32_bf16 v[60:63], v[84:87], v[248:251], v[60:63]
    s_nop 1
    v_mfma_f32_16x16x32_bf16 v[48:51], v[88:91], v[244:247], v[48:51]
    s_nop 0
    v_mfma_f32_16x16x32_bf16 v[56:59], v[88:91], v[252:255], v[56:59]
    v_cvt_pk_bf16_f32 v32, v32, v33
    v_cvt_pk_bf16_f32 v33, v34, v35
    v_mfma_f32_16x16x32_bf16 v[52:55], v[92:95], v[244:247], v[52:55]
    v_cvt_pk_bf16_f32 v34, v36, v37
    v_cvt_pk_bf16_f32 v35, v38, v39
    v_mfma_f32_16x16x32_bf16 v[60:63], v[92:95], v[252:255], v[60:63]
    v_cvt_pk_bf16_f32 v36, v40, v41
    v_cvt_pk_bf16_f32 v37, v42, v43
    v_mfma_f32_16x16x32_bf16 v[24:27], a[112:115], v[84:87], v[24:27]
    v_cvt_pk_bf16_f32 v38, v44, v45
    v_cvt_pk_bf16_f32 v39, v46, v47
    v_mfma_f32_16x16x32_bf16 v[28:31], a[120:123], v[84:87], v[28:31]
    buffer_store_dwordx4 v[32:35], v4, s[4:7], s78 offen sc1
    v_mfma_f32_16x16x32_bf16 v[16:19], a[116:119], v[88:91], v[16:19]
    buffer_store_dwordx4 v[36:39], v4, s[4:7], s78 offen offset:128 sc1
    v_mfma_f32_16x16x32_bf16 v[20:23], a[124:127], v[88:91], v[20:23]
    v_cvt_pk_bf16_f32 v96, v48, v49
    v_cvt_pk_bf16_f32 v97, v50, v51
    v_mfma_f32_16x16x32_bf16 v[24:27], a[116:119], v[92:95], v[24:27]
    v_cvt_pk_bf16_f32 v98, v52, v53
    v_cvt_pk_bf16_f32 v99, v54, v55
    v_mfma_f32_16x16x32_bf16 v[28:31], a[124:127], v[92:95], v[28:31]
    v_cvt_pk_bf16_f32 v100, v56, v57
    v_cvt_pk_bf16_f32 v101, v58, v59
    v_cvt_pk_bf16_f32 v102, v60, v61
    v_cvt_pk_bf16_f32 v103, v62, v63
    buffer_store_dwordx4 v[96:99], v3, s[4:7], s76 offen sc1
    buffer_store_dwordx4 v[100:103], v3, s[4:7], s76 offen offset:256 sc1
    v_cvt_pk_bf16_f32 v104, v16, v17
    v_cvt_pk_bf16_f32 v105, v18, v19
    v_cvt_pk_bf16_f32 v106, v20, v21
    v_cvt_pk_bf16_f32 v107, v22, v23
    v_cvt_pk_bf16_f32 v108, v24, v25
    v_cvt_pk_bf16_f32 v109, v26, v27
    v_cvt_pk_bf16_f32 v110, v28, v29
    v_cvt_pk_bf16_f32 v111, v30, v31
    buffer_store_dwordx4 v[104:107], v4, s[4:7], s77 offen sc1
    buffer_store_dwordx4 v[108:111], v4, s[4:7], s77 offen offset:128 sc1
    s_waitcnt vmcnt(0)
    s_mov_b64 exec, 1
    buffer_store_dword v5, off, s[4:7], s73 sc1
    s_mov_b64 exec, -1
    s_mov_b32 s73, 0
    s_cmp_le_u32 s69, s88
    s_cbranch_scc1 L_qkv_block
    s_branch L_dump_role_qkv
L_qkv_done:
    s_waitcnt vmcnt(0)
    s_mov_b64 exec, 1
    buffer_store_dword v5, off, s[4:7], s73 sc1
    s_mov_b64 exec, -1
L_dump_role_qkv:
    s_cmp_eq_u32 s89, 0
    s_cbranch_scc1 L_qkv_fin
    s_waitcnt vmcnt(0) lgkmcnt(0)
    s_barrier
    s_cmp_eq_u32 s89, 3
    s_cbranch_scc1 L_role_F
    s_mov_b32 s89, 2
    s_branch L_role_CH
L_qkv_fin:
    s_branch L_end
L_role_R:
    s_lshr_b32 s64, s25, 3
    s_and_b32 s65, s25, 7
    s_lshl_b32 s21, s65, 1
    s_add_u32 s21, s21, 1
    s_cmp_eq_u32 s64, 4
    s_cselect_b32 s65, s21, s65
    s_lshl_b32 s66, s16, 13
    s_lshl_b32 s67, s65, 12
    s_lshl_b32 s21, s16, 8
    s_add_u32 s67, s67, s21
    s_lshl_b32 s72, s65, 7
    s_lshl_b32 s21, s16, 2
    s_add_u32 s72, s72, s21
    v_lshrrev_b32 v11, 3, v0
    v_and_b32 v12, 7, v0
    v_lshlrev_b32 v1, 10, v11
    v_lshl_add_u32 v1, v12, 4, v1
    v_and_b32 v12, 7, v11
    v_xor_b32 v12, s65, v12
    v_lshl_add_u32 v1, v12, 7, v1
    v_bfe_u32 v12, v0, 1, 2
    v_lshlrev_b32 v2, 10, v12
    v_lshl_add_u32 v2, v11, 5, v2
    v_and_b32 v11, 1, v0
    v_lshl_add_u32 v2, v11, 4, v2
    v_lshlrev_b32 v5, 5, v12
    v_add_u32 v5, 0x10000, v5
    s_lshl_b32 s21, s16, 2
    v_bfe_u32 v11, v0, 4, 1
    v_lshl_add_u32 v4, v11, 4, v5
    v_add_u32 v4, s21, v4
    v_mov_b32 v6, 1
    v_mov_b32 v7, 0
    v_mov_b32 v9, 0x3f80
    v_mov_b32 v10, 0x3f800000
    s_lshl_b32 s21, s16, 14
    v_lshlrev_b32 v8, 4, v0
    v_add_u32 v8, s21, v8
    s_mov_b32 s8, s32
    s_and_b32 s9, s33, 0xffff
    s_mov_b32 s10, 2097152
    s_mov_b32 s11, 0x20000
    s_mov_b32 s12, s54
    s_and_b32 s13, s55, 0xffff
    s_mov_b32 s14, 2097152
    s_mov_b32 s15, 0x20000
    s_cmp_eq_u32 s91, 0
    s_cbranch_scc0 L_arr_56
    s_mov_b32 s91, 1
    s_waitcnt vmcnt(0)
    s_barrier
    s_cmp_eq_u32 s16, 0
    s_cbranch_scc0 L_arr_56
    s_lshl_b32 s21, s17, 5
    s_add_u32 s21, s21, 4
    s_atomic_add s3, s[56:57], s21
L_arr_56:
    s_cmp_eq_u32 s64, 4
    s_cbranch_scc0 L_r_main
    v_mov_b32 v13, v1
    v_mov_b32 v14, v2
    s_cmp_eq_u32 s91, 0
    s_cbranch_scc0 L_arr_60
    s_mov_b32 s91, 1
    s_waitcnt vmcnt(0)
    s_barrier
    s_cmp_eq_u32 s16, 0
    s_cbranch_scc0 L_arr_60
    s_lshl_b32 s21, s17, 5
    s_add_u32 s21, s21, 4
    s_atomic_add s3, s[56:57], s21
L_arr_60:
    s_cmp_eq_u32 s20, 0
    s_cbranch_scc0 L_rdv_done_58
    s_mov_b32 s27, 0
    v_lshlrev_b32 v1, 2, v0
L_rdv_57:
    buffer_load_dword v2, v1, s[60:63], 0 offen sc1
    s_add_u32 s27, s27, 1
    s_cmp_gt_u32 s27, 262144
    s_cbranch_scc1 L_end
L_rdv_57_p:
    s_waitcnt vmcnt(0)
    s_mov_b32 s21, 0
    v_readlane_b32 s22, v2, 1
    s_nop 0
    s_add_u32 s21, s21, s22
    v_readlane_b32 s22, v2, 9
    s_nop 0
    s_add_u32 s21, s21, s22
    v_readlane_b32 s22, v2, 17
    s_nop 0
    s_add_u32 s21, s21, s22
    v_readlane_b32 s22, v2, 25
    s_nop 0
    s_add_u32 s21, s21, s22
    v_readlane_b32 s22, v2, 33
    s_nop 0
    s_add_u32 s21, s21, s22
    v_readlane_b32 s22, v2, 41
    s_nop 0
    s_add_u32 s21, s21, s22
    v_readlane_b32 s22, v2, 49
    s_nop 0
    s_add_u32 s21, s21, s22
    v_readlane_b32 s22, v2, 57
    s_nop 0
    s_add_u32 s21, s21, s22
    s_cmp_eq_u32 s21, 256
    s_cbranch_scc1 L_rdv_l_59
    s_sleep 4
    s_branch L_rdv_57
L_rdv_l_59:
    s_mov_b32 s21, 0
    s_mov_b32 s23, 0
    v_readlane_b32 s22, v2, 0
    s_cmp_gt_u32 s17, 0
    s_cselect_b32 s24, s22, 0
    s_add_u32 s23, s23, s24
    s_xor_b32 s22, s22, 32
    s_or_b32 s21, s21, s22
    v_readlane_b32 s22, v2, 8
    s_cmp_gt_u32 s17, 1
    s_cselect_b32 s24, s22, 0
    s_add_u32 s23, s23, s24
    s_xor_b32 s22, s22, 32
    s_or_b32 s21, s21, s22
    v_readlane_b32 s22, v2, 16
    s_cmp_gt_u32 s17, 2
    s_cselect_b32 s24, s22, 0
    s_add_u32 s23, s23, s24
    s_xor_b32 s22, s22, 32
    s_or_b32 s21, s21, s22
    v_readlane_b32 s22, v2, 24
    s_cmp_gt_u32 s17, 3
    s_cselect_b32 s24, s22, 0
    s_add_u32 s23, s23, s24
    s_xor_b32 s22, s22, 32
    s_or_b32 s21, s21, s22
    v_readlane_b32 s22, v2, 32
    s_cmp_gt_u32 s17, 4
    s_cselect_b32 s24, s22, 0
    s_add_u32 s23, s23, s24
    s_xor_b32 s22, s22, 32
    s_or_b32 s21, s21, s22
    v_readlane_b32 s22, v2, 40
    s_cmp_gt_u32 s17, 5
    s_cselect_b32 s24, s22, 0
    s_add_u32 s23, s23, s24
    s_xor_b32 s22, s22, 32
    s_or_b32 s21, s21, s22
    v_readlane_b32 s22, v2, 48
    s_cmp_gt_u32 s17, 6
    s_cselect_b32 s24, s22, 0
    s_add_u32 s23, s23, s24
    s_xor_b32 s22, s22, 32
    s_or_b32 s21, s21, s22
    v_readlane_b32 s22, v2, 56
    s_cmp_gt_u32 s17, 7
    s_cselect_b32 s24, s22, 0
    s_add_u32 s23, s23, s24
    s_xor_b32 s22, s22, 32
    s_or_b32 s21, s21, s22
    s_mov_b32 s20, 1
    s_cmp_eq_u32 s21, 0
    s_cbranch_scc1 L_rdv_done_58
    s_mov_b32 s20, 2
    s_add_u32 s19, s23, s18
    s_waitcnt vmcnt(0) lgkmcnt(0)
    s_barrier
    s_branch L_dispatch
L_rdv_done_58:
    v_mov_b32 v1, v13
    v_mov_b32 v2, v14
    s_branch L_r_steady
L_r_main:
    s_lshl_b32 s21, s16, 14
    s_lshl_b32 s22, s64, 15
    s_add_u32 s22, s22, s67
    s_mov_b32 m0, s21
    s_nop 0
    buffer_load_dwordx4 v2, s[8:11], s22 offen lds
    s_add_u32 s22, s22, 0x20000
    s_add_u32 m0, m0, 1024
    s_nop 0
    buffer_load_dwordx4 v2, s[8:11], s22 offen lds
    s_add_u32 s22, s22, 0x20000
    s_add_u32 m0, m0, 1024
    s_nop 0
    buffer_load_dwordx4 v2, s[8:11], s22 offen lds
    s_add_u32 s22, s22, 0x20000
    s_add_u32 m0, m0, 1024
    s_nop 0
    buffer_load_dwordx4 v2, s[8:11], s22 offen lds
    s_add_u32 s22, s22, 0x20000
    s_add_u32 m0, m0, 1024
    s_nop 0
    buffer_load_dwordx4 v2, s[8:11], s22 offen lds
    s_add_u32 s22, s22, 0x20000
    s_add_u32 m0, m0, 1024
    s_nop 0
    buffer_load_dwordx4 v2, s[8:11], s22 offen lds
    s_add_u32 s22, s22, 0x20000
    s_add_u32 m0, m0, 1024
    s_nop 0
    buffer_load_dwordx4 v2, s[8:11], s22 offen lds
    s_add_u32 s22, s22, 0x20000
    s_add_u32 m0, m0, 1024
    s_nop 0
    buffer_load_dwordx4 v2, s[8:11], s22 offen lds
    s_add_u32 s22, s22, 0x20000
    s_add_u32 m0, m0, 1024
    s_nop 0
    buffer_load_dwordx4 v2, s[8:11], s22 offen lds
    s_add_u32 s22, s22, 0x20000
    s_add_u32 m0, m0, 1024
    s_nop 0
    buffer_load_dwordx4 v2, s[8:11], s22 offen lds
    s_add_u32 s22, s22, 0x20000
    s_add_u32 m0, m0, 1024
    s_nop 0
    buffer_load_dwordx4 v2, s[8:11], s22 offen lds
    s_add_u32 s22, s22, 0x20000
    s_add_u32 m0, m0, 1024
    s_nop 0
    buffer_load_dwordx4 v2, s[8:11], s22 offen lds
    s_add_u32 s22, s22, 0x20000
    s_add_u32 m0, m0, 1024
    s_nop 0
    buffer_load_dwordx4 v2, s[8:11], s22 offen lds
    s_add_u32 s22, s22, 0x20000
    s_add_u32 m0, m0, 1024
    s_nop 0
    buffer_load_dwordx4 v2, s[8:11], s22 offen lds
    s_add_u32 s22, s22, 0x20000
    s_add_u32 m0, m0, 1024
    s_nop 0
    buffer_load_dwordx4 v2, s[8:11], s22 offen lds
    s_add_u32 s22, s22, 0x20000
    s_add_u32 m0, m0, 1024
    s_nop 0
    buffer_load_dwordx4 v2, s[8:11], s22 offen lds
    v_mov_b32 v13, v1
    v_mov_b32 v14, v2
    s_cmp_eq_u32 s91, 0
    s_cbranch_scc0 L_arr_64
    s_mov_b32 s91, 1
    s_waitcnt vmcnt(16)
    s_barrier
    s_cmp_eq_u32 s16, 0
    s_cbranch_scc0 L_arr_64
    s_lshl_b32 s21, s17, 5
    s_add_u32 s21, s21, 4
    s_atomic_add s3, s[56:57], s21
L_arr_64:
    s_cmp_eq_u32 s20, 0
    s_cbranch_scc0 L_rdv_done_62
    s_mov_b32 s27, 0
    v_lshlrev_b32 v1, 2, v0
L_rdv_61:
    buffer_load_dword v2, v1, s[60:63], 0 offen sc1
    s_add_u32 s27, s27, 1
    s_cmp_gt_u32 s27, 262144
    s_cbranch_scc1 L_end
L_rdv_61_p:
    s_waitcnt vmcnt(0)
    s_mov_b32 s21, 0
    v_readlane_b32 s22, v2, 1
    s_nop 0
    s_add_u32 s21, s21, s22
    v_readlane_b32 s22, v2, 9
    s_nop 0
    s_add_u32 s21, s21, s22
    v_readlane_b32 s22, v2, 17
    s_nop 0
    s_add_u32 s21, s21, s22
    v_readlane_b32 s22, v2, 25
    s_nop 0
    s_add_u32 s21, s21, s22
    v_readlane_b32 s22, v2, 33
    s_nop 0
    s_add_u32 s21, s21, s22
    v_readlane_b32 s22, v2, 41
    s_nop 0
    s_add_u32 s21, s21, s22
    v_readlane_b32 s22, v2, 49
    s_nop 0
    s_add_u32 s21, s21, s22
    v_readlane_b32 s22, v2, 57
    s_nop 0
    s_add_u32 s21, s21, s22
    s_cmp_eq_u32 s21, 256
    s_cbranch_scc1 L_rdv_l_63
    s_sleep 4
    s_branch L_rdv_61
L_rdv_l_63:
    s_mov_b32 s21, 0
    s_mov_b32 s23, 0
    v_readlane_b32 s22, v2, 0
    s_cmp_gt_u32 s17, 0
    s_cselect_b32 s24, s22, 0
    s_add_u32 s23, s23, s24
    s_xor_b32 s22, s22, 32
    s_or_b32 s21, s21, s22
    v_readlane_b32 s22, v2, 8
    s_cmp_gt_u32 s17, 1
    s_cselect_b32 s24, s22, 0
    s_add_u32 s23, s23, s24
    s_xor_b32 s22, s22, 32
    s_or_b32 s21, s21, s22
    v_readlane_b32 s22, v2, 16
    s_cmp_gt_u32 s17, 2
    s_cselect_b32 s24, s22, 0
    s_add_u32 s23, s23, s24
    s_xor_b32 s22, s22, 32
    s_or_b32 s21, s21, s22
    v_readlane_b32 s22, v2, 24
    s_cmp_gt_u32 s17, 3
    s_cselect_b32 s24, s22, 0
    s_add_u32 s23, s23, s24
    s_xor_b32 s22, s22, 32
    s_or_b32 s21, s21, s22
    v_readlane_b32 s22, v2, 32
    s_cmp_gt_u32 s17, 4
    s_cselect_b32 s24, s22, 0
    s_add_u32 s23, s23, s24
    s_xor_b32 s22, s22, 32
    s_or_b32 s21, s21, s22
    v_readlane_b32 s22, v2, 40
    s_cmp_gt_u32 s17, 5
    s_cselect_b32 s24, s22, 0
    s_add_u32 s23, s23, s24
    s_xor_b32 s22, s22, 32
    s_or_b32 s21, s21, s22
    v_readlane_b32 s22, v2, 48
    s_cmp_gt_u32 s17, 6
    s_cselect_b32 s24, s22, 0
    s_add_u32 s23, s23, s24
    s_xor_b32 s22, s22, 32
    s_or_b32 s21, s21, s22
    v_readlane_b32 s22, v2, 56
    s_cmp_gt_u32 s17, 7
    s_cselect_b32 s24, s22, 0
    s_add_u32 s23, s23, s24
    s_xor_b32 s22, s22, 32
    s_or_b32 s21, s21, s22
    s_mov_b32 s20, 1
    s_cmp_eq_u32 s21, 0
    s_cbranch_scc1 L_rdv_done_62
    s_mov_b32 s20, 2
    s_add_u32 s19, s23, s18
    s_waitcnt vmcnt(0) lgkmcnt(0)
    s_barrier
    s_branch L_dispatch
L_rdv_done_62:
    v_mov_b32 v1, v13
    v_mov_b32 v2, v14
    s_waitcnt vmcnt(0)
    s_mov_b32 s68, s64
    s_mov_b32 s69, 0
L_r0:
    ds_read_b128 v[40:43], v8
    v_add_u32 v8, 1024, v8
    s_waitcnt lgkmcnt(0)
    v_lshlrev_b32 v16, 16, v40
    v_and_b32 v17, 0xffff0000, v40
    v_lshlrev_b32 v18, 16, v41
    v_and_b32 v19, 0xffff0000, v41
    v_lshlrev_b32 v20, 16, v42
    v_and_b32 v21, 0xffff0000, v42
    v_lshlrev_b32 v22, 16, v43
    v_and_b32 v23, 0xffff0000, v43
    v_pk_add_f32 v[32:33], v[16:17], v[18:19]
    v_pk_mul_f32 v[34:35], v[16:17], v[16:17]
    v_pk_add_f32 v[36:37], v[20:21], v[22:23]
    v_pk_fma_f32 v[34:35], v[18:19], v[18:19], v[34:35]
    v_pk_add_f32 v[32:33], v[32:33], v[36:37]
    v_pk_fma_f32 v[34:35], v[20:21], v[20:21], v[34:35]
    v_add_f32 v28, v32, v33
    v_pk_fma_f32 v[34:35], v[22:23], v[22:23], v[34:35]
    v_add_u32 v38, s69, v4
    v_add_f32 v29, v34, v35
    v_add_f32_dpp v30, v28, v28 quad_perm:[1,0,3,2] row_mask:0xf bank_mask:0xf
    v_add_u32 v39, s69, v5
    v_add_f32_dpp v31, v29, v29 quad_perm:[1,0,3,2] row_mask:0xf bank_mask:0xf
    v_add_f32_dpp v28, v30, v30 row_ror:8 row_mask:0xf bank_mask:0xf
    s_nop 0
    v_add_f32_dpp v29, v31, v31 row_ror:8 row_mask:0xf bank_mask:0xf
    s_nop 1
    v_permlane16_swap_b32 v28, v29
    v_add_f32 v28, v28, v29
    v_mov_b32 v30, v28
    s_nop 1
    v_permlane32_swap_b32 v30, v28
    v_add_f32 v28, v28, v30
    s_mov_b64 exec, 0x550055
    ds_write_b32 v38, v28
    s_mov_b64 exec, -1
    s_waitcnt lgkmcnt(0)
    s_barrier
    ds_read_b128 v[32:35], v39
    ds_read_b128 v[36:39], v39 offset:16
    s_waitcnt lgkmcnt(1)
    v_pk_add_f32 v[32:33], v[32:33], v[34:35]
    s_waitcnt lgkmcnt(0)
    v_pk_add_f32 v[36:37], v[36:37], v[38:39]
    v_add_f32 v28, v32, v33
    v_add_f32 v29, v36, v37
    v_mul_f32 v28, 0x3b000000, v28
    v_mul_f32 v29, 0x3b000000, v29
    v_fma_f32 v29, -v28, v28, v29
    v_max_f32 v29, 0, v29
    v_cvt_pk_bf16_f32 v29, v29, v29
    v_and_b32 v29, 0xffff0000, v29
    v_add_f32 v29, 0x3727c5ac, v29
    v_cvt_pk_bf16_f32 v29, v29, v29
    v_and_b32 v29, 0xffff0000, v29
    v_sqrt_f32 v29, v29
    v_cvt_pk_bf16_f32 v28, v28, v28
    v_and_b32 v28, 0xffff0000, v28
    v_cvt_pk_bf16_f32 v29, v29, v29
    v_and_b32 v29, 0xffff0000, v29
    v_rcp_f32 v30, v29
    v_pk_add_f32 v[32:33], v[16:17], v[28:29] op_sel_hi:[1,0] neg_lo:[0,1] neg_hi:[0,1]
    v_pk_add_f32 v[34:35], v[18:19], v[28:29] op_sel_hi:[1,0] neg_lo:[0,1] neg_hi:[0,1]
    v_pk_add_f32 v[36:37], v[20:21], v[28:29] op_sel_hi:[1,0] neg_lo:[0,1] neg_hi:[0,1]
    v_pk_add_f32 v[38:39], v[22:23], v[28:29] op_sel_hi:[1,0] neg_lo:[0,1] neg_hi:[0,1]
    v_pk_mul_f32 v[32:33], v[32:33], v[30:31] op_sel_hi:[1,0]
    v_pk_mul_f32 v[34:35], v[34:35], v[30:31] op_sel_hi:[1,0]
    v_pk_mul_f32 v[36:37], v[36:37], v[30:31] op_sel_hi:[1,0]
    v_pk_mul_f32 v[38:39], v[38:39], v[30:31] op_sel_hi:[1,0]
    v_cvt_pk_bf16_f32 v24, v32, v33
    v_cvt_pk_bf16_f32 v25, v34, v35
    v_cvt_pk_bf16_f32 v26, v36, v37
    v_cvt_pk_bf16_f32 v27, v38, v39
    s_xor_b32 s69, s69, 128
    s_cmp_lt_u32 s68, 8
    s_cbranch_scc1 L_r0_a
    s_waitcnt vmcnt(0)
    s_mov_b64 exec, 1
    buffer_store_dword v6, off, s[4:7], s71 sc1
    s_mov_b64 exec, -1
L_r0_a:
    s_lshl_b32 s70, s68, 15
    s_add_u32 s70, s70, s66
    s_add_u32 s70, s70, 4194304
    buffer_store_dwordx4 v[24:27], v1, s[4:7], s70 offen sc1
    s_lshl_b32 s71, s68, 14
    s_add_u32 s71, s71, s72
    s_cmp_lt_u32 s68, 4
    s_cbranch_scc0 L_r0_b
    s_waitcnt vmcnt(0)
    s_mov_b64 exec, 1
    buffer_store_dword v6, off, s[4:7], s71 sc1
    s_mov_b64 exec, -1
L_r0_b:
    s_add_u32 s68, s68, 4
    s_cmp_lt_u32 s68, 64
    s_cbranch_scc1 L_r0
    s_waitcnt vmcnt(0)
    s_mov_b64 exec, 1
    buffer_store_dword v6, off, s[4:7], s71 sc1
    s_mov_b64 exec, -1
L_r_steady:
    v_and_b32 v3, 7, v0
    v_lshlrev_b32 v3, 8, v3
    v_bfe_u32 v11, v0, 3, 1
    v_lshl_add_u32 v3, v11, 2, v3
    s_lshr_b32 s21, s16, 1
    s_lshl_b32 s21, s21, 7
    s_and_b32 s22, s16, 1
    s_lshl_b32 s22, s22, 3
    s_add_u32 s21, s21, s22
    v_add_u32 v3, s21, v3
    v_and_b32 v13, 15, v0
    v_min_u32 v13, 13, v13
    v_lshlrev_b32 v13, 7, v13
    s_lshl_b32 s21, s16, 2
    v_add_u32 v13, s21, v13
    s_mov_b32 s68, 64
    s_cmp_eq_u32 s64, 2
    s_cbranch_scc1 L_r_start_2
    s_mov_b32 s68, 128
    s_cmp_eq_u32 s64, 4
    s_cbranch_scc1 L_r_start_4
    s_lshr_b32 s68, s64, 1
    s_cmp_eq_u32 s64, 0
    s_cbranch_scc0 L_r_start_1
L_r_0:
L_r_start_0:
    s_mov_b32 s73, s68
    s_mov_b32 s24, s68
    s_lshl_b32 s71, s24, 14
    s_add_u32 s71, s71, 2048
L_r_wait_0:
    s_mov_b32 s27, 0
L_poll_65:
    buffer_load_dword v11, v3, s[4:7], s71 offen sc1
    s_add_u32 s27, s27, 1
    s_cmp_gt_u32 s27, 262144
    s_cbranch_scc1 L_end
    s_waitcnt vmcnt(0)
    v_cmp_gt_u32 vcc, 1, v11
    s_cbranch_vccz L_poll_65_ok
    s_sleep 4
    s_branch L_poll_65
L_poll_65_ok:
L_r_go_0:
    s_mov_b32 s24, s73
    s_mul_i32 s21, s24, 262144
    s_add_u32 s21, s21, s66
    s_add_u32 s21, s21, 35651584
    buffer_load_dwordx4 v[128:131], v1, s[4:7], s21 offen sc1
    s_add_u32 s21, s21, 32768
    buffer_load_dwordx4 v[132:135], v1, s[4:7], s21 offen sc1
    s_add_u32 s21, s21, 32768
    buffer_load_dwordx4 v[136:139], v1, s[4:7], s21 offen sc1
    s_add_u32 s21, s21, 32768
    buffer_load_dwordx4 v[140:143], v1, s[4:7], s21 offen sc1
    s_add_u32 s21, s21, 32768
    buffer_load_dwordx4 v[144:147], v1, s[4:7], s21 offen sc1
    s_add_u32 s21, s21, 32768
    buffer_load_dwordx4 v[148:151], v1, s[4:7], s21 offen sc1
    s_add_u32 s21, s21, 32768
    buffer_load_dwordx4 v[152:155], v1, s[4:7], s21 offen sc1
    s_add_u32 s21, s21, 32768
    buffer_load_dwordx4 v[156:159], v1, s[4:7], s21 offen sc1
    s_lshl_b32 s21, s73, 15
    s_add_u32 s21, s21, s67
    buffer_load_dwordx4 v[184:187], v2, s[8:11], s21 offen
    s_cmp_ge_u32 s73, 1000
    s_cselect_b32 s23, 2, 1
    s_add_u32 s21, s73, s23
    s_mov_b32 s24, s21
    s_lshl_b32 s71, s24, 14
    s_add_u32 s71, s71, 2048
    s_cmp_lt_u32 s21, 64
    s_cselect_b32 s71, s71, 14336
    buffer_load_dword v11, v3, s[4:7], s71 offen sc1
L_r_loop_0:
    s_cmp_ge_u32 s68, 1000
    s_cselect_b32 s23, 2, 1
    s_add_u32 s73, s68, s23
    s_waitcnt vmcnt(9)
    v_lshlrev_b32 v16, 16, v128
    v_and_b32 v17, 0xffff0000, v128
    v_lshlrev_b32 v18, 16, v129
    v_and_b32 v19, 0xffff0000, v129
    v_lshlrev_b32 v20, 16, v130
    v_and_b32 v21, 0xffff0000, v130
    v_lshlrev_b32 v22, 16, v131
    v_and_b32 v23, 0xffff0000, v131
    s_waitcnt vmcnt(8)
    v_dot2c_f32_bf16 v16, v132, v9
    v_dot2c_f32_bf16 v17, v132, v10
    v_dot2c_f32_bf16 v18, v133, v9
    v_dot2c_f32_bf16 v19, v133, v10
    v_dot2c_f32_bf16 v20, v134, v9
    v_dot2c_f32_bf16 v21, v134, v10
    v_dot2c_f32_bf16 v22, v135, v9
    v_dot2c_f32_bf16 v23, v135, v10
    s_waitcnt vmcnt(7)
    v_dot2c_f32_bf16 v16, v136, v9
    v_dot2c_f32_bf16 v17, v136, v10
    v_dot2c_f32_bf16 v18, v137, v9
    v_dot2c_f32_bf16 v19, v137, v10
    v_dot2c_f32_bf16 v20, v138, v9
    v_dot2c_f32_bf16 v21, v138, v10
    v_dot2c_f32_bf16 v22, v139, v9
    v_dot2c_f32_bf16 v23, v139, v10
    s_waitcnt vmcnt(6)
    v_dot2c_f32_bf16 v16, v140, v9
    v_dot2c_f32_bf16 v17, v140, v10
    v_dot2c_f32_bf16 v18, v141, v9
    v_dot2c_f32_bf16 v19, v141, v10
    v_dot2c_f32_bf16 v20, v142, v9
    v_dot2c_f32_bf16 v21, v142, v10
    v_dot2c_f32_bf16 v22, v143, v9
    v_dot2c_f32_bf16 v23, v143, v10
    s_waitcnt vmcnt(5)
    v_dot2c_f32_bf16 v16, v144, v9
    v_dot2c_f32_bf16 v17, v144, v10
    v_dot2c_f32_bf16 v18, v145, v9
    v_dot2c_f32_bf16 v19, v145, v10
    v_dot2c_f32_bf16 v20, v146, v9
    v_dot2c_f32_bf16 v21, v146, v10
    v_dot2c_f32_bf16 v22, v147, v9
    v_dot2c_f32_bf16 v23, v147, v10
    s_waitcnt vmcnt(4)
    v_dot2c_f32_bf16 v16, v148, v9
    v_dot2c_f32_bf16 v17, v148, v10
    v_dot2c_f32_bf16 v18, v149, v9
    v_dot2c_f32_bf16 v19, v149, v10
    v_dot2c_f32_bf16 v20, v150, v9
    v_dot2c_f32_bf16 v21, v150, v10
    v_dot2c_f32_bf16 v22, v151, v9
    v_dot2c_f32_bf16 v23, v151, v10
    s_waitcnt vmcnt(3)
    v_dot2c_f32_bf16 v16, v152, v9
    v_dot2c_f32_bf16 v17, v152, v10
    v_dot2c_f32_bf16 v18, v153, v9
    v_dot2c_f32_bf16 v19, v153, v10
    v_dot2c_f32_bf16 v20, v154, v9
    v_dot2c_f32_bf16 v21, v154, v10
    v_dot2c_f32_bf16 v22, v155, v9
    v_dot2c_f32_bf16 v23, v155, v10
    s_waitcnt vmcnt(2)
    v_dot2c_f32_bf16 v16, v156, v9
    v_dot2c_f32_bf16 v17, v156, v10
    v_dot2c_f32_bf16 v18, v157, v9
    v_dot2c_f32_bf16 v19, v157, v10
    v_dot2c_f32_bf16 v20, v158, v9
    v_dot2c_f32_bf16 v21, v158, v10
    v_dot2c_f32_bf16 v22, v159, v9
    v_dot2c_f32_bf16 v23, v159, v10
    s_waitcnt vmcnt(1)
    v_dot2c_f32_bf16 v16, v184, v9
    v_dot2c_f32_bf16 v17, v184, v10
    v_dot2c_f32_bf16 v18, v185, v9
    v_dot2c_f32_bf16 v19, v185, v10
    v_dot2c_f32_bf16 v20, v186, v9
    v_dot2c_f32_bf16 v21, v186, v10
    v_dot2c_f32_bf16 v22, v187, v9
    v_dot2c_f32_bf16 v23, v187, v10
    s_waitcnt vmcnt(0)
    v_cmp_gt_u32 vcc, 1, v11
    s_cbranch_vccnz L_r_np_0
    v_cvt_pk_bf16_f32 v44, v16, v17
    v_cvt_pk_bf16_f32 v45, v18, v19
    v_cvt_pk_bf16_f32 v46, v20, v21
    v_cvt_pk_bf16_f32 v47, v22, v23
    s_lshl_b32 s70, s68, 15
    s_add_u32 s70, s70, s66
    s_add_u32 s22, s70, 12582912
    s_mov_b32 s24, s73
    s_mul_i32 s21, s24, 262144
    s_add_u32 s21, s21, s66
    s_add_u32 s21, s21, 35651584
    buffer_load_dwordx4 v[128:131], v1, s[4:7], s21 offen sc1
    buffer_store_dwordx4 v[44:47], v1, s[4:7], s22 offen sc1
    v_lshlrev_b32 v16, 16, v44
    v_and_b32 v17, 0xffff0000, v44
    v_lshlrev_b32 v18, 16, v45
    v_and_b32 v19, 0xffff0000, v45
    v_lshlrev_b32 v20, 16, v46
    v_and_b32 v21, 0xffff0000, v46
    s_add_u32 s21, s21, 32768
    buffer_load_dwordx4 v[132:135], v1, s[4:7], s21 offen sc1
    v_lshlrev_b32 v22, 16, v47
    v_and_b32 v23, 0xffff0000, v47
    v_pk_add_f32 v[32:33], v[16:17], v[18:19]
    v_pk_mul_f32 v[34:35], v[16:17], v[16:17]
    v_pk_add_f32 v[36:37], v[20:21], v[22:23]
    v_pk_fma_f32 v[34:35], v[18:19], v[18:19], v[34:35]
    v_pk_add_f32 v[32:33], v[32:33], v[36:37]
    s_add_u32 s21, s21, 32768
    buffer_load_dwordx4 v[136:139], v1, s[4:7], s21 offen sc1
    v_pk_fma_f32 v[34:35], v[20:21], v[20:21], v[34:35]
    v_add_f32 v28, v32, v33
    v_pk_fma_f32 v[34:35], v[22:23], v[22:23], v[34:35]
    v_add_u32 v38, s69, v4
    v_add_f32 v29, v34, v35
    v_add_f32_dpp v30, v28, v28 quad_perm:[1,0,3,2] row_mask:0xf bank_mask:0xf
    v_add_u32 v39, s69, v5
    s_add_u32 s21, s21, 32768
    buffer_load_dwordx4 v[140:143], v1, s[4:7], s21 offen sc1
    v_add_f32_dpp v31, v29, v29 quad_perm:[1,0,3,2] row_mask:0xf bank_mask:0xf
    v_add_f32_dpp v28, v30, v30 row_ror:8 row_mask:0xf bank_mask:0xf
    s_nop 0
    v_add_f32_dpp v29, v31, v31 row_ror:8 row_mask:0xf bank_mask:0xf
    s_nop 1
    v_permlane16_swap_b32 v28, v29
    v_add_f32 v28, v28, v29
    v_mov_b32 v30, v28
    s_nop 1
    v_permlane32_swap_b32 v30, v28
    s_add_u32 s21, s21, 32768
    buffer_load_dwordx4 v[144:147], v1, s[4:7], s21 offen sc1
    v_add_f32 v28, v28, v30
    s_mov_b64 exec, 0x550055
    ds_write_b32 v38, v28
    s_mov_b64 exec, -1
    s_waitcnt lgkmcnt(0)
    s_barrier
    ds_read_b128 v[32:35], v39
    s_add_u32 s21, s21, 32768
    buffer_load_dwordx4 v[148:151], v1, s[4:7], s21 offen sc1
    ds_read_b128 v[36:39], v39 offset:16
    s_waitcnt lgkmcnt(1)
    v_pk_add_f32 v[32:33], v[32:33], v[34:35]
    s_waitcnt lgkmcnt(0)
    v_pk_add_f32 v[36:37], v[36:37], v[38:39]
    v_add_f32 v28, v32, v33
    v_add_f32 v29, v36, v37
    s_add_u32 s21, s21, 32768
    buffer_load_dwordx4 v[152:155], v1, s[4:7], s21 offen sc1
    v_mul_f32 v28, 0x3b000000, v28
    v_mul_f32 v29, 0x3b000000, v29
    v_fma_f32 v29, -v28, v28, v29
    v_max_f32 v29, 0, v29
    v_cvt_pk_bf16_f32 v29, v29, v29
    v_and_b32 v29, 0xffff0000, v29
    v_add_f32 v29, 0x3727c5ac, v29
    s_add_u32 s21, s21, 32768
    buffer_load_dwordx4 v[156:159], v1, s[4:7], s21 offen sc1
    v_cvt_pk_bf16_f32 v29, v29, v29
    v_and_b32 v29, 0xffff0000, v29
    v_sqrt_f32 v29, v29
    v_cvt_pk_bf16_f32 v28, v28, v28
    v_and_b32 v28, 0xffff0000, v28
    v_cvt_pk_bf16_f32 v29, v29, v29
    v_and_b32 v29, 0xffff0000, v29
    s_lshl_b32 s21, s73, 15
    s_add_u32 s21, s21, s67
    buffer_load_dwordx4 v[184:187], v2, s[8:11], s21 offen
    v_rcp_f32 v30, v29
    v_pk_add_f32 v[32:33], v[16:17], v[28:29] op_sel_hi:[1,0] neg_lo:[0,1] neg_hi:[0,1]
    v_pk_add_f32 v[34:35], v[18:19], v[28:29] op_sel_hi:[1,0] neg_lo:[0,1] neg_hi:[0,1]
    v_pk_add_f32 v[36:37], v[20:21], v[28:29] op_sel_hi:[1,0] neg_lo:[0,1] neg_hi:[0,1]
    v_pk_add_f32 v[38:39], v[22:23], v[28:29] op_sel_hi:[1,0] neg_lo:[0,1] neg_hi:[0,1]
    v_pk_mul_f32 v[32:33], v[32:33], v[30:31] op_sel_hi:[1,0]
    v_pk_mul_f32 v[34:35], v[34:35], v[30:31] op_sel_hi:[1,0]
    s_cmp_ge_u32 s73, 1000
    s_cselect_b32 s23, 2, 1
    s_add_u32 s21, s73, s23
    s_mov_b32 s24, s21
    s_lshl_b32 s71, s24, 14
    s_add_u32 s71, s71, 2048
    s_cmp_lt_u32 s21, 64
    s_cselect_b32 s71, s71, 14336
    buffer_load_dword v11, v3, s[4:7], s71 offen sc1
    v_pk_mul_f32 v[36:37], v[36:37], v[30:31] op_sel_hi:[1,0]
    v_pk_mul_f32 v[38:39], v[38:39], v[30:31] op_sel_hi:[1,0]
    v_cvt_pk_bf16_f32 v24, v32, v33
    v_cvt_pk_bf16_f32 v25, v34, v35
    v_cvt_pk_bf16_f32 v26, v36, v37
    v_cvt_pk_bf16_f32 v27, v38, v39
    s_xor_b32 s69, s69, 128
    s_add_u32 s22, s70, 8388608
    buffer_store_dwordx4 v[24:27], v1, s[4:7], s22 offen sc1
    s_mov_b32 s74, 1
    s_branch L_r_np_0_j
L_r_deep_0:
    s_cmp_ge_u32 s68, 1000
    s_cselect_b32 s23, 2, 1
    s_add_u32 s73, s68, s23
    v_lshlrev_b32 v16, 16, v128
    v_and_b32 v17, 0xffff0000, v128
    v_lshlrev_b32 v18, 16, v129
    v_and_b32 v19, 0xffff0000, v129
    v_lshlrev_b32 v20, 16, v130
    v_and_b32 v21, 0xffff0000, v130
    v_lshlrev_b32 v22, 16, v131
    v_and_b32 v23, 0xffff0000, v131
    v_dot2c_f32_bf16 v16, v132, v9
    v_dot2c_f32_bf16 v17, v132, v10
    v_dot2c_f32_bf16 v18, v133, v9
    v_dot2c_f32_bf16 v19, v133, v10
    v_dot2c_f32_bf16 v20, v134, v9
    v_dot2c_f32_bf16 v21, v134, v10
    v_dot2c_f32_bf16 v22, v135, v9
    v_dot2c_f32_bf16 v23, v135, v10
    s_mov_b32 s24, s73
    s_mul_i32 s21, s24, 262144
    s_add_u32 s21, s21, s66
    s_add_u32 s21, s21, 35651584
    buffer_load_dwordx4 v[128:131], v1, s[4:7], s21 offen sc1
    v_dot2c_f32_bf16 v16, v136, v9
    v_dot2c_f32_bf16 v17, v136, v10
    v_dot2c_f32_bf16 v18, v137, v9
    v_dot2c_f32_bf16 v19, v137, v10
    v_dot2c_f32_bf16 v20, v138, v9
    v_dot2c_f32_bf16 v21, v138, v10
    v_dot2c_f32_bf16 v22, v139, v9
    v_dot2c_f32_bf16 v23, v139, v10
    s_add_u32 s21, s21, 32768
    buffer_load_dwordx4 v[132:135], v1, s[4:7], s21 offen sc1
    v_dot2c_f32_bf16 v16, v140, v9
    v_dot2c_f32_bf16 v17, v140, v10
    v_dot2c_f32_bf16 v18, v141, v9
    v_dot2c_f32_bf16 v19, v141, v10
    v_dot2c_f32_bf16 v20, v142, v9
    v_dot2c_f32_bf16 v21, v142, v10
    v_dot2c_f32_bf16 v22, v143, v9
    v_dot2c_f32_bf16 v23, v143, v10
    s_add_u32 s21, s21, 32768
    buffer_load_dwordx4 v[136:139], v1, s[4:7], s21 offen sc1
    v_dot2c_f32_bf16 v16, v144, v9
    v_dot2c_f32_bf16 v17, v144, v10
    v_dot2c_f32_bf16 v18, v145, v9
    v_dot2c_f32_bf16 v19, v145, v10
    v_dot2c_f32_bf16 v20, v146, v9
    v_dot2c_f32_bf16 v21, v146, v10
    v_dot2c_f32_bf16 v22, v147, v9
    v_dot2c_f32_bf16 v23, v147, v10
    s_add_u32 s21, s21, 32768
    buffer_load_dwordx4 v[140:143], v1, s[4:7], s21 offen sc1
    v_dot2c_f32_bf16 v16, v148, v9
    v_dot2c_f32_bf16 v17, v148, v10
    v_dot2c_f32_bf16 v18, v149, v9
    v_dot2c_f32_bf16 v19, v149, v10
    v_dot2c_f32_bf16 v20, v150, v9
    v_dot2c_f32_bf16 v21, v150, v10
    v_dot2c_f32_bf16 v22, v151, v9
    v_dot2c_f32_bf16 v23, v151, v10
    s_add_u32 s21, s21, 32768
    buffer_load_dwordx4 v[144:147], v1, s[4:7], s21 offen sc1
    v_dot2c_f32_bf16 v16, v152, v9
    v_dot2c_f32_bf16 v17, v152, v10
    v_dot2c_f32_bf16 v18, v153, v9
    v_dot2c_f32_bf16 v19, v153, v10
    v_dot2c_f32_bf16 v20, v154, v9
    v_dot2c_f32_bf16 v21, v154, v10
    v_dot2c_f32_bf16 v22, v155, v9
    v_dot2c_f32_bf16 v23, v155, v10
    s_add_u32 s21, s21, 32768
    buffer_load_dwordx4 v[148:151], v1, s[4:7], s21 offen sc1
    v_dot2c_f32_bf16 v16, v156, v9
    v_dot2c_f32_bf16 v17, v156, v10
    v_dot2c_f32_bf16 v18, v157, v9
    v_dot2c_f32_bf16 v19, v157, v10
    v_dot2c_f32_bf16 v20, v158, v9
    v_dot2c_f32_bf16 v21, v158, v10
    v_dot2c_f32_bf16 v22, v159, v9
    v_dot2c_f32_bf16 v23, v159, v10
    s_add_u32 s21, s21, 32768
    buffer_load_dwordx4 v[152:155], v1, s[4:7], s21 offen sc1
    v_dot2c_f32_bf16 v16, v184, v9
    v_dot2c_f32_bf16 v17, v184, v10
    v_dot2c_f32_bf16 v18, v185, v9
    v_dot2c_f32_bf16 v19, v185, v10
    v_dot2c_f32_bf16 v20, v186, v9
    v_dot2c_f32_bf16 v21, v186, v10
    v_dot2c_f32_bf16 v22, v187, v9
    v_dot2c_f32_bf16 v23, v187, v10
    s_add_u32 s21, s21, 32768
    buffer_load_dwordx4 v[156:159], v1, s[4:7], s21 offen sc1
    s_lshl_b32 s21, s73, 15
    s_add_u32 s21, s21, s67
    buffer_load_dwordx4 v[184:187], v2, s[8:11], s21 offen
    s_cmp_ge_u32 s73, 1000
    s_cselect_b32 s23, 2, 1
    s_add_u32 s21, s73, s23
    s_mov_b32 s24, s21
    s_lshl_b32 s71, s24, 14
    s_add_u32 s71, s71, 2048
    s_cmp_lt_u32 s21, 64
    s_cselect_b32 s71, s71, 14336
    buffer_load_dword v11, v3, s[4:7], s71 offen sc1
    s_mov_b32 s74, 1
    s_branch L_r_np_0_p
L_r_np_0:
    s_mov_b32 s74, 0
L_r_np_0_p:
    v_cvt_pk_bf16_f32 v44, v16, v17
    v_cvt_pk_bf16_f32 v45, v18, v19
    v_cvt_pk_bf16_f32 v46, v20, v21
    v_cvt_pk_bf16_f32 v47, v22, v23
    s_lshl_b32 s70, s68, 15
    s_add_u32 s70, s70, s66
    s_add_u32 s22, s70, 12582912
    buffer_store_dwordx4 v[44:47], v1, s[4:7], s22 offen sc1
    v_lshlrev_b32 v16, 16, v44
    v_and_b32 v17, 0xffff0000, v44
    v_lshlrev_b32 v18, 16, v45
    v_and_b32 v19, 0xffff0000, v45
    v_lshlrev_b32 v20, 16, v46
    v_and_b32 v21, 0xffff0000, v46
    v_lshlrev_b32 v22, 16, v47
    v_and_b32 v23, 0xffff0000, v47
    v_pk_add_f32 v[32:33], v[16:17], v[18:19]
    v_pk_mul_f32 v[34:35], v[16:17], v[16:17]
    v_pk_add_f32 v[36:37], v[20:21], v[22:23]
    v_pk_fma_f32 v[34:35], v[18:19], v[18:19], v[34:35]
    v_pk_add_f32 v[32:33], v[32:33], v[36:37]
    v_pk_fma_f32 v[34:35], v[20:21], v[20:21], v[34:35]
    v_add_f32 v28, v32, v33
    v_pk_fma_f32 v[34:35], v[22:23], v[22:23], v[34:35]
    v_add_u32 v38, s69, v4
    v_add_f32 v29, v34, v35
    v_add_f32_dpp v30, v28, v28 quad_perm:[1,0,3,2] row_mask:0xf bank_mask:0xf
    v_add_u32 v39, s69, v5
    v_add_f32_dpp v31, v29, v29 quad_perm:[1,0,3,2] row_mask:0xf bank_mask:0xf
    v_add_f32_dpp v28, v30, v30 row_ror:8 row_mask:0xf bank_mask:0xf
    s_nop 0
    v_add_f32_dpp v29, v31, v31 row_ror:8 row_mask:0xf bank_mask:0xf
    s_nop 1
    v_permlane16_swap_b32 v28, v29
    v_add_f32 v28, v28, v29
    v_mov_b32 v30, v28
    s_nop 1
    v_permlane32_swap_b32 v30, v28
    v_add_f32 v28, v28, v30
    s_mov_b64 exec, 0x550055
    ds_write_b32 v38, v28
    s_mov_b64 exec, -1
    s_waitcnt lgkmcnt(0)
    s_barrier
    ds_read_b128 v[32:35], v39
    ds_read_b128 v[36:39], v39 offset:16
    s_waitcnt lgkmcnt(1)
    v_pk_add_f32 v[32:33], v[32:33], v[34:35]
    s_waitcnt lgkmcnt(0)
    v_pk_add_f32 v[36:37], v[36:37], v[38:39]
    v_add_f32 v28, v32, v33
    v_add_f32 v29, v36, v37
    v_mul_f32 v28, 0x3b000000, v28
    v_mul_f32 v29, 0x3b000000, v29
    v_fma_f32 v29, -v28, v28, v29
    v_max_f32 v29, 0, v29
    v_cvt_pk_bf16_f32 v29, v29, v29
    v_and_b32 v29, 0xffff0000, v29
    v_add_f32 v29, 0x3727c5ac, v29
    v_cvt_pk_bf16_f32 v29, v29, v29
    v_and_b32 v29, 0xffff0000, v29
    v_sqrt_f32 v29, v29
    v_cvt_pk_bf16_f32 v28, v28, v28
    v_and_b32 v28, 0xffff0000, v28
    v_cvt_pk_bf16_f32 v29, v29, v29
    v_and_b32 v29, 0xffff0000, v29
    v_rcp_f32 v30, v29
    v_pk_add_f32 v[32:33], v[16:17], v[28:29] op_sel_hi:[1,0] neg_lo:[0,1] neg_hi:[0,1]
    v_pk_add_f32 v[34:35], v[18:19], v[28:29] op_sel_hi:[1,0] neg_lo:[0,1] neg_hi:[0,1]
    v_pk_add_f32 v[36:37], v[20:21], v[28:29] op_sel_hi:[1,0] neg_lo:[0,1] neg_hi:[0,1]
    v_pk_add_f32 v[38:39], v[22:23], v[28:29] op_sel_hi:[1,0] neg_lo:[0,1] neg_hi:[0,1]
    v_pk_mul_f32 v[32:33], v[32:33], v[30:31] op_sel_hi:[1,0]
    v_pk_mul_f32 v[34:35], v[34:35], v[30:31] op_sel_hi:[1,0]
    v_pk_mul_f32 v[36:37], v[36:37], v[30:31] op_sel_hi:[1,0]
    v_pk_mul_f32 v[38:39], v[38:39], v[30:31] op_sel_hi:[1,0]
    v_cvt_pk_bf16_f32 v24, v32, v33
    v_cvt_pk_bf16_f32 v25, v34, v35
    v_cvt_pk_bf16_f32 v26, v36, v37
    v_cvt_pk_bf16_f32 v27, v38, v39
    s_xor_b32 s69, s69, 128
    s_add_u32 s22, s70, 8388608
    buffer_store_dwordx4 v[24:27], v1, s[4:7], s22 offen sc1
L_r_np_0_j:
    s_lshl_b32 s22, s68, 14
    s_add_u32 s22, s22, s72
    s_add_u32 s22, s22, 1024
    buffer_load_dword v12, v3, s[4:7], s71 offen sc1
    s_waitcnt vmcnt(1)
    s_mov_b64 exec, 1
    buffer_store_dword v6, off, s[4:7], s22 sc1
    s_mov_b64 exec, -1
    s_mov_b32 s68, s73
    s_cmp_lt_u32 s68, 64
    s_cbranch_scc0 L_r_end_0
    s_waitcnt vmcnt(1)
    v_cmp_gt_u32 vcc, 1, v12
    s_cmp_eq_u32 s74, 1
    s_cbranch_scc0 L_r_x_0
    s_cbranch_vccz L_r_deep_0
    v_mov_b32 v11, v12
    s_branch L_r_loop_0
L_r_x_0:
    s_cbranch_vccz L_r_go_0
    s_branch L_r_wait_0
L_r_end_0:
    s_mov_b32 s68, 109
    s_waitcnt vmcnt(0)
    s_branch L_r_start_2
L_r_1:
L_r_start_1:
    s_mov_b32 s73, s68
    s_mov_b32 s24, s68
    s_lshl_b32 s71, s24, 14
    s_add_u32 s71, s71, 4096
L_r_wait_1:
    s_mov_b32 s27, 0
L_poll_66:
    buffer_load_dword v11, v13, s[4:7], s71 offen sc1
    s_add_u32 s27, s27, 1
    s_cmp_gt_u32 s27, 262144
    s_cbranch_scc1 L_end
    s_waitcnt vmcnt(0)
    v_cmp_gt_u32 vcc, 1, v11
    s_cbranch_vccz L_poll_66_ok
    s_sleep 4
    s_branch L_poll_66
L_poll_66_ok:
L_r_go_1:
    s_mov_b32 s24, s73
    s_mul_i32 s21, s24, 458752
    s_add_u32 s21, s21, s66
    s_add_u32 s21, s21, 69206016
    buffer_load_dwordx4 v[128:131], v1, s[4:7], s21 offen sc1
    s_add_u32 s21, s21, 32768
    buffer_load_dwordx4 v[132:135], v1, s[4:7], s21 offen sc1
    s_add_u32 s21, s21, 32768
    buffer_load_dwordx4 v[136:139], v1, s[4:7], s21 offen sc1
    s_add_u32 s21, s21, 32768
    buffer_load_dwordx4 v[140:143], v1, s[4:7], s21 offen sc1
    s_add_u32 s21, s21, 32768
    buffer_load_dwordx4 v[144:147], v1, s[4:7], s21 offen sc1
    s_add_u32 s21, s21, 32768
    buffer_load_dwordx4 v[148:151], v1, s[4:7], s21 offen sc1
    s_add_u32 s21, s21, 32768
    buffer_load_dwordx4 v[152:155], v1, s[4:7], s21 offen sc1
    s_add_u32 s21, s21, 32768
    buffer_load_dwordx4 v[156:159], v1, s[4:7], s21 offen sc1
    s_add_u32 s21, s21, 32768
    buffer_load_dwordx4 v[160:163], v1, s[4:7], s21 offen sc1
    s_add_u32 s21, s21, 32768
    buffer_load_dwordx4 v[164:167], v1, s[4:7], s21 offen sc1
    s_add_u32 s21, s21, 32768
    buffer_load_dwordx4 v[168:171], v1, s[4:7], s21 offen sc1
    s_add_u32 s21, s21, 32768
    buffer_load_dwordx4 v[172:175], v1, s[4:7], s21 offen sc1
    s_add_u32 s21, s21, 32768
    buffer_load_dwordx4 v[176:179], v1, s[4:7], s21 offen sc1
    s_add_u32 s21, s21, 32768
    buffer_load_dwordx4 v[180:183], v1, s[4:7], s21 offen sc1
    s_lshl_b32 s21, s24, 15
    s_add_u32 s21, s21, s66
    s_add_u32 s21, s21, 12582912
    buffer_load_dwordx4 v[184:187], v1, s[4:7], s21 offen sc1
    s_cmp_ge_u32 s73, 0
    s_cselect_b32 s23, 2, 1
    s_add_u32 s21, s73, s23
    s_mov_b32 s24, s21
    s_lshl_b32 s71, s24, 14
    s_add_u32 s71, s71, 4096
    s_cmp_lt_u32 s21, 64
    s_cselect_b32 s71, s71, 14336
    buffer_load_dword v11, v13, s[4:7], s71 offen sc1
L_r_loop_1:
    s_cmp_ge_u32 s68, 0
    s_cselect_b32 s23, 2, 1
    s_add_u32 s73, s68, s23
    s_waitcnt vmcnt(15)
    v_lshlrev_b32 v16, 16, v128
    v_and_b32 v17, 0xffff0000, v128
    v_lshlrev_b32 v18, 16, v129
    v_and_b32 v19, 0xffff0000, v129
    v_lshlrev_b32 v20, 16, v130
    v_and_b32 v21, 0xffff0000, v130
    v_lshlrev_b32 v22, 16, v131
    v_and_b32 v23, 0xffff0000, v131
    s_waitcnt vmcnt(14)
    v_dot2c_f32_bf16 v16, v132, v9
    v_dot2c_f32_bf16 v17, v132, v10
    v_dot2c_f32_bf16 v18, v133, v9
    v_dot2c_f32_bf16 v19, v133, v10
    v_dot2c_f32_bf16 v20, v134, v9
    v_dot2c_f32_bf16 v21, v134, v10
    v_dot2c_f32_bf16 v22, v135, v9
    v_dot2c_f32_bf16 v23, v135, v10
    s_waitcnt vmcnt(13)
    v_dot2c_f32_bf16 v16, v136, v9
    v_dot2c_f32_bf16 v17, v136, v10
    v_dot2c_f32_bf16 v18, v137, v9
    v_dot2c_f32_bf16 v19, v137, v10
    v_dot2c_f32_bf16 v20, v138, v9
    v_dot2c_f32_bf16 v21, v138, v10
    v_dot2c_f32_bf16 v22, v139, v9
    v_dot2c_f32_bf16 v23, v139, v10
    s_waitcnt vmcnt(12)
    v_dot2c_f32_bf16 v16, v140, v9
    v_dot2c_f32_bf16 v17, v140, v10
    v_dot2c_f32_bf16 v18, v141, v9
    v_dot2c_f32_bf16 v19, v141, v10
    v_dot2c_f32_bf16 v20, v142, v9
    v_dot2c_f32_bf16 v21, v142, v10
    v_dot2c_f32_bf16 v22, v143, v9
    v_dot2c_f32_bf16 v23, v143, v10
    s_waitcnt vmcnt(11)
    v_dot2c_f32_bf16 v16, v144, v9
    v_dot2c_f32_bf16 v17, v144, v10
    v_dot2c_f32_bf16 v18, v145, v9
    v_dot2c_f32_bf16 v19, v145, v10
    v_dot2c_f32_bf16 v20, v146, v9
    v_dot2c_f32_bf16 v21, v146, v10
    v_dot2c_f32_bf16 v22, v147, v9
    v_dot2c_f32_bf16 v23, v147, v10
    s_waitcnt vmcnt(10)
    v_dot2c_f32_bf16 v16, v148, v9
    v_dot2c_f32_bf16 v17, v148, v10
    v_dot2c_f32_bf16 v18, v149, v9
    v_dot2c_f32_bf16 v19, v149, v10
    v_dot2c_f32_bf16 v20, v150, v9
    v_dot2c_f32_bf16 v21, v150, v10
    v_dot2c_f32_bf16 v22, v151, v9
    v_dot2c_f32_bf16 v23, v151, v10
    s_waitcnt vmcnt(9)
    v_dot2c_f32_bf16 v16, v152, v9
    v_dot2c_f32_bf16 v17, v152, v10
    v_dot2c_f32_bf16 v18, v153, v9
    v_dot2c_f32_bf16 v19, v153, v10
    v_dot2c_f32_bf16 v20, v154, v9
    v_dot2c_f32_bf16 v21, v154, v10
    v_dot2c_f32_bf16 v22, v155, v9
    v_dot2c_f32_bf16 v23, v155, v10
    s_waitcnt vmcnt(8)
    v_dot2c_f32_bf16 v16, v156, v9
    v_dot2c_f32_bf16 v17, v156, v10
    v_dot2c_f32_bf16 v18, v157, v9
    v_dot2c_f32_bf16 v19, v157, v10
    v_dot2c_f32_bf16 v20, v158, v9
    v_dot2c_f32_bf16 v21, v158, v10
    v_dot2c_f32_bf16 v22, v159, v9
    v_dot2c_f32_bf16 v23, v159, v10
    s_waitcnt vmcnt(7)
    v_dot2c_f32_bf16 v16, v160, v9
    v_dot2c_f32_bf16 v17, v160, v10
    v_dot2c_f32_bf16 v18, v161, v9
    v_dot2c_f32_bf16 v19, v161, v10
    v_dot2c_f32_bf16 v20, v162, v9
    v_dot2c_f32_bf16 v21, v162, v10
    v_dot2c_f32_bf16 v22, v163, v9
    v_dot2c_f32_bf16 v23, v163, v10
    s_waitcnt vmcnt(6)
    v_dot2c_f32_bf16 v16, v164, v9
    v_dot2c_f32_bf16 v17, v164, v10
    v_dot2c_f32_bf16 v18, v165, v9
    v_dot2c_f32_bf16 v19, v165, v10
    v_dot2c_f32_bf16 v20, v166, v9
    v_dot2c_f32_bf16 v21, v166, v10
    v_dot2c_f32_bf16 v22, v167, v9
    v_dot2c_f32_bf16 v23, v167, v10
    s_waitcnt vmcnt(5)
    v_dot2c_f32_bf16 v16, v168, v9
    v_dot2c_f32_bf16 v17, v168, v10
    v_dot2c_f32_bf16 v18, v169, v9
    v_dot2c_f32_bf16 v19, v169, v10
    v_dot2c_f32_bf16 v20, v170, v9
    v_dot2c_f32_bf16 v21, v170, v10
    v_dot2c_f32_bf16 v22, v171, v9
    v_dot2c_f32_bf16 v23, v171, v10
    s_waitcnt vmcnt(4)
    v_dot2c_f32_bf16 v16, v172, v9
    v_dot2c_f32_bf16 v17, v172, v10
    v_dot2c_f32_bf16 v18, v173, v9
    v_dot2c_f32_bf16 v19, v173, v10
    v_dot2c_f32_bf16 v20, v174, v9
    v_dot2c_f32_bf16 v21, v174, v10
    v_dot2c_f32_bf16 v22, v175, v9
    v_dot2c_f32_bf16 v23, v175, v10
    s_waitcnt vmcnt(3)
    v_dot2c_f32_bf16 v16, v176, v9
    v_dot2c_f32_bf16 v17, v176, v10
    v_dot2c_f32_bf16 v18, v177, v9
    v_dot2c_f32_bf16 v19, v177, v10
    v_dot2c_f32_bf16 v20, v178, v9
    v_dot2c_f32_bf16 v21, v178, v10
    v_dot2c_f32_bf16 v22, v179, v9
    v_dot2c_f32_bf16 v23, v179, v10
    s_waitcnt vmcnt(2)
    v_dot2c_f32_bf16 v16, v180, v9
    v_dot2c_f32_bf16 v17, v180, v10
    v_dot2c_f32_bf16 v18, v181, v9
    v_dot2c_f32_bf16 v19, v181, v10
    v_dot2c_f32_bf16 v20, v182, v9
    v_dot2c_f32_bf16 v21, v182, v10
    v_dot2c_f32_bf16 v22, v183, v9
    v_dot2c_f32_bf16 v23, v183, v10
    s_waitcnt vmcnt(1)
    v_dot2c_f32_bf16 v16, v184, v9
    v_dot2c_f32_bf16 v17, v184, v10
    v_dot2c_f32_bf16 v18, v185, v9
    v_dot2c_f32_bf16 v19, v185, v10
    v_dot2c_f32_bf16 v20, v186, v9
    v_dot2c_f32_bf16 v21, v186, v10
    v_dot2c_f32_bf16 v22, v187, v9
    v_dot2c_f32_bf16 v23, v187, v10
    s_waitcnt vmcnt(0)
    v_cmp_gt_u32 vcc, 1, v11
    s_cbranch_vccnz L_r_np_1
    v_cvt_pk_bf16_f32 v44, v16, v17
    v_cvt_pk_bf16_f32 v45, v18, v19
    v_cvt_pk_bf16_f32 v46, v20, v21
    v_cvt_pk_bf16_f32 v47, v22, v23
    s_mov_b32 s24, s73
    s_mul_i32 s21, s24, 458752
    s_add_u32 s21, s21, s66
    s_add_u32 s21, s21, 69206016
    buffer_load_dwordx4 v[128:131], v1, s[4:7], s21 offen sc1
    s_lshl_b32 s70, s68, 15
    s_add_u32 s70, s70, s66
    s_add_u32 s22, s70, 16777216
    buffer_store_dwordx4 v[44:47], v1, s[4:7], s22 offen sc1
    s_add_u32 s21, s21, 32768
    buffer_load_dwordx4 v[132:135], v1, s[4:7], s21 offen sc1
    v_lshlrev_b32 v16, 16, v44
    v_and_b32 v17, 0xffff0000, v44
    v_lshlrev_b32 v18, 16, v45
    v_and_b32 v19, 0xffff0000, v45
    s_add_u32 s21, s21, 32768
    buffer_load_dwordx4 v[136:139], v1, s[4:7], s21 offen sc1
    v_lshlrev_b32 v20, 16, v46
    v_and_b32 v21, 0xffff0000, v46
    v_lshlrev_b32 v22, 16, v47
    v_and_b32 v23, 0xffff0000, v47
    s_add_u32 s21, s21, 32768
    buffer_load_dwordx4 v[140:143], v1, s[4:7], s21 offen sc1
    v_pk_add_f32 v[32:33], v[16:17], v[18:19]
    v_pk_mul_f32 v[34:35], v[16:17], v[16:17]
    v_pk_add_f32 v[36:37], v[20:21], v[22:23]
    v_pk_fma_f32 v[34:35], v[18:19], v[18:19], v[34:35]
    s_add_u32 s21, s21, 32768
    buffer_load_dwordx4 v[144:147], v1, s[4:7], s21 offen sc1
    v_pk_add_f32 v[32:33], v[32:33], v[36:37]
    v_pk_fma_f32 v[34:35], v[20:21], v[20:21], v[34:35]
    v_add_f32 v28, v32, v33
    v_pk_fma_f32 v[34:35], v[22:23], v[22:23], v[34:35]
    s_add_u32 s21, s21, 32768
    buffer_load_dwordx4 v[148:151], v1, s[4:7], s21 offen sc1
    v_add_u32 v38, s69, v4
    v_add_f32 v29, v34, v35
    v_add_f32_dpp v30, v28, v28 quad_perm:[1,0,3,2] row_mask:0xf bank_mask:0xf
    v_add_u32 v39, s69, v5
    s_add_u32 s21, s21, 32768
    buffer_load_dwordx4 v[152:155], v1, s[4:7], s21 offen sc1
    v_add_f32_dpp v31, v29, v29 quad_perm:[1,0,3,2] row_mask:0xf bank_mask:0xf
    v_add_f32_dpp v28, v30, v30 row_ror:8 row_mask:0xf bank_mask:0xf
    s_nop 0
    v_add_f32_dpp v29, v31, v31 row_ror:8 row_mask:0xf bank_mask:0xf
    s_nop 1
    v_permlane16_swap_b32 v28, v29
    s_add_u32 s21, s21, 32768
    buffer_load_dwordx4 v[156:159], v1, s[4:7], s21 offen sc1
    v_add_f32 v28, v28, v29
    v_mov_b32 v30, v28
    s_nop 1
    v_permlane32_swap_b32 v30, v28
    v_add_f32 v28, v28, v30
    s_add_u32 s21, s21, 32768
    buffer_load_dwordx4 v[160:163], v1, s[4:7], s21 offen sc1
    s_mov_b64 exec, 0x550055
    ds_write_b32 v38, v28
    s_mov_b64 exec, -1
    s_waitcnt lgkmcnt(0)
    s_add_u32 s21, s21, 32768
    buffer_load_dwordx4 v[164:167], v1, s[4:7], s21 offen sc1
    s_barrier
    ds_read_b128 v[32:35], v39
    ds_read_b128 v[36:39], v39 offset:16
    s_waitcnt lgkmcnt(1)
    s_add_u32 s21, s21, 32768
    buffer_load_dwordx4 v[168:171], v1, s[4:7], s21 offen sc1
    v_pk_add_f32 v[32:33], v[32:33], v[34:35]
    s_waitcnt lgkmcnt(0)
    v_pk_add_f32 v[36:37], v[36:37], v[38:39]
    v_add_f32 v28, v32, v33
    s_add_u32 s21, s21, 32768
    buffer_load_dwordx4 v[172:175], v1, s[4:7], s21 offen sc1
    v_add_f32 v29, v36, v37
    v_mul_f32 v28, 0x3b000000, v28
    v_mul_f32 v29, 0x3b000000, v29
    v_fma_f32 v29, -v28, v28, v29
    s_add_u32 s21, s21, 32768
    buffer_load_dwordx4 v[176:179], v1, s[4:7], s21 offen sc1
    v_max_f32 v29, 0, v29
    v_cvt_pk_bf16_f32 v29, v29, v29
    v_and_b32 v29, 0xffff0000, v29
    v_add_f32 v29, 0x3727c5ac, v29
    s_add_u32 s21, s21, 32768
    buffer_load_dwordx4 v[180:183], v1, s[4:7], s21 offen sc1
    v_cvt_pk_bf16_f32 v29, v29, v29
    v_and_b32 v29, 0xffff0000, v29
    v_sqrt_f32 v29, v29
    v_cvt_pk_bf16_f32 v28, v28, v28
    s_lshl_b32 s21, s24, 15
    s_add_u32 s21, s21, s66
    s_add_u32 s21, s21, 12582912
    buffer_load_dwordx4 v[184:187], v1, s[4:7], s21 offen sc1
    v_and_b32 v28, 0xffff0000, v28
    v_cvt_pk_bf16_f32 v29, v29, v29
    v_and_b32 v29, 0xffff0000, v29
    v_rcp_f32 v30, v29
    s_cmp_ge_u32 s73, 0
    s_cselect_b32 s23, 2, 1
    s_add_u32 s21, s73, s23
    s_mov_b32 s24, s21
    s_lshl_b32 s71, s24, 14
    s_add_u32 s71, s71, 4096
    s_cmp_lt_u32 s21, 64
    s_cselect_b32 s71, s71, 14336
    buffer_load_dword v11, v13, s[4:7], s71 offen sc1
    v_pk_add_f32 v[32:33], v[16:17], v[28:29] op_sel_hi:[1,0] neg_lo:[0,1] neg_hi:[0,1]
    v_pk_add_f32 v[34:35], v[18:19], v[28:29] op_sel_hi:[1,0] neg_lo:[0,1] neg_hi:[0,1]
    v_pk_add_f32 v[36:37], v[20:21], v[28:29] op_sel_hi:[1,0] neg_lo:[0,1] neg_hi:[0,1]
    v_pk_add_f32 v[38:39], v[22:23], v[28:29] op_sel_hi:[1,0] neg_lo:[0,1] neg_hi:[0,1]
    v_pk_mul_f32 v[32:33], v[32:33], v[30:31] op_sel_hi:[1,0]
    v_pk_mul_f32 v[34:35], v[34:35], v[30:31] op_sel_hi:[1,0]
    v_pk_mul_f32 v[36:37], v[36:37], v[30:31] op_sel_hi:[1,0]
    v_pk_mul_f32 v[38:39], v[38:39], v[30:31] op_sel_hi:[1,0]
    v_cvt_pk_bf16_f32 v24, v32, v33
    v_cvt_pk_bf16_f32 v25, v34, v35
    v_cvt_pk_bf16_f32 v26, v36, v37
    v_cvt_pk_bf16_f32 v27, v38, v39
    s_xor_b32 s69, s69, 128
    s_add_u32 s22, s70, 6291456
    buffer_store_dwordx4 v[24:27], v1, s[4:7], s22 offen sc1
    s_mov_b32 s74, 1
    s_branch L_r_np_1_j
L_r_deep_1:
    s_cmp_ge_u32 s68, 0
    s_cselect_b32 s23, 2, 1
    s_add_u32 s73, s68, s23
    v_lshlrev_b32 v16, 16, v128
    v_and_b32 v17, 0xffff0000, v128
    v_lshlrev_b32 v18, 16, v129
    v_and_b32 v19, 0xffff0000, v129
    v_lshlrev_b32 v20, 16, v130
    v_and_b32 v21, 0xffff0000, v130
    v_lshlrev_b32 v22, 16, v131
    v_and_b32 v23, 0xffff0000, v131
    v_dot2c_f32_bf16 v16, v132, v9
    v_dot2c_f32_bf16 v17, v132, v10
    v_dot2c_f32_bf16 v18, v133, v9
    v_dot2c_f32_bf16 v19, v133, v10
    v_dot2c_f32_bf16 v20, v134, v9
    v_dot2c_f32_bf16 v21, v134, v10
    v_dot2c_f32_bf16 v22, v135, v9
    v_dot2c_f32_bf16 v23, v135, v10
    s_mov_b32 s24, s73
    s_mul_i32 s21, s24, 458752
    s_add_u32 s21, s21, s66
    s_add_u32 s21, s21, 69206016
    buffer_load_dwordx4 v[128:131], v1, s[4:7], s21 offen sc1
    v_dot2c_f32_bf16 v16, v136, v9
    v_dot2c_f32_bf16 v17, v136, v10
    v_dot2c_f32_bf16 v18, v137, v9
    v_dot2c_f32_bf16 v19, v137, v10
    v_dot2c_f32_bf16 v20, v138, v9
    v_dot2c_f32_bf16 v21, v138, v10
    v_dot2c_f32_bf16 v22, v139, v9
    v_dot2c_f32_bf16 v23, v139, v10
    s_add_u32 s21, s21, 32768
    buffer_load_dwordx4 v[132:135], v1, s[4:7], s21 offen sc1
    v_dot2c_f32_bf16 v16, v140, v9
    v_dot2c_f32_bf16 v17, v140, v10
    v_dot2c_f32_bf16 v18, v141, v9
    v_dot2c_f32_bf16 v19, v141, v10
    v_dot2c_f32_bf16 v20, v142, v9
    v_dot2c_f32_bf16 v21, v142, v10
    v_dot2c_f32_bf16 v22, v143, v9
    v_dot2c_f32_bf16 v23, v143, v10
    s_add_u32 s21, s21, 32768
    buffer_load_dwordx4 v[136:139], v1, s[4:7], s21 offen sc1
    v_dot2c_f32_bf16 v16, v144, v9
    v_dot2c_f32_bf16 v17, v144, v10
    v_dot2c_f32_bf16 v18, v145, v9
    v_dot2c_f32_bf16 v19, v145, v10
    v_dot2c_f32_bf16 v20, v146, v9
    v_dot2c_f32_bf16 v21, v146, v10
    v_dot2c_f32_bf16 v22, v147, v9
    v_dot2c_f32_bf16 v23, v147, v10
    s_add_u32 s21, s21, 32768
    buffer_load_dwordx4 v[140:143], v1, s[4:7], s21 offen sc1
    v_dot2c_f32_bf16 v16, v148, v9
    v_dot2c_f32_bf16 v17, v148, v10
    v_dot2c_f32_bf16 v18, v149, v9
    v_dot2c_f32_bf16 v19, v149, v10
    v_dot2c_f32_bf16 v20, v150, v9
    v_dot2c_f32_bf16 v21, v150, v10
    v_dot2c_f32_bf16 v22, v151, v9
    v_dot2c_f32_bf16 v23, v151, v10
    s_add_u32 s21, s21, 32768
    buffer_load_dwordx4 v[144:147], v1, s[4:7], s21 offen sc1
    v_dot2c_f32_bf16 v16, v152, v9
    v_dot2c_f32_bf16 v17, v152, v10
    v_dot2c_f32_bf16 v18, v153, v9
    v_dot2c_f32_bf16 v19, v153, v10
    v_dot2c_f32_bf16 v20, v154, v9
    v_dot2c_f32_bf16 v21, v154, v10
    v_dot2c_f32_bf16 v22, v155, v9
    v_dot2c_f32_bf16 v23, v155, v10
    s_add_u32 s21, s21, 32768
    buffer_load_dwordx4 v[148:151], v1, s[4:7], s21 offen sc1
    v_dot2c_f32_bf16 v16, v156, v9
    v_dot2c_f32_bf16 v17, v156, v10
    v_dot2c_f32_bf16 v18, v157, v9
    v_dot2c_f32_bf16 v19, v157, v10
    v_dot2c_f32_bf16 v20, v158, v9
    v_dot2c_f32_bf16 v21, v158, v10
    v_dot2c_f32_bf16 v22, v159, v9
    v_dot2c_f32_bf16 v23, v159, v10
    s_add_u32 s21, s21, 32768
    buffer_load_dwordx4 v[152:155], v1, s[4:7], s21 offen sc1
    v_dot2c_f32_bf16 v16, v160, v9
    v_dot2c_f32_bf16 v17, v160, v10
    v_dot2c_f32_bf16 v18, v161, v9
    v_dot2c_f32_bf16 v19, v161, v10
    v_dot2c_f32_bf16 v20, v162, v9
    v_dot2c_f32_bf16 v21, v162, v10
    v_dot2c_f32_bf16 v22, v163, v9
    v_dot2c_f32_bf16 v23, v163, v10
    s_add_u32 s21, s21, 32768
    buffer_load_dwordx4 v[156:159], v1, s[4:7], s21 offen sc1
    v_dot2c_f32_bf16 v16, v164, v9
    v_dot2c_f32_bf16 v17, v164, v10
    v_dot2c_f32_bf16 v18, v165, v9
    v_dot2c_f32_bf16 v19, v165, v10
    v_dot2c_f32_bf16 v20, v166, v9
    v_dot2c_f32_bf16 v21, v166, v10
    v_dot2c_f32_bf16 v22, v167, v9
    v_dot2c_f32_bf16 v23, v167, v10
    s_add_u32 s21, s21, 32768
    buffer_load_dwordx4 v[160:163], v1, s[4:7], s21 offen sc1
    v_dot2c_f32_bf16 v16, v168, v9
    v_dot2c_f32_bf16 v17, v168, v10
    v_dot2c_f32_bf16 v18, v169, v9
    v_dot2c_f32_bf16 v19, v169, v10
    v_dot2c_f32_bf16 v20, v170, v9
    v_dot2c_f32_bf16 v21, v170, v10
    v_dot2c_f32_bf16 v22, v171, v9
    v_dot2c_f32_bf16 v23, v171, v10
    s_add_u32 s21, s21, 32768
    buffer_load_dwordx4 v[164:167], v1, s[4:7], s21 offen sc1
    v_dot2c_f32_bf16 v16, v172, v9
    v_dot2c_f32_bf16 v17, v172, v10
    v_dot2c_f32_bf16 v18, v173, v9
    v_dot2c_f32_bf16 v19, v173, v10
    v_dot2c_f32_bf16 v20, v174, v9
    v_dot2c_f32_bf16 v21, v174, v10
    v_dot2c_f32_bf16 v22, v175, v9
    v_dot2c_f32_bf16 v23, v175, v10
    s_add_u32 s21, s21, 32768
    buffer_load_dwordx4 v[168:171], v1, s[4:7], s21 offen sc1
    v_dot2c_f32_bf16 v16, v176, v9
    v_dot2c_f32_bf16 v17, v176, v10
    v_dot2c_f32_bf16 v18, v177, v9
    v_dot2c_f32_bf16 v19, v177, v10
    v_dot2c_f32_bf16 v20, v178, v9
    v_dot2c_f32_bf16 v21, v178, v10
    v_dot2c_f32_bf16 v22, v179, v9
    v_dot2c_f32_bf16 v23, v179, v10
    s_add_u32 s21, s21, 32768
    buffer_load_dwordx4 v[172:175], v1, s[4:7], s21 offen sc1
    v_dot2c_f32_bf16 v16, v180, v9
    v_dot2c_f32_bf16 v17, v180, v10
    v_dot2c_f32_bf16 v18, v181, v9
    v_dot2c_f32_bf16 v19, v181, v10
    v_dot2c_f32_bf16 v20, v182, v9
    v_dot2c_f32_bf16 v21, v182, v10
    v_dot2c_f32_bf16 v22, v183, v9
    v_dot2c_f32_bf16 v23, v183, v10
    s_add_u32 s21, s21, 32768
    buffer_load_dwordx4 v[176:179], v1, s[4:7], s21 offen sc1
    v_dot2c_f32_bf16 v16, v184, v9
    v_dot2c_f32_bf16 v17, v184, v10
    v_dot2c_f32_bf16 v18, v185, v9
    v_dot2c_f32_bf16 v19, v185, v10
    v_dot2c_f32_bf16 v20, v186, v9
    v_dot2c_f32_bf16 v21, v186, v10
    v_dot2c_f32_bf16 v22, v187, v9
    v_dot2c_f32_bf16 v23, v187, v10
    s_add_u32 s21, s21, 32768
    buffer_load_dwordx4 v[180:183], v1, s[4:7], s21 offen sc1
    s_lshl_b32 s21, s24, 15
    s_add_u32 s21, s21, s66
    s_add_u32 s21, s21, 12582912
    buffer_load_dwordx4 v[184:187], v1, s[4:7], s21 offen sc1
    s_cmp_ge_u32 s73, 0
    s_cselect_b32 s23, 2, 1
    s_add_u32 s21, s73, s23
    s_mov_b32 s24, s21
    s_lshl_b32 s71, s24, 14
    s_add_u32 s71, s71, 4096
    s_cmp_lt_u32 s21, 64
    s_cselect_b32 s71, s71, 14336
    buffer_load_dword v11, v13, s[4:7], s71 offen sc1
    s_mov_b32 s74, 1
    s_branch L_r_np_1_p
L_r_np_1:
    s_mov_b32 s74, 0
L_r_np_1_p:
    v_cvt_pk_bf16_f32 v44, v16, v17
    v_cvt_pk_bf16_f32 v45, v18, v19
    v_cvt_pk_bf16_f32 v46, v20, v21
    v_cvt_pk_bf16_f32 v47, v22, v23
    s_lshl_b32 s70, s68, 15
    s_add_u32 s70, s70, s66
    s_add_u32 s22, s70, 16777216
    buffer_store_dwordx4 v[44:47], v1, s[4:7], s22 offen sc1
    v_lshlrev_b32 v16, 16, v44
    v_and_b32 v17, 0xffff0000, v44
    v_lshlrev_b32 v18, 16, v45
    v_and_b32 v19, 0xffff0000, v45
    v_lshlrev_b32 v20, 16, v46
    v_and_b32 v21, 0xffff0000, v46
    v_lshlrev_b32 v22, 16, v47
    v_and_b32 v23, 0xffff0000, v47
    v_pk_add_f32 v[32:33], v[16:17], v[18:19]
    v_pk_mul_f32 v[34:35], v[16:17], v[16:17]
    v_pk_add_f32 v[36:37], v[20:21], v[22:23]
    v_pk_fma_f32 v[34:35], v[18:19], v[18:19], v[34:35]
    v_pk_add_f32 v[32:33], v[32:33], v[36:37]
    v_pk_fma_f32 v[34:35], v[20:21], v[20:21], v[34:35]
    v_add_f32 v28, v32, v33
    v_pk_fma_f32 v[34:35], v[22:23], v[22:23], v[34:35]
    v_add_u32 v38, s69, v4
    v_add_f32 v29, v34, v35
    v_add_f32_dpp v30, v28, v28 quad_perm:[1,0,3,2] row_mask:0xf bank_mask:0xf
    v_add_u32 v39, s69, v5
    v_add_f32_dpp v31, v29, v29 quad_perm:[1,0,3,2] row_mask:0xf bank_mask:0xf
    v_add_f32_dpp v28, v30, v30 row_ror:8 row_mask:0xf bank_mask:0xf
    s_nop 0
    v_add_f32_dpp v29, v31, v31 row_ror:8 row_mask:0xf bank_mask:0xf
    s_nop 1
    v_permlane16_swap_b32 v28, v29
    v_add_f32 v28, v28, v29
    v_mov_b32 v30, v28
    s_nop 1
    v_permlane32_swap_b32 v30, v28
    v_add_f32 v28, v28, v30
    s_mov_b64 exec, 0x550055
    ds_write_b32 v38, v28
    s_mov_b64 exec, -1
    s_waitcnt lgkmcnt(0)
    s_barrier
    ds_read_b128 v[32:35], v39
    ds_read_b128 v[36:39], v39 offset:16
    s_waitcnt lgkmcnt(1)
    v_pk_add_f32 v[32:33], v[32:33], v[34:35]
    s_waitcnt lgkmcnt(0)
    v_pk_add_f32 v[36:37], v[36:37], v[38:39]
    v_add_f32 v28, v32, v33
    v_add_f32 v29, v36, v37
    v_mul_f32 v28, 0x3b000000, v28
    v_mul_f32 v29, 0x3b000000, v29
    v_fma_f32 v29, -v28, v28, v29
    v_max_f32 v29, 0, v29
    v_cvt_pk_bf16_f32 v29, v29, v29
    v_and_b32 v29, 0xffff0000, v29
    v_add_f32 v29, 0x3727c5ac, v29
    v_cvt_pk_bf16_f32 v29, v29, v29
    v_and_b32 v29, 0xffff0000, v29
    v_sqrt_f32 v29, v29
    v_cvt_pk_bf16_f32 v28, v28, v28
    v_and_b32 v28, 0xffff0000, v28
    v_cvt_pk_bf16_f32 v29, v29, v29
    v_and_b32 v29, 0xffff0000, v29
    v_rcp_f32 v30, v29
    v_pk_add_f32 v[32:33], v[16:17], v[28:29] op_sel_hi:[1,0] neg_lo:[0,1] neg_hi:[0,1]
    v_pk_add_f32 v[34:35], v[18:19], v[28:29] op_sel_hi:[1,0] neg_lo:[0,1] neg_hi:[0,1]
    v_pk_add_f32 v[36:37], v[20:21], v[28:29] op_sel_hi:[1,0] neg_lo:[0,1] neg_hi:[0,1]
    v_pk_add_f32 v[38:39], v[22:23], v[28:29] op_sel_hi:[1,0] neg_lo:[0,1] neg_hi:[0,1]
    v_pk_mul_f32 v[32:33], v[32:33], v[30:31] op_sel_hi:[1,0]
    v_pk_mul_f32 v[34:35], v[34:35], v[30:31] op_sel_hi:[1,0]
    v_pk_mul_f32 v[36:37], v[36:37], v[30:31] op_sel_hi:[1,0]
    v_pk_mul_f32 v[38:39], v[38:39], v[30:31] op_sel_hi:[1,0]
    v_cvt_pk_bf16_f32 v24, v32, v33
    v_cvt_pk_bf16_f32 v25, v34, v35
    v_cvt_pk_bf16_f32 v26, v36, v37
    v_cvt_pk_bf16_f32 v27, v38, v39
    s_xor_b32 s69, s69, 128
    s_add_u32 s22, s70, 6291456
    buffer_store_dwordx4 v[24:27], v1, s[4:7], s22 offen sc1
L_r_np_1_j:
    s_lshl_b32 s22, s68, 14
    s_add_u32 s22, s22, s72
    s_add_u32 s22, s22, 1048576
    buffer_load_dword v12, v13, s[4:7], s71 offen sc1
    s_waitcnt vmcnt(1)
    s_mov_b64 exec, 1
    buffer_store_dword v6, off, s[4:7], s22 sc1
    s_mov_b64 exec, -1
    s_mov_b32 s68, s73
    s_cmp_lt_u32 s68, 64
    s_cbranch_scc0 L_r_end_1
    s_waitcnt vmcnt(1)
    v_cmp_gt_u32 vcc, 1, v12
    s_cmp_eq_u32 s74, 1
    s_cbranch_scc0 L_r_x_1
    s_cbranch_vccz L_r_deep_1
    v_mov_b32 v11, v12
    s_branch L_r_loop_1
L_r_x_1:
    s_cbranch_vccz L_r_go_1
    s_branch L_r_wait_1
L_r_end_1:
    s_lshr_b32 s68, s64, 1
    s_add_u32 s68, s68, 110
    s_waitcnt vmcnt(0)
    s_branch L_r_start_3
L_r_2:
L_r_start_2:
    s_mov_b32 s73, s68
    s_mov_b32 s24, s68
    s_lshl_b32 s71, s24, 14
    s_add_u32 s71, s71, 2048
L_r_wait_2:
    s_mov_b32 s27, 0
L_poll_67:
    buffer_load_dword v11, v3, s[4:7], s71 offen sc1
    s_add_u32 s27, s27, 1
    s_cmp_gt_u32 s27, 262144
    s_cbranch_scc1 L_end
    s_waitcnt vmcnt(0)
    v_cmp_gt_u32 vcc, 1, v11
    s_cbranch_vccz L_poll_67_ok
    s_sleep 4
    s_branch L_poll_67
L_poll_67_ok:
L_r_go_2:
    s_mov_b32 s24, s73
    s_mul_i32 s21, s24, 262144
    s_add_u32 s21, s21, s66
    s_add_u32 s21, s21, 35651584
    buffer_load_dwordx4 v[128:131], v1, s[4:7], s21 offen sc1
    s_add_u32 s21, s21, 32768
    buffer_load_dwordx4 v[132:135], v1, s[4:7], s21 offen sc1
    s_add_u32 s21, s21, 32768
    buffer_load_dwordx4 v[136:139], v1, s[4:7], s21 offen sc1
    s_add_u32 s21, s21, 32768
    buffer_load_dwordx4 v[140:143], v1, s[4:7], s21 offen sc1
    s_add_u32 s21, s21, 32768
    buffer_load_dwordx4 v[144:147], v1, s[4:7], s21 offen sc1
    s_add_u32 s21, s21, 32768
    buffer_load_dwordx4 v[148:151], v1, s[4:7], s21 offen sc1
    s_add_u32 s21, s21, 32768
    buffer_load_dwordx4 v[152:155], v1, s[4:7], s21 offen sc1
    s_add_u32 s21, s21, 32768
    buffer_load_dwordx4 v[156:159], v1, s[4:7], s21 offen sc1
    s_lshl_b32 s21, s24, 15
    s_add_u32 s21, s21, s66
    s_add_u32 s21, s21, 14680064
    buffer_load_dwordx4 v[184:187], v1, s[4:7], s21 offen sc1
    s_cmp_ge_u32 s73, 108
    s_cselect_b32 s23, 2, 1
    s_add_u32 s21, s73, s23
    s_mov_b32 s24, s21
    s_lshl_b32 s71, s24, 14
    s_add_u32 s71, s71, 2048
    s_cmp_lt_u32 s21, 128
    s_cselect_b32 s71, s71, 14336
    buffer_load_dword v11, v3, s[4:7], s71 offen sc1
L_r_loop_2:
    s_cmp_ge_u32 s68, 108
    s_cselect_b32 s23, 2, 1
    s_add_u32 s73, s68, s23
    s_waitcnt vmcnt(9)
    v_lshlrev_b32 v16, 16, v128
    v_and_b32 v17, 0xffff0000, v128
    v_lshlrev_b32 v18, 16, v129
    v_and_b32 v19, 0xffff0000, v129
    v_lshlrev_b32 v20, 16, v130
    v_and_b32 v21, 0xffff0000, v130
    v_lshlrev_b32 v22, 16, v131
    v_and_b32 v23, 0xffff0000, v131
    s_waitcnt vmcnt(8)
    v_dot2c_f32_bf16 v16, v132, v9
    v_dot2c_f32_bf16 v17, v132, v10
    v_dot2c_f32_bf16 v18, v133, v9
    v_dot2c_f32_bf16 v19, v133, v10
    v_dot2c_f32_bf16 v20, v134, v9
    v_dot2c_f32_bf16 v21, v134, v10
    v_dot2c_f32_bf16 v22, v135, v9
    v_dot2c_f32_bf16 v23, v135, v10
    s_waitcnt vmcnt(7)
    v_dot2c_f32_bf16 v16, v136, v9
    v_dot2c_f32_bf16 v17, v136, v10
    v_dot2c_f32_bf16 v18, v137, v9
    v_dot2c_f32_bf16 v19, v137, v10
    v_dot2c_f32_bf16 v20, v138, v9
    v_dot2c_f32_bf16 v21, v138, v10
    v_dot2c_f32_bf16 v22, v139, v9
    v_dot2c_f32_bf16 v23, v139, v10
    s_waitcnt vmcnt(6)
    v_dot2c_f32_bf16 v16, v140, v9
    v_dot2c_f32_bf16 v17, v140, v10
    v_dot2c_f32_bf16 v18, v141, v9
    v_dot2c_f32_bf16 v19, v141, v10
    v_dot2c_f32_bf16 v20, v142, v9
    v_dot2c_f32_bf16 v21, v142, v10
    v_dot2c_f32_bf16 v22, v143, v9
    v_dot2c_f32_bf16 v23, v143, v10
    s_waitcnt vmcnt(5)
    v_dot2c_f32_bf16 v16, v144, v9
    v_dot2c_f32_bf16 v17, v144, v10
    v_dot2c_f32_bf16 v18, v145, v9
    v_dot2c_f32_bf16 v19, v145, v10
    v_dot2c_f32_bf16 v20, v146, v9
    v_dot2c_f32_bf16 v21, v146, v10
    v_dot2c_f32_bf16 v22, v147, v9
    v_dot2c_f32_bf16 v23, v147, v10
    s_waitcnt vmcnt(4)
    v_dot2c_f32_bf16 v16, v148, v9
    v_dot2c_f32_bf16 v17, v148, v10
    v_dot2c_f32_bf16 v18, v149, v9
    v_dot2c_f32_bf16 v19, v149, v10
    v_dot2c_f32_bf16 v20, v150, v9
    v_dot2c_f32_bf16 v21, v150, v10
    v_dot2c_f32_bf16 v22, v151, v9
    v_dot2c_f32_bf16 v23, v151, v10
    s_waitcnt vmcnt(3)
    v_dot2c_f32_bf16 v16, v152, v9
    v_dot2c_f32_bf16 v17, v152, v10
    v_dot2c_f32_bf16 v18, v153, v9
    v_dot2c_f32_bf16 v19, v153, v10
    v_dot2c_f32_bf16 v20, v154, v9
    v_dot2c_f32_bf16 v21, v154, v10
    v_dot2c_f32_bf16 v22, v155, v9
    v_dot2c_f32_bf16 v23, v155, v10
    s_waitcnt vmcnt(2)
    v_dot2c_f32_bf16 v16, v156, v9
    v_dot2c_f32_bf16 v17, v156, v10
    v_dot2c_f32_bf16 v18, v157, v9
    v_dot2c_f32_bf16 v19, v157, v10
    v_dot2c_f32_bf16 v20, v158, v9
    v_dot2c_f32_bf16 v21, v158, v10
    v_dot2c_f32_bf16 v22, v159, v9
    v_dot2c_f32_bf16 v23, v159, v10
    s_waitcnt vmcnt(1)
    v_dot2c_f32_bf16 v16, v184, v9
    v_dot2c_f32_bf16 v17, v184, v10
    v_dot2c_f32_bf16 v18, v185, v9
    v_dot2c_f32_bf16 v19, v185, v10
    v_dot2c_f32_bf16 v20, v186, v9
    v_dot2c_f32_bf16 v21, v186, v10
    v_dot2c_f32_bf16 v22, v187, v9
    v_dot2c_f32_bf16 v23, v187, v10
    s_waitcnt vmcnt(0)
    v_cmp_gt_u32 vcc, 1, v11
    s_cbranch_vccnz L_r_np_2
    v_cvt_pk_bf16_f32 v44, v16, v17
    v_cvt_pk_bf16_f32 v45, v18, v19
    v_cvt_pk_bf16_f32 v46, v20, v21
    v_cvt_pk_bf16_f32 v47, v22, v23
    s_lshl_b32 s70, s68, 15
    s_add_u32 s70, s70, s66
    s_add_u32 s22, s70, 12582912
    s_mov_b32 s24, s73
    s_mul_i32 s21, s24, 262144
    s_add_u32 s21, s21, s66
    s_add_u32 s21, s21, 35651584
    buffer_load_dwordx4 v[128:131], v1, s[4:7], s21 offen sc1
    buffer_store_dwordx4 v[44:47], v1, s[4:7], s22 offen sc1
    v_lshlrev_b32 v16, 16, v44
    v_and_b32 v17, 0xffff0000, v44
    v_lshlrev_b32 v18, 16, v45
    v_and_b32 v19, 0xffff0000, v45
    v_lshlrev_b32 v20, 16, v46
    v_and_b32 v21, 0xffff0000, v46
    s_add_u32 s21, s21, 32768
    buffer_load_dwordx4 v[132:135], v1, s[4:7], s21 offen sc1
    v_lshlrev_b32 v22, 16, v47
    v_and_b32 v23, 0xffff0000, v47
    v_pk_add_f32 v[32:33], v[16:17], v[18:19]
    v_pk_mul_f32 v[34:35], v[16:17], v[16:17]
    v_pk_add_f32 v[36:37], v[20:21], v[22:23]
    v_pk_fma_f32 v[34:35], v[18:19], v[18:19], v[34:35]
    v_pk_add_f32 v[32:33], v[32:33], v[36:37]
    s_add_u32 s21, s21, 32768
    buffer_load_dwordx4 v[136:139], v1, s[4:7], s21 offen sc1
    v_pk_fma_f32 v[34:35], v[20:21], v[20:21], v[34:35]
    v_add_f32 v28, v32, v33
    v_pk_fma_f32 v[34:35], v[22:23], v[22:23], v[34:35]
    v_add_u32 v38, s69, v4
    v_add_f32 v29, v34, v35
    v_add_f32_dpp v30, v28, v28 quad_perm:[1,0,3,2] row_mask:0xf bank_mask:0xf
    v_add_u32 v39, s69, v5
    s_add_u32 s21, s21, 32768
    buffer_load_dwordx4 v[140:143], v1, s[4:7], s21 offen sc1
    v_add_f32_dpp v31, v29, v29 quad_perm:[1,0,3,2] row_mask:0xf bank_mask:0xf
    v_add_f32_dpp v28, v30, v30 row_ror:8 row_mask:0xf bank_mask:0xf
    s_nop 0
    v_add_f32_dpp v29, v31, v31 row_ror:8 row_mask:0xf bank_mask:0xf
    s_nop 1
    v_permlane16_swap_b32 v28, v29
    v_add_f32 v28, v28, v29
    v_mov_b32 v30, v28
    s_nop 1
    v_permlane32_swap_b32 v30, v28
    s_add_u32 s21, s21, 32768
    buffer_load_dwordx4 v[144:147], v1, s[4:7], s21 offen sc1
    v_add_f32 v28, v28, v30
    s_mov_b64 exec, 0x550055
    ds_write_b32 v38, v28
    s_mov_b64 exec, -1
    s_waitcnt lgkmcnt(0)
    s_barrier
    ds_read_b128 v[32:35], v39
    s_add_u32 s21, s21, 32768
    buffer_load_dwordx4 v[148:151], v1, s[4:7], s21 offen sc1
    ds_read_b128 v[36:39], v39 offset:16
    s_waitcnt lgkmcnt(1)
    v_pk_add_f32 v[32:33], v[32:33], v[34:35]
    s_waitcnt lgkmcnt(0)
    v_pk_add_f32 v[36:37], v[36:37], v[38:39]
    v_add_f32 v28, v32, v33
    v_add_f32 v29, v36, v37
    s_add_u32 s21, s21, 32768
    buffer_load_dwordx4 v[152:155], v1, s[4:7], s21 offen sc1
    v_mul_f32 v28, 0x3b000000, v28
    v_mul_f32 v29, 0x3b000000, v29
    v_fma_f32 v29, -v28, v28, v29
    v_max_f32 v29, 0, v29
    v_cvt_pk_bf16_f32 v29, v29, v29
    v_and_b32 v29, 0xffff0000, v29
    v_add_f32 v29, 0x3727c5ac, v29
    s_add_u32 s21, s21, 32768
    buffer_load_dwordx4 v[156:159], v1, s[4:7], s21 offen sc1
    v_cvt_pk_bf16_f32 v29, v29, v29
    v_and_b32 v29, 0xffff0000, v29
    v_sqrt_f32 v29, v29
    v_cvt_pk_bf16_f32 v28, v28, v28
    v_and_b32 v28, 0xffff0000, v28
    v_cvt_pk_bf16_f32 v29, v29, v29
    v_and_b32 v29, 0xffff0000, v29
    s_lshl_b32 s21, s24, 15
    s_add_u32 s21, s21, s66
    s_add_u32 s21, s21, 14680064
    buffer_load_dwordx4 v[184:187], v1, s[4:7], s21 offen sc1
    v_rcp_f32 v30, v29
    v_pk_add_f32 v[32:33], v[16:17], v[28:29] op_sel_hi:[1,0] neg_lo:[0,1] neg_hi:[0,1]
    v_pk_add_f32 v[34:35], v[18:19], v[28:29] op_sel_hi:[1,0] neg_lo:[0,1] neg_hi:[0,1]
    v_pk_add_f32 v[36:37], v[20:21], v[28:29] op_sel_hi:[1,0] neg_lo:[0,1] neg_hi:[0,1]
    v_pk_add_f32 v[38:39], v[22:23], v[28:29] op_sel_hi:[1,0] neg_lo:[0,1] neg_hi:[0,1]
    v_pk_mul_f32 v[32:33], v[32:33], v[30:31] op_sel_hi:[1,0]
    v_pk_mul_f32 v[34:35], v[34:35], v[30:31] op_sel_hi:[1,0]
    s_cmp_ge_u32 s73, 108
    s_cselect_b32 s23, 2, 1
    s_add_u32 s21, s73, s23
    s_mov_b32 s24, s21
    s_lshl_b32 s71, s24, 14
    s_add_u32 s71, s71, 2048
    s_cmp_lt_u32 s21, 128
    s_cselect_b32 s71, s71, 14336
    buffer_load_dword v11, v3, s[4:7], s71 offen sc1
    v_pk_mul_f32 v[36:37], v[36:37], v[30:31] op_sel_hi:[1,0]
    v_pk_mul_f32 v[38:39], v[38:39], v[30:31] op_sel_hi:[1,0]
    v_cvt_pk_bf16_f32 v24, v32, v33
    v_cvt_pk_bf16_f32 v25, v34, v35
    v_cvt_pk_bf16_f32 v26, v36, v37
    v_cvt_pk_bf16_f32 v27, v38, v39
    s_xor_b32 s69, s69, 128
    s_add_u32 s22, s70, 8388608
    buffer_store_dwordx4 v[24:27], v1, s[4:7], s22 offen sc1
    s_mov_b32 s74, 1
    s_branch L_r_np_2_j
L_r_deep_2:
    s_cmp_ge_u32 s68, 108
    s_cselect_b32 s23, 2, 1
    s_add_u32 s73, s68, s23
    v_lshlrev_b32 v16, 16, v128
    v_and_b32 v17, 0xffff0000, v128
    v_lshlrev_b32 v18, 16, v129
    v_and_b32 v19, 0xffff0000, v129
    v_lshlrev_b32 v20, 16, v130
    v_and_b32 v21, 0xffff0000, v130
    v_lshlrev_b32 v22, 16, v131
    v_and_b32 v23, 0xffff0000, v131
    v_dot2c_f32_bf16 v16, v132, v9
    v_dot2c_f32_bf16 v17, v132, v10
    v_dot2c_f32_bf16 v18, v133, v9
    v_dot2c_f32_bf16 v19, v133, v10
    v_dot2c_f32_bf16 v20, v134, v9
    v_dot2c_f32_bf16 v21, v134, v10
    v_dot2c_f32_bf16 v22, v135, v9
    v_dot2c_f32_bf16 v23, v135, v10
    s_mov_b32 s24, s73
    s_mul_i32 s21, s24, 262144
    s_add_u32 s21, s21, s66
    s_add_u32 s21, s21, 35651584
    buffer_load_dwordx4 v[128:131], v1, s[4:7], s21 offen sc1
    v_dot2c_f32_bf16 v16, v136, v9
    v_dot2c_f32_bf16 v17, v136, v10
    v_dot2c_f32_bf16 v18, v137, v9
    v_dot2c_f32_bf16 v19, v137, v10
    v_dot2c_f32_bf16 v20, v138, v9
    v_dot2c_f32_bf16 v21, v138, v10
    v_dot2c_f32_bf16 v22, v139, v9
    v_dot2c_f32_bf16 v23, v139, v10
    s_add_u32 s21, s21, 32768
    buffer_load_dwordx4 v[132:135], v1, s[4:7], s21 offen sc1
    v_dot2c_f32_bf16 v16, v140, v9
    v_dot2c_f32_bf16 v17, v140, v10
    v_dot2c_f32_bf16 v18, v141, v9
    v_dot2c_f32_bf16 v19, v141, v10
    v_dot2c_f32_bf16 v20, v142, v9
    v_dot2c_f32_bf16 v21, v142, v10
    v_dot2c_f32_bf16 v22, v143, v9
    v_dot2c_f32_bf16 v23, v143, v10
    s_add_u32 s21, s21, 32768
    buffer_load_dwordx4 v[136:139], v1, s[4:7], s21 offen sc1
    v_dot2c_f32_bf16 v16, v144, v9
    v_dot2c_f32_bf16 v17, v144, v10
    v_dot2c_f32_bf16 v18, v145, v9
    v_dot2c_f32_bf16 v19, v145, v10
    v_dot2c_f32_bf16 v20, v146, v9
    v_dot2c_f32_bf16 v21, v146, v10
    v_dot2c_f32_bf16 v22, v147, v9
    v_dot2c_f32_bf16 v23, v147, v10
    s_add_u32 s21, s21, 32768
    buffer_load_dwordx4 v[140:143], v1, s[4:7], s21 offen sc1
    v_dot2c_f32_bf16 v16, v148, v9
    v_dot2c_f32_bf16 v17, v148, v10
    v_dot2c_f32_bf16 v18, v149, v9
    v_dot2c_f32_bf16 v19, v149, v10
    v_dot2c_f32_bf16 v20, v150, v9
    v_dot2c_f32_bf16 v21, v150, v10
    v_dot2c_f32_bf16 v22, v151, v9
    v_dot2c_f32_bf16 v23, v151, v10
    s_add_u32 s21, s21, 32768
    buffer_load_dwordx4 v[144:147], v1, s[4:7], s21 offen sc1
    v_dot2c_f32_bf16 v16, v152, v9
    v_dot2c_f32_bf16 v17, v152, v10
    v_dot2c_f32_bf16 v18, v153, v9
    v_dot2c_f32_bf16 v19, v153, v10
    v_dot2c_f32_bf16 v20, v154, v9
    v_dot2c_f32_bf16 v21, v154, v10
    v_dot2c_f32_bf16 v22, v155, v9
    v_dot2c_f32_bf16 v23, v155, v10
    s_add_u32 s21, s21, 32768
    buffer_load_dwordx4 v[148:151], v1, s[4:7], s21 offen sc1
    v_dot2c_f32_bf16 v16, v156, v9
    v_dot2c_f32_bf16 v17, v156, v10
    v_dot2c_f32_bf16 v18, v157, v9
    v_dot2c_f32_bf16 v19, v157, v10
    v_dot2c_f32_bf16 v20, v158, v9
    v_dot2c_f32_bf16 v21, v158, v10
    v_dot2c_f32_bf16 v22, v159, v9
    v_dot2c_f32_bf16 v23, v159, v10
    s_add_u32 s21, s21, 32768
    buffer_load_dwordx4 v[152:155], v1, s[4:7], s21 offen sc1
    v_dot2c_f32_bf16 v16, v184, v9
    v_dot2c_f32_bf16 v17, v184, v10
    v_dot2c_f32_bf16 v18, v185, v9
    v_dot2c_f32_bf16 v19, v185, v10
    v_dot2c_f32_bf16 v20, v186, v9
    v_dot2c_f32_bf16 v21, v186, v10
    v_dot2c_f32_bf16 v22, v187, v9
    v_dot2c_f32_bf16 v23, v187, v10
    s_add_u32 s21, s21, 32768
    buffer_load_dwordx4 v[156:159], v1, s[4:7], s21 offen sc1
    s_lshl_b32 s21, s24, 15
    s_add_u32 s21, s21, s66
    s_add_u32 s21, s21, 14680064
    buffer_load_dwordx4 v[184:187], v1, s[4:7], s21 offen sc1
    s_cmp_ge_u32 s73, 108
    s_cselect_b32 s23, 2, 1
    s_add_u32 s21, s73, s23
    s_mov_b32 s24, s21
    s_lshl_b32 s71, s24, 14
    s_add_u32 s71, s71, 2048
    s_cmp_lt_u32 s21, 128
    s_cselect_b32 s71, s71, 14336
    buffer_load_dword v11, v3, s[4:7], s71 offen sc1
    s_mov_b32 s74, 1
    s_branch L_r_np_2_p
L_r_np_2:
    s_mov_b32 s74, 0
L_r_np_2_p:
    v_cvt_pk_bf16_f32 v44, v16, v17
    v_cvt_pk_bf16_f32 v45, v18, v19
    v_cvt_pk_bf16_f32 v46, v20, v21
    v_cvt_pk_bf16_f32 v47, v22, v23
    s_lshl_b32 s70, s68, 15
    s_add_u32 s70, s70, s66
    s_add_u32 s22, s70, 12582912
    buffer_store_dwordx4 v[44:47], v1, s[4:7], s22 offen sc1
    v_lshlrev_b32 v16, 16, v44
    v_and_b32 v17, 0xffff0000, v44
    v_lshlrev_b32 v18, 16, v45
    v_and_b32 v19, 0xffff0000, v45
    v_lshlrev_b32 v20, 16, v46
    v_and_b32 v21, 0xffff0000, v46
    v_lshlrev_b32 v22, 16, v47
    v_and_b32 v23, 0xffff0000, v47
    v_pk_add_f32 v[32:33], v[16:17], v[18:19]
    v_pk_mul_f32 v[34:35], v[16:17], v[16:17]
    v_pk_add_f32 v[36:37], v[20:21], v[22:23]
    v_pk_fma_f32 v[34:35], v[18:19], v[18:19], v[34:35]
    v_pk_add_f32 v[32:33], v[32:33], v[36:37]
    v_pk_fma_f32 v[34:35], v[20:21], v[20:21], v[34:35]
    v_add_f32 v28, v32, v33
    v_pk_fma_f32 v[34:35], v[22:23], v[22:23], v[34:35]
    v_add_u32 v38, s69, v4
    v_add_f32 v29, v34, v35
    v_add_f32_dpp v30, v28, v28 quad_perm:[1,0,3,2] row_mask:0xf bank_mask:0xf
    v_add_u32 v39, s69, v5
    v_add_f32_dpp v31, v29, v29 quad_perm:[1,0,3,2] row_mask:0xf bank_mask:0xf
    v_add_f32_dpp v28, v30, v30 row_ror:8 row_mask:0xf bank_mask:0xf
    s_nop 0
    v_add_f32_dpp v29, v31, v31 row_ror:8 row_mask:0xf bank_mask:0xf
    s_nop 1
    v_permlane16_swap_b32 v28, v29
    v_add_f32 v28, v28, v29
    v_mov_b32 v30, v28
    s_nop 1
    v_permlane32_swap_b32 v30, v28
    v_add_f32 v28, v28, v30
    s_mov_b64 exec, 0x550055
    ds_write_b32 v38, v28
    s_mov_b64 exec, -1
    s_waitcnt lgkmcnt(0)
    s_barrier
    ds_read_b128 v[32:35], v39
    ds_read_b128 v[36:39], v39 offset:16
    s_waitcnt lgkmcnt(1)
    v_pk_add_f32 v[32:33], v[32:33], v[34:35]
    s_waitcnt lgkmcnt(0)
    v_pk_add_f32 v[36:37], v[36:37], v[38:39]
    v_add_f32 v28, v32, v33
    v_add_f32 v29, v36, v37
    v_mul_f32 v28, 0x3b000000, v28
    v_mul_f32 v29, 0x3b000000, v29
    v_fma_f32 v29, -v28, v28, v29
    v_max_f32 v29, 0, v29
    v_cvt_pk_bf16_f32 v29, v29, v29
    v_and_b32 v29, 0xffff0000, v29
    v_add_f32 v29, 0x3727c5ac, v29
    v_cvt_pk_bf16_f32 v29, v29, v29
    v_and_b32 v29, 0xffff0000, v29
    v_sqrt_f32 v29, v29
    v_cvt_pk_bf16_f32 v28, v28, v28
    v_and_b32 v28, 0xffff0000, v28
    v_cvt_pk_bf16_f32 v29, v29, v29
    v_and_b32 v29, 0xffff0000, v29
    v_rcp_f32 v30, v29
    v_pk_add_f32 v[32:33], v[16:17], v[28:29] op_sel_hi:[1,0] neg_lo:[0,1] neg_hi:[0,1]
    v_pk_add_f32 v[34:35], v[18:19], v[28:29] op_sel_hi:[1,0] neg_lo:[0,1] neg_hi:[0,1]
    v_pk_add_f32 v[36:37], v[20:21], v[28:29] op_sel_hi:[1,0] neg_lo:[0,1] neg_hi:[0,1]
    v_pk_add_f32 v[38:39], v[22:23], v[28:29] op_sel_hi:[1,0] neg_lo:[0,1] neg_hi:[0,1]
    v_pk_mul_f32 v[32:33], v[32:33], v[30:31] op_sel_hi:[1,0]
    v_pk_mul_f32 v[34:35], v[34:35], v[30:31] op_sel_hi:[1,0]
    v_pk_mul_f32 v[36:37], v[36:37], v[30:31] op_sel_hi:[1,0]
    v_pk_mul_f32 v[38:39], v[38:39], v[30:31] op_sel_hi:[1,0]
    v_cvt_pk_bf16_f32 v24, v32, v33
    v_cvt_pk_bf16_f32 v25, v34, v35
    v_cvt_pk_bf16_f32 v26, v36, v37
    v_cvt_pk_bf16_f32 v27, v38, v39
    s_xor_b32 s69, s69, 128
    s_add_u32 s22, s70, 8388608
    buffer_store_dwordx4 v[24:27], v1, s[4:7], s22 offen sc1
L_r_np_2_j:
    s_lshl_b32 s22, s68, 14
    s_add_u32 s22, s22, s72
    s_add_u32 s22, s22, 1024
    buffer_load_dword v12, v3, s[4:7], s71 offen sc1
    s_waitcnt vmcnt(1)
    s_mov_b64 exec, 1
    buffer_store_dword v6, off, s[4:7], s22 sc1
    s_mov_b64 exec, -1
    s_mov_b32 s68, s73
    s_cmp_lt_u32 s68, 128
    s_cbranch_scc0 L_r_end_2
    s_waitcnt vmcnt(1)
    v_cmp_gt_u32 vcc, 1, v12
    s_cmp_eq_u32 s74, 1
    s_cbranch_scc0 L_r_x_2
    s_cbranch_vccz L_r_deep_2
    v_mov_b32 v11, v12
    s_branch L_r_loop_2
L_r_x_2:
    s_cbranch_vccz L_r_go_2
    s_branch L_r_wait_2
L_r_end_2:
    s_branch L_dump_role_r
L_r_3:
L_r_start_3:
    s_mov_b32 s73, s68
    s_mov_b32 s24, s68
    s_lshl_b32 s71, s24, 14
    s_add_u32 s71, s71, 4096
L_r_wait_3:
    s_mov_b32 s27, 0
L_poll_68:
    buffer_load_dword v11, v13, s[4:7], s71 offen sc1
    s_add_u32 s27, s27, 1
    s_cmp_gt_u32 s27, 262144
    s_cbranch_scc1 L_end
    s_waitcnt vmcnt(0)
    v_cmp_gt_u32 vcc, 1, v11
    s_cbranch_vccz L_poll_68_ok
    s_sleep 4
    s_branch L_poll_68
L_poll_68_ok:
L_r_go_3:
    s_mov_b32 s24, s73
    s_mul_i32 s21, s24, 458752
    s_add_u32 s21, s21, s66
    s_add_u32 s21, s21, 69206016
    buffer_load_dwordx4 v[128:131], v1, s[4:7], s21 offen sc1
    s_add_u32 s21, s21, 32768
    buffer_load_dwordx4 v[132:135], v1, s[4:7], s21 offen sc1
    s_add_u32 s21, s21, 32768
    buffer_load_dwordx4 v[136:139], v1, s[4:7], s21 offen sc1
    s_add_u32 s21, s21, 32768
    buffer_load_dwordx4 v[140:143], v1, s[4:7], s21 offen sc1
    s_add_u32 s21, s21, 32768
    buffer_load_dwordx4 v[144:147], v1, s[4:7], s21 offen sc1
    s_add_u32 s21, s21, 32768
    buffer_load_dwordx4 v[148:151], v1, s[4:7], s21 offen sc1
    s_add_u32 s21, s21, 32768
    buffer_load_dwordx4 v[152:155], v1, s[4:7], s21 offen sc1
    s_add_u32 s21, s21, 32768
    buffer_load_dwordx4 v[156:159], v1, s[4:7], s21 offen sc1
    s_add_u32 s21, s21, 32768
    buffer_load_dwordx4 v[160:163], v1, s[4:7], s21 offen sc1
    s_add_u32 s21, s21, 32768
    buffer_load_dwordx4 v[164:167], v1, s[4:7], s21 offen sc1
    s_add_u32 s21, s21, 32768
    buffer_load_dwordx4 v[168:171], v1, s[4:7], s21 offen sc1
    s_add_u32 s21, s21, 32768
    buffer_load_dwordx4 v[172:175], v1, s[4:7], s21 offen sc1
    s_add_u32 s21, s21, 32768
    buffer_load_dwordx4 v[176:179], v1, s[4:7], s21 offen sc1
    s_add_u32 s21, s21, 32768
    buffer_load_dwordx4 v[180:183], v1, s[4:7], s21 offen sc1
    s_lshl_b32 s21, s24, 15
    s_add_u32 s21, s21, s66
    s_add_u32 s21, s21, 12582912
    buffer_load_dwordx4 v[184:187], v1, s[4:7], s21 offen sc1
    s_cmp_ge_u32 s73, 0
    s_cselect_b32 s23, 2, 1
    s_add_u32 s21, s73, s23
    s_mov_b32 s24, s21
    s_lshl_b32 s71, s24, 14
    s_add_u32 s71, s71, 4096
    s_cmp_lt_u32 s21, 128
    s_cselect_b32 s71, s71, 14336
    buffer_load_dword v11, v13, s[4:7], s71 offen sc1
L_r_loop_3:
    s_cmp_ge_u32 s68, 0
    s_cselect_b32 s23, 2, 1
    s_add_u32 s73, s68, s23
    s_waitcnt vmcnt(15)
    v_lshlrev_b32 v16, 16, v128
    v_and_b32 v17, 0xffff0000, v128
    v_lshlrev_b32 v18, 16, v129
    v_and_b32 v19, 0xffff0000, v129
    v_lshlrev_b32 v20, 16, v130
    v_and_b32 v21, 0xffff0000, v130
    v_lshlrev_b32 v22, 16, v131
    v_and_b32 v23, 0xffff0000, v131
    s_waitcnt vmcnt(14)
    v_dot2c_f32_bf16 v16, v132, v9
    v_dot2c_f32_bf16 v17, v132, v10
    v_dot2c_f32_bf16 v18, v133, v9
    v_dot2c_f32_bf16 v19, v133, v10
    v_dot2c_f32_bf16 v20, v134, v9
    v_dot2c_f32_bf16 v21, v134, v10
    v_dot2c_f32_bf16 v22, v135, v9
    v_dot2c_f32_bf16 v23, v135, v10
    s_waitcnt vmcnt(13)
    v_dot2c_f32_bf16 v16, v136, v9
    v_dot2c_f32_bf16 v17, v136, v10
    v_dot2c_f32_bf16 v18, v137, v9
    v_dot2c_f32_bf16 v19, v137, v10
    v_dot2c_f32_bf16 v20, v138, v9
    v_dot2c_f32_bf16 v21, v138, v10
    v_dot2c_f32_bf16 v22, v139, v9
    v_dot2c_f32_bf16 v23, v139, v10
    s_waitcnt vmcnt(12)
    v_dot2c_f32_bf16 v16, v140, v9
    v_dot2c_f32_bf16 v17, v140, v10
    v_dot2c_f32_bf16 v18, v141, v9
    v_dot2c_f32_bf16 v19, v141, v10
    v_dot2c_f32_bf16 v20, v142, v9
    v_dot2c_f32_bf16 v21, v142, v10
    v_dot2c_f32_bf16 v22, v143, v9
    v_dot2c_f32_bf16 v23, v143, v10
    s_waitcnt vmcnt(11)
    v_dot2c_f32_bf16 v16, v144, v9
    v_dot2c_f32_bf16 v17, v144, v10
    v_dot2c_f32_bf16 v18, v145, v9
    v_dot2c_f32_bf16 v19, v145, v10
    v_dot2c_f32_bf16 v20, v146, v9
    v_dot2c_f32_bf16 v21, v146, v10
    v_dot2c_f32_bf16 v22, v147, v9
    v_dot2c_f32_bf16 v23, v147, v10
    s_waitcnt vmcnt(10)
    v_dot2c_f32_bf16 v16, v148, v9
    v_dot2c_f32_bf16 v17, v148, v10
    v_dot2c_f32_bf16 v18, v149, v9
    v_dot2c_f32_bf16 v19, v149, v10
    v_dot2c_f32_bf16 v20, v150, v9
    v_dot2c_f32_bf16 v21, v150, v10
    v_dot2c_f32_bf16 v22, v151, v9
    v_dot2c_f32_bf16 v23, v151, v10
    s_waitcnt vmcnt(9)
    v_dot2c_f32_bf16 v16, v152, v9
    v_dot2c_f32_bf16 v17, v152, v10
    v_dot2c_f32_bf16 v18, v153, v9
    v_dot2c_f32_bf16 v19, v153, v10
    v_dot2c_f32_bf16 v20, v154, v9
    v_dot2c_f32_bf16 v21, v154, v10
    v_dot2c_f32_bf16 v22, v155, v9
    v_dot2c_f32_bf16 v23, v155, v10
    s_waitcnt vmcnt(8)
    v_dot2c_f32_bf16 v16, v156, v9
    v_dot2c_f32_bf16 v17, v156, v10
    v_dot2c_f32_bf16 v18, v157, v9
    v_dot2c_f32_bf16 v19, v157, v10
    v_dot2c_f32_bf16 v20, v158, v9
    v_dot2c_f32_bf16 v21, v158, v10
    v_dot2c_f32_bf16 v22, v159, v9
    v_dot2c_f32_bf16 v23, v159, v10
    s_waitcnt vmcnt(7)
    v_dot2c_f32_bf16 v16, v160, v9
    v_dot2c_f32_bf16 v17, v160, v10
    v_dot2c_f32_bf16 v18, v161, v9
    v_dot2c_f32_bf16 v19, v161, v10
    v_dot2c_f32_bf16 v20, v162, v9
    v_dot2c_f32_bf16 v21, v162, v10
    v_dot2c_f32_bf16 v22, v163, v9
    v_dot2c_f32_bf16 v23, v163, v10
    s_waitcnt vmcnt(6)
    v_dot2c_f32_bf16 v16, v164, v9
    v_dot2c_f32_bf16 v17, v164, v10
    v_dot2c_f32_bf16 v18, v165, v9
    v_dot2c_f32_bf16 v19, v165, v10
    v_dot2c_f32_bf16 v20, v166, v9
    v_dot2c_f32_bf16 v21, v166, v10
    v_dot2c_f32_bf16 v22, v167, v9
    v_dot2c_f32_bf16 v23, v167, v10
    s_waitcnt vmcnt(5)
    v_dot2c_f32_bf16 v16, v168, v9
    v_dot2c_f32_bf16 v17, v168, v10
    v_dot2c_f32_bf16 v18, v169, v9
    v_dot2c_f32_bf16 v19, v169, v10
    v_dot2c_f32_bf16 v20, v170, v9
    v_dot2c_f32_bf16 v21, v170, v10
    v_dot2c_f32_bf16 v22, v171, v9
    v_dot2c_f32_bf16 v23, v171, v10
    s_waitcnt vmcnt(4)
    v_dot2c_f32_bf16 v16, v172, v9
    v_dot2c_f32_bf16 v17, v172, v10
    v_dot2c_f32_bf16 v18, v173, v9
    v_dot2c_f32_bf16 v19, v173, v10
    v_dot2c_f32_bf16 v20, v174, v9
    v_dot2c_f32_bf16 v21, v174, v10
    v_dot2c_f32_bf16 v22, v175, v9
    v_dot2c_f32_bf16 v23, v175, v10
    s_waitcnt vmcnt(3)
    v_dot2c_f32_bf16 v16, v176, v9
    v_dot2c_f32_bf16 v17, v176, v10
    v_dot2c_f32_bf16 v18, v177, v9
    v_dot2c_f32_bf16 v19, v177, v10
    v_dot2c_f32_bf16 v20, v178, v9
    v_dot2c_f32_bf16 v21, v178, v10
    v_dot2c_f32_bf16 v22, v179, v9
    v_dot2c_f32_bf16 v23, v179, v10
    s_waitcnt vmcnt(2)
    v_dot2c_f32_bf16 v16, v180, v9
    v_dot2c_f32_bf16 v17, v180, v10
    v_dot2c_f32_bf16 v18, v181, v9
    v_dot2c_f32_bf16 v19, v181, v10
    v_dot2c_f32_bf16 v20, v182, v9
    v_dot2c_f32_bf16 v21, v182, v10
    v_dot2c_f32_bf16 v22, v183, v9
    v_dot2c_f32_bf16 v23, v183, v10
    s_waitcnt vmcnt(1)
    v_dot2c_f32_bf16 v16, v184, v9
    v_dot2c_f32_bf16 v17, v184, v10
    v_dot2c_f32_bf16 v18, v185, v9
    v_dot2c_f32_bf16 v19, v185, v10
    v_dot2c_f32_bf16 v20, v186, v9
    v_dot2c_f32_bf16 v21, v186, v10
    v_dot2c_f32_bf16 v22, v187, v9
    v_dot2c_f32_bf16 v23, v187, v10
    s_waitcnt vmcnt(0)
    v_cmp_gt_u32 vcc, 1, v11
    s_cbranch_vccnz L_r_np_3
    v_cvt_pk_bf16_f32 v44, v16, v17
    s_mov_b32 s24, s73
    s_mul_i32 s21, s24, 458752
    s_add_u32 s21, s21, s66
    s_add_u32 s21, s21, 69206016
    buffer_load_dwordx4 v[128:131], v1, s[4:7], s21 offen sc1
    v_cvt_pk_bf16_f32 v45, v18, v19
    s_add_u32 s21, s21, 32768
    buffer_load_dwordx4 v[132:135], v1, s[4:7], s21 offen sc1
    v_cvt_pk_bf16_f32 v46, v20, v21
    s_add_u32 s21, s21, 32768
    buffer_load_dwordx4 v[136:139], v1, s[4:7], s21 offen sc1
    v_cvt_pk_bf16_f32 v47, v22, v23
    s_add_u32 s21, s21, 32768
    buffer_load_dwordx4 v[140:143], v1, s[4:7], s21 offen sc1
    s_mov_b32 s70, s68
    s_add_u32 s21, s21, 32768
    buffer_load_dwordx4 v[144:147], v1, s[4:7], s21 offen sc1
    s_lshl_b32 s70, s70, 15
    s_add_u32 s21, s21, 32768
    buffer_load_dwordx4 v[148:151], v1, s[4:7], s21 offen sc1
    s_add_u32 s70, s70, s67
    s_add_u32 s21, s21, 32768
    buffer_load_dwordx4 v[152:155], v1, s[4:7], s21 offen sc1
    s_sub_u32 s70, s70, 2097152
    buffer_store_dwordx4 v[44:47], v2, s[12:15], s70 offen
    s_add_u32 s21, s21, 32768
    buffer_load_dwordx4 v[156:159], v1, s[4:7], s21 offen sc1
    s_add_u32 s21, s21, 32768
    buffer_load_dwordx4 v[160:163], v1, s[4:7], s21 offen sc1
    s_add_u32 s21, s21, 32768
    buffer_load_dwordx4 v[164:167], v1, s[4:7], s21 offen sc1
    s_add_u32 s21, s21, 32768
    buffer_load_dwordx4 v[168:171], v1, s[4:7], s21 offen sc1
    s_add_u32 s21, s21, 32768
    buffer_load_dwordx4 v[172:175], v1, s[4:7], s21 offen sc1
    s_add_u32 s21, s21, 32768
    buffer_load_dwordx4 v[176:179], v1, s[4:7], s21 offen sc1
    s_add_u32 s21, s21, 32768
    buffer_load_dwordx4 v[180:183], v1, s[4:7], s21 offen sc1
    s_lshl_b32 s21, s24, 15
    s_add_u32 s21, s21, s66
    s_add_u32 s21, s21, 12582912
    buffer_load_dwordx4 v[184:187], v1, s[4:7], s21 offen sc1
    s_cmp_ge_u32 s73, 0
    s_cselect_b32 s23, 2, 1
    s_add_u32 s21, s73, s23
    s_mov_b32 s24, s21
    s_lshl_b32 s71, s24, 14
    s_add_u32 s71, s71, 4096
    s_cmp_lt_u32 s21, 128
    s_cselect_b32 s71, s71, 14336
    buffer_load_dword v11, v13, s[4:7], s71 offen sc1
    s_mov_b32 s74, 1
    s_branch L_r_np_3_j
L_r_deep_3:
    s_cmp_ge_u32 s68, 0
    s_cselect_b32 s23, 2, 1
    s_add_u32 s73, s68, s23
    v_lshlrev_b32 v16, 16, v128
    v_and_b32 v17, 0xffff0000, v128
    v_lshlrev_b32 v18, 16, v129
    v_and_b32 v19, 0xffff0000, v129
    v_lshlrev_b32 v20, 16, v130
    v_and_b32 v21, 0xffff0000, v130
    v_lshlrev_b32 v22, 16, v131
    v_and_b32 v23, 0xffff0000, v131
    v_dot2c_f32_bf16 v16, v132, v9
    v_dot2c_f32_bf16 v17, v132, v10
    v_dot2c_f32_bf16 v18, v133, v9
    v_dot2c_f32_bf16 v19, v133, v10
    v_dot2c_f32_bf16 v20, v134, v9
    v_dot2c_f32_bf16 v21, v134, v10
    v_dot2c_f32_bf16 v22, v135, v9
    v_dot2c_f32_bf16 v23, v135, v10
    s_mov_b32 s24, s73
    s_mul_i32 s21, s24, 458752
    s_add_u32 s21, s21, s66
    s_add_u32 s21, s21, 69206016
    buffer_load_dwordx4 v[128:131], v1, s[4:7], s21 offen sc1
    v_dot2c_f32_bf16 v16, v136, v9
    v_dot2c_f32_bf16 v17, v136, v10
    v_dot2c_f32_bf16 v18, v137, v9
    v_dot2c_f32_bf16 v19, v137, v10
    v_dot2c_f32_bf16 v20, v138, v9
    v_dot2c_f32_bf16 v21, v138, v10
    v_dot2c_f32_bf16 v22, v139, v9
    v_dot2c_f32_bf16 v23, v139, v10
    s_add_u32 s21, s21, 32768
    buffer_load_dwordx4 v[132:135], v1, s[4:7], s21 offen sc1
    v_dot2c_f32_bf16 v16, v140, v9
    v_dot2c_f32_bf16 v17, v140, v10
    v_dot2c_f32_bf16 v18, v141, v9
    v_dot2c_f32_bf16 v19, v141, v10
    v_dot2c_f32_bf16 v20, v142, v9
    v_dot2c_f32_bf16 v21, v142, v10
    v_dot2c_f32_bf16 v22, v143, v9
    v_dot2c_f32_bf16 v23, v143, v10
    s_add_u32 s21, s21, 32768
    buffer_load_dwordx4 v[136:139], v1, s[4:7], s21 offen sc1
    v_dot2c_f32_bf16 v16, v144, v9
    v_dot2c_f32_bf16 v17, v144, v10
    v_dot2c_f32_bf16 v18, v145, v9
    v_dot2c_f32_bf16 v19, v145, v10
    v_dot2c_f32_bf16 v20, v146, v9
    v_dot2c_f32_bf16 v21, v146, v10
    v_dot2c_f32_bf16 v22, v147, v9
    v_dot2c_f32_bf16 v23, v147, v10
    s_add_u32 s21, s21, 32768
    buffer_load_dwordx4 v[140:143], v1, s[4:7], s21 offen sc1
    v_dot2c_f32_bf16 v16, v148, v9
    v_dot2c_f32_bf16 v17, v148, v10
    v_dot2c_f32_bf16 v18, v149, v9
    v_dot2c_f32_bf16 v19, v149, v10
    v_dot2c_f32_bf16 v20, v150, v9
    v_dot2c_f32_bf16 v21, v150, v10
    v_dot2c_f32_bf16 v22, v151, v9
    v_dot2c_f32_bf16 v23, v151, v10
    s_add_u32 s21, s21, 32768
    buffer_load_dwordx4 v[144:147], v1, s[4:7], s21 offen sc1
    v_dot2c_f32_bf16 v16, v152, v9
    v_dot2c_f32_bf16 v17, v152, v10
    v_dot2c_f32_bf16 v18, v153, v9
    v_dot2c_f32_bf16 v19, v153, v10
    v_dot2c_f32_bf16 v20, v154, v9
    v_dot2c_f32_bf16 v21, v154, v10
    v_dot2c_f32_bf16 v22, v155, v9
    v_dot2c_f32_bf16 v23, v155, v10
    s_add_u32 s21, s21, 32768
    buffer_load_dwordx4 v[148:151], v1, s[4:7], s21 offen sc1
    v_dot2c_f32_bf16 v16, v156, v9
    v_dot2c_f32_bf16 v17, v156, v10
    v_dot2c_f32_bf16 v18, v157, v9
    v_dot2c_f32_bf16 v19, v157, v10
    v_dot2c_f32_bf16 v20, v158, v9
    v_dot2c_f32_bf16 v21, v158, v10
    v_dot2c_f32_bf16 v22, v159, v9
    v_dot2c_f32_bf16 v23, v159, v10
    s_add_u32 s21, s21, 32768
    buffer_load_dwordx4 v[152:155], v1, s[4:7], s21 offen sc1
    v_dot2c_f32_bf16 v16, v160, v9
    v_dot2c_f32_bf16 v17, v160, v10
    v_dot2c_f32_bf16 v18, v161, v9
    v_dot2c_f32_bf16 v19, v161, v10
    v_dot2c_f32_bf16 v20, v162, v9
    v_dot2c_f32_bf16 v21, v162, v10
    v_dot2c_f32_bf16 v22, v163, v9
    v_dot2c_f32_bf16 v23, v163, v10
    s_add_u32 s21, s21, 32768
    buffer_load_dwordx4 v[156:159], v1, s[4:7], s21 offen sc1
    v_dot2c_f32_bf16 v16, v164, v9
    v_dot2c_f32_bf16 v17, v164, v10
    v_dot2c_f32_bf16 v18, v165, v9
    v_dot2c_f32_bf16 v19, v165, v10
    v_dot2c_f32_bf16 v20, v166, v9
    v_dot2c_f32_bf16 v21, v166, v10
    v_dot2c_f32_bf16 v22, v167, v9
    v_dot2c_f32_bf16 v23, v167, v10
    s_add_u32 s21, s21, 32768
    buffer_load_dwordx4 v[160:163], v1, s[4:7], s21 offen sc1
    v_dot2c_f32_bf16 v16, v168, v9
    v_dot2c_f32_bf16 v17, v168, v10
    v_dot2c_f32_bf16 v18, v169, v9
    v_dot2c_f32_bf16 v19, v169, v10
    v_dot2c_f32_bf16 v20, v170, v9
    v_dot2c_f32_bf16 v21, v170, v10
    v_dot2c_f32_bf16 v22, v171, v9
    v_dot2c_f32_bf16 v23, v171, v10
    s_add_u32 s21, s21, 32768
    buffer_load_dwordx4 v[164:167], v1, s[4:7], s21 offen sc1
    v_dot2c_f32_bf16 v16, v172, v9
    v_dot2c_f32_bf16 v17, v172, v10
    v_dot2c_f32_bf16 v18, v173, v9
    v_dot2c_f32_bf16 v19, v173, v10
    v_dot2c_f32_bf16 v20, v174, v9
    v_dot2c_f32_bf16 v21, v174, v10
    v_dot2c_f32_bf16 v22, v175, v9
    v_dot2c_f32_bf16 v23, v175, v10
    s_add_u32 s21, s21, 32768
    buffer_load_dwordx4 v[168:171], v1, s[4:7], s21 offen sc1
    v_dot2c_f32_bf16 v16, v176, v9
    v_dot2c_f32_bf16 v17, v176, v10
    v_dot2c_f32_bf16 v18, v177, v9
    v_dot2c_f32_bf16 v19, v177, v10
    v_dot2c_f32_bf16 v20, v178, v9
    v_dot2c_f32_bf16 v21, v178, v10
    v_dot2c_f32_bf16 v22, v179, v9
    v_dot2c_f32_bf16 v23, v179, v10
    s_add_u32 s21, s21, 32768
    buffer_load_dwordx4 v[172:175], v1, s[4:7], s21 offen sc1
    v_dot2c_f32_bf16 v16, v180, v9
    v_dot2c_f32_bf16 v17, v180, v10
    v_dot2c_f32_bf16 v18, v181, v9
    v_dot2c_f32_bf16 v19, v181, v10
    v_dot2c_f32_bf16 v20, v182, v9
    v_dot2c_f32_bf16 v21, v182, v10
    v_dot2c_f32_bf16 v22, v183, v9
    v_dot2c_f32_bf16 v23, v183, v10
    s_add_u32 s21, s21, 32768
    buffer_load_dwordx4 v[176:179], v1, s[4:7], s21 offen sc1
    v_dot2c_f32_bf16 v16, v184, v9
    v_dot2c_f32_bf16 v17, v184, v10
    v_dot2c_f32_bf16 v18, v185, v9
    v_dot2c_f32_bf16 v19, v185, v10
    v_dot2c_f32_bf16 v20, v186, v9
    v_dot2c_f32_bf16 v21, v186, v10
    v_dot2c_f32_bf16 v22, v187, v9
    v_dot2c_f32_bf16 v23, v187, v10
    s_add_u32 s21, s21, 32768
    buffer_load_dwordx4 v[180:183], v1, s[4:7], s21 offen sc1
    s_lshl_b32 s21, s24, 15
    s_add_u32 s21, s21, s66
    s_add_u32 s21, s21, 12582912
    buffer_load_dwordx4 v[184:187], v1, s[4:7], s21 offen sc1
    s_cmp_ge_u32 s73, 0
    s_cselect_b32 s23, 2, 1
    s_add_u32 s21, s73, s23
    s_mov_b32 s24, s21
    s_lshl_b32 s71, s24, 14
    s_add_u32 s71, s71, 4096
    s_cmp_lt_u32 s21, 128
    s_cselect_b32 s71, s71, 14336
    buffer_load_dword v11, v13, s[4:7], s71 offen sc1
    s_mov_b32 s74, 1
    s_branch L_r_np_3_p
L_r_np_3:
    s_mov_b32 s74, 0
L_r_np_3_p:
    v_cvt_pk_bf16_f32 v44, v16, v17
    v_cvt_pk_bf16_f32 v45, v18, v19
    v_cvt_pk_bf16_f32 v46, v20, v21
    v_cvt_pk_bf16_f32 v47, v22, v23
    s_mov_b32 s70, s68
    s_lshl_b32 s70, s70, 15
    s_add_u32 s70, s70, s67
    s_sub_u32 s70, s70, 2097152
    buffer_store_dwordx4 v[44:47], v2, s[12:15], s70 offen
L_r_np_3_j:
    buffer_load_dword v12, v13, s[4:7], s71 offen sc1
    s_mov_b32 s68, s73
    s_cmp_lt_u32 s68, 128
    s_cbranch_scc0 L_r_end_3
    s_waitcnt vmcnt(0)
    v_cmp_gt_u32 vcc, 1, v12
    s_cmp_eq_u32 s74, 1
    s_cbranch_scc0 L_r_x_3
    s_cbranch_vccz L_r_deep_3
    v_mov_b32 v11, v12
    s_branch L_r_loop_3
L_r_x_3:
    s_cbranch_vccz L_r_go_3
    s_branch L_r_wait_3
L_r_end_3:
    s_branch L_dump_role_r
L_r_4:
L_r_start_4:
    s_mov_b32 s73, s68
    s_lshr_b32 s24, s68, 1
    s_lshl_b32 s71, s24, 14
    s_add_u32 s71, s71, 4096
L_r_wait_4:
    s_mov_b32 s27, 0
L_poll_69:
    buffer_load_dword v11, v13, s[4:7], s71 offen sc1
    s_add_u32 s27, s27, 1
    s_cmp_gt_u32 s27, 262144
    s_cbranch_scc1 L_end
    s_waitcnt vmcnt(0)
    v_cmp_gt_u32 vcc, 1, v11
    s_cbranch_vccz L_poll_69_ok
    s_sleep 4
    s_branch L_poll_69
L_poll_69_ok:
L_r_go_4:
    s_lshr_b32 s24, s73, 1
    v_xor_b32 v1, 128, v1
    s_mul_i32 s21, s24, 458752
    s_add_u32 s21, s21, s66
    s_add_u32 s21, s21, 69206016
    buffer_load_dwordx4 v[128:131], v1, s[4:7], s21 offen sc1
    s_add_u32 s21, s21, 32768
    buffer_load_dwordx4 v[132:135], v1, s[4:7], s21 offen sc1
    s_add_u32 s21, s21, 32768
    buffer_load_dwordx4 v[136:139], v1, s[4:7], s21 offen sc1
    s_add_u32 s21, s21, 32768
    buffer_load_dwordx4 v[140:143], v1, s[4:7], s21 offen sc1
    s_add_u32 s21, s21, 32768
    buffer_load_dwordx4 v[144:147], v1, s[4:7], s21 offen sc1
    s_add_u32 s21, s21, 32768
    buffer_load_dwordx4 v[148:151], v1, s[4:7], s21 offen sc1
    s_add_u32 s21, s21, 32768
    buffer_load_dwordx4 v[152:155], v1, s[4:7], s21 offen sc1
    s_add_u32 s21, s21, 32768
    buffer_load_dwordx4 v[156:159], v1, s[4:7], s21 offen sc1
    s_add_u32 s21, s21, 32768
    buffer_load_dwordx4 v[160:163], v1, s[4:7], s21 offen sc1
    s_add_u32 s21, s21, 32768
    buffer_load_dwordx4 v[164:167], v1, s[4:7], s21 offen sc1
    s_add_u32 s21, s21, 32768
    buffer_load_dwordx4 v[168:171], v1, s[4:7], s21 offen sc1
    s_add_u32 s21, s21, 32768
    buffer_load_dwordx4 v[172:175], v1, s[4:7], s21 offen sc1
    s_add_u32 s21, s21, 32768
    buffer_load_dwordx4 v[176:179], v1, s[4:7], s21 offen sc1
    s_add_u32 s21, s21, 32768
    buffer_load_dwordx4 v[180:183], v1, s[4:7], s21 offen sc1
    s_lshl_b32 s21, s24, 15
    s_add_u32 s21, s21, s66
    s_add_u32 s21, s21, 12582912
    buffer_load_dwordx4 v[184:187], v1, s[4:7], s21 offen sc1
    s_cmp_ge_u32 s73, 1000
    s_cselect_b32 s23, 2, 1
    s_add_u32 s21, s73, s23
    s_lshr_b32 s24, s21, 1
    s_lshl_b32 s71, s24, 14
    s_add_u32 s71, s71, 4096
    s_cmp_lt_u32 s21, 220
    s_cselect_b32 s71, s71, 14336
    buffer_load_dword v11, v13, s[4:7], s71 offen sc1
L_r_loop_4:
    s_cmp_ge_u32 s68, 1000
    s_cselect_b32 s23, 2, 1
    s_add_u32 s73, s68, s23
    s_waitcnt vmcnt(15)
    v_lshlrev_b32 v16, 16, v128
    v_and_b32 v17, 0xffff0000, v128
    v_lshlrev_b32 v18, 16, v129
    v_and_b32 v19, 0xffff0000, v129
    v_lshlrev_b32 v20, 16, v130
    v_and_b32 v21, 0xffff0000, v130
    v_lshlrev_b32 v22, 16, v131
    v_and_b32 v23, 0xffff0000, v131
    s_waitcnt vmcnt(14)
    v_dot2c_f32_bf16 v16, v132, v9
    v_dot2c_f32_bf16 v17, v132, v10
    v_dot2c_f32_bf16 v18, v133, v9
    v_dot2c_f32_bf16 v19, v133, v10
    v_dot2c_f32_bf16 v20, v134, v9
    v_dot2c_f32_bf16 v21, v134, v10
    v_dot2c_f32_bf16 v22, v135, v9
    v_dot2c_f32_bf16 v23, v135, v10
    s_waitcnt vmcnt(13)
    v_dot2c_f32_bf16 v16, v136, v9
    v_dot2c_f32_bf16 v17, v136, v10
    v_dot2c_f32_bf16 v18, v137, v9
    v_dot2c_f32_bf16 v19, v137, v10
    v_dot2c_f32_bf16 v20, v138, v9
    v_dot2c_f32_bf16 v21, v138, v10
    v_dot2c_f32_bf16 v22, v139, v9
    v_dot2c_f32_bf16 v23, v139, v10
    s_waitcnt vmcnt(12)
    v_dot2c_f32_bf16 v16, v140, v9
    v_dot2c_f32_bf16 v17, v140, v10
    v_dot2c_f32_bf16 v18, v141, v9
    v_dot2c_f32_bf16 v19, v141, v10
    v_dot2c_f32_bf16 v20, v142, v9
    v_dot2c_f32_bf16 v21, v142, v10
    v_dot2c_f32_bf16 v22, v143, v9
    v_dot2c_f32_bf16 v23, v143, v10
    s_waitcnt vmcnt(11)
    v_dot2c_f32_bf16 v16, v144, v9
    v_dot2c_f32_bf16 v17, v144, v10
    v_dot2c_f32_bf16 v18, v145, v9
    v_dot2c_f32_bf16 v19, v145, v10
    v_dot2c_f32_bf16 v20, v146, v9
    v_dot2c_f32_bf16 v21, v146, v10
    v_dot2c_f32_bf16 v22, v147, v9
    v_dot2c_f32_bf16 v23, v147, v10
    s_waitcnt vmcnt(10)
    v_dot2c_f32_bf16 v16, v148, v9
    v_dot2c_f32_bf16 v17, v148, v10
    v_dot2c_f32_bf16 v18, v149, v9
    v_dot2c_f32_bf16 v19, v149, v10
    v_dot2c_f32_bf16 v20, v150, v9
    v_dot2c_f32_bf16 v21, v150, v10
    v_dot2c_f32_bf16 v22, v151, v9
    v_dot2c_f32_bf16 v23, v151, v10
    s_waitcnt vmcnt(9)
    v_dot2c_f32_bf16 v16, v152, v9
    v_dot2c_f32_bf16 v17, v152, v10
    v_dot2c_f32_bf16 v18, v153, v9
    v_dot2c_f32_bf16 v19, v153, v10
    v_dot2c_f32_bf16 v20, v154, v9
    v_dot2c_f32_bf16 v21, v154, v10
    v_dot2c_f32_bf16 v22, v155, v9
    v_dot2c_f32_bf16 v23, v155, v10
    s_waitcnt vmcnt(8)
    v_dot2c_f32_bf16 v16, v156, v9
    v_dot2c_f32_bf16 v17, v156, v10
    v_dot2c_f32_bf16 v18, v157, v9
    v_dot2c_f32_bf16 v19, v157, v10
    v_dot2c_f32_bf16 v20, v158, v9
    v_dot2c_f32_bf16 v21, v158, v10
    v_dot2c_f32_bf16 v22, v159, v9
    v_dot2c_f32_bf16 v23, v159, v10
    s_waitcnt vmcnt(7)
    v_dot2c_f32_bf16 v16, v160, v9
    v_dot2c_f32_bf16 v17, v160, v10
    v_dot2c_f32_bf16 v18, v161, v9
    v_dot2c_f32_bf16 v19, v161, v10
    v_dot2c_f32_bf16 v20, v162, v9
    v_dot2c_f32_bf16 v21, v162, v10
    v_dot2c_f32_bf16 v22, v163, v9
    v_dot2c_f32_bf16 v23, v163, v10
    s_waitcnt vmcnt(6)
    v_dot2c_f32_bf16 v16, v164, v9
    v_dot2c_f32_bf16 v17, v164, v10
    v_dot2c_f32_bf16 v18, v165, v9
    v_dot2c_f32_bf16 v19, v165, v10
    v_dot2c_f32_bf16 v20, v166, v9
    v_dot2c_f32_bf16 v21, v166, v10
    v_dot2c_f32_bf16 v22, v167, v9
    v_dot2c_f32_bf16 v23, v167, v10
    s_waitcnt vmcnt(5)
    v_dot2c_f32_bf16 v16, v168, v9
    v_dot2c_f32_bf16 v17, v168, v10
    v_dot2c_f32_bf16 v18, v169, v9
    v_dot2c_f32_bf16 v19, v169, v10
    v_dot2c_f32_bf16 v20, v170, v9
    v_dot2c_f32_bf16 v21, v170, v10
    v_dot2c_f32_bf16 v22, v171, v9
    v_dot2c_f32_bf16 v23, v171, v10
    s_waitcnt vmcnt(4)
    v_dot2c_f32_bf16 v16, v172, v9
    v_dot2c_f32_bf16 v17, v172, v10
    v_dot2c_f32_bf16 v18, v173, v9
    v_dot2c_f32_bf16 v19, v173, v10
    v_dot2c_f32_bf16 v20, v174, v9
    v_dot2c_f32_bf16 v21, v174, v10
    v_dot2c_f32_bf16 v22, v175, v9
    v_dot2c_f32_bf16 v23, v175, v10
    s_waitcnt vmcnt(3)
    v_dot2c_f32_bf16 v16, v176, v9
    v_dot2c_f32_bf16 v17, v176, v10
    v_dot2c_f32_bf16 v18, v177, v9
    v_dot2c_f32_bf16 v19, v177, v10
    v_dot2c_f32_bf16 v20, v178, v9
    v_dot2c_f32_bf16 v21, v178, v10
    v_dot2c_f32_bf16 v22, v179, v9
    v_dot2c_f32_bf16 v23, v179, v10
    s_waitcnt vmcnt(2)
    v_dot2c_f32_bf16 v16, v180, v9
    v_dot2c_f32_bf16 v17, v180, v10
    v_dot2c_f32_bf16 v18, v181, v9
    v_dot2c_f32_bf16 v19, v181, v10
    v_dot2c_f32_bf16 v20, v182, v9
    v_dot2c_f32_bf16 v21, v182, v10
    v_dot2c_f32_bf16 v22, v183, v9
    v_dot2c_f32_bf16 v23, v183, v10
    s_waitcnt vmcnt(1)
    v_dot2c_f32_bf16 v16, v184, v9
    v_dot2c_f32_bf16 v17, v184, v10
    v_dot2c_f32_bf16 v18, v185, v9
    v_dot2c_f32_bf16 v19, v185, v10
    v_dot2c_f32_bf16 v20, v186, v9
    v_dot2c_f32_bf16 v21, v186, v10
    v_dot2c_f32_bf16 v22, v187, v9
    v_dot2c_f32_bf16 v23, v187, v10
    s_waitcnt vmcnt(0)
    v_cmp_gt_u32 vcc, 1, v11
    s_cbranch_vccnz L_r_np_4
    v_cvt_pk_bf16_f32 v44, v16, v17
    s_lshr_b32 s24, s73, 1
    v_xor_b32 v1, 128, v1
    s_mul_i32 s21, s24, 458752
    s_add_u32 s21, s21, s66
    s_add_u32 s21, s21, 69206016
    buffer_load_dwordx4 v[128:131], v1, s[4:7], s21 offen sc1
    v_cvt_pk_bf16_f32 v45, v18, v19
    s_add_u32 s21, s21, 32768
    buffer_load_dwordx4 v[132:135], v1, s[4:7], s21 offen sc1
    v_cvt_pk_bf16_f32 v46, v20, v21
    s_add_u32 s21, s21, 32768
    buffer_load_dwordx4 v[136:139], v1, s[4:7], s21 offen sc1
    v_cvt_pk_bf16_f32 v47, v22, v23
    s_add_u32 s21, s21, 32768
    buffer_load_dwordx4 v[140:143], v1, s[4:7], s21 offen sc1
    s_xor_b32 s67, s67, 4096
    s_add_u32 s21, s21, 32768
    buffer_load_dwordx4 v[144:147], v1, s[4:7], s21 offen sc1
    s_lshr_b32 s70, s68, 1
    s_add_u32 s21, s21, 32768
    buffer_load_dwordx4 v[148:151], v1, s[4:7], s21 offen sc1
    s_lshl_b32 s70, s70, 15
    s_add_u32 s21, s21, 32768
    buffer_load_dwordx4 v[152:155], v1, s[4:7], s21 offen sc1
    s_add_u32 s70, s70, s67
    s_add_u32 s21, s21, 32768
    buffer_load_dwordx4 v[156:159], v1, s[4:7], s21 offen sc1
    s_sub_u32 s70, s70, 2097152
    buffer_store_dwordx4 v[44:47], v2, s[12:15], s70 offen
    s_add_u32 s21, s21, 32768
    buffer_load_dwordx4 v[160:163], v1, s[4:7], s21 offen sc1
    s_add_u32 s21, s21, 32768
    buffer_load_dwordx4 v[164:167], v1, s[4:7], s21 offen sc1
    s_add_u32 s21, s21, 32768
    buffer_load_dwordx4 v[168:171], v1, s[4:7], s21 offen sc1
    s_add_u32 s21, s21, 32768
    buffer_load_dwordx4 v[172:175], v1, s[4:7], s21 offen sc1
    s_add_u32 s21, s21, 32768
    buffer_load_dwordx4 v[176:179], v1, s[4:7], s21 offen sc1
    s_add_u32 s21, s21, 32768
    buffer_load_dwordx4 v[180:183], v1, s[4:7], s21 offen sc1
    s_lshl_b32 s21, s24, 15
    s_add_u32 s21, s21, s66
    s_add_u32 s21, s21, 12582912
    buffer_load_dwordx4 v[184:187], v1, s[4:7], s21 offen sc1
    s_cmp_ge_u32 s73, 1000
    s_cselect_b32 s23, 2, 1
    s_add_u32 s21, s73, s23
    s_lshr_b32 s24, s21, 1
    s_lshl_b32 s71, s24, 14
    s_add_u32 s71, s71, 4096
    s_cmp_lt_u32 s21, 220
    s_cselect_b32 s71, s71, 14336
    buffer_load_dword v11, v13, s[4:7], s71 offen sc1
    s_mov_b32 s74, 1
    s_branch L_r_np_4_j
L_r_deep_4:
    s_cmp_ge_u32 s68, 1000
    s_cselect_b32 s23, 2, 1
    s_add_u32 s73, s68, s23
    v_lshlrev_b32 v16, 16, v128
    v_and_b32 v17, 0xffff0000, v128
    v_lshlrev_b32 v18, 16, v129
    v_and_b32 v19, 0xffff0000, v129
    v_lshlrev_b32 v20, 16, v130
    v_and_b32 v21, 0xffff0000, v130
    v_lshlrev_b32 v22, 16, v131
    v_and_b32 v23, 0xffff0000, v131
    v_dot2c_f32_bf16 v16, v132, v9
    v_dot2c_f32_bf16 v17, v132, v10
    v_dot2c_f32_bf16 v18, v133, v9
    v_dot2c_f32_bf16 v19, v133, v10
    v_dot2c_f32_bf16 v20, v134, v9
    v_dot2c_f32_bf16 v21, v134, v10
    v_dot2c_f32_bf16 v22, v135, v9
    v_dot2c_f32_bf16 v23, v135, v10
    s_lshr_b32 s24, s73, 1
    v_xor_b32 v1, 128, v1
    s_mul_i32 s21, s24, 458752
    s_add_u32 s21, s21, s66
    s_add_u32 s21, s21, 69206016
    buffer_load_dwordx4 v[128:131], v1, s[4:7], s21 offen sc1
    v_dot2c_f32_bf16 v16, v136, v9
    v_dot2c_f32_bf16 v17, v136, v10
    v_dot2c_f32_bf16 v18, v137, v9
    v_dot2c_f32_bf16 v19, v137, v10
    v_dot2c_f32_bf16 v20, v138, v9
    v_dot2c_f32_bf16 v21, v138, v10
    v_dot2c_f32_bf16 v22, v139, v9
    v_dot2c_f32_bf16 v23, v139, v10
    s_add_u32 s21, s21, 32768
    buffer_load_dwordx4 v[132:135], v1, s[4:7], s21 offen sc1
    v_dot2c_f32_bf16 v16, v140, v9
    v_dot2c_f32_bf16 v17, v140, v10
    v_dot2c_f32_bf16 v18, v141, v9
    v_dot2c_f32_bf16 v19, v141, v10
    v_dot2c_f32_bf16 v20, v142, v9
    v_dot2c_f32_bf16 v21, v142, v10
    v_dot2c_f32_bf16 v22, v143, v9
    v_dot2c_f32_bf16 v23, v143, v10
    s_add_u32 s21, s21, 32768
    buffer_load_dwordx4 v[136:139], v1, s[4:7], s21 offen sc1
    v_dot2c_f32_bf16 v16, v144, v9
    v_dot2c_f32_bf16 v17, v144, v10
    v_dot2c_f32_bf16 v18, v145, v9
    v_dot2c_f32_bf16 v19, v145, v10
    v_dot2c_f32_bf16 v20, v146, v9
    v_dot2c_f32_bf16 v21, v146, v10
    v_dot2c_f32_bf16 v22, v147, v9
    v_dot2c_f32_bf16 v23, v147, v10
    s_add_u32 s21, s21, 32768
    buffer_load_dwordx4 v[140:143], v1, s[4:7], s21 offen sc1
    v_dot2c_f32_bf16 v16, v148, v9
    v_dot2c_f32_bf16 v17, v148, v10
    v_dot2c_f32_bf16 v18, v149, v9
    v_dot2c_f32_bf16 v19, v149, v10
    v_dot2c_f32_bf16 v20, v150, v9
    v_dot2c_f32_bf16 v21, v150, v10
    v_dot2c_f32_bf16 v22, v151, v9
    v_dot2c_f32_bf16 v23, v151, v10
    s_add_u32 s21, s21, 32768
    buffer_load_dwordx4 v[144:147], v1, s[4:7], s21 offen sc1
    v_dot2c_f32_bf16 v16, v152, v9
    v_dot2c_f32_bf16 v17, v152, v10
    v_dot2c_f32_bf16 v18, v153, v9
    v_dot2c_f32_bf16 v19, v153, v10
    v_dot2c_f32_bf16 v20, v154, v9
    v_dot2c_f32_bf16 v21, v154, v10
    v_dot2c_f32_bf16 v22, v155, v9
    v_dot2c_f32_bf16 v23, v155, v10
    s_add_u32 s21, s21, 32768
    buffer_load_dwordx4 v[148:151], v1, s[4:7], s21 offen sc1
    v_dot2c_f32_bf16 v16, v156, v9
    v_dot2c_f32_bf16 v17, v156, v10
    v_dot2c_f32_bf16 v18, v157, v9
    v_dot2c_f32_bf16 v19, v157, v10
    v_dot2c_f32_bf16 v20, v158, v9
    v_dot2c_f32_bf16 v21, v158, v10
    v_dot2c_f32_bf16 v22, v159, v9
    v_dot2c_f32_bf16 v23, v159, v10
    s_add_u32 s21, s21, 32768
    buffer_load_dwordx4 v[152:155], v1, s[4:7], s21 offen sc1
    v_dot2c_f32_bf16 v16, v160, v9
    v_dot2c_f32_bf16 v17, v160, v10
    v_dot2c_f32_bf16 v18, v161, v9
    v_dot2c_f32_bf16 v19, v161, v10
    v_dot2c_f32_bf16 v20, v162, v9
    v_dot2c_f32_bf16 v21, v162, v10
    v_dot2c_f32_bf16 v22, v163, v9
    v_dot2c_f32_bf16 v23, v163, v10
    s_add_u32 s21, s21, 32768
    buffer_load_dwordx4 v[156:159], v1, s[4:7], s21 offen sc1
    v_dot2c_f32_bf16 v16, v164, v9
    v_dot2c_f32_bf16 v17, v164, v10
    v_dot2c_f32_bf16 v18, v165, v9
    v_dot2c_f32_bf16 v19, v165, v10
    v_dot2c_f32_bf16 v20, v166, v9
    v_dot2c_f32_bf16 v21, v166, v10
    v_dot2c_f32_bf16 v22, v167, v9
    v_dot2c_f32_bf16 v23, v167, v10
    s_add_u32 s21, s21, 32768
    buffer_load_dwordx4 v[160:163], v1, s[4:7], s21 offen sc1
    v_dot2c_f32_bf16 v16, v168, v9
    v_dot2c_f32_bf16 v17, v168, v10
    v_dot2c_f32_bf16 v18, v169, v9
    v_dot2c_f32_bf16 v19, v169, v10
    v_dot2c_f32_bf16 v20, v170, v9
    v_dot2c_f32_bf16 v21, v170, v10
    v_dot2c_f32_bf16 v22, v171, v9
    v_dot2c_f32_bf16 v23, v171, v10
    s_add_u32 s21, s21, 32768
    buffer_load_dwordx4 v[164:167], v1, s[4:7], s21 offen sc1
    v_dot2c_f32_bf16 v16, v172, v9
    v_dot2c_f32_bf16 v17, v172, v10
    v_dot2c_f32_bf16 v18, v173, v9
    v_dot2c_f32_bf16 v19, v173, v10
    v_dot2c_f32_bf16 v20, v174, v9
    v_dot2c_f32_bf16 v21, v174, v10
    v_dot2c_f32_bf16 v22, v175, v9
    v_dot2c_f32_bf16 v23, v175, v10
    s_add_u32 s21, s21, 32768
    buffer_load_dwordx4 v[168:171], v1, s[4:7], s21 offen sc1
    v_dot2c_f32_bf16 v16, v176, v9
    v_dot2c_f32_bf16 v17, v176, v10
    v_dot2c_f32_bf16 v18, v177, v9
    v_dot2c_f32_bf16 v19, v177, v10
    v_dot2c_f32_bf16 v20, v178, v9
    v_dot2c_f32_bf16 v21, v178, v10
    v_dot2c_f32_bf16 v22, v179, v9
    v_dot2c_f32_bf16 v23, v179, v10
    s_add_u32 s21, s21, 32768
    buffer_load_dwordx4 v[172:175], v1, s[4:7], s21 offen sc1
    v_dot2c_f32_bf16 v16, v180, v9
    v_dot2c_f32_bf16 v17, v180, v10
    v_dot2c_f32_bf16 v18, v181, v9
    v_dot2c_f32_bf16 v19, v181, v10
    v_dot2c_f32_bf16 v20, v182, v9
    v_dot2c_f32_bf16 v21, v182, v10
    v_dot2c_f32_bf16 v22, v183, v9
    v_dot2c_f32_bf16 v23, v183, v10
    s_add_u32 s21, s21, 32768
    buffer_load_dwordx4 v[176:179], v1, s[4:7], s21 offen sc1
    v_dot2c_f32_bf16 v16, v184, v9
    v_dot2c_f32_bf16 v17, v184, v10
    v_dot2c_f32_bf16 v18, v185, v9
    v_dot2c_f32_bf16 v19, v185, v10
    v_dot2c_f32_bf16 v20, v186, v9
    v_dot2c_f32_bf16 v21, v186, v10
    v_dot2c_f32_bf16 v22, v187, v9
    v_dot2c_f32_bf16 v23, v187, v10
    s_add_u32 s21, s21, 32768
    buffer_load_dwordx4 v[180:183], v1, s[4:7], s21 offen sc1
    s_lshl_b32 s21, s24, 15
    s_add_u32 s21, s21, s66
    s_add_u32 s21, s21, 12582912
    buffer_load_dwordx4 v[184:187], v1, s[4:7], s21 offen sc1
    s_cmp_ge_u32 s73, 1000
    s_cselect_b32 s23, 2, 1
    s_add_u32 s21, s73, s23
    s_lshr_b32 s24, s21, 1
    s_lshl_b32 s71, s24, 14
    s_add_u32 s71, s71, 4096
    s_cmp_lt_u32 s21, 220
    s_cselect_b32 s71, s71, 14336
    buffer_load_dword v11, v13, s[4:7], s71 offen sc1
    s_mov_b32 s74, 1
    s_branch L_r_np_4_p
L_r_np_4:
    s_mov_b32 s74, 0
L_r_np_4_p:
    v_cvt_pk_bf16_f32 v44, v16, v17
    v_cvt_pk_bf16_f32 v45, v18, v19
    v_cvt_pk_bf16_f32 v46, v20, v21
    v_cvt_pk_bf16_f32 v47, v22, v23
    s_xor_b32 s67, s67, 4096
    s_lshr_b32 s70, s68, 1
    s_lshl_b32 s70, s70, 15
    s_add_u32 s70, s70, s67
    s_sub_u32 s70, s70, 2097152
    buffer_store_dwordx4 v[44:47], v2, s[12:15], s70 offen
L_r_np_4_j:
    buffer_load_dword v12, v13, s[4:7], s71 offen sc1
    s_mov_b32 s68, s73
    s_cmp_lt_u32 s68, 220
    s_cbranch_scc0 L_r_end_4
    s_waitcnt vmcnt(0)
    v_cmp_gt_u32 vcc, 1, v12
    s_cmp_eq_u32 s74, 1
    s_cbranch_scc0 L_r_x_4
    s_cbranch_vccz L_r_deep_4
    v_mov_b32 v11, v12
    s_branch L_r_loop_4
L_r_x_4:
    s_cbranch_vccz L_r_go_4
    s_branch L_r_wait_4
L_r_end_4:
    s_branch L_dump_role_r
L_dump_role_r:
    s_branch L_end
L_role_AO:
    s_and_b32 s65, s25, 1
    s_lshr_b32 s22, s25, 1
    s_mul_i32 s64, s22, 0x5556
    s_lshr_b32 s64, s64, 16
    s_mul_i32 s23, s64, 3
    s_sub_u32 s67, s22, s23
    s_lshl_b32 s66, s64, 2
    s_add_u32 s66, s66, s16
    s_lshl_b32 s74, s64, 19
    s_lshl_b32 s21, s65, 9
    s_add_u32 s74, s74, s21
    v_lshrrev_b32 v105, 5, v0
    v_and_b32 v106, 31, v0
    v_lshlrev_b32 v107, 2, v105
    v_xor_b32 v106, v106, v107
    v_mul_u32_u24 v105, 1024, v105
    v_lshl_add_u32 v100, v106, 4, v105
    v_lshrrev_b32 v105, 4, v0
    v_lshlrev_b32 v105, 3, v105
    v_bfe_u32 v108, v0, 2, 2
    v_add_u32 v105, v105, v108
    v_mul_u32_u24 v105, 512, v105
    v_and_b32 v106, 3, v0
    v_lshl_add_u32 v105, v106, 4, v105
    s_mul_i32 s21, s16, 2
    s_add_u32 s21, s21, 0
    v_xor_b32 v106, s21, v108
    v_lshl_add_u32 v101, v106, 6, v105
    s_mul_i32 s21, s16, 2
    s_add_u32 s21, s21, 1
    v_xor_b32 v106, s21, v108
    v_lshl_add_u32 v102, v106, 6, v105
    s_lshl_b32 s26, s16, 13
    s_mov_b32 s8, s42
    s_and_b32 s9, s43, 0xffff
    s_mov_b32 s10, 4194304
    s_mov_b32 s11, 0x20000
    s_mul_i32 s22, s16, 16384
    s_add_u32 s22, s22, s74
    s_add_u32 m0, s26, 0
    s_add_u32 s22, s22, 0
    buffer_load_dwordx4 v100, s[8:11], s22 offen lds
    s_add_u32 m0, m0, 1024
    s_add_u32 s22, s22, 2048
    v_xor_b32 v109, 128, v100
    buffer_load_dwordx4 v109, s[8:11], s22 offen lds
    s_add_u32 m0, m0, 1024
    s_add_u32 s22, s22, 2048
    buffer_load_dwordx4 v100, s[8:11], s22 offen lds
    s_add_u32 m0, m0, 1024
    s_add_u32 s22, s22, 2048
    v_xor_b32 v109, 128, v100
    buffer_load_dwordx4 v109, s[8:11], s22 offen lds
    s_add_u32 m0, m0, 1024
    s_add_u32 s22, s22, 2048
    buffer_load_dwordx4 v100, s[8:11], s22 offen lds
    s_add_u32 m0, m0, 1024
    s_add_u32 s22, s22, 2048
    v_xor_b32 v109, 128, v100
    buffer_load_dwordx4 v109, s[8:11], s22 offen lds
    s_add_u32 m0, m0, 1024
    s_add_u32 s22, s22, 2048
    buffer_load_dwordx4 v100, s[8:11], s22 offen lds
    s_add_u32 m0, m0, 1024
    s_add_u32 s22, s22, 2048
    v_xor_b32 v109, 128, v100
    buffer_load_dwordx4 v109, s[8:11], s22 offen lds
    s_cmp_eq_u32 s91, 0
    s_cbranch_scc0 L_arr_70
    s_mov_b32 s91, 1
    s_waitcnt vmcnt(8)
    s_barrier
    s_cmp_eq_u32 s16, 0
    s_cbranch_scc0 L_arr_70
    s_lshl_b32 s21, s17, 5
    s_add_u32 s21, s21, 4
    s_atomic_add s3, s[56:57], s21
L_arr_70:
    s_mul_i32 s22, s16, 16384
    s_add_u32 s22, s22, s74
    s_add_u32 m0, s26, 32768
    s_add_u32 s22, s22, 65536
    buffer_load_dwordx4 v100, s[8:11], s22 offen lds
    s_add_u32 m0, m0, 1024
    s_add_u32 s22, s22, 2048
    v_xor_b32 v109, 128, v100
    buffer_load_dwordx4 v109, s[8:11], s22 offen lds
    s_add_u32 m0, m0, 1024
    s_add_u32 s22, s22, 2048
    buffer_load_dwordx4 v100, s[8:11], s22 offen lds
    s_add_u32 m0, m0, 1024
    s_add_u32 s22, s22, 2048
    v_xor_b32 v109, 128, v100
    buffer_load_dwordx4 v109, s[8:11], s22 offen lds
    s_add_u32 m0, m0, 1024
    s_add_u32 s22, s22, 2048
    buffer_load_dwordx4 v100, s[8:11], s22 offen lds
    s_add_u32 m0, m0, 1024
    s_add_u32 s22, s22, 2048
    v_xor_b32 v109, 128, v100
    buffer_load_dwordx4 v109, s[8:11], s22 offen lds
    s_add_u32 m0, m0, 1024
    s_add_u32 s22, s22, 2048
    buffer_load_dwordx4 v100, s[8:11], s22 offen lds
    s_add_u32 m0, m0, 1024
    s_add_u32 s22, s22, 2048
    v_xor_b32 v109, 128, v100
    buffer_load_dwordx4 v109, s[8:11], s22 offen lds
    s_mul_i32 s22, s16, 16384
    s_add_u32 s22, s22, s74
    s_add_u32 m0, s26, 65536
    s_add_u32 s22, s22, 131072
    buffer_load_dwordx4 v100, s[8:11], s22 offen lds
    s_add_u32 m0, m0, 1024
    s_add_u32 s22, s22, 2048
    v_xor_b32 v109, 128, v100
    buffer_load_dwordx4 v109, s[8:11], s22 offen lds
    s_add_u32 m0, m0, 1024
    s_add_u32 s22, s22, 2048
    buffer_load_dwordx4 v100, s[8:11], s22 offen lds
    s_add_u32 m0, m0, 1024
    s_add_u32 s22, s22, 2048
    v_xor_b32 v109, 128, v100
    buffer_load_dwordx4 v109, s[8:11], s22 offen lds
    s_add_u32 m0, m0, 1024
    s_add_u32 s22, s22, 2048
    buffer_load_dwordx4 v100, s[8:11], s22 offen lds
    s_add_u32 m0, m0, 1024
    s_add_u32 s22, s22, 2048
    v_xor_b32 v109, 128, v100
    buffer_load_dwordx4 v109, s[8:11], s22 offen lds
    s_add_u32 m0, m0, 1024
    s_add_u32 s22, s22, 2048
    buffer_load_dwordx4 v100, s[8:11], s22 offen lds
    s_add_u32 m0, m0, 1024
    s_add_u32 s22, s22, 2048
    v_xor_b32 v109, 128, v100
    buffer_load_dwordx4 v109, s[8:11], s22 offen lds
    s_mul_i32 s22, s16, 16384
    s_add_u32 s22, s22, s74
    s_add_u32 m0, s26, 98304
    s_add_u32 s22, s22, 196608
    buffer_load_dwordx4 v100, s[8:11], s22 offen lds
    s_add_u32 m0, m0, 1024
    s_add_u32 s22, s22, 2048
    v_xor_b32 v109, 128, v100
    buffer_load_dwordx4 v109, s[8:11], s22 offen lds
    s_add_u32 m0, m0, 1024
    s_add_u32 s22, s22, 2048
    buffer_load_dwordx4 v100, s[8:11], s22 offen lds
    s_add_u32 m0, m0, 1024
    s_add_u32 s22, s22, 2048
    v_xor_b32 v109, 128, v100
    buffer_load_dwordx4 v109, s[8:11], s22 offen lds
    s_add_u32 m0, m0, 1024
    s_add_u32 s22, s22, 2048
    buffer_load_dwordx4 v100, s[8:11], s22 offen lds
    s_add_u32 m0, m0, 1024
    s_add_u32 s22, s22, 2048
    v_xor_b32 v109, 128, v100
    buffer_load_dwordx4 v109, s[8:11], s22 offen lds
    s_add_u32 m0, m0, 1024
    s_add_u32 s22, s22, 2048
    buffer_load_dwordx4 v100, s[8:11], s22 offen lds
    s_add_u32 m0, m0, 1024
    s_add_u32 s22, s22, 2048
    v_xor_b32 v109, 128, v100
    buffer_load_dwordx4 v109, s[8:11], s22 offen lds
    s_waitcnt vmcnt(24)
    s_barrier
    s_cmp_eq_u32 s16, 0
    s_cbranch_scc0 L_w_71_1
    ds_read_b64_tr_b16 a[0:1], v101 offset:0
    ds_read_b64_tr_b16 a[2:3], v101 offset:2048
    ds_read_b64_tr_b16 a[4:5], v101 offset:8
    ds_read_b64_tr_b16 a[6:7], v101 offset:2056
    ds_read_b64_tr_b16 a[8:9], v101 offset:16384
    ds_read_b64_tr_b16 a[10:11], v101 offset:18432
    ds_read_b64_tr_b16 a[12:13], v101 offset:16392
    ds_read_b64_tr_b16 a[14:15], v101 offset:18440
    s_waitcnt lgkmcnt(0)
    ds_read_b64_tr_b16 a[128:129], v102 offset:0
    ds_read_b64_tr_b16 a[130:131], v102 offset:2048
    ds_read_b64_tr_b16 a[132:133], v102 offset:8
    ds_read_b64_tr_b16 a[134:135], v102 offset:2056
    ds_read_b64_tr_b16 a[136:137], v102 offset:16384
    ds_read_b64_tr_b16 a[138:139], v102 offset:18432
    ds_read_b64_tr_b16 a[140:141], v102 offset:16392
    ds_read_b64_tr_b16 a[142:143], v102 offset:18440
    s_branch L_w_71
L_w_71_1:
    s_cmp_eq_u32 s16, 1
    s_cbranch_scc0 L_w_71_2
    ds_read_b64_tr_b16 a[32:33], v101 offset:0
    ds_read_b64_tr_b16 a[34:35], v101 offset:2048
    ds_read_b64_tr_b16 a[36:37], v101 offset:8
    ds_read_b64_tr_b16 a[38:39], v101 offset:2056
    ds_read_b64_tr_b16 a[40:41], v101 offset:16384
    ds_read_b64_tr_b16 a[42:43], v101 offset:18432
    ds_read_b64_tr_b16 a[44:45], v101 offset:16392
    ds_read_b64_tr_b16 a[46:47], v101 offset:18440
    s_waitcnt lgkmcnt(0)
    ds_read_b64_tr_b16 a[160:161], v102 offset:0
    ds_read_b64_tr_b16 a[162:163], v102 offset:2048
    ds_read_b64_tr_b16 a[164:165], v102 offset:8
    ds_read_b64_tr_b16 a[166:167], v102 offset:2056
    ds_read_b64_tr_b16 a[168:169], v102 offset:16384
    ds_read_b64_tr_b16 a[170:171], v102 offset:18432
    ds_read_b64_tr_b16 a[172:173], v102 offset:16392
    ds_read_b64_tr_b16 a[174:175], v102 offset:18440
    s_branch L_w_71
L_w_71_2:
    s_cmp_eq_u32 s16, 2
    s_cbranch_scc0 L_w_71_3
    ds_read_b64_tr_b16 a[64:65], v101 offset:0
    ds_read_b64_tr_b16 a[66:67], v101 offset:2048
    ds_read_b64_tr_b16 a[68:69], v101 offset:8
    ds_read_b64_tr_b16 a[70:71], v101 offset:2056
    ds_read_b64_tr_b16 a[72:73], v101 offset:16384
    ds_read_b64_tr_b16 a[74:75], v101 offset:18432
    ds_read_b64_tr_b16 a[76:77], v101 offset:16392
    ds_read_b64_tr_b16 a[78:79], v101 offset:18440
    s_waitcnt lgkmcnt(0)
    ds_read_b64_tr_b16 a[192:193], v102 offset:0
    ds_read_b64_tr_b16 a[194:195], v102 offset:2048
    ds_read_b64_tr_b16 a[196:197], v102 offset:8
    ds_read_b64_tr_b16 a[198:199], v102 offset:2056
    ds_read_b64_tr_b16 a[200:201], v102 offset:16384
    ds_read_b64_tr_b16 a[202:203], v102 offset:18432
    ds_read_b64_tr_b16 a[204:205], v102 offset:16392
    ds_read_b64_tr_b16 a[206:207], v102 offset:18440
    s_branch L_w_71
L_w_71_3:
    ds_read_b64_tr_b16 a[96:97], v101 offset:0
    ds_read_b64_tr_b16 a[98:99], v101 offset:2048
    ds_read_b64_tr_b16 a[100:101], v101 offset:8
    ds_read_b64_tr_b16 a[102:103], v101 offset:2056
    ds_read_b64_tr_b16 a[104:105], v101 offset:16384
    ds_read_b64_tr_b16 a[106:107], v101 offset:18432
    ds_read_b64_tr_b16 a[108:109], v101 offset:16392
    ds_read_b64_tr_b16 a[110:111], v101 offset:18440
    s_waitcnt lgkmcnt(0)
    ds_read_b64_tr_b16 a[224:225], v102 offset:0
    ds_read_b64_tr_b16 a[226:227], v102 offset:2048
    ds_read_b64_tr_b16 a[228:229], v102 offset:8
    ds_read_b64_tr_b16 a[230:231], v102 offset:2056
    ds_read_b64_tr_b16 a[232:233], v102 offset:16384
    ds_read_b64_tr_b16 a[234:235], v102 offset:18432
    ds_read_b64_tr_b16 a[236:237], v102 offset:16392
    ds_read_b64_tr_b16 a[238:239], v102 offset:18440
L_w_71:
    s_waitcnt lgkmcnt(0)
    s_waitcnt vmcnt(16)
    s_barrier
    s_mul_i32 s22, s16, 16384
    s_add_u32 s22, s22, s74
    s_add_u32 m0, s26, 0
    s_add_u32 s22, s22, 262144
    buffer_load_dwordx4 v100, s[8:11], s22 offen lds
    s_add_u32 m0, m0, 1024
    s_add_u32 s22, s22, 2048
    v_xor_b32 v109, 128, v100
    buffer_load_dwordx4 v109, s[8:11], s22 offen lds
    s_add_u32 m0, m0, 1024
    s_add_u32 s22, s22, 2048
    buffer_load_dwordx4 v100, s[8:11], s22 offen lds
    s_add_u32 m0, m0, 1024
    s_add_u32 s22, s22, 2048
    v_xor_b32 v109, 128, v100
    buffer_load_dwordx4 v109, s[8:11], s22 offen lds
    s_add_u32 m0, m0, 1024
    s_add_u32 s22, s22, 2048
    buffer_load_dwordx4 v100, s[8:11], s22 offen lds
    s_add_u32 m0, m0, 1024
    s_add_u32 s22, s22, 2048
    v_xor_b32 v109, 128, v100
    buffer_load_dwordx4 v109, s[8:11], s22 offen lds
    s_add_u32 m0, m0, 1024
    s_add_u32 s22, s22, 2048
    buffer_load_dwordx4 v100, s[8:11], s22 offen lds
    s_add_u32 m0, m0, 1024
    s_add_u32 s22, s22, 2048
    v_xor_b32 v109, 128, v100
    buffer_load_dwordx4 v109, s[8:11], s22 offen lds
    s_cmp_eq_u32 s16, 0
    s_cbranch_scc0 L_w_72_1
    ds_read_b64_tr_b16 a[16:17], v101 offset:32768
    ds_read_b64_tr_b16 a[18:19], v101 offset:34816
    ds_read_b64_tr_b16 a[20:21], v101 offset:32776
    ds_read_b64_tr_b16 a[22:23], v101 offset:34824
    ds_read_b64_tr_b16 a[24:25], v101 offset:49152
    ds_read_b64_tr_b16 a[26:27], v101 offset:51200
    ds_read_b64_tr_b16 a[28:29], v101 offset:49160
    ds_read_b64_tr_b16 a[30:31], v101 offset:51208
    s_waitcnt lgkmcnt(0)
    ds_read_b64_tr_b16 a[144:145], v102 offset:32768
    ds_read_b64_tr_b16 a[146:147], v102 offset:34816
    ds_read_b64_tr_b16 a[148:149], v102 offset:32776
    ds_read_b64_tr_b16 a[150:151], v102 offset:34824
    ds_read_b64_tr_b16 a[152:153], v102 offset:49152
    ds_read_b64_tr_b16 a[154:155], v102 offset:51200
    ds_read_b64_tr_b16 a[156:157], v102 offset:49160
    ds_read_b64_tr_b16 a[158:159], v102 offset:51208
    s_branch L_w_72
L_w_72_1:
    s_cmp_eq_u32 s16, 1
    s_cbranch_scc0 L_w_72_2
    ds_read_b64_tr_b16 a[48:49], v101 offset:32768
    ds_read_b64_tr_b16 a[50:51], v101 offset:34816
    ds_read_b64_tr_b16 a[52:53], v101 offset:32776
    ds_read_b64_tr_b16 a[54:55], v101 offset:34824
    ds_read_b64_tr_b16 a[56:57], v101 offset:49152
    ds_read_b64_tr_b16 a[58:59], v101 offset:51200
    ds_read_b64_tr_b16 a[60:61], v101 offset:49160
    ds_read_b64_tr_b16 a[62:63], v101 offset:51208
    s_waitcnt lgkmcnt(0)
    ds_read_b64_tr_b16 a[176:177], v102 offset:32768
    ds_read_b64_tr_b16 a[178:179], v102 offset:34816
    ds_read_b64_tr_b16 a[180:181], v102 offset:32776
    ds_read_b64_tr_b16 a[182:183], v102 offset:34824
    ds_read_b64_tr_b16 a[184:185], v102 offset:49152
    ds_read_b64_tr_b16 a[186:187], v102 offset:51200
    ds_read_b64_tr_b16 a[188:189], v102 offset:49160
    ds_read_b64_tr_b16 a[190:191], v102 offset:51208
    s_branch L_w_72
L_w_72_2:
    s_cmp_eq_u32 s16, 2
    s_cbranch_scc0 L_w_72_3
    ds_read_b64_tr_b16 a[80:81], v101 offset:32768
    ds_read_b64_tr_b16 a[82:83], v101 offset:34816
    ds_read_b64_tr_b16 a[84:85], v101 offset:32776
    ds_read_b64_tr_b16 a[86:87], v101 offset:34824
    ds_read_b64_tr_b16 a[88:89], v101 offset:49152
    ds_read_b64_tr_b16 a[90:91], v101 offset:51200
    ds_read_b64_tr_b16 a[92:93], v101 offset:49160
    ds_read_b64_tr_b16 a[94:95], v101 offset:51208
    s_waitcnt lgkmcnt(0)
    ds_read_b64_tr_b16 a[208:209], v102 offset:32768
    ds_read_b64_tr_b16 a[210:211], v102 offset:34816
    ds_read_b64_tr_b16 a[212:213], v102 offset:32776
    ds_read_b64_tr_b16 a[214:215], v102 offset:34824
    ds_read_b64_tr_b16 a[216:217], v102 offset:49152
    ds_read_b64_tr_b16 a[218:219], v102 offset:51200
    ds_read_b64_tr_b16 a[220:221], v102 offset:49160
    ds_read_b64_tr_b16 a[222:223], v102 offset:51208
    s_branch L_w_72
L_w_72_3:
    ds_read_b64_tr_b16 a[112:113], v101 offset:32768
    ds_read_b64_tr_b16 a[114:115], v101 offset:34816
    ds_read_b64_tr_b16 a[116:117], v101 offset:32776
    ds_read_b64_tr_b16 a[118:119], v101 offset:34824
    ds_read_b64_tr_b16 a[120:121], v101 offset:49152
    ds_read_b64_tr_b16 a[122:123], v101 offset:51200
    ds_read_b64_tr_b16 a[124:125], v101 offset:49160
    ds_read_b64_tr_b16 a[126:127], v101 offset:51208
    s_waitcnt lgkmcnt(0)
    ds_read_b64_tr_b16 a[240:241], v102 offset:32768
    ds_read_b64_tr_b16 a[242:243], v102 offset:34816
    ds_read_b64_tr_b16 a[244:245], v102 offset:32776
    ds_read_b64_tr_b16 a[246:247], v102 offset:34824
    ds_read_b64_tr_b16 a[248:249], v102 offset:49152
    ds_read_b64_tr_b16 a[250:251], v102 offset:51200
    ds_read_b64_tr_b16 a[252:253], v102 offset:49160
    ds_read_b64_tr_b16 a[254:255], v102 offset:51208
L_w_72:
    s_waitcnt lgkmcnt(0)
    s_waitcnt vmcnt(16)
    s_barrier
    s_mul_i32 s22, s16, 16384
    s_add_u32 s22, s22, s74
    s_add_u32 m0, s26, 32768
    s_add_u32 s22, s22, 327680
    buffer_load_dwordx4 v100, s[8:11], s22 offen lds
    s_add_u32 m0, m0, 1024
    s_add_u32 s22, s22, 2048
    v_xor_b32 v109, 128, v100
    buffer_load_dwordx4 v109, s[8:11], s22 offen lds
    s_add_u32 m0, m0, 1024
    s_add_u32 s22, s22, 2048
    buffer_load_dwordx4 v100, s[8:11], s22 offen lds
    s_add_u32 m0, m0, 1024
    s_add_u32 s22, s22, 2048
    v_xor_b32 v109, 128, v100
    buffer_load_dwordx4 v109, s[8:11], s22 offen lds
    s_add_u32 m0, m0, 1024
    s_add_u32 s22, s22, 2048
    buffer_load_dwordx4 v100, s[8:11], s22 offen lds
    s_add_u32 m0, m0, 1024
    s_add_u32 s22, s22, 2048
    v_xor_b32 v109, 128, v100
    buffer_load_dwordx4 v109, s[8:11], s22 offen lds
    s_add_u32 m0, m0, 1024
    s_add_u32 s22, s22, 2048
    buffer_load_dwordx4 v100, s[8:11], s22 offen lds
    s_add_u32 m0, m0, 1024
    s_add_u32 s22, s22, 2048
    v_xor_b32 v109, 128, v100
    buffer_load_dwordx4 v109, s[8:11], s22 offen lds
    v_xor_b32 v101, 0x10000, v101
    v_xor_b32 v102, 0x10000, v102
    v_xor_b32 v103, 0x10000, v103
    v_xor_b32 v104, 0x10000, v104
    s_cmp_eq_u32 s16, 0
    s_cbranch_scc0 L_w_73_1
    ds_read_b64_tr_b16 a[32:33], v101 offset:0
    ds_read_b64_tr_b16 a[34:35], v101 offset:2048
    ds_read_b64_tr_b16 a[36:37], v101 offset:8
    ds_read_b64_tr_b16 a[38:39], v101 offset:2056
    ds_read_b64_tr_b16 a[40:41], v101 offset:16384
    ds_read_b64_tr_b16 a[42:43], v101 offset:18432
    ds_read_b64_tr_b16 a[44:45], v101 offset:16392
    ds_read_b64_tr_b16 a[46:47], v101 offset:18440
    s_waitcnt lgkmcnt(0)
    ds_read_b64_tr_b16 a[160:161], v102 offset:0
    ds_read_b64_tr_b16 a[162:163], v102 offset:2048
    ds_read_b64_tr_b16 a[164:165], v102 offset:8
    ds_read_b64_tr_b16 a[166:167], v102 offset:2056
    ds_read_b64_tr_b16 a[168:169], v102 offset:16384
    ds_read_b64_tr_b16 a[170:171], v102 offset:18432
    ds_read_b64_tr_b16 a[172:173], v102 offset:16392
    ds_read_b64_tr_b16 a[174:175], v102 offset:18440
    s_branch L_w_73
L_w_73_1:
    s_cmp_eq_u32 s16, 1
    s_cbranch_scc0 L_w_73_2
    ds_read_b64_tr_b16 a[0:1], v101 offset:0
    ds_read_b64_tr_b16 a[2:3], v101 offset:2048
    ds_read_b64_tr_b16 a[4:5], v101 offset:8
    ds_read_b64_tr_b16 a[6:7], v101 offset:2056
    ds_read_b64_tr_b16 a[8:9], v101 offset:16384
    ds_read_b64_tr_b16 a[10:11], v101 offset:18432
    ds_read_b64_tr_b16 a[12:13], v101 offset:16392
    ds_read_b64_tr_b16 a[14:15], v101 offset:18440
    s_waitcnt lgkmcnt(0)
    ds_read_b64_tr_b16 a[128:129], v102 offset:0
    ds_read_b64_tr_b16 a[130:131], v102 offset:2048
    ds_read_b64_tr_b16 a[132:133], v102 offset:8
    ds_read_b64_tr_b16 a[134:135], v102 offset:2056
    ds_read_b64_tr_b16 a[136:137], v102 offset:16384
    ds_read_b64_tr_b16 a[138:139], v102 offset:18432
    ds_read_b64_tr_b16 a[140:141], v102 offset:16392
    ds_read_b64_tr_b16 a[142:143], v102 offset:18440
    s_branch L_w_73
L_w_73_2:
    s_cmp_eq_u32 s16, 2
    s_cbranch_scc0 L_w_73_3
    ds_read_b64_tr_b16 a[96:97], v101 offset:0
    ds_read_b64_tr_b16 a[98:99], v101 offset:2048
    ds_read_b64_tr_b16 a[100:101], v101 offset:8
    ds_read_b64_tr_b16 a[102:103], v101 offset:2056
    ds_read_b64_tr_b16 a[104:105], v101 offset:16384
    ds_read_b64_tr_b16 a[106:107], v101 offset:18432
    ds_read_b64_tr_b16 a[108:109], v101 offset:16392
    ds_read_b64_tr_b16 a[110:111], v101 offset:18440
    s_waitcnt lgkmcnt(0)
    ds_read_b64_tr_b16 a[224:225], v102 offset:0
    ds_read_b64_tr_b16 a[226:227], v102 offset:2048
    ds_read_b64_tr_b16 a[228:229], v102 offset:8
    ds_read_b64_tr_b16 a[230:231], v102 offset:2056
    ds_read_b64_tr_b16 a[232:233], v102 offset:16384
    ds_read_b64_tr_b16 a[234:235], v102 offset:18432
    ds_read_b64_tr_b16 a[236:237], v102 offset:16392
    ds_read_b64_tr_b16 a[238:239], v102 offset:18440
    s_branch L_w_73
L_w_73_3:
    ds_read_b64_tr_b16 a[64:65], v101 offset:0
    ds_read_b64_tr_b16 a[66:67], v101 offset:2048
    ds_read_b64_tr_b16 a[68:69], v101 offset:8
    ds_read_b64_tr_b16 a[70:71], v101 offset:2056
    ds_read_b64_tr_b16 a[72:73], v101 offset:16384
    ds_read_b64_tr_b16 a[74:75], v101 offset:18432
    ds_read_b64_tr_b16 a[76:77], v101 offset:16392
    ds_read_b64_tr_b16 a[78:79], v101 offset:18440
    s_waitcnt lgkmcnt(0)
    ds_read_b64_tr_b16 a[192:193], v102 offset:0
    ds_read_b64_tr_b16 a[194:195], v102 offset:2048
    ds_read_b64_tr_b16 a[196:197], v102 offset:8
    ds_read_b64_tr_b16 a[198:199], v102 offset:2056
    ds_read_b64_tr_b16 a[200:201], v102 offset:16384
    ds_read_b64_tr_b16 a[202:203], v102 offset:18432
    ds_read_b64_tr_b16 a[204:205], v102 offset:16392
    ds_read_b64_tr_b16 a[206:207], v102 offset:18440
L_w_73:
    s_waitcnt lgkmcnt(0)
    s_waitcnt vmcnt(16)
    s_barrier
    s_mul_i32 s22, s16, 16384
    s_add_u32 s22, s22, s74
    s_add_u32 m0, s26, 65536
    s_add_u32 s22, s22, 393216
    buffer_load_dwordx4 v100, s[8:11], s22 offen lds
    s_add_u32 m0, m0, 1024
    s_add_u32 s22, s22, 2048
    v_xor_b32 v109, 128, v100
    buffer_load_dwordx4 v109, s[8:11], s22 offen lds
    s_add_u32 m0, m0, 1024
    s_add_u32 s22, s22, 2048
    buffer_load_dwordx4 v100, s[8:11], s22 offen lds
    s_add_u32 m0, m0, 1024
    s_add_u32 s22, s22, 2048
    v_xor_b32 v109, 128, v100
    buffer_load_dwordx4 v109, s[8:11], s22 offen lds
    s_add_u32 m0, m0, 1024
    s_add_u32 s22, s22, 2048
    buffer_load_dwordx4 v100, s[8:11], s22 offen lds
    s_add_u32 m0, m0, 1024
    s_add_u32 s22, s22, 2048
    v_xor_b32 v109, 128, v100
    buffer_load_dwordx4 v109, s[8:11], s22 offen lds
    s_add_u32 m0, m0, 1024
    s_add_u32 s22, s22, 2048
    buffer_load_dwordx4 v100, s[8:11], s22 offen lds
    s_add_u32 m0, m0, 1024
    s_add_u32 s22, s22, 2048
    v_xor_b32 v109, 128, v100
    buffer_load_dwordx4 v109, s[8:11], s22 offen lds
    s_cmp_eq_u32 s16, 0
    s_cbranch_scc0 L_w_74_1
    ds_read_b64_tr_b16 a[48:49], v101 offset:32768
    ds_read_b64_tr_b16 a[50:51], v101 offset:34816
    ds_read_b64_tr_b16 a[52:53], v101 offset:32776
    ds_read_b64_tr_b16 a[54:55], v101 offset:34824
    ds_read_b64_tr_b16 a[56:57], v101 offset:49152
    ds_read_b64_tr_b16 a[58:59], v101 offset:51200
    ds_read_b64_tr_b16 a[60:61], v101 offset:49160
    ds_read_b64_tr_b16 a[62:63], v101 offset:51208
    s_waitcnt lgkmcnt(0)
    ds_read_b64_tr_b16 a[176:177], v102 offset:32768
    ds_read_b64_tr_b16 a[178:179], v102 offset:34816
    ds_read_b64_tr_b16 a[180:181], v102 offset:32776
    ds_read_b64_tr_b16 a[182:183], v102 offset:34824
    ds_read_b64_tr_b16 a[184:185], v102 offset:49152
    ds_read_b64_tr_b16 a[186:187], v102 offset:51200
    ds_read_b64_tr_b16 a[188:189], v102 offset:49160
    ds_read_b64_tr_b16 a[190:191], v102 offset:51208
    s_branch L_w_74
L_w_74_1:
    s_cmp_eq_u32 s16, 1
    s_cbranch_scc0 L_w_74_2
    ds_read_b64_tr_b16 a[16:17], v101 offset:32768
    ds_read_b64_tr_b16 a[18:19], v101 offset:34816
    ds_read_b64_tr_b16 a[20:21], v101 offset:32776
    ds_read_b64_tr_b16 a[22:23], v101 offset:34824
    ds_read_b64_tr_b16 a[24:25], v101 offset:49152
    ds_read_b64_tr_b16 a[26:27], v101 offset:51200
    ds_read_b64_tr_b16 a[28:29], v101 offset:49160
    ds_read_b64_tr_b16 a[30:31], v101 offset:51208
    s_waitcnt lgkmcnt(0)
    ds_read_b64_tr_b16 a[144:145], v102 offset:32768
    ds_read_b64_tr_b16 a[146:147], v102 offset:34816
    ds_read_b64_tr_b16 a[148:149], v102 offset:32776
    ds_read_b64_tr_b16 a[150:151], v102 offset:34824
    ds_read_b64_tr_b16 a[152:153], v102 offset:49152
    ds_read_b64_tr_b16 a[154:155], v102 offset:51200
    ds_read_b64_tr_b16 a[156:157], v102 offset:49160
    ds_read_b64_tr_b16 a[158:159], v102 offset:51208
    s_branch L_w_74
L_w_74_2:
    s_cmp_eq_u32 s16, 2
    s_cbranch_scc0 L_w_74_3
    ds_read_b64_tr_b16 a[112:113], v101 offset:32768
    ds_read_b64_tr_b16 a[114:115], v101 offset:34816
    ds_read_b64_tr_b16 a[116:117], v101 offset:32776
    ds_read_b64_tr_b16 a[118:119], v101 offset:34824
    ds_read_b64_tr_b16 a[120:121], v101 offset:49152
    ds_read_b64_tr_b16 a[122:123], v101 offset:51200
    ds_read_b64_tr_b16 a[124:125], v101 offset:49160
    ds_read_b64_tr_b16 a[126:127], v101 offset:51208
    s_waitcnt lgkmcnt(0)
    ds_read_b64_tr_b16 a[240:241], v102 offset:32768
    ds_read_b64_tr_b16 a[242:243], v102 offset:34816
    ds_read_b64_tr_b16 a[244:245], v102 offset:32776
    ds_read_b64_tr_b16 a[246:247], v102 offset:34824
    ds_read_b64_tr_b16 a[248:249], v102 offset:49152
    ds_read_b64_tr_b16 a[250:251], v102 offset:51200
    ds_read_b64_tr_b16 a[252:253], v102 offset:49160
    ds_read_b64_tr_b16 a[254:255], v102 offset:51208
    s_branch L_w_74
L_w_74_3:
    ds_read_b64_tr_b16 a[80:81], v101 offset:32768
    ds_read_b64_tr_b16 a[82:83], v101 offset:34816
    ds_read_b64_tr_b16 a[84:85], v101 offset:32776
    ds_read_b64_tr_b16 a[86:87], v101 offset:34824
    ds_read_b64_tr_b16 a[88:89], v101 offset:49152
    ds_read_b64_tr_b16 a[90:91], v101 offset:51200
    ds_read_b64_tr_b16 a[92:93], v101 offset:49160
    ds_read_b64_tr_b16 a[94:95], v101 offset:51208
    s_waitcnt lgkmcnt(0)
    ds_read_b64_tr_b16 a[208:209], v102 offset:32768
    ds_read_b64_tr_b16 a[210:211], v102 offset:34816
    ds_read_b64_tr_b16 a[212:213], v102 offset:32776
    ds_read_b64_tr_b16 a[214:215], v102 offset:34824
    ds_read_b64_tr_b16 a[216:217], v102 offset:49152
    ds_read_b64_tr_b16 a[218:219], v102 offset:51200
    ds_read_b64_tr_b16 a[220:221], v102 offset:49160
    ds_read_b64_tr_b16 a[222:223], v102 offset:51208
L_w_74:
    s_waitcnt lgkmcnt(0)
    s_waitcnt vmcnt(16)
    s_barrier
    s_mul_i32 s22, s16, 16384
    s_add_u32 s22, s22, s74
    s_add_u32 m0, s26, 98304
    s_add_u32 s22, s22, 458752
    buffer_load_dwordx4 v100, s[8:11], s22 offen lds
    s_add_u32 m0, m0, 1024
    s_add_u32 s22, s22, 2048
    v_xor_b32 v109, 128, v100
    buffer_load_dwordx4 v109, s[8:11], s22 offen lds
    s_add_u32 m0, m0, 1024
    s_add_u32 s22, s22, 2048
    buffer_load_dwordx4 v100, s[8:11], s22 offen lds
    s_add_u32 m0, m0, 1024
    s_add_u32 s22, s22, 2048
    v_xor_b32 v109, 128, v100
    buffer_load_dwordx4 v109, s[8:11], s22 offen lds
    s_add_u32 m0, m0, 1024
    s_add_u32 s22, s22, 2048
    buffer_load_dwordx4 v100, s[8:11], s22 offen lds
    s_add_u32 m0, m0, 1024
    s_add_u32 s22, s22, 2048
    v_xor_b32 v109, 128, v100
    buffer_load_dwordx4 v109, s[8:11], s22 offen lds
    s_add_u32 m0, m0, 1024
    s_add_u32 s22, s22, 2048
    buffer_load_dwordx4 v100, s[8:11], s22 offen lds
    s_add_u32 m0, m0, 1024
    s_add_u32 s22, s22, 2048
    v_xor_b32 v109, 128, v100
    buffer_load_dwordx4 v109, s[8:11], s22 offen lds
    v_xor_b32 v101, 0x10000, v101
    v_xor_b32 v102, 0x10000, v102
    v_xor_b32 v103, 0x10000, v103
    v_xor_b32 v104, 0x10000, v104
    s_cmp_eq_u32 s16, 0
    s_cbranch_scc0 L_w_75_1
    ds_read_b64_tr_b16 a[64:65], v101 offset:0
    ds_read_b64_tr_b16 a[66:67], v101 offset:2048
    ds_read_b64_tr_b16 a[68:69], v101 offset:8
    ds_read_b64_tr_b16 a[70:71], v101 offset:2056
    ds_read_b64_tr_b16 a[72:73], v101 offset:16384
    ds_read_b64_tr_b16 a[74:75], v101 offset:18432
    ds_read_b64_tr_b16 a[76:77], v101 offset:16392
    ds_read_b64_tr_b16 a[78:79], v101 offset:18440
    s_waitcnt lgkmcnt(0)
    ds_read_b64_tr_b16 a[192:193], v102 offset:0
    ds_read_b64_tr_b16 a[194:195], v102 offset:2048
    ds_read_b64_tr_b16 a[196:197], v102 offset:8
    ds_read_b64_tr_b16 a[198:199], v102 offset:2056
    ds_read_b64_tr_b16 a[200:201], v102 offset:16384
    ds_read_b64_tr_b16 a[202:203], v102 offset:18432
    ds_read_b64_tr_b16 a[204:205], v102 offset:16392
    ds_read_b64_tr_b16 a[206:207], v102 offset:18440
    s_branch L_w_75
L_w_75_1:
    s_cmp_eq_u32 s16, 1
    s_cbranch_scc0 L_w_75_2
    ds_read_b64_tr_b16 a[96:97], v101 offset:0
    ds_read_b64_tr_b16 a[98:99], v101 offset:2048
    ds_read_b64_tr_b16 a[100:101], v101 offset:8
    ds_read_b64_tr_b16 a[102:103], v101 offset:2056
    ds_read_b64_tr_b16 a[104:105], v101 offset:16384
    ds_read_b64_tr_b16 a[106:107], v101 offset:18432
    ds_read_b64_tr_b16 a[108:109], v101 offset:16392
    ds_read_b64_tr_b16 a[110:111], v101 offset:18440
    s_waitcnt lgkmcnt(0)
    ds_read_b64_tr_b16 a[224:225], v102 offset:0
    ds_read_b64_tr_b16 a[226:227], v102 offset:2048
    ds_read_b64_tr_b16 a[228:229], v102 offset:8
    ds_read_b64_tr_b16 a[230:231], v102 offset:2056
    ds_read_b64_tr_b16 a[232:233], v102 offset:16384
    ds_read_b64_tr_b16 a[234:235], v102 offset:18432
    ds_read_b64_tr_b16 a[236:237], v102 offset:16392
    ds_read_b64_tr_b16 a[238:239], v102 offset:18440
    s_branch L_w_75
L_w_75_2:
    s_cmp_eq_u32 s16, 2
    s_cbranch_scc0 L_w_75_3
    ds_read_b64_tr_b16 a[0:1], v101 offset:0
    ds_read_b64_tr_b16 a[2:3], v101 offset:2048
    ds_read_b64_tr_b16 a[4:5], v101 offset:8
    ds_read_b64_tr_b16 a[6:7], v101 offset:2056
    ds_read_b64_tr_b16 a[8:9], v101 offset:16384
    ds_read_b64_tr_b16 a[10:11], v101 offset:18432
    ds_read_b64_tr_b16 a[12:13], v101 offset:16392
    ds_read_b64_tr_b16 a[14:15], v101 offset:18440
    s_waitcnt lgkmcnt(0)
    ds_read_b64_tr_b16 a[128:129], v102 offset:0
    ds_read_b64_tr_b16 a[130:131], v102 offset:2048
    ds_read_b64_tr_b16 a[132:133], v102 offset:8
    ds_read_b64_tr_b16 a[134:135], v102 offset:2056
    ds_read_b64_tr_b16 a[136:137], v102 offset:16384
    ds_read_b64_tr_b16 a[138:139], v102 offset:18432
    ds_read_b64_tr_b16 a[140:141], v102 offset:16392
    ds_read_b64_tr_b16 a[142:143], v102 offset:18440
    s_branch L_w_75
L_w_75_3:
    ds_read_b64_tr_b16 a[32:33], v101 offset:0
    ds_read_b64_tr_b16 a[34:35], v101 offset:2048
    ds_read_b64_tr_b16 a[36:37], v101 offset:8
    ds_read_b64_tr_b16 a[38:39], v101 offset:2056
    ds_read_b64_tr_b16 a[40:41], v101 offset:16384
    ds_read_b64_tr_b16 a[42:43], v101 offset:18432
    ds_read_b64_tr_b16 a[44:45], v101 offset:16392
    ds_read_b64_tr_b16 a[46:47], v101 offset:18440
    s_waitcnt lgkmcnt(0)
    ds_read_b64_tr_b16 a[160:161], v102 offset:0
    ds_read_b64_tr_b16 a[162:163], v102 offset:2048
    ds_read_b64_tr_b16 a[164:165], v102 offset:8
    ds_read_b64_tr_b16 a[166:167], v102 offset:2056
    ds_read_b64_tr_b16 a[168:169], v102 offset:16384
    ds_read_b64_tr_b16 a[170:171], v102 offset:18432
    ds_read_b64_tr_b16 a[172:173], v102 offset:16392
    ds_read_b64_tr_b16 a[174:175], v102 offset:18440
L_w_75:
    s_waitcnt lgkmcnt(0)
    s_waitcnt vmcnt(16)
    s_barrier
    s_cmp_eq_u32 s16, 0
    s_cbranch_scc0 L_w_76_1
    ds_read_b64_tr_b16 a[80:81], v101 offset:32768
    ds_read_b64_tr_b16 a[82:83], v101 offset:34816
    ds_read_b64_tr_b16 a[84:85], v101 offset:32776
    ds_read_b64_tr_b16 a[86:87], v101 offset:34824
    ds_read_b64_tr_b16 a[88:89], v101 offset:49152
    ds_read_b64_tr_b16 a[90:91], v101 offset:51200
    ds_read_b64_tr_b16 a[92:93], v101 offset:49160
    ds_read_b64_tr_b16 a[94:95], v101 offset:51208
    s_waitcnt lgkmcnt(0)
    ds_read_b64_tr_b16 a[208:209], v102 offset:32768
    ds_read_b64_tr_b16 a[210:211], v102 offset:34816
    ds_read_b64_tr_b16 a[212:213], v102 offset:32776
    ds_read_b64_tr_b16 a[214:215], v102 offset:34824
    ds_read_b64_tr_b16 a[216:217], v102 offset:49152
    ds_read_b64_tr_b16 a[218:219], v102 offset:51200
    ds_read_b64_tr_b16 a[220:221], v102 offset:49160
    ds_read_b64_tr_b16 a[222:223], v102 offset:51208
    s_branch L_w_76
L_w_76_1:
    s_cmp_eq_u32 s16, 1
    s_cbranch_scc0 L_w_76_2
    ds_read_b64_tr_b16 a[112:113], v101 offset:32768
    ds_read_b64_tr_b16 a[114:115], v101 offset:34816
    ds_read_b64_tr_b16 a[116:117], v101 offset:32776
    ds_read_b64_tr_b16 a[118:119], v101 offset:34824
    ds_read_b64_tr_b16 a[120:121], v101 offset:49152
    ds_read_b64_tr_b16 a[122:123], v101 offset:51200
    ds_read_b64_tr_b16 a[124:125], v101 offset:49160
    ds_read_b64_tr_b16 a[126:127], v101 offset:51208
    s_waitcnt lgkmcnt(0)
    ds_read_b64_tr_b16 a[240:241], v102 offset:32768
    ds_read_b64_tr_b16 a[242:243], v102 offset:34816
    ds_read_b64_tr_b16 a[244:245], v102 offset:32776
    ds_read_b64_tr_b16 a[246:247], v102 offset:34824
    ds_read_b64_tr_b16 a[248:249], v102 offset:49152
    ds_read_b64_tr_b16 a[250:251], v102 offset:51200
    ds_read_b64_tr_b16 a[252:253], v102 offset:49160
    ds_read_b64_tr_b16 a[254:255], v102 offset:51208
    s_branch L_w_76
L_w_76_2:
    s_cmp_eq_u32 s16, 2
    s_cbranch_scc0 L_w_76_3
    ds_read_b64_tr_b16 a[16:17], v101 offset:32768
    ds_read_b64_tr_b16 a[18:19], v101 offset:34816
    ds_read_b64_tr_b16 a[20:21], v101 offset:32776
    ds_read_b64_tr_b16 a[22:23], v101 offset:34824
    ds_read_b64_tr_b16 a[24:25], v101 offset:49152
    ds_read_b64_tr_b16 a[26:27], v101 offset:51200
    ds_read_b64_tr_b16 a[28:29], v101 offset:49160
    ds_read_b64_tr_b16 a[30:31], v101 offset:51208
    s_waitcnt lgkmcnt(0)
    ds_read_b64_tr_b16 a[144:145], v102 offset:32768
    ds_read_b64_tr_b16 a[146:147], v102 offset:34816
    ds_read_b64_tr_b16 a[148:149], v102 offset:32776
    ds_read_b64_tr_b16 a[150:151], v102 offset:34824
    ds_read_b64_tr_b16 a[152:153], v102 offset:49152
    ds_read_b64_tr_b16 a[154:155], v102 offset:51200
    ds_read_b64_tr_b16 a[156:157], v102 offset:49160
    ds_read_b64_tr_b16 a[158:159], v102 offset:51208
    s_branch L_w_76
L_w_76_3:
    ds_read_b64_tr_b16 a[48:49], v101 offset:32768
    ds_read_b64_tr_b16 a[50:51], v101 offset:34816
    ds_read_b64_tr_b16 a[52:53], v101 offset:32776
    ds_read_b64_tr_b16 a[54:55], v101 offset:34824
    ds_read_b64_tr_b16 a[56:57], v101 offset:49152
    ds_read_b64_tr_b16 a[58:59], v101 offset:51200
    ds_read_b64_tr_b16 a[60:61], v101 offset:49160
    ds_read_b64_tr_b16 a[62:63], v101 offset:51208
    s_waitcnt lgkmcnt(0)
    ds_read_b64_tr_b16 a[176:177], v102 offset:32768
    ds_read_b64_tr_b16 a[178:179], v102 offset:34816
    ds_read_b64_tr_b16 a[180:181], v102 offset:32776
    ds_read_b64_tr_b16 a[182:183], v102 offset:34824
    ds_read_b64_tr_b16 a[184:185], v102 offset:49152
    ds_read_b64_tr_b16 a[186:187], v102 offset:51200
    ds_read_b64_tr_b16 a[188:189], v102 offset:49160
    ds_read_b64_tr_b16 a[190:191], v102 offset:51208
L_w_76:
    s_waitcnt lgkmcnt(0)
    s_waitcnt vmcnt(8)
    s_barrier
    v_xor_b32 v101, 0x10000, v101
    v_xor_b32 v102, 0x10000, v102
    v_xor_b32 v103, 0x10000, v103
    v_xor_b32 v104, 0x10000, v104
    s_cmp_eq_u32 s16, 0
    s_cbranch_scc0 L_w_77_1
    ds_read_b64_tr_b16 a[96:97], v101 offset:0
    ds_read_b64_tr_b16 a[98:99], v101 offset:2048
    ds_read_b64_tr_b16 a[100:101], v101 offset:8
    ds_read_b64_tr_b16 a[102:103], v101 offset:2056
    ds_read_b64_tr_b16 a[104:105], v101 offset:16384
    ds_read_b64_tr_b16 a[106:107], v101 offset:18432
    ds_read_b64_tr_b16 a[108:109], v101 offset:16392
    ds_read_b64_tr_b16 a[110:111], v101 offset:18440
    s_waitcnt lgkmcnt(0)
    ds_read_b64_tr_b16 a[224:225], v102 offset:0
    ds_read_b64_tr_b16 a[226:227], v102 offset:2048
    ds_read_b64_tr_b16 a[228:229], v102 offset:8
    ds_read_b64_tr_b16 a[230:231], v102 offset:2056
    ds_read_b64_tr_b16 a[232:233], v102 offset:16384
    ds_read_b64_tr_b16 a[234:235], v102 offset:18432
    ds_read_b64_tr_b16 a[236:237], v102 offset:16392
    ds_read_b64_tr_b16 a[238:239], v102 offset:18440
    s_branch L_w_77
L_w_77_1:
    s_cmp_eq_u32 s16, 1
    s_cbranch_scc0 L_w_77_2
    ds_read_b64_tr_b16 a[64:65], v101 offset:0
    ds_read_b64_tr_b16 a[66:67], v101 offset:2048
    ds_read_b64_tr_b16 a[68:69], v101 offset:8
    ds_read_b64_tr_b16 a[70:71], v101 offset:2056
    ds_read_b64_tr_b16 a[72:73], v101 offset:16384
    ds_read_b64_tr_b16 a[74:75], v101 offset:18432
    ds_read_b64_tr_b16 a[76:77], v101 offset:16392
    ds_read_b64_tr_b16 a[78:79], v101 offset:18440
    s_waitcnt lgkmcnt(0)
    ds_read_b64_tr_b16 a[192:193], v102 offset:0
    ds_read_b64_tr_b16 a[194:195], v102 offset:2048
    ds_read_b64_tr_b16 a[196:197], v102 offset:8
    ds_read_b64_tr_b16 a[198:199], v102 offset:2056
    ds_read_b64_tr_b16 a[200:201], v102 offset:16384
    ds_read_b64_tr_b16 a[202:203], v102 offset:18432
    ds_read_b64_tr_b16 a[204:205], v102 offset:16392
    ds_read_b64_tr_b16 a[206:207], v102 offset:18440
    s_branch L_w_77
L_w_77_2:
    s_cmp_eq_u32 s16, 2
    s_cbranch_scc0 L_w_77_3
    ds_read_b64_tr_b16 a[32:33], v101 offset:0
    ds_read_b64_tr_b16 a[34:35], v101 offset:2048
    ds_read_b64_tr_b16 a[36:37], v101 offset:8
    ds_read_b64_tr_b16 a[38:39], v101 offset:2056
    ds_read_b64_tr_b16 a[40:41], v101 offset:16384
    ds_read_b64_tr_b16 a[42:43], v101 offset:18432
    ds_read_b64_tr_b16 a[44:45], v101 offset:16392
    ds_read_b64_tr_b16 a[46:47], v101 offset:18440
    s_waitcnt lgkmcnt(0)
    ds_read_b64_tr_b16 a[160:161], v102 offset:0
    ds_read_b64_tr_b16 a[162:163], v102 offset:2048
    ds_read_b64_tr_b16 a[164:165], v102 offset:8
    ds_read_b64_tr_b16 a[166:167], v102 offset:2056
    ds_read_b64_tr_b16 a[168:169], v102 offset:16384
    ds_read_b64_tr_b16 a[170:171], v102 offset:18432
    ds_read_b64_tr_b16 a[172:173], v102 offset:16392
    ds_read_b64_tr_b16 a[174:175], v102 offset:18440
    s_branch L_w_77
L_w_77_3:
    ds_read_b64_tr_b16 a[0:1], v101 offset:0
    ds_read_b64_tr_b16 a[2:3], v101 offset:2048
    ds_read_b64_tr_b16 a[4:5], v101 offset:8
    ds_read_b64_tr_b16 a[6:7], v101 offset:2056
    ds_read_b64_tr_b16 a[8:9], v101 offset:16384
    ds_read_b64_tr_b16 a[10:11], v101 offset:18432
    ds_read_b64_tr_b16 a[12:13], v101 offset:16392
    ds_read_b64_tr_b16 a[14:15], v101 offset:18440
    s_waitcnt lgkmcnt(0)
    ds_read_b64_tr_b16 a[128:129], v102 offset:0
    ds_read_b64_tr_b16 a[130:131], v102 offset:2048
    ds_read_b64_tr_b16 a[132:133], v102 offset:8
    ds_read_b64_tr_b16 a[134:135], v102 offset:2056
    ds_read_b64_tr_b16 a[136:137], v102 offset:16384
    ds_read_b64_tr_b16 a[138:139], v102 offset:18432
    ds_read_b64_tr_b16 a[140:141], v102 offset:16392
    ds_read_b64_tr_b16 a[142:143], v102 offset:18440
L_w_77:
    s_waitcnt lgkmcnt(0)
    s_waitcnt vmcnt(0)
    s_barrier
    s_cmp_eq_u32 s16, 0
    s_cbranch_scc0 L_w_78_1
    ds_read_b64_tr_b16 a[112:113], v101 offset:32768
    ds_read_b64_tr_b16 a[114:115], v101 offset:34816
    ds_read_b64_tr_b16 a[116:117], v101 offset:32776
    ds_read_b64_tr_b16 a[118:119], v101 offset:34824
    ds_read_b64_tr_b16 a[120:121], v101 offset:49152
    ds_read_b64_tr_b16 a[122:123], v101 offset:51200
    ds_read_b64_tr_b16 a[124:125], v101 offset:49160
    ds_read_b64_tr_b16 a[126:127], v101 offset:51208
    s_waitcnt lgkmcnt(0)
    ds_read_b64_tr_b16 a[240:241], v102 offset:32768
    ds_read_b64_tr_b16 a[242:243], v102 offset:34816
    ds_read_b64_tr_b16 a[244:245], v102 offset:32776
    ds_read_b64_tr_b16 a[246:247], v102 offset:34824
    ds_read_b64_tr_b16 a[248:249], v102 offset:49152
    ds_read_b64_tr_b16 a[250:251], v102 offset:51200
    ds_read_b64_tr_b16 a[252:253], v102 offset:49160
    ds_read_b64_tr_b16 a[254:255], v102 offset:51208
    s_branch L_w_78
L_w_78_1:
    s_cmp_eq_u32 s16, 1
    s_cbranch_scc0 L_w_78_2
    ds_read_b64_tr_b16 a[80:81], v101 offset:32768
    ds_read_b64_tr_b16 a[82:83], v101 offset:34816
    ds_read_b64_tr_b16 a[84:85], v101 offset:32776
    ds_read_b64_tr_b16 a[86:87], v101 offset:34824
    ds_read_b64_tr_b16 a[88:89], v101 offset:49152
    ds_read_b64_tr_b16 a[90:91], v101 offset:51200
    ds_read_b64_tr_b16 a[92:93], v101 offset:49160
    ds_read_b64_tr_b16 a[94:95], v101 offset:51208
    s_waitcnt lgkmcnt(0)
    ds_read_b64_tr_b16 a[208:209], v102 offset:32768
    ds_read_b64_tr_b16 a[210:211], v102 offset:34816
    ds_read_b64_tr_b16 a[212:213], v102 offset:32776
    ds_read_b64_tr_b16 a[214:215], v102 offset:34824
    ds_read_b64_tr_b16 a[216:217], v102 offset:49152
    ds_read_b64_tr_b16 a[218:219], v102 offset:51200
    ds_read_b64_tr_b16 a[220:221], v102 offset:49160
    ds_read_b64_tr_b16 a[222:223], v102 offset:51208
    s_branch L_w_78
L_w_78_2:
    s_cmp_eq_u32 s16, 2
    s_cbranch_scc0 L_w_78_3
    ds_read_b64_tr_b16 a[48:49], v101 offset:32768
    ds_read_b64_tr_b16 a[50:51], v101 offset:34816
    ds_read_b64_tr_b16 a[52:53], v101 offset:32776
    ds_read_b64_tr_b16 a[54:55], v101 offset:34824
    ds_read_b64_tr_b16 a[56:57], v101 offset:49152
    ds_read_b64_tr_b16 a[58:59], v101 offset:51200
    ds_read_b64_tr_b16 a[60:61], v101 offset:49160
    ds_read_b64_tr_b16 a[62:63], v101 offset:51208
    s_waitcnt lgkmcnt(0)
    ds_read_b64_tr_b16 a[176:177], v102 offset:32768
    ds_read_b64_tr_b16 a[178:179], v102 offset:34816
    ds_read_b64_tr_b16 a[180:181], v102 offset:32776
    ds_read_b64_tr_b16 a[182:183], v102 offset:34824
    ds_read_b64_tr_b16 a[184:185], v102 offset:49152
    ds_read_b64_tr_b16 a[186:187], v102 offset:51200
    ds_read_b64_tr_b16 a[188:189], v102 offset:49160
    ds_read_b64_tr_b16 a[190:191], v102 offset:51208
    s_branch L_w_78
L_w_78_3:
    ds_read_b64_tr_b16 a[16:17], v101 offset:32768
    ds_read_b64_tr_b16 a[18:19], v101 offset:34816
    ds_read_b64_tr_b16 a[20:21], v101 offset:32776
    ds_read_b64_tr_b16 a[22:23], v101 offset:34824
    ds_read_b64_tr_b16 a[24:25], v101 offset:49152
    ds_read_b64_tr_b16 a[26:27], v101 offset:51200
    ds_read_b64_tr_b16 a[28:29], v101 offset:49160
    ds_read_b64_tr_b16 a[30:31], v101 offset:51208
    s_waitcnt lgkmcnt(0)
    ds_read_b64_tr_b16 a[144:145], v102 offset:32768
    ds_read_b64_tr_b16 a[146:147], v102 offset:34816
    ds_read_b64_tr_b16 a[148:149], v102 offset:32776
    ds_read_b64_tr_b16 a[150:151], v102 offset:34824
    ds_read_b64_tr_b16 a[152:153], v102 offset:49152
    ds_read_b64_tr_b16 a[154:155], v102 offset:51200
    ds_read_b64_tr_b16 a[156:157], v102 offset:49160
    ds_read_b64_tr_b16 a[158:159], v102 offset:51208
L_w_78:
    s_waitcnt lgkmcnt(0)
    s_cmp_eq_u32 s91, 0
    s_cbranch_scc0 L_arr_82
    s_mov_b32 s91, 1
    s_waitcnt vmcnt(0)
    s_barrier
    s_cmp_eq_u32 s16, 0
    s_cbranch_scc0 L_arr_82
    s_lshl_b32 s21, s17, 5
    s_add_u32 s21, s21, 4
    s_atomic_add s3, s[56:57], s21
L_arr_82:
    s_cmp_eq_u32 s20, 0
    s_cbranch_scc0 L_rdv_done_80
    s_mov_b32 s27, 0
    v_lshlrev_b32 v1, 2, v0
L_rdv_79:
    buffer_load_dword v2, v1, s[60:63], 0 offen sc1
    s_add_u32 s27, s27, 1
    s_cmp_gt_u32 s27, 262144
    s_cbranch_scc1 L_end
L_rdv_79_p:
    s_waitcnt vmcnt(0)
    s_mov_b32 s21, 0
    v_readlane_b32 s22, v2, 1
    s_nop 0
    s_add_u32 s21, s21, s22
    v_readlane_b32 s22, v2, 9
    s_nop 0
    s_add_u32 s21, s21, s22
    v_readlane_b32 s22, v2, 17
    s_nop 0
    s_add_u32 s21, s21, s22
    v_readlane_b32 s22, v2, 25
    s_nop 0
    s_add_u32 s21, s21, s22
    v_readlane_b32 s22, v2, 33
    s_nop 0
    s_add_u32 s21, s21, s22
    v_readlane_b32 s22, v2, 41
    s_nop 0
    s_add_u32 s21, s21, s22
    v_readlane_b32 s22, v2, 49
    s_nop 0
    s_add_u32 s21, s21, s22
    v_readlane_b32 s22, v2, 57
    s_nop 0
    s_add_u32 s21, s21, s22
    s_cmp_eq_u32 s21, 256
    s_cbranch_scc1 L_rdv_l_81
    s_sleep 4
    s_branch L_rdv_79
L_rdv_l_81:
    s_mov_b32 s21, 0
    s_mov_b32 s23, 0
    v_readlane_b32 s22, v2, 0
    s_cmp_gt_u32 s17, 0
    s_cselect_b32 s24, s22, 0
    s_add_u32 s23, s23, s24
    s_xor_b32 s22, s22, 32
    s_or_b32 s21, s21, s22
    v_readlane_b32 s22, v2, 8
    s_cmp_gt_u32 s17, 1
    s_cselect_b32 s24, s22, 0
    s_add_u32 s23, s23, s24
    s_xor_b32 s22, s22, 32
    s_or_b32 s21, s21, s22
    v_readlane_b32 s22, v2, 16
    s_cmp_gt_u32 s17, 2
    s_cselect_b32 s24, s22, 0
    s_add_u32 s23, s23, s24
    s_xor_b32 s22, s22, 32
    s_or_b32 s21, s21, s22
    v_readlane_b32 s22, v2, 24
    s_cmp_gt_u32 s17, 3
    s_cselect_b32 s24, s22, 0
    s_add_u32 s23, s23, s24
    s_xor_b32 s22, s22, 32
    s_or_b32 s21, s21, s22
    v_readlane_b32 s22, v2, 32
    s_cmp_gt_u32 s17, 4
    s_cselect_b32 s24, s22, 0
    s_add_u32 s23, s23, s24
    s_xor_b32 s22, s22, 32
    s_or_b32 s21, s21, s22
    v_readlane_b32 s22, v2, 40
    s_cmp_gt_u32 s17, 5
    s_cselect_b32 s24, s22, 0
    s_add_u32 s23, s23, s24
    s_xor_b32 s22, s22, 32
    s_or_b32 s21, s21, s22
    v_readlane_b32 s22, v2, 48
    s_cmp_gt_u32 s17, 6
    s_cselect_b32 s24, s22, 0
    s_add_u32 s23, s23, s24
    s_xor_b32 s22, s22, 32
    s_or_b32 s21, s21, s22
    v_readlane_b32 s22, v2, 56
    s_cmp_gt_u32 s17, 7
    s_cselect_b32 s24, s22, 0
    s_add_u32 s23, s23, s24
    s_xor_b32 s22, s22, 32
    s_or_b32 s21, s21, s22
    s_mov_b32 s20, 1
    s_cmp_eq_u32 s21, 0
    s_cbranch_scc1 L_rdv_done_80
    s_mov_b32 s20, 2
    s_add_u32 s19, s23, s18
    s_waitcnt vmcnt(0) lgkmcnt(0)
    s_barrier
    s_branch L_dispatch
L_rdv_done_80:
    v_lshrrev_b32 v11, 5, v0
    v_bfe_u32 v12, v0, 2, 2
    v_xor_b32 v12, v12, v11
    v_lshlrev_b32 v2, 10, v11
    v_lshl_add_u32 v2, v12, 7, v2
    v_and_b32 v11, 3, v0
    v_lshl_add_u32 v2, v11, 5, v2
    v_bfe_u32 v11, v0, 4, 1
    v_lshl_add_u32 v2, v11, 4, v2
    v_lshrrev_b32 v11, 4, v0
    v_and_b32 v12, 15, v0
    v_lshlrev_b32 v11, 9, v11
    v_lshl_add_u32 v11, v12, 4, v11
    s_xor_b32 s21, s16, 0
    s_lshl_b32 s21, s21, 13
    s_add_u32 s21, s21, 0
    v_add_u32 v236, s21, v11
    s_xor_b32 s21, s16, 1
    s_lshl_b32 s21, s21, 13
    s_add_u32 s21, s21, 0
    v_add_u32 v237, s21, v11
    s_xor_b32 s21, s16, 2
    s_lshl_b32 s21, s21, 13
    s_add_u32 s21, s21, 0
    v_add_u32 v238, s21, v11
    s_xor_b32 s21, s16, 3
    s_lshl_b32 s21, s21, 13
    s_add_u32 s21, s21, 0
    v_add_u32 v239, s21, v11
    s_and_b32 s21, s16, 1
    s_lshl_b32 s21, s21, 9
    v_xor_b32 v2, s21, v2
    v_and_b32 v12, 0x13, v0
    v_bfe_u32 v11, v0, 2, 1
    v_lshl_add_u32 v12, v11, 3, v12
    v_bfe_u32 v11, v0, 3, 1
    v_lshl_add_u32 v12, v11, 2, v12
    s_barrier
    v_lshlrev_b32 v1, 4, v0
    v_lshrrev_b32 v11, 5, v0
    v_lshlrev_b32 v3, 11, v11
    v_lshl_add_u32 v3, v12, 4, v3
    v_add_u32 v3, 16384, v3
    v_lshlrev_b32 v5, 10, v11
    v_lshl_add_u32 v5, v12, 3, v5
    v_add_u32 v5, 2048, v5
    v_and_b32 v12, 7, v0
    v_lshlrev_b32 v4, 7, v11
    v_lshl_add_u32 v4, v12, 4, v4
    v_bfe_u32 v12, v0, 3, 2
    v_lshl_add_u32 v4, v12, 8, v4
    v_and_b32 v12, 3, v0
    v_lshlrev_b32 v6, 2, v12
    v_mov_b32 v8, 1
    v_mov_b64 v[26:27], 0
    s_mov_b32 s78, 1040356334
    s_mov_b32 s79, 1040356334
    s_mov_b32 s71, 0
    s_lshl_b32 s21, s16, 13
    v_add_u32 v10, s21, v1
    v_and_b32 v12, 31, v0
    v_lshlrev_b32 v11, 2, v11
    v_sub_u32 v12, v12, v11
    v_mov_b32 v13, 0xf149f2ca
    v_cmp_gt_i32 vcc, 0, v12
    s_nop 1
    v_cndmask_b32 v36, 0, v13, vcc
    v_cmp_gt_i32 vcc, 1, v12
    s_nop 1
    v_cndmask_b32 v37, 0, v13, vcc
    v_cmp_gt_i32 vcc, 2, v12
    s_nop 1
    v_cndmask_b32 v38, 0, v13, vcc
    v_cmp_gt_i32 vcc, 3, v12
    s_nop 1
    v_cndmask_b32 v39, 0, v13, vcc
    v_cmp_gt_i32 vcc, 8, v12
    s_nop 1
    v_cndmask_b32 v40, 0, v13, vcc
    v_cmp_gt_i32 vcc, 9, v12
    s_nop 1
    v_cndmask_b32 v41, 0, v13, vcc
    v_cmp_gt_i32 vcc, 10, v12
    s_nop 1
    v_cndmask_b32 v42, 0, v13, vcc
    v_cmp_gt_i32 vcc, 11, v12
    s_nop 1
    v_cndmask_b32 v43, 0, v13, vcc
    v_cmp_gt_i32 vcc, 16, v12
    s_nop 1
    v_cndmask_b32 v44, 0, v13, vcc
    v_cmp_gt_i32 vcc, 17, v12
    s_nop 1
    v_cndmask_b32 v45, 0, v13, vcc
    v_cmp_gt_i32 vcc, 18, v12
    s_nop 1
    v_cndmask_b32 v46, 0, v13, vcc
    v_cmp_gt_i32 vcc, 19, v12
    s_nop 1
    v_cndmask_b32 v47, 0, v13, vcc
    v_cmp_gt_i32 vcc, 24, v12
    s_nop 1
    v_cndmask_b32 v48, 0, v13, vcc
    v_cmp_gt_i32 vcc, 25, v12
    s_nop 1
    v_cndmask_b32 v49, 0, v13, vcc
    v_cmp_gt_i32 vcc, 26, v12
    s_nop 1
    v_cndmask_b32 v50, 0, v13, vcc
    v_cmp_gt_i32 vcc, 27, v12
    s_nop 1
    v_cndmask_b32 v51, 0, v13, vcc
    v_mov_b64 v[54:55], 0
    v_mov_b64 v[58:59], 0
    v_mov_b64 v[62:63], 0
    v_mov_b64 v[66:67], 0
    s_mul_i32 s70, s66, 24576
    s_add_u32 s70, s70, 127926272
    s_lshl_b32 s83, s64, 15
    s_lshl_b32 s21, s65, 14
    s_add_u32 s83, s83, s21
    s_lshl_b32 s21, s16, 12
    s_add_u32 s83, s83, s21
    s_add_u32 s83, s83, 35651584
    s_lshl_b32 s84, s64, 8
    s_lshl_b32 s21, s65, 7
    s_add_u32 s84, s84, s21
    s_lshl_b32 s21, s16, 2
    s_add_u32 s84, s84, s21
    s_lshl_b32 s87, s66, 7
    s_add_u32 s87, s87, 6144
    s_add_u32 s84, s84, 2048
    s_lshl_b32 s85, s66, 12
    s_add_u32 s85, s85, 18874368
    s_mov_b32 s77, 0
    s_sub_u32 s21, s67, 16
    s_lshr_b32 s22, s21, 1
    s_add_u32 s23, s22, 64
    s_add_u32 s22, s22, 16
    s_bitcmp1_b32 s21, 0
    s_cselect_b32 s69, s23, s22
    s_cmp_lt_u32 s67, 16
    s_cselect_b32 s69, s67, s69
    s_cmp_ge_u32 s67, 112
    s_cselect_b32 s69, s67, s69
    s_lshl_b32 s75, s69, 14
    s_add_u32 s75, s75, s87
    s_cmp_lt_u32 s67, 128
    s_cselect_b32 s75, s75, 14336
    s_mul_i32 s76, s69, 786432
    s_add_u32 s76, s76, s70
    s_add_u32 s80, s76, 4096
    s_add_u32 s81, s76, 8192
    s_add_u32 s82, s76, 12288
L_ao_block:
    s_mov_b32 s27, 0
L_poll_83:
    buffer_load_dword v7, v6, s[4:7], s75 offen sc1
    s_add_u32 s27, s27, 1
    s_cmp_gt_u32 s27, 262144
    s_cbranch_scc1 L_end
    s_waitcnt vmcnt(0)
    v_cmp_gt_u32 vcc, 1, v7
    s_cbranch_vccz L_poll_83_ok
    s_sleep 4
    s_branch L_poll_83
L_poll_83_ok:
    buffer_load_dwordx4 v[100:103], v1, s[4:7], s81 offen offset:0 sc1
    buffer_load_dwordx4 v[68:71], v1, s[4:7], s76 offen offset:0 sc1
    buffer_load_dwordx4 v[104:107], v1, s[4:7], s81 offen offset:1024 sc1
    buffer_load_dwordx4 v[72:75], v1, s[4:7], s76 offen offset:1024 sc1
    buffer_load_dwordx4 v[108:111], v1, s[4:7], s81 offen offset:2048 sc1
    buffer_load_dwordx4 v[76:79], v1, s[4:7], s76 offen offset:2048 sc1
    buffer_load_dwordx4 v[112:115], v1, s[4:7], s81 offen offset:3072 sc1
    buffer_load_dwordx4 v[80:83], v1, s[4:7], s76 offen offset:3072 sc1
    buffer_load_dwordx4 v[116:119], v1, s[4:7], s82 offen offset:0 sc1
    buffer_load_dwordx4 v[84:87], v1, s[4:7], s80 offen offset:0 sc1
    buffer_load_dwordx4 v[120:123], v1, s[4:7], s82 offen offset:1024 sc1
    buffer_load_dwordx4 v[88:91], v1, s[4:7], s80 offen offset:1024 sc1
    buffer_load_dwordx4 v[124:127], v1, s[4:7], s82 offen offset:2048 sc1
    buffer_load_dwordx4 v[92:95], v1, s[4:7], s80 offen offset:2048 sc1
    buffer_load_dwordx4 v[128:131], v1, s[4:7], s82 offen offset:3072 sc1
    buffer_load_dwordx4 v[96:99], v1, s[4:7], s80 offen offset:3072 sc1
    s_add_u32 s21, s75, 4096
    buffer_load_dword v22, off, s[4:7], s21 sc1
    s_waitcnt vmcnt(0)
L_ao_top1:
    s_mov_b32 s68, s69
    s_add_u32 s72, s75, 4096
    s_lshl_b32 s73, s68, 17
    s_add_u32 s73, s73, s85
    v_cmp_gt_u32 vcc, 4, v22
    s_cbranch_vccnz L_ao_top1_n
    buffer_load_dwordx4 v[228:231], v4, s[4:7], s73 offen offset:0 sc1
    buffer_load_dwordx4 v[232:235], v4, s[4:7], s73 offen offset:1024 sc1
    buffer_load_dwordx2 v[52:53], v5, s[4:7], s73 offen offset:0 sc1
    buffer_load_dwordx2 v[56:57], v5, s[4:7], s73 offen offset:256 sc1
    buffer_load_dwordx2 v[60:61], v5, s[4:7], s73 offen offset:512 sc1
    buffer_load_dwordx2 v[64:65], v5, s[4:7], s73 offen offset:768 sc1
    v_mfma_f32_32x32x16_bf16 v[196:211], v[100:103], v[68:71], v[36:51]
    buffer_load_dwordx4 v[132:135], v3, s[4:7], s76 offen offset:0 sc1
    v_mfma_f32_32x32x16_bf16 v[196:211], v[104:107], v[72:75], v[196:211]
    buffer_load_dwordx4 v[136:139], v3, s[4:7], s80 offen offset:0 sc1
    v_mfma_f32_32x32x16_bf16 v[196:211], v[108:111], v[76:79], v[196:211]
    buffer_load_dwordx4 v[140:143], v3, s[4:7], s76 offen offset:512 sc1
    v_mfma_f32_32x32x16_bf16 v[196:211], v[112:115], v[80:83], v[196:211]
    buffer_load_dwordx4 v[144:147], v3, s[4:7], s80 offen offset:512 sc1
    v_mfma_f32_32x32x16_bf16 v[196:211], v[116:119], v[84:87], v[196:211]
    buffer_load_dwordx4 v[148:151], v3, s[4:7], s76 offen offset:1024 sc1
    v_mfma_f32_32x32x16_bf16 v[196:211], v[120:123], v[88:91], v[196:211]
    buffer_load_dwordx4 v[152:155], v3, s[4:7], s80 offen offset:1024 sc1
    v_mfma_f32_32x32x16_bf16 v[196:211], v[124:127], v[92:95], v[196:211]
    buffer_load_dwordx4 v[156:159], v3, s[4:7], s76 offen offset:1536 sc1
    v_mfma_f32_32x32x16_bf16 v[196:211], v[128:131], v[96:99], v[196:211]
    buffer_load_dwordx4 v[160:163], v3, s[4:7], s80 offen offset:1536 sc1
    s_add_u32 s67, s67, 3
    s_mov_b32 s86, 1
    s_sub_u32 s21, s67, 16
    s_lshr_b32 s22, s21, 1
    s_add_u32 s23, s22, 64
    s_add_u32 s22, s22, 16
    s_bitcmp1_b32 s21, 0
    s_cselect_b32 s69, s23, s22
    s_cmp_lt_u32 s67, 16
    s_cselect_b32 s69, s67, s69
    s_cmp_ge_u32 s67, 112
    s_cselect_b32 s69, s67, s69
    s_lshl_b32 s75, s69, 14
    s_add_u32 s75, s75, s87
    s_cmp_lt_u32 s67, 128
    s_cselect_b32 s75, s75, 14336
    s_mul_i32 s76, s69, 786432
    s_add_u32 s76, s76, s70
    s_add_u32 s80, s76, 4096
    s_add_u32 s81, s76, 8192
    s_add_u32 s82, s76, 12288
    v_max3_f32 v12, v196, v197, v198
    v_max3_f32 v14, v199, v200, v201
    v_max3_f32 v12, v12, v202, v203
    v_max3_f32 v14, v14, v204, v205
    v_max3_f32 v12, v12, v206, v207
    v_max3_f32 v14, v14, v208, v209
    v_max3_f32 v12, v12, v210, v211
    v_max_f32 v12, v12, v14
    v_mov_b32 v14, v12
    s_nop 1
    v_permlane32_swap_b32 v14, v12
    v_max_f32 v12, v12, v14
    v_mul_f32 v12, s78, v12
    v_pk_fma_f32 v[196:197], v[196:197], s[78:79], v[12:13] op_sel_hi:[1,1,0] neg_lo:[0,0,1] neg_hi:[0,0,1]
    v_pk_fma_f32 v[198:199], v[198:199], s[78:79], v[12:13] op_sel_hi:[1,1,0] neg_lo:[0,0,1] neg_hi:[0,0,1]
    v_pk_fma_f32 v[200:201], v[200:201], s[78:79], v[12:13] op_sel_hi:[1,1,0] neg_lo:[0,0,1] neg_hi:[0,0,1]
    v_pk_fma_f32 v[202:203], v[202:203], s[78:79], v[12:13] op_sel_hi:[1,1,0] neg_lo:[0,0,1] neg_hi:[0,0,1]
    v_pk_fma_f32 v[204:205], v[204:205], s[78:79], v[12:13] op_sel_hi:[1,1,0] neg_lo:[0,0,1] neg_hi:[0,0,1]
    v_pk_fma_f32 v[206:207], v[206:207], s[78:79], v[12:13] op_sel_hi:[1,1,0] neg_lo:[0,0,1] neg_hi:[0,0,1]
    v_pk_fma_f32 v[208:209], v[208:209], s[78:79], v[12:13] op_sel_hi:[1,1,0] neg_lo:[0,0,1] neg_hi:[0,0,1]
    v_pk_fma_f32 v[210:211], v[210:211], s[78:79], v[12:13] op_sel_hi:[1,1,0] neg_lo:[0,0,1] neg_hi:[0,0,1]
    v_exp_f32 v196, v196
    v_exp_f32 v197, v197
    v_exp_f32 v198, v198
    v_exp_f32 v199, v199
    v_exp_f32 v200, v200
    v_exp_f32 v201, v201
    v_exp_f32 v202, v202
    v_exp_f32 v203, v203
    s_cmp_eq_u32 s77, 0
    s_cbranch_scc1 L_df1
    s_waitcnt vmcnt(14)
    s_mov_b64 exec, 1
    buffer_store_dword v8, off, s[4:7], s77 sc1
    s_mov_b64 exec, -1
L_df1:
    s_branch L_ao_exp
L_ao_top1_n:
    v_mfma_f32_32x32x16_bf16 v[196:211], v[100:103], v[68:71], v[36:51]
    buffer_load_dwordx4 v[132:135], v3, s[4:7], s76 offen offset:0 sc1
    v_mfma_f32_32x32x16_bf16 v[196:211], v[104:107], v[72:75], v[196:211]
    buffer_load_dwordx4 v[136:139], v3, s[4:7], s80 offen offset:0 sc1
    v_mfma_f32_32x32x16_bf16 v[196:211], v[108:111], v[76:79], v[196:211]
    buffer_load_dwordx4 v[140:143], v3, s[4:7], s76 offen offset:512 sc1
    v_mfma_f32_32x32x16_bf16 v[196:211], v[112:115], v[80:83], v[196:211]
    buffer_load_dwordx4 v[144:147], v3, s[4:7], s80 offen offset:512 sc1
    v_mfma_f32_32x32x16_bf16 v[196:211], v[116:119], v[84:87], v[196:211]
    buffer_load_dwordx4 v[148:151], v3, s[4:7], s76 offen offset:1024 sc1
    v_mfma_f32_32x32x16_bf16 v[196:211], v[120:123], v[88:91], v[196:211]
    buffer_load_dwordx4 v[152:155], v3, s[4:7], s80 offen offset:1024 sc1
    v_mfma_f32_32x32x16_bf16 v[196:211], v[124:127], v[92:95], v[196:211]
    buffer_load_dwordx4 v[156:159], v3, s[4:7], s76 offen offset:1536 sc1
    v_mfma_f32_32x32x16_bf16 v[196:211], v[128:131], v[96:99], v[196:211]
    buffer_load_dwordx4 v[160:163], v3, s[4:7], s80 offen offset:1536 sc1
    s_add_u32 s67, s67, 3
    s_mov_b32 s86, 0
    s_sub_u32 s21, s67, 16
    s_lshr_b32 s22, s21, 1
    s_add_u32 s23, s22, 64
    s_add_u32 s22, s22, 16
    s_bitcmp1_b32 s21, 0
    s_cselect_b32 s69, s23, s22
    s_cmp_lt_u32 s67, 16
    s_cselect_b32 s69, s67, s69
    s_cmp_ge_u32 s67, 112
    s_cselect_b32 s69, s67, s69
    s_lshl_b32 s75, s69, 14
    s_add_u32 s75, s75, s87
    s_cmp_lt_u32 s67, 128
    s_cselect_b32 s75, s75, 14336
    s_mul_i32 s76, s69, 786432
    s_add_u32 s76, s76, s70
    s_add_u32 s80, s76, 4096
    s_add_u32 s81, s76, 8192
    s_add_u32 s82, s76, 12288
    v_max3_f32 v12, v196, v197, v198
    v_max3_f32 v14, v199, v200, v201
    v_max3_f32 v12, v12, v202, v203
    v_max3_f32 v14, v14, v204, v205
    v_max3_f32 v12, v12, v206, v207
    v_max3_f32 v14, v14, v208, v209
    v_max3_f32 v12, v12, v210, v211
    v_max_f32 v12, v12, v14
    v_mov_b32 v14, v12
    s_nop 1
    v_permlane32_swap_b32 v14, v12
    v_max_f32 v12, v12, v14
    v_mul_f32 v12, s78, v12
    v_pk_fma_f32 v[196:197], v[196:197], s[78:79], v[12:13] op_sel_hi:[1,1,0] neg_lo:[0,0,1] neg_hi:[0,0,1]
    v_pk_fma_f32 v[198:199], v[198:199], s[78:79], v[12:13] op_sel_hi:[1,1,0] neg_lo:[0,0,1] neg_hi:[0,0,1]
    v_pk_fma_f32 v[200:201], v[200:201], s[78:79], v[12:13] op_sel_hi:[1,1,0] neg_lo:[0,0,1] neg_hi:[0,0,1]
    v_pk_fma_f32 v[202:203], v[202:203], s[78:79], v[12:13] op_sel_hi:[1,1,0] neg_lo:[0,0,1] neg_hi:[0,0,1]
    v_pk_fma_f32 v[204:205], v[204:205], s[78:79], v[12:13] op_sel_hi:[1,1,0] neg_lo:[0,0,1] neg_hi:[0,0,1]
    v_pk_fma_f32 v[206:207], v[206:207], s[78:79], v[12:13] op_sel_hi:[1,1,0] neg_lo:[0,0,1] neg_hi:[0,0,1]
    v_pk_fma_f32 v[208:209], v[208:209], s[78:79], v[12:13] op_sel_hi:[1,1,0] neg_lo:[0,0,1] neg_hi:[0,0,1]
    v_pk_fma_f32 v[210:211], v[210:211], s[78:79], v[12:13] op_sel_hi:[1,1,0] neg_lo:[0,0,1] neg_hi:[0,0,1]
    v_exp_f32 v196, v196
    v_exp_f32 v197, v197
    v_exp_f32 v198, v198
    v_exp_f32 v199, v199
    v_exp_f32 v200, v200
    v_exp_f32 v201, v201
    v_exp_f32 v202, v202
    v_exp_f32 v203, v203
    s_cmp_eq_u32 s77, 0
    s_cbranch_scc1 L_df2
    s_waitcnt vmcnt(8)
    s_mov_b64 exec, 1
    buffer_store_dword v8, off, s[4:7], s77 sc1
    s_mov_b64 exec, -1
L_df2:
    s_branch L_ao_exp
L_ao_top0:
    s_mov_b32 s68, s69
    s_add_u32 s72, s75, 4096
    s_lshl_b32 s73, s68, 17
    s_add_u32 s73, s73, s85
    v_cmp_gt_u32 vcc, 4, v22
    s_cbranch_vccnz L_ao_top0_n
    v_mfma_f32_32x32x16_bf16 v[196:211], v[100:103], v[68:71], v[36:51]
    buffer_load_dwordx4 v[228:231], v4, s[4:7], s73 offen offset:0 sc1
    v_mfma_f32_32x32x16_bf16 v[196:211], v[104:107], v[72:75], v[196:211]
    buffer_load_dwordx4 v[232:235], v4, s[4:7], s73 offen offset:1024 sc1
    v_mfma_f32_32x32x16_bf16 v[196:211], v[108:111], v[76:79], v[196:211]
    buffer_load_dwordx2 v[52:53], v5, s[4:7], s73 offen offset:0 sc1
    v_mfma_f32_32x32x16_bf16 v[196:211], v[112:115], v[80:83], v[196:211]
    buffer_load_dwordx2 v[56:57], v5, s[4:7], s73 offen offset:256 sc1
    v_mfma_f32_32x32x16_bf16 v[196:211], v[116:119], v[84:87], v[196:211]
    buffer_load_dwordx2 v[60:61], v5, s[4:7], s73 offen offset:512 sc1
    v_mfma_f32_32x32x16_bf16 v[196:211], v[120:123], v[88:91], v[196:211]
    buffer_load_dwordx2 v[64:65], v5, s[4:7], s73 offen offset:768 sc1
    v_mfma_f32_32x32x16_bf16 v[196:211], v[124:127], v[92:95], v[196:211]
    v_mfma_f32_32x32x16_bf16 v[196:211], v[128:131], v[96:99], v[196:211]
    s_add_u32 s67, s67, 3
    s_mov_b32 s86, 1
    s_sub_u32 s21, s67, 16
    s_lshr_b32 s22, s21, 1
    s_add_u32 s23, s22, 64
    s_add_u32 s22, s22, 16
    s_bitcmp1_b32 s21, 0
    s_cselect_b32 s69, s23, s22
    s_cmp_lt_u32 s67, 16
    s_cselect_b32 s69, s67, s69
    s_cmp_ge_u32 s67, 112
    s_cselect_b32 s69, s67, s69
    s_lshl_b32 s75, s69, 14
    s_add_u32 s75, s75, s87
    s_cmp_lt_u32 s67, 128
    s_cselect_b32 s75, s75, 14336
    s_mul_i32 s76, s69, 786432
    s_add_u32 s76, s76, s70
    s_add_u32 s80, s76, 4096
    s_add_u32 s81, s76, 8192
    s_add_u32 s82, s76, 12288
    v_max3_f32 v12, v196, v197, v198
    v_max3_f32 v14, v199, v200, v201
    v_max3_f32 v12, v12, v202, v203
    v_max3_f32 v14, v14, v204, v205
    v_max3_f32 v12, v12, v206, v207
    v_max3_f32 v14, v14, v208, v209
    v_max3_f32 v12, v12, v210, v211
    v_max_f32 v12, v12, v14
    v_mov_b32 v14, v12
    s_nop 1
    v_permlane32_swap_b32 v14, v12
    v_max_f32 v12, v12, v14
    v_mul_f32 v12, s78, v12
    v_pk_fma_f32 v[196:197], v[196:197], s[78:79], v[12:13] op_sel_hi:[1,1,0] neg_lo:[0,0,1] neg_hi:[0,0,1]
    v_pk_fma_f32 v[198:199], v[198:199], s[78:79], v[12:13] op_sel_hi:[1,1,0] neg_lo:[0,0,1] neg_hi:[0,0,1]
    v_pk_fma_f32 v[200:201], v[200:201], s[78:79], v[12:13] op_sel_hi:[1,1,0] neg_lo:[0,0,1] neg_hi:[0,0,1]
    v_pk_fma_f32 v[202:203], v[202:203], s[78:79], v[12:13] op_sel_hi:[1,1,0] neg_lo:[0,0,1] neg_hi:[0,0,1]
    v_pk_fma_f32 v[204:205], v[204:205], s[78:79], v[12:13] op_sel_hi:[1,1,0] neg_lo:[0,0,1] neg_hi:[0,0,1]
    v_pk_fma_f32 v[206:207], v[206:207], s[78:79], v[12:13] op_sel_hi:[1,1,0] neg_lo:[0,0,1] neg_hi:[0,0,1]
    v_pk_fma_f32 v[208:209], v[208:209], s[78:79], v[12:13] op_sel_hi:[1,1,0] neg_lo:[0,0,1] neg_hi:[0,0,1]
    v_pk_fma_f32 v[210:211], v[210:211], s[78:79], v[12:13] op_sel_hi:[1,1,0] neg_lo:[0,0,1] neg_hi:[0,0,1]
    v_exp_f32 v196, v196
    v_exp_f32 v197, v197
    v_exp_f32 v198, v198
    v_exp_f32 v199, v199
    v_exp_f32 v200, v200
    v_exp_f32 v201, v201
    v_exp_f32 v202, v202
    v_exp_f32 v203, v203
    s_cmp_eq_u32 s77, 0
    s_cbranch_scc1 L_df3
    s_waitcnt vmcnt(6)
    s_mov_b64 exec, 1
    buffer_store_dword v8, off, s[4:7], s77 sc1
    s_mov_b64 exec, -1
L_df3:
    s_branch L_ao_exp
L_ao_top0_n:
    v_mfma_f32_32x32x16_bf16 v[196:211], v[100:103], v[68:71], v[36:51]
    v_mfma_f32_32x32x16_bf16 v[196:211], v[104:107], v[72:75], v[196:211]
    v_mfma_f32_32x32x16_bf16 v[196:211], v[108:111], v[76:79], v[196:211]
    v_mfma_f32_32x32x16_bf16 v[196:211], v[112:115], v[80:83], v[196:211]
    v_mfma_f32_32x32x16_bf16 v[196:211], v[116:119], v[84:87], v[196:211]
    v_mfma_f32_32x32x16_bf16 v[196:211], v[120:123], v[88:91], v[196:211]
    v_mfma_f32_32x32x16_bf16 v[196:211], v[124:127], v[92:95], v[196:211]
    v_mfma_f32_32x32x16_bf16 v[196:211], v[128:131], v[96:99], v[196:211]
    s_add_u32 s67, s67, 3
    s_mov_b32 s86, 0
    s_sub_u32 s21, s67, 16
    s_lshr_b32 s22, s21, 1
    s_add_u32 s23, s22, 64
    s_add_u32 s22, s22, 16
    s_bitcmp1_b32 s21, 0
    s_cselect_b32 s69, s23, s22
    s_cmp_lt_u32 s67, 16
    s_cselect_b32 s69, s67, s69
    s_cmp_ge_u32 s67, 112
    s_cselect_b32 s69, s67, s69
    s_lshl_b32 s75, s69, 14
    s_add_u32 s75, s75, s87
    s_cmp_lt_u32 s67, 128
    s_cselect_b32 s75, s75, 14336
    s_mul_i32 s76, s69, 786432
    s_add_u32 s76, s76, s70
    s_add_u32 s80, s76, 4096
    s_add_u32 s81, s76, 8192
    s_add_u32 s82, s76, 12288
    v_max3_f32 v12, v196, v197, v198
    v_max3_f32 v14, v199, v200, v201
    v_max3_f32 v12, v12, v202, v203
    v_max3_f32 v14, v14, v204, v205
    v_max3_f32 v12, v12, v206, v207
    v_max3_f32 v14, v14, v208, v209
    v_max3_f32 v12, v12, v210, v211
    v_max_f32 v12, v12, v14
    v_mov_b32 v14, v12
    s_nop 1
    v_permlane32_swap_b32 v14, v12
    v_max_f32 v12, v12, v14
    v_mul_f32 v12, s78, v12
    v_pk_fma_f32 v[196:197], v[196:197], s[78:79], v[12:13] op_sel_hi:[1,1,0] neg_lo:[0,0,1] neg_hi:[0,0,1]
    v_pk_fma_f32 v[198:199], v[198:199], s[78:79], v[12:13] op_sel_hi:[1,1,0] neg_lo:[0,0,1] neg_hi:[0,0,1]
    v_pk_fma_f32 v[200:201], v[200:201], s[78:79], v[12:13] op_sel_hi:[1,1,0] neg_lo:[0,0,1] neg_hi:[0,0,1]
    v_pk_fma_f32 v[202:203], v[202:203], s[78:79], v[12:13] op_sel_hi:[1,1,0] neg_lo:[0,0,1] neg_hi:[0,0,1]
    v_pk_fma_f32 v[204:205], v[204:205], s[78:79], v[12:13] op_sel_hi:[1,1,0] neg_lo:[0,0,1] neg_hi:[0,0,1]
    v_pk_fma_f32 v[206:207], v[206:207], s[78:79], v[12:13] op_sel_hi:[1,1,0] neg_lo:[0,0,1] neg_hi:[0,0,1]
    v_pk_fma_f32 v[208:209], v[208:209], s[78:79], v[12:13] op_sel_hi:[1,1,0] neg_lo:[0,0,1] neg_hi:[0,0,1]
    v_pk_fma_f32 v[210:211], v[210:211], s[78:79], v[12:13] op_sel_hi:[1,1,0] neg_lo:[0,0,1] neg_hi:[0,0,1]
    v_exp_f32 v196, v196
    v_exp_f32 v197, v197
    v_exp_f32 v198, v198
    v_exp_f32 v199, v199
    v_exp_f32 v200, v200
    v_exp_f32 v201, v201
    v_exp_f32 v202, v202
    v_exp_f32 v203, v203
    s_cmp_eq_u32 s77, 0
    s_cbranch_scc1 L_df4
    s_waitcnt vmcnt(0)
    s_mov_b64 exec, 1
    buffer_store_dword v8, off, s[4:7], s77 sc1
    s_mov_b64 exec, -1
L_df4:
L_ao_exp:
    buffer_load_dword v7, v6, s[4:7], s75 offen sc1
    v_exp_f32 v204, v204
    v_exp_f32 v205, v205
    v_exp_f32 v206, v206
    v_exp_f32 v207, v207
    v_exp_f32 v208, v208
    v_exp_f32 v209, v209
    v_exp_f32 v210, v210
    v_exp_f32 v211, v211
    v_pk_add_f32 v[16:17], v[196:197], v[198:199]
    v_pk_add_f32 v[16:17], v[16:17], v[200:201]
    v_pk_add_f32 v[16:17], v[16:17], v[202:203]
    v_pk_add_f32 v[16:17], v[16:17], v[204:205]
    v_pk_add_f32 v[16:17], v[16:17], v[206:207]
    v_pk_add_f32 v[16:17], v[16:17], v[208:209]
    v_pk_add_f32 v[16:17], v[16:17], v[210:211]
    v_add_f32 v15, v16, v17
    s_cmp_eq_u32 s86, 1
    s_cbranch_scc1 L_ao_got
    s_mov_b32 s27, 0
L_poll_84:
    buffer_load_dword v22, off, s[4:7], s72 sc1
    s_add_u32 s27, s27, 1
    s_cmp_gt_u32 s27, 262144
    s_cbranch_scc1 L_end
    s_waitcnt vmcnt(0)
    v_cmp_gt_u32 vcc, 4, v22
    s_cbranch_vccz L_poll_84_ok
    s_sleep 4
    s_branch L_poll_84
L_poll_84_ok:
    buffer_load_dwordx4 v[228:231], v4, s[4:7], s73 offen offset:0 sc1
    buffer_load_dwordx4 v[232:235], v4, s[4:7], s73 offen offset:1024 sc1
    buffer_load_dwordx2 v[52:53], v5, s[4:7], s73 offen offset:0 sc1
    buffer_load_dwordx2 v[56:57], v5, s[4:7], s73 offen offset:256 sc1
    buffer_load_dwordx2 v[60:61], v5, s[4:7], s73 offen offset:512 sc1
    buffer_load_dwordx2 v[64:65], v5, s[4:7], s73 offen offset:768 sc1
L_ao_got:
    s_waitcnt vmcnt(5)
    v_mfma_f32_32x32x16_bf16 v[164:179], v[228:231], v[68:71], 0
    v_mfma_f32_32x32x16_bf16 v[180:195], v[228:231], v[72:75], 0
    v_mfma_f32_32x32x16_bf16 v[100:115], v[228:231], v[76:79], 0
    v_mfma_f32_32x32x16_bf16 v[212:227], v[228:231], v[80:83], 0
    s_waitcnt vmcnt(4)
    v_mfma_f32_32x32x16_bf16 v[164:179], v[232:235], v[84:87], v[164:179]
    v_mfma_f32_32x32x16_bf16 v[180:195], v[232:235], v[88:91], v[180:195]
    v_mfma_f32_32x32x16_bf16 v[100:115], v[232:235], v[92:95], v[100:115]
    v_mfma_f32_32x32x16_bf16 v[212:227], v[232:235], v[96:99], v[212:227]
    s_lshl_b32 s72, s68, 18
    s_add_u32 s72, s72, s83
    s_lshl_b32 s77, s68, 14
    s_add_u32 s77, s77, s84
    v_add_u32 v9, s71, v10
    s_nop 4
    v_pk_add_f32 v[164:165], v[164:165], v[184:185]
    v_pk_add_f32 v[166:167], v[166:167], v[186:187]
    v_pk_add_f32 v[164:165], v[164:165], v[108:109]
    v_pk_add_f32 v[166:167], v[166:167], v[110:111]
    v_pk_add_f32 v[212:213], v[164:165], v[224:225]
    v_pk_add_f32 v[214:215], v[166:167], v[226:227]
    v_max3_f32 v20, v212, v213, v214
    v_max_f32 v20, v20, v215
    v_mov_b32 v14, v20
    s_nop 1
    v_permlane32_swap_b32 v14, v20
    v_max_f32 v20, v20, v14
    v_mul_f32 v20, s78, v20
    v_max_f32 v20, v20, v12
    v_sub_f32 v16, v12, v20
    v_pk_fma_f32 v[212:213], v[212:213], s[78:79], v[20:21] op_sel_hi:[1,1,0] neg_lo:[0,0,1] neg_hi:[0,0,1]
    v_pk_fma_f32 v[214:215], v[214:215], s[78:79], v[20:21] op_sel_hi:[1,1,0] neg_lo:[0,0,1] neg_hi:[0,0,1]
    v_exp_f32 v16, v16
    v_exp_f32 v212, v212
    v_exp_f32 v213, v213
    v_exp_f32 v214, v214
    v_exp_f32 v215, v215
    v_add_f32 v14, v212, v213
    v_fmac_f32 v14, v15, v16
    v_add_f32 v15, v214, v215
    v_add_f32 v15, v15, v14
    v_mov_b32 v14, v15
    s_nop 1
    v_permlane32_swap_b32 v14, v15
    v_add_f32 v15, v15, v14
    v_rcp_f32 v18, v15
    s_nop 0
    v_mul_f32 v16, v16, v18
    v_pk_mul_f32 v[196:197], v[196:197], v[16:17] op_sel_hi:[1,0]
    v_pk_mul_f32 v[198:199], v[198:199], v[16:17] op_sel_hi:[1,0]
    v_pk_mul_f32 v[200:201], v[200:201], v[16:17] op_sel_hi:[1,0]
    v_pk_mul_f32 v[202:203], v[202:203], v[16:17] op_sel_hi:[1,0]
    v_pk_mul_f32 v[204:205], v[204:205], v[16:17] op_sel_hi:[1,0]
    v_pk_mul_f32 v[206:207], v[206:207], v[16:17] op_sel_hi:[1,0]
    v_pk_mul_f32 v[208:209], v[208:209], v[16:17] op_sel_hi:[1,0]
    v_pk_mul_f32 v[210:211], v[210:211], v[16:17] op_sel_hi:[1,0]
    v_cvt_pk_bf16_f32 v28, v196, v197
    v_cvt_pk_bf16_f32 v29, v198, v199
    v_cvt_pk_bf16_f32 v30, v200, v201
    v_cvt_pk_bf16_f32 v31, v202, v203
    v_cvt_pk_bf16_f32 v32, v204, v205
    v_cvt_pk_bf16_f32 v33, v206, v207
    v_cvt_pk_bf16_f32 v34, v208, v209
    v_cvt_pk_bf16_f32 v35, v210, v211
    v_pk_mul_f32 v[212:213], v[212:213], v[18:19] op_sel_hi:[1,0]
    v_pk_mul_f32 v[214:215], v[214:215], v[18:19] op_sel_hi:[1,0]
    v_cvt_pk_bf16_f32 v24, v212, v213
    v_cvt_pk_bf16_f32 v25, v214, v215
    s_waitcnt vmcnt(0)
    v_cmp_gt_u32 vcc, 1, v7
    s_cbranch_vccnz L_ao_pvn
    v_mfma_f32_32x32x16_bf16 v[164:179], v[132:135], v[28:31], 0
    buffer_load_dwordx4 v[100:103], v1, s[4:7], s81 offen offset:0 sc1
    v_mfma_f32_32x32x16_bf16 v[164:179], v[136:139], v[32:35], v[164:179]
    v_mfma_f32_32x32x16_bf16 v[164:179], v[52:55], v[24:27], v[164:179]
    buffer_load_dwordx4 v[68:71], v1, s[4:7], s76 offen offset:0 sc1
    v_mfma_f32_32x32x16_bf16 v[180:195], v[140:143], v[28:31], 0
    s_nop 3
    v_mfma_f32_32x32x16_bf16 v[180:195], v[144:147], v[32:35], v[180:195]
    buffer_load_dwordx4 v[104:107], v1, s[4:7], s81 offen offset:1024 sc1
    s_nop 3
    v_mfma_f32_32x32x16_bf16 v[180:195], v[56:59], v[24:27], v[180:195]
    v_cvt_pk_bf16_f32 v164, v164, v165
    v_cvt_pk_bf16_f32 v165, v166, v167
    v_cvt_pk_bf16_f32 v166, v168, v169
    v_cvt_pk_bf16_f32 v167, v170, v171
    v_mfma_f32_32x32x16_bf16 v[196:211], v[148:151], v[28:31], 0
    buffer_load_dwordx4 v[72:75], v1, s[4:7], s76 offen offset:1024 sc1
    v_cvt_pk_bf16_f32 v168, v172, v173
    v_cvt_pk_bf16_f32 v169, v174, v175
    v_cvt_pk_bf16_f32 v170, v176, v177
    v_cvt_pk_bf16_f32 v171, v178, v179
    v_mfma_f32_32x32x16_bf16 v[196:211], v[152:155], v[32:35], v[196:211]
    ds_write_b128 v9, v[164:167] offset:0
    ds_write_b128 v9, v[168:171] offset:1024
    v_mfma_f32_32x32x16_bf16 v[196:211], v[60:63], v[24:27], v[196:211]
    buffer_load_dwordx4 v[108:111], v1, s[4:7], s81 offen offset:2048 sc1
    v_cvt_pk_bf16_f32 v180, v180, v181
    v_cvt_pk_bf16_f32 v181, v182, v183
    v_cvt_pk_bf16_f32 v182, v184, v185
    v_cvt_pk_bf16_f32 v183, v186, v187
    v_mfma_f32_32x32x16_bf16 v[212:227], v[156:159], v[28:31], 0
    v_cvt_pk_bf16_f32 v184, v188, v189
    v_cvt_pk_bf16_f32 v185, v190, v191
    v_cvt_pk_bf16_f32 v186, v192, v193
    v_cvt_pk_bf16_f32 v187, v194, v195
    v_mfma_f32_32x32x16_bf16 v[212:227], v[160:163], v[32:35], v[212:227]
    buffer_load_dwordx4 v[76:79], v1, s[4:7], s76 offen offset:2048 sc1
    ds_write_b128 v9, v[180:183] offset:2048
    ds_write_b128 v9, v[184:187] offset:3072
    v_mfma_f32_32x32x16_bf16 v[212:227], v[64:67], v[24:27], v[212:227]
    v_cvt_pk_bf16_f32 v196, v196, v197
    v_cvt_pk_bf16_f32 v197, v198, v199
    v_cvt_pk_bf16_f32 v198, v200, v201
    v_cvt_pk_bf16_f32 v199, v202, v203
    v_cvt_pk_bf16_f32 v200, v204, v205
    v_cvt_pk_bf16_f32 v201, v206, v207
    v_cvt_pk_bf16_f32 v202, v208, v209
    v_cvt_pk_bf16_f32 v203, v210, v211
    ds_write_b128 v9, v[196:199] offset:4096
    ds_write_b128 v9, v[200:203] offset:5120
    s_nop 1
    v_cvt_pk_bf16_f32 v212, v212, v213
    v_cvt_pk_bf16_f32 v213, v214, v215
    v_cvt_pk_bf16_f32 v214, v216, v217
    v_cvt_pk_bf16_f32 v215, v218, v219
    v_cvt_pk_bf16_f32 v216, v220, v221
    v_cvt_pk_bf16_f32 v217, v222, v223
    v_cvt_pk_bf16_f32 v218, v224, v225
    v_cvt_pk_bf16_f32 v219, v226, v227
    ds_write_b128 v9, v[212:215] offset:6144
    ds_write_b128 v9, v[216:219] offset:7168
    s_xor_b32 s71, s71, 0x8000
    s_waitcnt lgkmcnt(0)
    ds_read_b128 v[196:199], v236 offset:0
    ds_read_b128 v[200:203], v236 offset:256
    ds_read_b128 v[204:207], v236 offset:2048
    s_waitcnt lgkmcnt(2)
    v_mfma_f32_16x16x32_bf16 v[164:167], a[0:3], v[196:199], 0
    ds_read_b128 v[208:211], v236 offset:2304
    v_mfma_f32_16x16x32_bf16 v[168:171], a[4:7], v[196:199], 0
    buffer_load_dwordx4 v[112:115], v1, s[4:7], s81 offen offset:3072 sc1
    v_mfma_f32_16x16x32_bf16 v[180:183], a[128:131], v[196:199], 0
    v_mfma_f32_16x16x32_bf16 v[184:187], a[132:135], v[196:199], 0
    s_waitcnt lgkmcnt(2)
    v_mfma_f32_16x16x32_bf16 v[172:175], a[0:3], v[200:203], 0
    ds_read_b128 v[196:199], v236 offset:4096
    v_mfma_f32_16x16x32_bf16 v[176:179], a[4:7], v[200:203], 0
    v_mfma_f32_16x16x32_bf16 v[188:191], a[128:131], v[200:203], 0
    v_mfma_f32_16x16x32_bf16 v[192:195], a[132:135], v[200:203], 0
    s_waitcnt lgkmcnt(2)
    v_mfma_f32_16x16x32_bf16 v[164:167], a[8:11], v[204:207], v[164:167]
    ds_read_b128 v[200:203], v236 offset:4352
    v_mfma_f32_16x16x32_bf16 v[168:171], a[12:15], v[204:207], v[168:171]
    buffer_load_dwordx4 v[80:83], v1, s[4:7], s76 offen offset:3072 sc1
    v_mfma_f32_16x16x32_bf16 v[180:183], a[136:139], v[204:207], v[180:183]
    v_mfma_f32_16x16x32_bf16 v[184:187], a[140:143], v[204:207], v[184:187]
    s_waitcnt lgkmcnt(2)
    v_mfma_f32_16x16x32_bf16 v[172:175], a[8:11], v[208:211], v[172:175]
    ds_read_b128 v[204:207], v236 offset:6144
    v_mfma_f32_16x16x32_bf16 v[176:179], a[12:15], v[208:211], v[176:179]
    buffer_load_dwordx4 v[116:119], v1, s[4:7], s82 offen offset:0 sc1
    v_mfma_f32_16x16x32_bf16 v[188:191], a[136:139], v[208:211], v[188:191]
    v_mfma_f32_16x16x32_bf16 v[192:195], a[140:143], v[208:211], v[192:195]
    s_waitcnt lgkmcnt(2)
    v_mfma_f32_16x16x32_bf16 v[164:167], a[16:19], v[196:199], v[164:167]
    ds_read_b128 v[208:211], v236 offset:6400
    v_mfma_f32_16x16x32_bf16 v[168:171], a[20:23], v[196:199], v[168:171]
    buffer_load_dwordx4 v[84:87], v1, s[4:7], s80 offen offset:0 sc1
    v_mfma_f32_16x16x32_bf16 v[180:183], a[144:147], v[196:199], v[180:183]
    v_mfma_f32_16x16x32_bf16 v[184:187], a[148:151], v[196:199], v[184:187]
    s_waitcnt lgkmcnt(2)
    v_mfma_f32_16x16x32_bf16 v[172:175], a[16:19], v[200:203], v[172:175]
    s_barrier
    ds_read_b128 v[196:199], v237 offset:0
    v_mfma_f32_16x16x32_bf16 v[176:179], a[20:23], v[200:203], v[176:179]
    v_mfma_f32_16x16x32_bf16 v[188:191], a[144:147], v[200:203], v[188:191]
    v_mfma_f32_16x16x32_bf16 v[192:195], a[148:151], v[200:203], v[192:195]
    s_waitcnt lgkmcnt(2)
    v_mfma_f32_16x16x32_bf16 v[164:167], a[24:27], v[204:207], v[164:167]
    ds_read_b128 v[200:203], v237 offset:256
    v_mfma_f32_16x16x32_bf16 v[168:171], a[28:31], v[204:207], v[168:171]
    buffer_load_dwordx4 v[120:123], v1, s[4:7], s82 offen offset:1024 sc1
    v_mfma_f32_16x16x32_bf16 v[180:183], a[152:155], v[204:207], v[180:183]
    v_mfma_f32_16x16x32_bf16 v[184:187], a[156:159], v[204:207], v[184:187]
    s_waitcnt lgkmcnt(2)
    v_mfma_f32_16x16x32_bf16 v[172:175], a[24:27], v[208:211], v[172:175]
    ds_read_b128 v[204:207], v237 offset:2048
    v_mfma_f32_16x16x32_bf16 v[176:179], a[28:31], v[208:211], v[176:179]
    v_mfma_f32_16x16x32_bf16 v[188:191], a[152:155], v[208:211], v[188:191]
    v_mfma_f32_16x16x32_bf16 v[192:195], a[156:159], v[208:211], v[192:195]
    s_waitcnt lgkmcnt(2)
    v_mfma_f32_16x16x32_bf16 v[164:167], a[32:35], v[196:199], v[164:167]
    ds_read_b128 v[208:211], v237 offset:2304
    v_mfma_f32_16x16x32_bf16 v[168:171], a[36:39], v[196:199], v[168:171]
    buffer_load_dwordx4 v[88:91], v1, s[4:7], s80 offen offset:1024 sc1
    v_mfma_f32_16x16x32_bf16 v[180:183], a[160:163], v[196:199], v[180:183]
    v_mfma_f32_16x16x32_bf16 v[184:187], a[164:167], v[196:199], v[184:187]
    s_waitcnt lgkmcnt(2)
    v_mfma_f32_16x16x32_bf16 v[172:175], a[32:35], v[200:203], v[172:175]
    ds_read_b128 v[196:199], v237 offset:4096
    v_mfma_f32_16x16x32_bf16 v[176:179], a[36:39], v[200:203], v[176:179]
    buffer_load_dwordx4 v[124:127], v1, s[4:7], s82 offen offset:2048 sc1
    v_mfma_f32_16x16x32_bf16 v[188:191], a[160:163], v[200:203], v[188:191]
    v_mfma_f32_16x16x32_bf16 v[192:195], a[164:167], v[200:203], v[192:195]
    s_waitcnt lgkmcnt(2)
    v_mfma_f32_16x16x32_bf16 v[164:167], a[40:43], v[204:207], v[164:167]
    ds_read_b128 v[200:203], v237 offset:4352
    v_mfma_f32_16x16x32_bf16 v[168:171], a[44:47], v[204:207], v[168:171]
    buffer_load_dwordx4 v[92:95], v1, s[4:7], s80 offen offset:2048 sc1
    v_mfma_f32_16x16x32_bf16 v[180:183], a[168:171], v[204:207], v[180:183]
    v_mfma_f32_16x16x32_bf16 v[184:187], a[172:175], v[204:207], v[184:187]
    s_waitcnt lgkmcnt(2)
    v_mfma_f32_16x16x32_bf16 v[172:175], a[40:43], v[208:211], v[172:175]
    ds_read_b128 v[204:207], v237 offset:6144
    v_mfma_f32_16x16x32_bf16 v[176:179], a[44:47], v[208:211], v[176:179]
    v_mfma_f32_16x16x32_bf16 v[188:191], a[168:171], v[208:211], v[188:191]
    v_mfma_f32_16x16x32_bf16 v[192:195], a[172:175], v[208:211], v[192:195]
    s_waitcnt lgkmcnt(2)
    v_mfma_f32_16x16x32_bf16 v[164:167], a[48:51], v[196:199], v[164:167]
    ds_read_b128 v[208:211], v237 offset:6400
    v_mfma_f32_16x16x32_bf16 v[168:171], a[52:55], v[196:199], v[168:171]
    buffer_load_dwordx4 v[128:131], v1, s[4:7], s82 offen offset:3072 sc1
    v_mfma_f32_16x16x32_bf16 v[180:183], a[176:179], v[196:199], v[180:183]
    v_mfma_f32_16x16x32_bf16 v[184:187], a[180:183], v[196:199], v[184:187]
    s_waitcnt lgkmcnt(2)
    v_mfma_f32_16x16x32_bf16 v[172:175], a[48:51], v[200:203], v[172:175]
    ds_read_b128 v[196:199], v238 offset:0
    v_mfma_f32_16x16x32_bf16 v[176:179], a[52:55], v[200:203], v[176:179]
    v_mfma_f32_16x16x32_bf16 v[188:191], a[176:179], v[200:203], v[188:191]
    v_mfma_f32_16x16x32_bf16 v[192:195], a[180:183], v[200:203], v[192:195]
    s_waitcnt lgkmcnt(2)
    v_mfma_f32_16x16x32_bf16 v[164:167], a[56:59], v[204:207], v[164:167]
    ds_read_b128 v[200:203], v238 offset:256
    v_mfma_f32_16x16x32_bf16 v[168:171], a[60:63], v[204:207], v[168:171]
    buffer_load_dwordx4 v[96:99], v1, s[4:7], s80 offen offset:3072 sc1
    v_mfma_f32_16x16x32_bf16 v[180:183], a[184:187], v[204:207], v[180:183]
    v_mfma_f32_16x16x32_bf16 v[184:187], a[188:191], v[204:207], v[184:187]
    s_waitcnt lgkmcnt(2)
    v_mfma_f32_16x16x32_bf16 v[172:175], a[56:59], v[208:211], v[172:175]
    ds_read_b128 v[204:207], v238 offset:2048
    v_mfma_f32_16x16x32_bf16 v[176:179], a[60:63], v[208:211], v[176:179]
    buffer_load_dwordx4 v[132:135], v3, s[4:7], s76 offen offset:0 sc1
    v_mfma_f32_16x16x32_bf16 v[188:191], a[184:187], v[208:211], v[188:191]
    v_mfma_f32_16x16x32_bf16 v[192:195], a[188:191], v[208:211], v[192:195]
    s_waitcnt lgkmcnt(2)
    v_mfma_f32_16x16x32_bf16 v[164:167], a[64:67], v[196:199], v[164:167]
    ds_read_b128 v[208:211], v238 offset:2304
    v_mfma_f32_16x16x32_bf16 v[168:171], a[68:71], v[196:199], v[168:171]
    buffer_load_dwordx4 v[136:139], v3, s[4:7], s80 offen offset:0 sc1
    v_mfma_f32_16x16x32_bf16 v[180:183], a[192:195], v[196:199], v[180:183]
    v_mfma_f32_16x16x32_bf16 v[184:187], a[196:199], v[196:199], v[184:187]
    s_waitcnt lgkmcnt(2)
    v_mfma_f32_16x16x32_bf16 v[172:175], a[64:67], v[200:203], v[172:175]
    ds_read_b128 v[196:199], v238 offset:4096
    v_mfma_f32_16x16x32_bf16 v[176:179], a[68:71], v[200:203], v[176:179]
    v_mfma_f32_16x16x32_bf16 v[188:191], a[192:195], v[200:203], v[188:191]
    v_mfma_f32_16x16x32_bf16 v[192:195], a[196:199], v[200:203], v[192:195]
    s_waitcnt lgkmcnt(2)
    v_mfma_f32_16x16x32_bf16 v[164:167], a[72:75], v[204:207], v[164:167]
    ds_read_b128 v[200:203], v238 offset:4352
    v_mfma_f32_16x16x32_bf16 v[168:171], a[76:79], v[204:207], v[168:171]
    buffer_load_dwordx4 v[140:143], v3, s[4:7], s76 offen offset:512 sc1
    v_mfma_f32_16x16x32_bf16 v[180:183], a[200:203], v[204:207], v[180:183]
    v_mfma_f32_16x16x32_bf16 v[184:187], a[204:207], v[204:207], v[184:187]
    s_waitcnt lgkmcnt(2)
    v_mfma_f32_16x16x32_bf16 v[172:175], a[72:75], v[208:211], v[172:175]
    ds_read_b128 v[204:207], v238 offset:6144
    v_mfma_f32_16x16x32_bf16 v[176:179], a[76:79], v[208:211], v[176:179]
    v_mfma_f32_16x16x32_bf16 v[188:191], a[200:203], v[208:211], v[188:191]
    v_mfma_f32_16x16x32_bf16 v[192:195], a[204:207], v[208:211], v[192:195]
    s_waitcnt lgkmcnt(2)
    v_mfma_f32_16x16x32_bf16 v[164:167], a[80:83], v[196:199], v[164:167]
    ds_read_b128 v[208:211], v238 offset:6400
    v_mfma_f32_16x16x32_bf16 v[168:171], a[84:87], v[196:199], v[168:171]
    buffer_load_dwordx4 v[144:147], v3, s[4:7], s80 offen offset:512 sc1
    v_mfma_f32_16x16x32_bf16 v[180:183], a[208:211], v[196:199], v[180:183]
    v_mfma_f32_16x16x32_bf16 v[184:187], a[212:215], v[196:199], v[184:187]
    s_waitcnt lgkmcnt(2)
    v_mfma_f32_16x16x32_bf16 v[172:175], a[80:83], v[200:203], v[172:175]
    ds_read_b128 v[196:199], v239 offset:0
    v_mfma_f32_16x16x32_bf16 v[176:179], a[84:87], v[200:203], v[176:179]
    buffer_load_dwordx4 v[148:151], v3, s[4:7], s76 offen offset:1024 sc1
    v_mfma_f32_16x16x32_bf16 v[188:191], a[208:211], v[200:203], v[188:191]
    v_mfma_f32_16x16x32_bf16 v[192:195], a[212:215], v[200:203], v[192:195]
    s_waitcnt lgkmcnt(2)
    v_mfma_f32_16x16x32_bf16 v[164:167], a[88:91], v[204:207], v[164:167]
    ds_read_b128 v[200:203], v239 offset:256
    v_mfma_f32_16x16x32_bf16 v[168:171], a[92:95], v[204:207], v[168:171]
    buffer_load_dwordx4 v[152:155], v3, s[4:7], s80 offen offset:1024 sc1
    v_mfma_f32_16x16x32_bf16 v[180:183], a[216:219], v[204:207], v[180:183]
    v_mfma_f32_16x16x32_bf16 v[184:187], a[220:223], v[204:207], v[184:187]
    s_waitcnt lgkmcnt(2)
    v_mfma_f32_16x16x32_bf16 v[172:175], a[88:91], v[208:211], v[172:175]
    ds_read_b128 v[204:207], v239 offset:2048
    v_mfma_f32_16x16x32_bf16 v[176:179], a[92:95], v[208:211], v[176:179]
    v_mfma_f32_16x16x32_bf16 v[188:191], a[216:219], v[208:211], v[188:191]
    v_mfma_f32_16x16x32_bf16 v[192:195], a[220:223], v[208:211], v[192:195]
    s_waitcnt lgkmcnt(2)
    v_mfma_f32_16x16x32_bf16 v[164:167], a[96:99], v[196:199], v[164:167]
    ds_read_b128 v[208:211], v239 offset:2304
    v_mfma_f32_16x16x32_bf16 v[168:171], a[100:103], v[196:199], v[168:171]
    buffer_load_dwordx4 v[156:159], v3, s[4:7], s76 offen offset:1536 sc1
    v_mfma_f32_16x16x32_bf16 v[180:183], a[224:227], v[196:199], v[180:183]
    v_mfma_f32_16x16x32_bf16 v[184:187], a[228:231], v[196:199], v[184:187]
    s_waitcnt lgkmcnt(2)
    v_mfma_f32_16x16x32_bf16 v[172:175], a[96:99], v[200:203], v[172:175]
    ds_read_b128 v[196:199], v239 offset:4096
    v_mfma_f32_16x16x32_bf16 v[176:179], a[100:103], v[200:203], v[176:179]
    v_mfma_f32_16x16x32_bf16 v[188:191], a[224:227], v[200:203], v[188:191]
    v_mfma_f32_16x16x32_bf16 v[192:195], a[228:231], v[200:203], v[192:195]
    s_waitcnt lgkmcnt(2)
    v_mfma_f32_16x16x32_bf16 v[164:167], a[104:107], v[204:207], v[164:167]
    ds_read_b128 v[200:203], v239 offset:4352
    v_mfma_f32_16x16x32_bf16 v[168:171], a[108:111], v[204:207], v[168:171]
    buffer_load_dwordx4 v[160:163], v3, s[4:7], s80 offen offset:1536 sc1
    v_mfma_f32_16x16x32_bf16 v[180:183], a[232:235], v[204:207], v[180:183]
    v_mfma_f32_16x16x32_bf16 v[184:187], a[236:239], v[204:207], v[184:187]
    s_waitcnt lgkmcnt(2)
    v_mfma_f32_16x16x32_bf16 v[172:175], a[104:107], v[208:211], v[172:175]
    ds_read_b128 v[204:207], v239 offset:6144
    v_mfma_f32_16x16x32_bf16 v[176:179], a[108:111], v[208:211], v[176:179]
    v_mfma_f32_16x16x32_bf16 v[188:191], a[232:235], v[208:211], v[188:191]
    v_mfma_f32_16x16x32_bf16 v[192:195], a[236:239], v[208:211], v[192:195]
    s_waitcnt lgkmcnt(2)
    v_mfma_f32_16x16x32_bf16 v[164:167], a[112:115], v[196:199], v[164:167]
    ds_read_b128 v[208:211], v239 offset:6400
    v_mfma_f32_16x16x32_bf16 v[168:171], a[116:119], v[196:199], v[168:171]
    s_add_u32 s21, s75, 4096
    buffer_load_dword v22, off, s[4:7], s21 sc1
    v_mfma_f32_16x16x32_bf16 v[180:183], a[240:243], v[196:199], v[180:183]
    v_mfma_f32_16x16x32_bf16 v[184:187], a[244:247], v[196:199], v[184:187]
    s_waitcnt lgkmcnt(2)
    v_mfma_f32_16x16x32_bf16 v[172:175], a[112:115], v[200:203], v[172:175]
    v_mfma_f32_16x16x32_bf16 v[176:179], a[116:119], v[200:203], v[176:179]
    v_mfma_f32_16x16x32_bf16 v[188:191], a[240:243], v[200:203], v[188:191]
    v_mfma_f32_16x16x32_bf16 v[192:195], a[244:247], v[200:203], v[192:195]
    s_waitcnt lgkmcnt(0)
    v_mfma_f32_16x16x32_bf16 v[164:167], a[120:123], v[204:207], v[164:167]
    v_xor_b32 v236, 0x8000, v236
    v_mfma_f32_16x16x32_bf16 v[168:171], a[124:127], v[204:207], v[168:171]
    v_xor_b32 v237, 0x8000, v237
    v_mfma_f32_16x16x32_bf16 v[172:175], a[120:123], v[208:211], v[172:175]
    v_xor_b32 v238, 0x8000, v238
    v_mfma_f32_16x16x32_bf16 v[176:179], a[124:127], v[208:211], v[176:179]
    v_xor_b32 v239, 0x8000, v239
    v_mfma_f32_16x16x32_bf16 v[180:183], a[248:251], v[204:207], v[180:183]
    s_nop 1
    v_mfma_f32_16x16x32_bf16 v[184:187], a[252:255], v[204:207], v[184:187]
    s_nop 1
    v_mfma_f32_16x16x32_bf16 v[188:191], a[248:251], v[208:211], v[188:191]
    s_nop 0
    v_mfma_f32_16x16x32_bf16 v[192:195], a[252:255], v[208:211], v[192:195]
    v_cvt_pk_bf16_f32 v164, v164, v165
    v_cvt_pk_bf16_f32 v165, v166, v167
    v_cvt_pk_bf16_f32 v166, v168, v169
    v_cvt_pk_bf16_f32 v167, v170, v171
    v_cvt_pk_bf16_f32 v168, v172, v173
    v_cvt_pk_bf16_f32 v169, v174, v175
    v_cvt_pk_bf16_f32 v170, v176, v177
    v_cvt_pk_bf16_f32 v171, v178, v179
    v_xor_b32 v11, 0, v2
    buffer_store_dwordx4 v[164:167], v11, s[4:7], s72 offen offset:0 sc1
    v_xor_b32 v11, 512, v2
    buffer_store_dwordx4 v[168:171], v11, s[4:7], s72 offen offset:0 sc1
    v_cvt_pk_bf16_f32 v180, v180, v181
    v_cvt_pk_bf16_f32 v181, v182, v183
    v_cvt_pk_bf16_f32 v182, v184, v185
    v_cvt_pk_bf16_f32 v183, v186, v187
    v_cvt_pk_bf16_f32 v184, v188, v189
    v_cvt_pk_bf16_f32 v185, v190, v191
    v_cvt_pk_bf16_f32 v186, v192, v193
    v_cvt_pk_bf16_f32 v187, v194, v195
    v_xor_b32 v11, 256, v2
    buffer_store_dwordx4 v[180:183], v11, s[4:7], s72 offen offset:2048 sc1
    v_xor_b32 v11, 768, v2
    buffer_store_dwordx4 v[184:187], v11, s[4:7], s72 offen offset:2048 sc1
    s_cmp_lt_u32 s67, 128
    s_waitcnt vmcnt(4)
    s_cbranch_scc1 L_ao_top0
    s_branch L_ao_done
L_ao_pvn:
    v_mfma_f32_32x32x16_bf16 v[164:179], v[132:135], v[28:31], 0
    v_mfma_f32_32x32x16_bf16 v[164:179], v[136:139], v[32:35], v[164:179]
    v_mfma_f32_32x32x16_bf16 v[164:179], v[52:55], v[24:27], v[164:179]
    v_mfma_f32_32x32x16_bf16 v[180:195], v[140:143], v[28:31], 0
    s_nop 3
    v_mfma_f32_32x32x16_bf16 v[180:195], v[144:147], v[32:35], v[180:195]
    s_nop 3
    v_mfma_f32_32x32x16_bf16 v[180:195], v[56:59], v[24:27], v[180:195]
    s_nop 0
    v_cvt_pk_bf16_f32 v164, v164, v165
    v_cvt_pk_bf16_f32 v165, v166, v167
    v_cvt_pk_bf16_f32 v166, v168, v169
    v_cvt_pk_bf16_f32 v167, v170, v171
    v_mfma_f32_32x32x16_bf16 v[196:211], v[148:151], v[28:31], 0
    v_cvt_pk_bf16_f32 v168, v172, v173
    v_cvt_pk_bf16_f32 v169, v174, v175
    v_cvt_pk_bf16_f32 v170, v176, v177
    v_cvt_pk_bf16_f32 v171, v178, v179
    v_mfma_f32_32x32x16_bf16 v[196:211], v[152:155], v[32:35], v[196:211]
    ds_write_b128 v9, v[164:167] offset:0
    ds_write_b128 v9, v[168:171] offset:1024
    v_mfma_f32_32x32x16_bf16 v[196:211], v[60:63], v[24:27], v[196:211]
    v_cvt_pk_bf16_f32 v180, v180, v181
    v_cvt_pk_bf16_f32 v181, v182, v183
    v_cvt_pk_bf16_f32 v182, v184, v185
    v_cvt_pk_bf16_f32 v183, v186, v187
    v_mfma_f32_32x32x16_bf16 v[212:227], v[156:159], v[28:31], 0
    v_cvt_pk_bf16_f32 v184, v188, v189
    v_cvt_pk_bf16_f32 v185, v190, v191
    v_cvt_pk_bf16_f32 v186, v192, v193
    v_cvt_pk_bf16_f32 v187, v194, v195
    v_mfma_f32_32x32x16_bf16 v[212:227], v[160:163], v[32:35], v[212:227]
    ds_write_b128 v9, v[180:183] offset:2048
    ds_write_b128 v9, v[184:187] offset:3072
    v_mfma_f32_32x32x16_bf16 v[212:227], v[64:67], v[24:27], v[212:227]
    v_cvt_pk_bf16_f32 v196, v196, v197
    v_cvt_pk_bf16_f32 v197, v198, v199
    v_cvt_pk_bf16_f32 v198, v200, v201
    v_cvt_pk_bf16_f32 v199, v202, v203
    v_cvt_pk_bf16_f32 v200, v204, v205
    v_cvt_pk_bf16_f32 v201, v206, v207
    v_cvt_pk_bf16_f32 v202, v208, v209
    v_cvt_pk_bf16_f32 v203, v210, v211
    ds_write_b128 v9, v[196:199] offset:4096
    ds_write_b128 v9, v[200:203] offset:5120
    s_nop 1
    v_cvt_pk_bf16_f32 v212, v212, v213
    v_cvt_pk_bf16_f32 v213, v214, v215
    v_cvt_pk_bf16_f32 v214, v216, v217
    v_cvt_pk_bf16_f32 v215, v218, v219
    v_cvt_pk_bf16_f32 v216, v220, v221
    v_cvt_pk_bf16_f32 v217, v222, v223
    v_cvt_pk_bf16_f32 v218, v224, v225
    v_cvt_pk_bf16_f32 v219, v226, v227
    ds_write_b128 v9, v[212:215] offset:6144
    ds_write_b128 v9, v[216:219] offset:7168
    s_xor_b32 s71, s71, 0x8000
    s_waitcnt lgkmcnt(0)
    ds_read_b128 v[196:199], v236 offset:0
    ds_read_b128 v[200:203], v236 offset:256
    ds_read_b128 v[204:207], v236 offset:2048
    s_waitcnt lgkmcnt(2)
    v_mfma_f32_16x16x32_bf16 v[164:167], a[0:3], v[196:199], 0
    ds_read_b128 v[208:211], v236 offset:2304
    v_mfma_f32_16x16x32_bf16 v[168:171], a[4:7], v[196:199], 0
    v_mfma_f32_16x16x32_bf16 v[180:183], a[128:131], v[196:199], 0
    v_mfma_f32_16x16x32_bf16 v[184:187], a[132:135], v[196:199], 0
    s_waitcnt lgkmcnt(2)
    v_mfma_f32_16x16x32_bf16 v[172:175], a[0:3], v[200:203], 0
    ds_read_b128 v[196:199], v236 offset:4096
    v_mfma_f32_16x16x32_bf16 v[176:179], a[4:7], v[200:203], 0
    v_mfma_f32_16x16x32_bf16 v[188:191], a[128:131], v[200:203], 0
    v_mfma_f32_16x16x32_bf16 v[192:195], a[132:135], v[200:203], 0
    s_waitcnt lgkmcnt(2)
    v_mfma_f32_16x16x32_bf16 v[164:167], a[8:11], v[204:207], v[164:167]
    ds_read_b128 v[200:203], v236 offset:4352
    v_mfma_f32_16x16x32_bf16 v[168:171], a[12:15], v[204:207], v[168:171]
    v_mfma_f32_16x16x32_bf16 v[180:183], a[136:139], v[204:207], v[180:183]
    v_mfma_f32_16x16x32_bf16 v[184:187], a[140:143], v[204:207], v[184:187]
    s_waitcnt lgkmcnt(2)
    v_mfma_f32_16x16x32_bf16 v[172:175], a[8:11], v[208:211], v[172:175]
    ds_read_b128 v[204:207], v236 offset:6144
    v_mfma_f32_16x16x32_bf16 v[176:179], a[12:15], v[208:211], v[176:179]
    v_mfma_f32_16x16x32_bf16 v[188:191], a[136:139], v[208:211], v[188:191]
    v_mfma_f32_16x16x32_bf16 v[192:195], a[140:143], v[208:211], v[192:195]
    s_waitcnt lgkmcnt(2)
    v_mfma_f32_16x16x32_bf16 v[164:167], a[16:19], v[196:199], v[164:167]
    ds_read_b128 v[208:211], v236 offset:6400
    v_mfma_f32_16x16x32_bf16 v[168:171], a[20:23], v[196:199], v[168:171]
    v_mfma_f32_16x16x32_bf16 v[180:183], a[144:147], v[196:199], v[180:183]
    v_mfma_f32_16x16x32_bf16 v[184:187], a[148:151], v[196:199], v[184:187]
    s_waitcnt lgkmcnt(2)
    v_mfma_f32_16x16x32_bf16 v[172:175], a[16:19], v[200:203], v[172:175]
    s_barrier
    ds_read_b128 v[196:199], v237 offset:0
    v_mfma_f32_16x16x32_bf16 v[176:179], a[20:23], v[200:203], v[176:179]
    v_mfma_f32_16x16x32_bf16 v[188:191], a[144:147], v[200:203], v[188:191]
    v_mfma_f32_16x16x32_bf16 v[192:195], a[148:151], v[200:203], v[192:195]
    s_waitcnt lgkmcnt(2)
    v_mfma_f32_16x16x32_bf16 v[164:167], a[24:27], v[204:207], v[164:167]
    ds_read_b128 v[200:203], v237 offset:256
    v_mfma_f32_16x16x32_bf16 v[168:171], a[28:31], v[204:207], v[168:171]
    buffer_load_dword v7, v6, s[4:7], s75 offen sc1
    v_mfma_f32_16x16x32_bf16 v[180:183], a[152:155], v[204:207], v[180:183]
    v_mfma_f32_16x16x32_bf16 v[184:187], a[156:159], v[204:207], v[184:187]
    s_waitcnt lgkmcnt(2)
    v_mfma_f32_16x16x32_bf16 v[172:175], a[24:27], v[208:211], v[172:175]
    ds_read_b128 v[204:207], v237 offset:2048
    v_mfma_f32_16x16x32_bf16 v[176:179], a[28:31], v[208:211], v[176:179]
    v_mfma_f32_16x16x32_bf16 v[188:191], a[152:155], v[208:211], v[188:191]
    v_mfma_f32_16x16x32_bf16 v[192:195], a[156:159], v[208:211], v[192:195]
    s_waitcnt lgkmcnt(2)
    v_mfma_f32_16x16x32_bf16 v[164:167], a[32:35], v[196:199], v[164:167]
    ds_read_b128 v[208:211], v237 offset:2304
    v_mfma_f32_16x16x32_bf16 v[168:171], a[36:39], v[196:199], v[168:171]
    v_mfma_f32_16x16x32_bf16 v[180:183], a[160:163], v[196:199], v[180:183]
    v_mfma_f32_16x16x32_bf16 v[184:187], a[164:167], v[196:199], v[184:187]
    s_waitcnt lgkmcnt(2)
    v_mfma_f32_16x16x32_bf16 v[172:175], a[32:35], v[200:203], v[172:175]
    ds_read_b128 v[196:199], v237 offset:4096
    v_mfma_f32_16x16x32_bf16 v[176:179], a[36:39], v[200:203], v[176:179]
    v_mfma_f32_16x16x32_bf16 v[188:191], a[160:163], v[200:203], v[188:191]
    v_mfma_f32_16x16x32_bf16 v[192:195], a[164:167], v[200:203], v[192:195]
    s_waitcnt lgkmcnt(2)
    v_mfma_f32_16x16x32_bf16 v[164:167], a[40:43], v[204:207], v[164:167]
    ds_read_b128 v[200:203], v237 offset:4352
    v_mfma_f32_16x16x32_bf16 v[168:171], a[44:47], v[204:207], v[168:171]
    v_mfma_f32_16x16x32_bf16 v[180:183], a[168:171], v[204:207], v[180:183]
    v_mfma_f32_16x16x32_bf16 v[184:187], a[172:175], v[204:207], v[184:187]
    s_waitcnt lgkmcnt(2)
    v_mfma_f32_16x16x32_bf16 v[172:175], a[40:43], v[208:211], v[172:175]
    ds_read_b128 v[204:207], v237 offset:6144
    v_mfma_f32_16x16x32_bf16 v[176:179], a[44:47], v[208:211], v[176:179]
    v_mfma_f32_16x16x32_bf16 v[188:191], a[168:171], v[208:211], v[188:191]
    v_mfma_f32_16x16x32_bf16 v[192:195], a[172:175], v[208:211], v[192:195]
    s_waitcnt vmcnt(0)
    v_cmp_gt_u32 vcc, 1, v7
    s_cbranch_vccnz L_ao_b0
    s_waitcnt lgkmcnt(2)
    v_mfma_f32_16x16x32_bf16 v[164:167], a[48:51], v[196:199], v[164:167]
    ds_read_b128 v[208:211], v237 offset:6400
    v_mfma_f32_16x16x32_bf16 v[168:171], a[52:55], v[196:199], v[168:171]
    buffer_load_dwordx4 v[100:103], v1, s[4:7], s81 offen offset:0 sc1
    v_mfma_f32_16x16x32_bf16 v[180:183], a[176:179], v[196:199], v[180:183]
    v_mfma_f32_16x16x32_bf16 v[184:187], a[180:183], v[196:199], v[184:187]
    s_waitcnt lgkmcnt(2)
    v_mfma_f32_16x16x32_bf16 v[172:175], a[48:51], v[200:203], v[172:175]
    ds_read_b128 v[196:199], v238 offset:0
    v_mfma_f32_16x16x32_bf16 v[176:179], a[52:55], v[200:203], v[176:179]
    buffer_load_dwordx4 v[68:71], v1, s[4:7], s76 offen offset:0 sc1
    v_mfma_f32_16x16x32_bf16 v[188:191], a[176:179], v[200:203], v[188:191]
    v_mfma_f32_16x16x32_bf16 v[192:195], a[180:183], v[200:203], v[192:195]
    s_waitcnt lgkmcnt(2)
    v_mfma_f32_16x16x32_bf16 v[164:167], a[56:59], v[204:207], v[164:167]
    ds_read_b128 v[200:203], v238 offset:256
    v_mfma_f32_16x16x32_bf16 v[168:171], a[60:63], v[204:207], v[168:171]
    buffer_load_dwordx4 v[104:107], v1, s[4:7], s81 offen offset:1024 sc1
    v_mfma_f32_16x16x32_bf16 v[180:183], a[184:187], v[204:207], v[180:183]
    v_mfma_f32_16x16x32_bf16 v[184:187], a[188:191], v[204:207], v[184:187]
    s_waitcnt lgkmcnt(2)
    v_mfma_f32_16x16x32_bf16 v[172:175], a[56:59], v[208:211], v[172:175]
    ds_read_b128 v[204:207], v238 offset:2048
    v_mfma_f32_16x16x32_bf16 v[176:179], a[60:63], v[208:211], v[176:179]
    buffer_load_dwordx4 v[72:75], v1, s[4:7], s76 offen offset:1024 sc1
    v_mfma_f32_16x16x32_bf16 v[188:191], a[184:187], v[208:211], v[188:191]
    v_mfma_f32_16x16x32_bf16 v[192:195], a[188:191], v[208:211], v[192:195]
    s_waitcnt lgkmcnt(2)
    v_mfma_f32_16x16x32_bf16 v[164:167], a[64:67], v[196:199], v[164:167]
    ds_read_b128 v[208:211], v238 offset:2304
    v_mfma_f32_16x16x32_bf16 v[168:171], a[68:71], v[196:199], v[168:171]
    buffer_load_dwordx4 v[108:111], v1, s[4:7], s81 offen offset:2048 sc1
    v_mfma_f32_16x16x32_bf16 v[180:183], a[192:195], v[196:199], v[180:183]
    v_mfma_f32_16x16x32_bf16 v[184:187], a[196:199], v[196:199], v[184:187]
    s_waitcnt lgkmcnt(2)
    v_mfma_f32_16x16x32_bf16 v[172:175], a[64:67], v[200:203], v[172:175]
    ds_read_b128 v[196:199], v238 offset:4096
    v_mfma_f32_16x16x32_bf16 v[176:179], a[68:71], v[200:203], v[176:179]
    buffer_load_dwordx4 v[76:79], v1, s[4:7], s76 offen offset:2048 sc1
    v_mfma_f32_16x16x32_bf16 v[188:191], a[192:195], v[200:203], v[188:191]
    v_mfma_f32_16x16x32_bf16 v[192:195], a[196:199], v[200:203], v[192:195]
    s_waitcnt lgkmcnt(2)
    v_mfma_f32_16x16x32_bf16 v[164:167], a[72:75], v[204:207], v[164:167]
    ds_read_b128 v[200:203], v238 offset:4352
    v_mfma_f32_16x16x32_bf16 v[168:171], a[76:79], v[204:207], v[168:171]
    buffer_load_dwordx4 v[112:115], v1, s[4:7], s81 offen offset:3072 sc1
    v_mfma_f32_16x16x32_bf16 v[180:183], a[200:203], v[204:207], v[180:183]
    v_mfma_f32_16x16x32_bf16 v[184:187], a[204:207], v[204:207], v[184:187]
    s_waitcnt lgkmcnt(2)
    v_mfma_f32_16x16x32_bf16 v[172:175], a[72:75], v[208:211], v[172:175]
    ds_read_b128 v[204:207], v238 offset:6144
    v_mfma_f32_16x16x32_bf16 v[176:179], a[76:79], v[208:211], v[176:179]
    buffer_load_dwordx4 v[80:83], v1, s[4:7], s76 offen offset:3072 sc1
    v_mfma_f32_16x16x32_bf16 v[188:191], a[200:203], v[208:211], v[188:191]
    v_mfma_f32_16x16x32_bf16 v[192:195], a[204:207], v[208:211], v[192:195]
    s_waitcnt lgkmcnt(2)
    v_mfma_f32_16x16x32_bf16 v[164:167], a[80:83], v[196:199], v[164:167]
    ds_read_b128 v[208:211], v238 offset:6400
    v_mfma_f32_16x16x32_bf16 v[168:171], a[84:87], v[196:199], v[168:171]
    buffer_load_dwordx4 v[116:119], v1, s[4:7], s82 offen offset:0 sc1
    v_mfma_f32_16x16x32_bf16 v[180:183], a[208:211], v[196:199], v[180:183]
    v_mfma_f32_16x16x32_bf16 v[184:187], a[212:215], v[196:199], v[184:187]
    s_waitcnt lgkmcnt(2)
    v_mfma_f32_16x16x32_bf16 v[172:175], a[80:83], v[200:203], v[172:175]
    ds_read_b128 v[196:199], v239 offset:0
    v_mfma_f32_16x16x32_bf16 v[176:179], a[84:87], v[200:203], v[176:179]
    buffer_load_dwordx4 v[84:87], v1, s[4:7], s80 offen offset:0 sc1
    v_mfma_f32_16x16x32_bf16 v[188:191], a[208:211], v[200:203], v[188:191]
    v_mfma_f32_16x16x32_bf16 v[192:195], a[212:215], v[200:203], v[192:195]
    s_waitcnt lgkmcnt(2)
    v_mfma_f32_16x16x32_bf16 v[164:167], a[88:91], v[204:207], v[164:167]
    ds_read_b128 v[200:203], v239 offset:256
    v_mfma_f32_16x16x32_bf16 v[168:171], a[92:95], v[204:207], v[168:171]
    buffer_load_dwordx4 v[120:123], v1, s[4:7], s82 offen offset:1024 sc1
    v_mfma_f32_16x16x32_bf16 v[180:183], a[216:219], v[204:207], v[180:183]
    v_mfma_f32_16x16x32_bf16 v[184:187], a[220:223], v[204:207], v[184:187]
    s_waitcnt lgkmcnt(2)
    v_mfma_f32_16x16x32_bf16 v[172:175], a[88:91], v[208:211], v[172:175]
    ds_read_b128 v[204:207], v239 offset:2048
    v_mfma_f32_16x16x32_bf16 v[176:179], a[92:95], v[208:211], v[176:179]
    buffer_load_dwordx4 v[88:91], v1, s[4:7], s80 offen offset:1024 sc1
    v_mfma_f32_16x16x32_bf16 v[188:191], a[216:219], v[208:211], v[188:191]
    v_mfma_f32_16x16x32_bf16 v[192:195], a[220:223], v[208:211], v[192:195]
    s_waitcnt lgkmcnt(2)
    v_mfma_f32_16x16x32_bf16 v[164:167], a[96:99], v[196:199], v[164:167]
    ds_read_b128 v[208:211], v239 offset:2304
    v_mfma_f32_16x16x32_bf16 v[168:171], a[100:103], v[196:199], v[168:171]
    buffer_load_dwordx4 v[124:127], v1, s[4:7], s82 offen offset:2048 sc1
    v_mfma_f32_16x16x32_bf16 v[180:183], a[224:227], v[196:199], v[180:183]
    v_mfma_f32_16x16x32_bf16 v[184:187], a[228:231], v[196:199], v[184:187]
    s_waitcnt lgkmcnt(2)
    v_mfma_f32_16x16x32_bf16 v[172:175], a[96:99], v[200:203], v[172:175]
    ds_read_b128 v[196:199], v239 offset:4096
    v_mfma_f32_16x16x32_bf16 v[176:179], a[100:103], v[200:203], v[176:179]
    buffer_load_dwordx4 v[92:95], v1, s[4:7], s80 offen offset:2048 sc1
    v_mfma_f32_16x16x32_bf16 v[188:191], a[224:227], v[200:203], v[188:191]
    v_mfma_f32_16x16x32_bf16 v[192:195], a[228:231], v[200:203], v[192:195]
    s_waitcnt lgkmcnt(2)
    v_mfma_f32_16x16x32_bf16 v[164:167], a[104:107], v[204:207], v[164:167]
    ds_read_b128 v[200:203], v239 offset:4352
    v_mfma_f32_16x16x32_bf16 v[168:171], a[108:111], v[204:207], v[168:171]
    buffer_load_dwordx4 v[128:131], v1, s[4:7], s82 offen offset:3072 sc1
    v_mfma_f32_16x16x32_bf16 v[180:183], a[232:235], v[204:207], v[180:183]
    v_mfma_f32_16x16x32_bf16 v[184:187], a[236:239], v[204:207], v[184:187]
    s_waitcnt lgkmcnt(2)
    v_mfma_f32_16x16x32_bf16 v[172:175], a[104:107], v[208:211], v[172:175]
    ds_read_b128 v[204:207], v239 offset:6144
    v_mfma_f32_16x16x32_bf16 v[176:179], a[108:111], v[208:211], v[176:179]
    buffer_load_dwordx4 v[96:99], v1, s[4:7], s80 offen offset:3072 sc1
    v_mfma_f32_16x16x32_bf16 v[188:191], a[232:235], v[208:211], v[188:191]
    v_mfma_f32_16x16x32_bf16 v[192:195], a[236:239], v[208:211], v[192:195]
    s_waitcnt lgkmcnt(2)
    v_mfma_f32_16x16x32_bf16 v[164:167], a[112:115], v[196:199], v[164:167]
    ds_read_b128 v[208:211], v239 offset:6400
    v_mfma_f32_16x16x32_bf16 v[168:171], a[116:119], v[196:199], v[168:171]
    s_add_u32 s21, s75, 4096
    buffer_load_dword v22, off, s[4:7], s21 sc1
    v_mfma_f32_16x16x32_bf16 v[180:183], a[240:243], v[196:199], v[180:183]
    v_mfma_f32_16x16x32_bf16 v[184:187], a[244:247], v[196:199], v[184:187]
    s_waitcnt lgkmcnt(2)
    v_mfma_f32_16x16x32_bf16 v[172:175], a[112:115], v[200:203], v[172:175]
    v_mfma_f32_16x16x32_bf16 v[176:179], a[116:119], v[200:203], v[176:179]
    v_mfma_f32_16x16x32_bf16 v[188:191], a[240:243], v[200:203], v[188:191]
    v_mfma_f32_16x16x32_bf16 v[192:195], a[244:247], v[200:203], v[192:195]
    s_waitcnt lgkmcnt(0)
    v_mfma_f32_16x16x32_bf16 v[164:167], a[120:123], v[204:207], v[164:167]
    v_xor_b32 v236, 0x8000, v236
    v_mfma_f32_16x16x32_bf16 v[168:171], a[124:127], v[204:207], v[168:171]
    v_xor_b32 v237, 0x8000, v237
    v_mfma_f32_16x16x32_bf16 v[172:175], a[120:123], v[208:211], v[172:175]
    v_xor_b32 v238, 0x8000, v238
    v_mfma_f32_16x16x32_bf16 v[176:179], a[124:127], v[208:211], v[176:179]
    v_xor_b32 v239, 0x8000, v239
    v_mfma_f32_16x16x32_bf16 v[180:183], a[248:251], v[204:207], v[180:183]
    s_nop 1
    v_mfma_f32_16x16x32_bf16 v[184:187], a[252:255], v[204:207], v[184:187]
    s_nop 1
    v_mfma_f32_16x16x32_bf16 v[188:191], a[248:251], v[208:211], v[188:191]
    s_nop 0
    v_mfma_f32_16x16x32_bf16 v[192:195], a[252:255], v[208:211], v[192:195]
    v_cvt_pk_bf16_f32 v164, v164, v165
    v_cvt_pk_bf16_f32 v165, v166, v167
    v_cvt_pk_bf16_f32 v166, v168, v169
    v_cvt_pk_bf16_f32 v167, v170, v171
    v_cvt_pk_bf16_f32 v168, v172, v173
    v_cvt_pk_bf16_f32 v169, v174, v175
    v_cvt_pk_bf16_f32 v170, v176, v177
    v_cvt_pk_bf16_f32 v171, v178, v179
    v_xor_b32 v11, 0, v2
    buffer_store_dwordx4 v[164:167], v11, s[4:7], s72 offen offset:0 sc1
    v_xor_b32 v11, 512, v2
    buffer_store_dwordx4 v[168:171], v11, s[4:7], s72 offen offset:0 sc1
    v_cvt_pk_bf16_f32 v180, v180, v181
    v_cvt_pk_bf16_f32 v181, v182, v183
    v_cvt_pk_bf16_f32 v182, v184, v185
    v_cvt_pk_bf16_f32 v183, v186, v187
    v_cvt_pk_bf16_f32 v184, v188, v189
    v_cvt_pk_bf16_f32 v185, v190, v191
    v_cvt_pk_bf16_f32 v186, v192, v193
    v_cvt_pk_bf16_f32 v187, v194, v195
    v_xor_b32 v11, 256, v2
    buffer_store_dwordx4 v[180:183], v11, s[4:7], s72 offen offset:2048 sc1
    v_xor_b32 v11, 768, v2
    buffer_store_dwordx4 v[184:187], v11, s[4:7], s72 offen offset:2048 sc1
    s_cmp_lt_u32 s67, 128
    s_waitcnt vmcnt(4)
    s_cbranch_scc1 L_ao_top1
    s_branch L_ao_done
L_ao_b0:
    s_waitcnt lgkmcnt(2)
    v_mfma_f32_16x16x32_bf16 v[164:167], a[48:51], v[196:199], v[164:167]
    ds_read_b128 v[208:211], v237 offset:6400
    v_mfma_f32_16x16x32_bf16 v[168:171], a[52:55], v[196:199], v[168:171]
    v_mfma_f32_16x16x32_bf16 v[180:183], a[176:179], v[196:199], v[180:183]
    v_mfma_f32_16x16x32_bf16 v[184:187], a[180:183], v[196:199], v[184:187]
    s_waitcnt lgkmcnt(2)
    v_mfma_f32_16x16x32_bf16 v[172:175], a[48:51], v[200:203], v[172:175]
    ds_read_b128 v[196:199], v238 offset:0
    v_mfma_f32_16x16x32_bf16 v[176:179], a[52:55], v[200:203], v[176:179]
    v_mfma_f32_16x16x32_bf16 v[188:191], a[176:179], v[200:203], v[188:191]
    v_mfma_f32_16x16x32_bf16 v[192:195], a[180:183], v[200:203], v[192:195]
    s_waitcnt lgkmcnt(2)
    v_mfma_f32_16x16x32_bf16 v[164:167], a[56:59], v[204:207], v[164:167]
    ds_read_b128 v[200:203], v238 offset:256
    v_mfma_f32_16x16x32_bf16 v[168:171], a[60:63], v[204:207], v[168:171]
    v_mfma_f32_16x16x32_bf16 v[180:183], a[184:187], v[204:207], v[180:183]
    v_mfma_f32_16x16x32_bf16 v[184:187], a[188:191], v[204:207], v[184:187]
    s_waitcnt lgkmcnt(2)
    v_mfma_f32_16x16x32_bf16 v[172:175], a[56:59], v[208:211], v[172:175]
    ds_read_b128 v[204:207], v238 offset:2048
    v_mfma_f32_16x16x32_bf16 v[176:179], a[60:63], v[208:211], v[176:179]
    v_mfma_f32_16x16x32_bf16 v[188:191], a[184:187], v[208:211], v[188:191]
    v_mfma_f32_16x16x32_bf16 v[192:195], a[188:191], v[208:211], v[192:195]
    s_waitcnt lgkmcnt(2)
    v_mfma_f32_16x16x32_bf16 v[164:167], a[64:67], v[196:199], v[164:167]
    ds_read_b128 v[208:211], v238 offset:2304
    v_mfma_f32_16x16x32_bf16 v[168:171], a[68:71], v[196:199], v[168:171]
    v_mfma_f32_16x16x32_bf16 v[180:183], a[192:195], v[196:199], v[180:183]
    v_mfma_f32_16x16x32_bf16 v[184:187], a[196:199], v[196:199], v[184:187]
    s_waitcnt lgkmcnt(2)
    v_mfma_f32_16x16x32_bf16 v[172:175], a[64:67], v[200:203], v[172:175]
    ds_read_b128 v[196:199], v238 offset:4096
    v_mfma_f32_16x16x32_bf16 v[176:179], a[68:71], v[200:203], v[176:179]
    v_mfma_f32_16x16x32_bf16 v[188:191], a[192:195], v[200:203], v[188:191]
    v_mfma_f32_16x16x32_bf16 v[192:195], a[196:199], v[200:203], v[192:195]
    s_waitcnt lgkmcnt(2)
    v_mfma_f32_16x16x32_bf16 v[164:167], a[72:75], v[204:207], v[164:167]
    ds_read_b128 v[200:203], v238 offset:4352
    v_mfma_f32_16x16x32_bf16 v[168:171], a[76:79], v[204:207], v[168:171]
    v_mfma_f32_16x16x32_bf16 v[180:183], a[200:203], v[204:207], v[180:183]
    v_mfma_f32_16x16x32_bf16 v[184:187], a[204:207], v[204:207], v[184:187]
    s_waitcnt lgkmcnt(2)
    v_mfma_f32_16x16x32_bf16 v[172:175], a[72:75], v[208:211], v[172:175]
    ds_read_b128 v[204:207], v238 offset:6144
    v_mfma_f32_16x16x32_bf16 v[176:179], a[76:79], v[208:211], v[176:179]
    v_mfma_f32_16x16x32_bf16 v[188:191], a[200:203], v[208:211], v[188:191]
    v_mfma_f32_16x16x32_bf16 v[192:195], a[204:207], v[208:211], v[192:195]
    s_waitcnt lgkmcnt(2)
    v_mfma_f32_16x16x32_bf16 v[164:167], a[80:83], v[196:199], v[164:167]
    ds_read_b128 v[208:211], v238 offset:6400
    v_mfma_f32_16x16x32_bf16 v[168:171], a[84:87], v[196:199], v[168:171]
    v_mfma_f32_16x16x32_bf16 v[180:183], a[208:211], v[196:199], v[180:183]
    v_mfma_f32_16x16x32_bf16 v[184:187], a[212:215], v[196:199], v[184:187]
    s_waitcnt lgkmcnt(2)
    v_mfma_f32_16x16x32_bf16 v[172:175], a[80:83], v[200:203], v[172:175]
    ds_read_b128 v[196:199], v239 offset:0
    v_mfma_f32_16x16x32_bf16 v[176:179], a[84:87], v[200:203], v[176:179]
    v_mfma_f32_16x16x32_bf16 v[188:191], a[208:211], v[200:203], v[188:191]
    v_mfma_f32_16x16x32_bf16 v[192:195], a[212:215], v[200:203], v[192:195]
    s_waitcnt lgkmcnt(2)
    v_mfma_f32_16x16x32_bf16 v[164:167], a[88:91], v[204:207], v[164:167]
    ds_read_b128 v[200:203], v239 offset:256
    v_mfma_f32_16x16x32_bf16 v[168:171], a[92:95], v[204:207], v[168:171]
    v_mfma_f32_16x16x32_bf16 v[180:183], a[216:219], v[204:207], v[180:183]
    v_mfma_f32_16x16x32_bf16 v[184:187], a[220:223], v[204:207], v[184:187]
    s_waitcnt lgkmcnt(2)
    v_mfma_f32_16x16x32_bf16 v[172:175], a[88:91], v[208:211], v[172:175]
    ds_read_b128 v[204:207], v239 offset:2048
    v_mfma_f32_16x16x32_bf16 v[176:179], a[92:95], v[208:211], v[176:179]
    v_mfma_f32_16x16x32_bf16 v[188:191], a[216:219], v[208:211], v[188:191]
    v_mfma_f32_16x16x32_bf16 v[192:195], a[220:223], v[208:211], v[192:195]
    s_waitcnt lgkmcnt(2)
    v_mfma_f32_16x16x32_bf16 v[164:167], a[96:99], v[196:199], v[164:167]
    ds_read_b128 v[208:211], v239 offset:2304
    v_mfma_f32_16x16x32_bf16 v[168:171], a[100:103], v[196:199], v[168:171]
    v_mfma_f32_16x16x32_bf16 v[180:183], a[224:227], v[196:199], v[180:183]
    v_mfma_f32_16x16x32_bf16 v[184:187], a[228:231], v[196:199], v[184:187]
    s_waitcnt lgkmcnt(2)
    v_mfma_f32_16x16x32_bf16 v[172:175], a[96:99], v[200:203], v[172:175]
    ds_read_b128 v[196:199], v239 offset:4096
    v_mfma_f32_16x16x32_bf16 v[176:179], a[100:103], v[200:203], v[176:179]
    v_mfma_f32_16x16x32_bf16 v[188:191], a[224:227], v[200:203], v[188:191]
    v_mfma_f32_16x16x32_bf16 v[192:195], a[228:231], v[200:203], v[192:195]
    s_waitcnt lgkmcnt(2)
    v_mfma_f32_16x16x32_bf16 v[164:167], a[104:107], v[204:207], v[164:167]
    ds_read_b128 v[200:203], v239 offset:4352
    v_mfma_f32_16x16x32_bf16 v[168:171], a[108:111], v[204:207], v[168:171]
    v_mfma_f32_16x16x32_bf16 v[180:183], a[232:235], v[204:207], v[180:183]
    v_mfma_f32_16x16x32_bf16 v[184:187], a[236:239], v[204:207], v[184:187]
    s_waitcnt lgkmcnt(2)
    v_mfma_f32_16x16x32_bf16 v[172:175], a[104:107], v[208:211], v[172:175]
    ds_read_b128 v[204:207], v239 offset:6144
    v_mfma_f32_16x16x32_bf16 v[176:179], a[108:111], v[208:211], v[176:179]
    v_mfma_f32_16x16x32_bf16 v[188:191], a[232:235], v[208:211], v[188:191]
    v_mfma_f32_16x16x32_bf16 v[192:195], a[236:239], v[208:211], v[192:195]
    s_waitcnt lgkmcnt(2)
    v_mfma_f32_16x16x32_bf16 v[164:167], a[112:115], v[196:199], v[164:167]
    ds_read_b128 v[208:211], v239 offset:6400
    v_mfma_f32_16x16x32_bf16 v[168:171], a[116:119], v[196:199], v[168:171]
    v_mfma_f32_16x16x32_bf16 v[180:183], a[240:243], v[196:199], v[180:183]
    v_mfma_f32_16x16x32_bf16 v[184:187], a[244:247], v[196:199], v[184:187]
    s_waitcnt lgkmcnt(2)
    v_mfma_f32_16x16x32_bf16 v[172:175], a[112:115], v[200:203], v[172:175]
    v_mfma_f32_16x16x32_bf16 v[176:179], a[116:119], v[200:203], v[176:179]
    v_mfma_f32_16x16x32_bf16 v[188:191], a[240:243], v[200:203], v[188:191]
    v_mfma_f32_16x16x32_bf16 v[192:195], a[244:247], v[200:203], v[192:195]
    s_waitcnt lgkmcnt(0)
    v_mfma_f32_16x16x32_bf16 v[164:167], a[120:123], v[204:207], v[164:167]
    v_xor_b32 v236, 0x8000, v236
    v_mfma_f32_16x16x32_bf16 v[168:171], a[124:127], v[204:207], v[168:171]
    v_xor_b32 v237, 0x8000, v237
    v_mfma_f32_16x16x32_bf16 v[172:175], a[120:123], v[208:211], v[172:175]
    v_xor_b32 v238, 0x8000, v238
    v_mfma_f32_16x16x32_bf16 v[176:179], a[124:127], v[208:211], v[176:179]
    v_xor_b32 v239, 0x8000, v239
    v_mfma_f32_16x16x32_bf16 v[180:183], a[248:251], v[204:207], v[180:183]
    s_nop 1
    v_mfma_f32_16x16x32_bf16 v[184:187], a[252:255], v[204:207], v[184:187]
    s_nop 1
    v_mfma_f32_16x16x32_bf16 v[188:191], a[248:251], v[208:211], v[188:191]
    s_nop 0
    v_mfma_f32_16x16x32_bf16 v[192:195], a[252:255], v[208:211], v[192:195]
    v_cvt_pk_bf16_f32 v164, v164, v165
    v_cvt_pk_bf16_f32 v165, v166, v167
    v_cvt_pk_bf16_f32 v166, v168, v169
    v_cvt_pk_bf16_f32 v167, v170, v171
    v_cvt_pk_bf16_f32 v168, v172, v173
    v_cvt_pk_bf16_f32 v169, v174, v175
    v_cvt_pk_bf16_f32 v170, v176, v177
    v_cvt_pk_bf16_f32 v171, v178, v179
    v_xor_b32 v11, 0, v2
    buffer_store_dwordx4 v[164:167], v11, s[4:7], s72 offen offset:0 sc1
    v_xor_b32 v11, 512, v2
    buffer_store_dwordx4 v[168:171], v11, s[4:7], s72 offen offset:0 sc1
    v_cvt_pk_bf16_f32 v180, v180, v181
    v_cvt_pk_bf16_f32 v181, v182, v183
    v_cvt_pk_bf16_f32 v182, v184, v185
    v_cvt_pk_bf16_f32 v183, v186, v187
    v_cvt_pk_bf16_f32 v184, v188, v189
    v_cvt_pk_bf16_f32 v185, v190, v191
    v_cvt_pk_bf16_f32 v186, v192, v193
    v_cvt_pk_bf16_f32 v187, v194, v195
    v_xor_b32 v11, 256, v2
    buffer_store_dwordx4 v[180:183], v11, s[4:7], s72 offen offset:2048 sc1
    v_xor_b32 v11, 768, v2
    buffer_store_dwordx4 v[184:187], v11, s[4:7], s72 offen offset:2048 sc1
    s_waitcnt vmcnt(0)
    s_mov_b64 exec, 1
    buffer_store_dword v8, off, s[4:7], s77 sc1
    s_mov_b64 exec, -1
    s_mov_b32 s77, 0
    s_cmp_lt_u32 s67, 128
    s_cbranch_scc1 L_ao_block
    s_branch L_dump_role_ao
L_ao_done:
    s_waitcnt vmcnt(0)
    s_mov_b64 exec, 1
    buffer_store_dword v8, off, s[4:7], s77 sc1
    s_mov_b64 exec, -1
L_dump_role_ao:
    s_branch L_end
L_role_F:
    s_mul_i32 s64, s25, 0x5556
    s_lshr_b32 s64, s64, 16
    s_mul_i32 s23, s64, 3
    s_sub_u32 s65, s25, s23
    s_lshl_b32 s72, s64, 8
    s_lshl_b32 s73, s64, 17
    v_lshrrev_b32 v110, 6, v0
    v_and_b32 v111, 63, v0
    v_lshlrev_b32 v112, 2, v110
    v_xor_b32 v111, v111, v112
    v_mul_u32_u24 v110, 1024, v110
    v_lshl_add_u32 v100, v111, 4, v110
    v_lshrrev_b32 v110, 4, v0
    v_and_b32 v111, 15, v0
    v_lshlrev_b32 v112, 2, v110
    v_xor_b32 v111, v111, v112
    v_mul_u32_u24 v110, 3584, v110
    v_lshl_add_u32 v101, v111, 4, v110
    v_lshrrev_b32 v110, 4, v0
    v_lshlrev_b32 v110, 3, v110
    v_bfe_u32 v113, v0, 2, 2
    v_add_u32 v110, v110, v113
    v_mul_u32_u24 v110, 256, v110
    v_and_b32 v111, 3, v0
    v_lshl_add_u32 v110, v111, 4, v110
    s_mul_i32 s21, s16, 1
    s_add_u32 s21, s21, 0
    v_xor_b32 v111, s21, v113
    v_lshl_add_u32 v102, v111, 6, v110
    v_lshrrev_b32 v110, 4, v0
    v_lshlrev_b32 v110, 3, v110
    v_bfe_u32 v113, v0, 2, 2
    v_add_u32 v110, v110, v113
    v_mul_u32_u24 v110, 1024, v110
    v_and_b32 v111, 3, v0
    v_lshl_add_u32 v110, v111, 4, v110
    s_mul_i32 s21, s16, 4
    s_add_u32 s21, s21, 0
    v_xor_b32 v111, s21, v113
    v_lshl_add_u32 v106, v111, 6, v110
    s_mul_i32 s21, s16, 4
    s_add_u32 s21, s21, 1
    v_xor_b32 v111, s21, v113
    v_lshl_add_u32 v107, v111, 6, v110
    s_mul_i32 s21, s16, 4
    s_add_u32 s21, s21, 2
    v_xor_b32 v111, s21, v113
    v_lshl_add_u32 v108, v111, 6, v110
    s_mul_i32 s21, s16, 4
    s_add_u32 s21, s21, 3
    v_xor_b32 v111, s21, v113
    v_lshl_add_u32 v109, v111, 6, v110
    s_lshl_b32 s26, s16, 13
    s_mov_b32 s8, s48
    s_and_b32 s9, s49, 0xffff
    s_mov_b32 s10, 1835008
    s_mov_b32 s11, 0x20000
    s_mul_i32 s22, s16, 114688
    s_add_u32 s22, s22, s72
    s_add_u32 m0, s26, 0
    s_add_u32 s22, s22, 0
    buffer_load_dwordx4 v101, s[8:11], s22 offen lds
    s_add_u32 m0, m0, 1024
    s_add_u32 s22, s22, 14336
    buffer_load_dwordx4 v101, s[8:11], s22 offen lds
    s_add_u32 m0, m0, 1024
    s_add_u32 s22, s22, 14336
    buffer_load_dwordx4 v101, s[8:11], s22 offen lds
    s_add_u32 m0, m0, 1024
    s_add_u32 s22, s22, 14336
    buffer_load_dwordx4 v101, s[8:11], s22 offen lds
    s_add_u32 m0, m0, 1024
    s_add_u32 s22, s22, 14336
    buffer_load_dwordx4 v101, s[8:11], s22 offen lds
    s_add_u32 m0, m0, 1024
    s_add_u32 s22, s22, 14336
    buffer_load_dwordx4 v101, s[8:11], s22 offen lds
    s_add_u32 m0, m0, 1024
    s_add_u32 s22, s22, 14336
    buffer_load_dwordx4 v101, s[8:11], s22 offen lds
    s_add_u32 m0, m0, 1024
    s_add_u32 s22, s22, 14336
    buffer_load_dwordx4 v101, s[8:11], s22 offen lds
    s_cmp_eq_u32 s91, 0
    s_cbranch_scc0 L_arr_85
    s_mov_b32 s91, 1
    s_waitcnt vmcnt(8)
    s_barrier
    s_cmp_eq_u32 s16, 0
    s_cbranch_scc0 L_arr_85
    s_lshl_b32 s21, s17, 5
    s_add_u32 s21, s21, 4
    s_atomic_add s3, s[56:57], s21
L_arr_85:
    s_mul_i32 s22, s16, 114688
    s_add_u32 s22, s22, s72
    s_add_u32 m0, s26, 32768
    s_add_u32 s22, s22, 458752
    buffer_load_dwordx4 v101, s[8:11], s22 offen lds
    s_add_u32 m0, m0, 1024
    s_add_u32 s22, s22, 14336
    buffer_load_dwordx4 v101, s[8:11], s22 offen lds
    s_add_u32 m0, m0, 1024
    s_add_u32 s22, s22, 14336
    buffer_load_dwordx4 v101, s[8:11], s22 offen lds
    s_add_u32 m0, m0, 1024
    s_add_u32 s22, s22, 14336
    buffer_load_dwordx4 v101, s[8:11], s22 offen lds
    s_add_u32 m0, m0, 1024
    s_add_u32 s22, s22, 14336
    buffer_load_dwordx4 v101, s[8:11], s22 offen lds
    s_add_u32 m0, m0, 1024
    s_add_u32 s22, s22, 14336
    buffer_load_dwordx4 v101, s[8:11], s22 offen lds
    s_add_u32 m0, m0, 1024
    s_add_u32 s22, s22, 14336
    buffer_load_dwordx4 v101, s[8:11], s22 offen lds
    s_add_u32 m0, m0, 1024
    s_add_u32 s22, s22, 14336
    buffer_load_dwordx4 v101, s[8:11], s22 offen lds
    s_mul_i32 s22, s16, 114688
    s_add_u32 s22, s22, s72
    s_add_u32 m0, s26, 65536
    s_add_u32 s22, s22, 917504
    buffer_load_dwordx4 v101, s[8:11], s22 offen lds
    s_add_u32 m0, m0, 1024
    s_add_u32 s22, s22, 14336
    buffer_load_dwordx4 v101, s[8:11], s22 offen lds
    s_add_u32 m0, m0, 1024
    s_add_u32 s22, s22, 14336
    buffer_load_dwordx4 v101, s[8:11], s22 offen lds
    s_add_u32 m0, m0, 1024
    s_add_u32 s22, s22, 14336
    buffer_load_dwordx4 v101, s[8:11], s22 offen lds
    s_add_u32 m0, m0, 1024
    s_add_u32 s22, s22, 14336
    buffer_load_dwordx4 v101, s[8:11], s22 offen lds
    s_add_u32 m0, m0, 1024
    s_add_u32 s22, s22, 14336
    buffer_load_dwordx4 v101, s[8:11], s22 offen lds
    s_add_u32 m0, m0, 1024
    s_add_u32 s22, s22, 14336
    buffer_load_dwordx4 v101, s[8:11], s22 offen lds
    s_add_u32 m0, m0, 1024
    s_add_u32 s22, s22, 14336
    buffer_load_dwordx4 v101, s[8:11], s22 offen lds
    s_mul_i32 s22, s16, 114688
    s_add_u32 s22, s22, s72
    s_add_u32 m0, s26, 98304
    s_add_u32 s22, s22, 1376256
    buffer_load_dwordx4 v101, s[8:11], s22 offen lds
    s_add_u32 m0, m0, 1024
    s_add_u32 s22, s22, 14336
    buffer_load_dwordx4 v101, s[8:11], s22 offen lds
    s_add_u32 m0, m0, 1024
    s_add_u32 s22, s22, 14336
    buffer_load_dwordx4 v101, s[8:11], s22 offen lds
    s_add_u32 m0, m0, 1024
    s_add_u32 s22, s22, 14336
    buffer_load_dwordx4 v101, s[8:11], s22 offen lds
    s_add_u32 m0, m0, 1024
    s_add_u32 s22, s22, 14336
    buffer_load_dwordx4 v101, s[8:11], s22 offen lds
    s_add_u32 m0, m0, 1024
    s_add_u32 s22, s22, 14336
    buffer_load_dwordx4 v101, s[8:11], s22 offen lds
    s_add_u32 m0, m0, 1024
    s_add_u32 s22, s22, 14336
    buffer_load_dwordx4 v101, s[8:11], s22 offen lds
    s_add_u32 m0, m0, 1024
    s_add_u32 s22, s22, 14336
    buffer_load_dwordx4 v101, s[8:11], s22 offen lds
    s_waitcnt vmcnt(24)
    s_barrier
    s_cmp_eq_u32 s16, 0
    s_cbranch_scc0 L_w_86_1
    ds_read_b64_tr_b16 a[0:1], v102 offset:0
    ds_read_b64_tr_b16 a[2:3], v102 offset:1024
    ds_read_b64_tr_b16 a[4:5], v102 offset:8
    ds_read_b64_tr_b16 a[6:7], v102 offset:1032
    ds_read_b64_tr_b16 a[8:9], v102 offset:8192
    ds_read_b64_tr_b16 a[10:11], v102 offset:9216
    ds_read_b64_tr_b16 a[12:13], v102 offset:8200
    ds_read_b64_tr_b16 a[14:15], v102 offset:9224
    s_waitcnt lgkmcnt(0)
    ds_read_b64_tr_b16 a[16:17], v102 offset:16384
    ds_read_b64_tr_b16 a[18:19], v102 offset:17408
    ds_read_b64_tr_b16 a[20:21], v102 offset:16392
    ds_read_b64_tr_b16 a[22:23], v102 offset:17416
    ds_read_b64_tr_b16 a[24:25], v102 offset:24576
    ds_read_b64_tr_b16 a[26:27], v102 offset:25600
    ds_read_b64_tr_b16 a[28:29], v102 offset:24584
    ds_read_b64_tr_b16 a[30:31], v102 offset:25608
    s_branch L_w_86
L_w_86_1:
    s_cmp_eq_u32 s16, 1
    s_cbranch_scc0 L_w_86_2
    ds_read_b64_tr_b16 a[32:33], v102 offset:0
    ds_read_b64_tr_b16 a[34:35], v102 offset:1024
    ds_read_b64_tr_b16 a[36:37], v102 offset:8
    ds_read_b64_tr_b16 a[38:39], v102 offset:1032
    ds_read_b64_tr_b16 a[40:41], v102 offset:8192
    ds_read_b64_tr_b16 a[42:43], v102 offset:9216
    ds_read_b64_tr_b16 a[44:45], v102 offset:8200
    ds_read_b64_tr_b16 a[46:47], v102 offset:9224
    s_waitcnt lgkmcnt(0)
    ds_read_b64_tr_b16 a[48:49], v102 offset:16384
    ds_read_b64_tr_b16 a[50:51], v102 offset:17408
    ds_read_b64_tr_b16 a[52:53], v102 offset:16392
    ds_read_b64_tr_b16 a[54:55], v102 offset:17416
    ds_read_b64_tr_b16 a[56:57], v102 offset:24576
    ds_read_b64_tr_b16 a[58:59], v102 offset:25600
    ds_read_b64_tr_b16 a[60:61], v102 offset:24584
    ds_read_b64_tr_b16 a[62:63], v102 offset:25608
    s_branch L_w_86
L_w_86_2:
    s_cmp_eq_u32 s16, 2
    s_cbranch_scc0 L_w_86_3
    ds_read_b64_tr_b16 a[64:65], v102 offset:0
    ds_read_b64_tr_b16 a[66:67], v102 offset:1024
    ds_read_b64_tr_b16 a[68:69], v102 offset:8
    ds_read_b64_tr_b16 a[70:71], v102 offset:1032
    ds_read_b64_tr_b16 a[72:73], v102 offset:8192
    ds_read_b64_tr_b16 a[74:75], v102 offset:9216
    ds_read_b64_tr_b16 a[76:77], v102 offset:8200
    ds_read_b64_tr_b16 a[78:79], v102 offset:9224
    s_waitcnt lgkmcnt(0)
    ds_read_b64_tr_b16 a[80:81], v102 offset:16384
    ds_read_b64_tr_b16 a[82:83], v102 offset:17408
    ds_read_b64_tr_b16 a[84:85], v102 offset:16392
    ds_read_b64_tr_b16 a[86:87], v102 offset:17416
    ds_read_b64_tr_b16 a[88:89], v102 offset:24576
    ds_read_b64_tr_b16 a[90:91], v102 offset:25600
    ds_read_b64_tr_b16 a[92:93], v102 offset:24584
    ds_read_b64_tr_b16 a[94:95], v102 offset:25608
    s_branch L_w_86
L_w_86_3:
    ds_read_b64_tr_b16 a[96:97], v102 offset:0
    ds_read_b64_tr_b16 a[98:99], v102 offset:1024
    ds_read_b64_tr_b16 a[100:101], v102 offset:8
    ds_read_b64_tr_b16 a[102:103], v102 offset:1032
    ds_read_b64_tr_b16 a[104:105], v102 offset:8192
    ds_read_b64_tr_b16 a[106:107], v102 offset:9216
    ds_read_b64_tr_b16 a[108:109], v102 offset:8200
    ds_read_b64_tr_b16 a[110:111], v102 offset:9224
    s_waitcnt lgkmcnt(0)
    ds_read_b64_tr_b16 a[112:113], v102 offset:16384
    ds_read_b64_tr_b16 a[114:115], v102 offset:17408
    ds_read_b64_tr_b16 a[116:117], v102 offset:16392
    ds_read_b64_tr_b16 a[118:119], v102 offset:17416
    ds_read_b64_tr_b16 a[120:121], v102 offset:24576
    ds_read_b64_tr_b16 a[122:123], v102 offset:25600
    ds_read_b64_tr_b16 a[124:125], v102 offset:24584
    ds_read_b64_tr_b16 a[126:127], v102 offset:25608
L_w_86:
    s_waitcnt lgkmcnt(0)
    s_waitcnt vmcnt(16)
    s_barrier
    s_mov_b32 s8, s50
    s_and_b32 s9, s51, 0xffff
    s_mov_b32 s10, 1835008
    s_mov_b32 s11, 0x20000
    s_mul_i32 s22, s16, 114688
    s_add_u32 s22, s22, s72
    s_add_u32 m0, s26, 0
    s_add_u32 s22, s22, 0
    buffer_load_dwordx4 v101, s[8:11], s22 offen lds
    s_add_u32 m0, m0, 1024
    s_add_u32 s22, s22, 14336
    buffer_load_dwordx4 v101, s[8:11], s22 offen lds
    s_add_u32 m0, m0, 1024
    s_add_u32 s22, s22, 14336
    buffer_load_dwordx4 v101, s[8:11], s22 offen lds
    s_add_u32 m0, m0, 1024
    s_add_u32 s22, s22, 14336
    buffer_load_dwordx4 v101, s[8:11], s22 offen lds
    s_add_u32 m0, m0, 1024
    s_add_u32 s22, s22, 14336
    buffer_load_dwordx4 v101, s[8:11], s22 offen lds
    s_add_u32 m0, m0, 1024
    s_add_u32 s22, s22, 14336
    buffer_load_dwordx4 v101, s[8:11], s22 offen lds
    s_add_u32 m0, m0, 1024
    s_add_u32 s22, s22, 14336
    buffer_load_dwordx4 v101, s[8:11], s22 offen lds
    s_add_u32 m0, m0, 1024
    s_add_u32 s22, s22, 14336
    buffer_load_dwordx4 v101, s[8:11], s22 offen lds
    s_cmp_eq_u32 s16, 0
    s_cbranch_scc0 L_w_87_1
    ds_read_b64_tr_b16 a[32:33], v102 offset:32768
    ds_read_b64_tr_b16 a[34:35], v102 offset:33792
    ds_read_b64_tr_b16 a[36:37], v102 offset:32776
    ds_read_b64_tr_b16 a[38:39], v102 offset:33800
    ds_read_b64_tr_b16 a[40:41], v102 offset:40960
    ds_read_b64_tr_b16 a[42:43], v102 offset:41984
    ds_read_b64_tr_b16 a[44:45], v102 offset:40968
    ds_read_b64_tr_b16 a[46:47], v102 offset:41992
    s_waitcnt lgkmcnt(0)
    ds_read_b64_tr_b16 a[48:49], v102 offset:49152
    ds_read_b64_tr_b16 a[50:51], v102 offset:50176
    ds_read_b64_tr_b16 a[52:53], v102 offset:49160
    ds_read_b64_tr_b16 a[54:55], v102 offset:50184
    ds_read_b64_tr_b16 a[56:57], v102 offset:57344
    ds_read_b64_tr_b16 a[58:59], v102 offset:58368
    ds_read_b64_tr_b16 a[60:61], v102 offset:57352
    ds_read_b64_tr_b16 a[62:63], v102 offset:58376
    s_branch L_w_87
L_w_87_1:
    s_cmp_eq_u32 s16, 1
    s_cbranch_scc0 L_w_87_2
    ds_read_b64_tr_b16 a[0:1], v102 offset:32768
    ds_read_b64_tr_b16 a[2:3], v102 offset:33792
    ds_read_b64_tr_b16 a[4:5], v102 offset:32776
    ds_read_b64_tr_b16 a[6:7], v102 offset:33800
    ds_read_b64_tr_b16 a[8:9], v102 offset:40960
    ds_read_b64_tr_b16 a[10:11], v102 offset:41984
    ds_read_b64_tr_b16 a[12:13], v102 offset:40968
    ds_read_b64_tr_b16 a[14:15], v102 offset:41992
    s_waitcnt lgkmcnt(0)
    ds_read_b64_tr_b16 a[16:17], v102 offset:49152
    ds_read_b64_tr_b16 a[18:19], v102 offset:50176
    ds_read_b64_tr_b16 a[20:21], v102 offset:49160
    ds_read_b64_tr_b16 a[22:23], v102 offset:50184
    ds_read_b64_tr_b16 a[24:25], v102 offset:57344
    ds_read_b64_tr_b16 a[26:27], v102 offset:58368
    ds_read_b64_tr_b16 a[28:29], v102 offset:57352
    ds_read_b64_tr_b16 a[30:31], v102 offset:58376
    s_branch L_w_87
L_w_87_2:
    s_cmp_eq_u32 s16, 2
    s_cbranch_scc0 L_w_87_3
    ds_read_b64_tr_b16 a[96:97], v102 offset:32768
    ds_read_b64_tr_b16 a[98:99], v102 offset:33792
    ds_read_b64_tr_b16 a[100:101], v102 offset:32776
    ds_read_b64_tr_b16 a[102:103], v102 offset:33800
    ds_read_b64_tr_b16 a[104:105], v102 offset:40960
    ds_read_b64_tr_b16 a[106:107], v102 offset:41984
    ds_read_b64_tr_b16 a[108:109], v102 offset:40968
    ds_read_b64_tr_b16 a[110:111], v102 offset:41992
    s_waitcnt lgkmcnt(0)
    ds_read_b64_tr_b16 a[112:113], v102 offset:49152
    ds_read_b64_tr_b16 a[114:115], v102 offset:50176
    ds_read_b64_tr_b16 a[116:117], v102 offset:49160
    ds_read_b64_tr_b16 a[118:119], v102 offset:50184
    ds_read_b64_tr_b16 a[120:121], v102 offset:57344
    ds_read_b64_tr_b16 a[122:123], v102 offset:58368
    ds_read_b64_tr_b16 a[124:125], v102 offset:57352
    ds_read_b64_tr_b16 a[126:127], v102 offset:58376
    s_branch L_w_87
L_w_87_3:
    ds_read_b64_tr_b16 a[64:65], v102 offset:32768
    ds_read_b64_tr_b16 a[66:67], v102 offset:33792
    ds_read_b64_tr_b16 a[68:69], v102 offset:32776
    ds_read_b64_tr_b16 a[70:71], v102 offset:33800
    ds_read_b64_tr_b16 a[72:73], v102 offset:40960
    ds_read_b64_tr_b16 a[74:75], v102 offset:41984
    ds_read_b64_tr_b16 a[76:77], v102 offset:40968
    ds_read_b64_tr_b16 a[78:79], v102 offset:41992
    s_waitcnt lgkmcnt(0)
    ds_read_b64_tr_b16 a[80:81], v102 offset:49152
    ds_read_b64_tr_b16 a[82:83], v102 offset:50176
    ds_read_b64_tr_b16 a[84:85], v102 offset:49160
    ds_read_b64_tr_b16 a[86:87], v102 offset:50184
    ds_read_b64_tr_b16 a[88:89], v102 offset:57344
    ds_read_b64_tr_b16 a[90:91], v102 offset:58368
    ds_read_b64_tr_b16 a[92:93], v102 offset:57352
    ds_read_b64_tr_b16 a[94:95], v102 offset:58376
L_w_87:
    s_waitcnt lgkmcnt(0)
    s_waitcnt vmcnt(16)
    s_barrier
    s_mul_i32 s22, s16, 114688
    s_add_u32 s22, s22, s72
    s_add_u32 m0, s26, 32768
    s_add_u32 s22, s22, 458752
    buffer_load_dwordx4 v101, s[8:11], s22 offen lds
    s_add_u32 m0, m0, 1024
    s_add_u32 s22, s22, 14336
    buffer_load_dwordx4 v101, s[8:11], s22 offen lds
    s_add_u32 m0, m0, 1024
    s_add_u32 s22, s22, 14336
    buffer_load_dwordx4 v101, s[8:11], s22 offen lds
    s_add_u32 m0, m0, 1024
    s_add_u32 s22, s22, 14336
    buffer_load_dwordx4 v101, s[8:11], s22 offen lds
    s_add_u32 m0, m0, 1024
    s_add_u32 s22, s22, 14336
    buffer_load_dwordx4 v101, s[8:11], s22 offen lds
    s_add_u32 m0, m0, 1024
    s_add_u32 s22, s22, 14336
    buffer_load_dwordx4 v101, s[8:11], s22 offen lds
    s_add_u32 m0, m0, 1024
    s_add_u32 s22, s22, 14336
    buffer_load_dwordx4 v101, s[8:11], s22 offen lds
    s_add_u32 m0, m0, 1024
    s_add_u32 s22, s22, 14336
    buffer_load_dwordx4 v101, s[8:11], s22 offen lds
    v_xor_b32 v102, 0x10000, v102
    v_xor_b32 v103, 0x10000, v103
    v_xor_b32 v104, 0x10000, v104
    v_xor_b32 v105, 0x10000, v105
    v_xor_b32 v106, 0x10000, v106
    v_xor_b32 v107, 0x10000, v107
    v_xor_b32 v108, 0x10000, v108
    v_xor_b32 v109, 0x10000, v109
    s_cmp_eq_u32 s16, 0
    s_cbranch_scc0 L_w_88_1
    ds_read_b64_tr_b16 a[64:65], v102 offset:0
    ds_read_b64_tr_b16 a[66:67], v102 offset:1024
    ds_read_b64_tr_b16 a[68:69], v102 offset:8
    ds_read_b64_tr_b16 a[70:71], v102 offset:1032
    ds_read_b64_tr_b16 a[72:73], v102 offset:8192
    ds_read_b64_tr_b16 a[74:75], v102 offset:9216
    ds_read_b64_tr_b16 a[76:77], v102 offset:8200
    ds_read_b64_tr_b16 a[78:79], v102 offset:9224
    s_waitcnt lgkmcnt(0)
    ds_read_b64_tr_b16 a[80:81], v102 offset:16384
    ds_read_b64_tr_b16 a[82:83], v102 offset:17408
    ds_read_b64_tr_b16 a[84:85], v102 offset:16392
    ds_read_b64_tr_b16 a[86:87], v102 offset:17416
    ds_read_b64_tr_b16 a[88:89], v102 offset:24576
    ds_read_b64_tr_b16 a[90:91], v102 offset:25600
    ds_read_b64_tr_b16 a[92:93], v102 offset:24584
    ds_read_b64_tr_b16 a[94:95], v102 offset:25608
    s_branch L_w_88
L_w_88_1:
    s_cmp_eq_u32 s16, 1
    s_cbranch_scc0 L_w_88_2
    ds_read_b64_tr_b16 a[96:97], v102 offset:0
    ds_read_b64_tr_b16 a[98:99], v102 offset:1024
    ds_read_b64_tr_b16 a[100:101], v102 offset:8
    ds_read_b64_tr_b16 a[102:103], v102 offset:1032
    ds_read_b64_tr_b16 a[104:105], v102 offset:8192
    ds_read_b64_tr_b16 a[106:107], v102 offset:9216
    ds_read_b64_tr_b16 a[108:109], v102 offset:8200
    ds_read_b64_tr_b16 a[110:111], v102 offset:9224
    s_waitcnt lgkmcnt(0)
    ds_read_b64_tr_b16 a[112:113], v102 offset:16384
    ds_read_b64_tr_b16 a[114:115], v102 offset:17408
    ds_read_b64_tr_b16 a[116:117], v102 offset:16392
    ds_read_b64_tr_b16 a[118:119], v102 offset:17416
    ds_read_b64_tr_b16 a[120:121], v102 offset:24576
    ds_read_b64_tr_b16 a[122:123], v102 offset:25600
    ds_read_b64_tr_b16 a[124:125], v102 offset:24584
    ds_read_b64_tr_b16 a[126:127], v102 offset:25608
    s_branch L_w_88
L_w_88_2:
    s_cmp_eq_u32 s16, 2
    s_cbranch_scc0 L_w_88_3
    ds_read_b64_tr_b16 a[0:1], v102 offset:0
    ds_read_b64_tr_b16 a[2:3], v102 offset:1024
    ds_read_b64_tr_b16 a[4:5], v102 offset:8
    ds_read_b64_tr_b16 a[6:7], v102 offset:1032
    ds_read_b64_tr_b16 a[8:9], v102 offset:8192
    ds_read_b64_tr_b16 a[10:11], v102 offset:9216
    ds_read_b64_tr_b16 a[12:13], v102 offset:8200
    ds_read_b64_tr_b16 a[14:15], v102 offset:9224
    s_waitcnt lgkmcnt(0)
    ds_read_b64_tr_b16 a[16:17], v102 offset:16384
    ds_read_b64_tr_b16 a[18:19], v102 offset:17408
    ds_read_b64_tr_b16 a[20:21], v102 offset:16392
    ds_read_b64_tr_b16 a[22:23], v102 offset:17416
    ds_read_b64_tr_b16 a[24:25], v102 offset:24576
    ds_read_b64_tr_b16 a[26:27], v102 offset:25600
    ds_read_b64_tr_b16 a[28:29], v102 offset:24584
    ds_read_b64_tr_b16 a[30:31], v102 offset:25608
    s_branch L_w_88
L_w_88_3:
    ds_read_b64_tr_b16 a[32:33], v102 offset:0
    ds_read_b64_tr_b16 a[34:35], v102 offset:1024
    ds_read_b64_tr_b16 a[36:37], v102 offset:8
    ds_read_b64_tr_b16 a[38:39], v102 offset:1032
    ds_read_b64_tr_b16 a[40:41], v102 offset:8192
    ds_read_b64_tr_b16 a[42:43], v102 offset:9216
    ds_read_b64_tr_b16 a[44:45], v102 offset:8200
    ds_read_b64_tr_b16 a[46:47], v102 offset:9224
    s_waitcnt lgkmcnt(0)
    ds_read_b64_tr_b16 a[48:49], v102 offset:16384
    ds_read_b64_tr_b16 a[50:51], v102 offset:17408
    ds_read_b64_tr_b16 a[52:53], v102 offset:16392
    ds_read_b64_tr_b16 a[54:55], v102 offset:17416
    ds_read_b64_tr_b16 a[56:57], v102 offset:24576
    ds_read_b64_tr_b16 a[58:59], v102 offset:25600
    ds_read_b64_tr_b16 a[60:61], v102 offset:24584
    ds_read_b64_tr_b16 a[62:63], v102 offset:25608
L_w_88:
    s_waitcnt lgkmcnt(0)
    s_waitcnt vmcnt(16)
    s_barrier
    s_mul_i32 s22, s16, 114688
    s_add_u32 s22, s22, s72
    s_add_u32 m0, s26, 65536
    s_add_u32 s22, s22, 917504
    buffer_load_dwordx4 v101, s[8:11], s22 offen lds
    s_add_u32 m0, m0, 1024
    s_add_u32 s22, s22, 14336
    buffer_load_dwordx4 v101, s[8:11], s22 offen lds
    s_add_u32 m0, m0, 1024
    s_add_u32 s22, s22, 14336
    buffer_load_dwordx4 v101, s[8:11], s22 offen lds
    s_add_u32 m0, m0, 1024
    s_add_u32 s22, s22, 14336
    buffer_load_dwordx4 v101, s[8:11], s22 offen lds
    s_add_u32 m0, m0, 1024
    s_add_u32 s22, s22, 14336
    buffer_load_dwordx4 v101, s[8:11], s22 offen lds
    s_add_u32 m0, m0, 1024
    s_add_u32 s22, s22, 14336
    buffer_load_dwordx4 v101, s[8:11], s22 offen lds
    s_add_u32 m0, m0, 1024
    s_add_u32 s22, s22, 14336
    buffer_load_dwordx4 v101, s[8:11], s22 offen lds
    s_add_u32 m0, m0, 1024
    s_add_u32 s22, s22, 14336
    buffer_load_dwordx4 v101, s[8:11], s22 offen lds
    s_cmp_eq_u32 s16, 0
    s_cbranch_scc0 L_w_89_1
    ds_read_b64_tr_b16 a[96:97], v102 offset:32768
    ds_read_b64_tr_b16 a[98:99], v102 offset:33792
    ds_read_b64_tr_b16 a[100:101], v102 offset:32776
    ds_read_b64_tr_b16 a[102:103], v102 offset:33800
    ds_read_b64_tr_b16 a[104:105], v102 offset:40960
    ds_read_b64_tr_b16 a[106:107], v102 offset:41984
    ds_read_b64_tr_b16 a[108:109], v102 offset:40968
    ds_read_b64_tr_b16 a[110:111], v102 offset:41992
    s_waitcnt lgkmcnt(0)
    ds_read_b64_tr_b16 a[112:113], v102 offset:49152
    ds_read_b64_tr_b16 a[114:115], v102 offset:50176
    ds_read_b64_tr_b16 a[116:117], v102 offset:49160
    ds_read_b64_tr_b16 a[118:119], v102 offset:50184
    ds_read_b64_tr_b16 a[120:121], v102 offset:57344
    ds_read_b64_tr_b16 a[122:123], v102 offset:58368
    ds_read_b64_tr_b16 a[124:125], v102 offset:57352
    ds_read_b64_tr_b16 a[126:127], v102 offset:58376
    s_branch L_w_89
L_w_89_1:
    s_cmp_eq_u32 s16, 1
    s_cbranch_scc0 L_w_89_2
    ds_read_b64_tr_b16 a[64:65], v102 offset:32768
    ds_read_b64_tr_b16 a[66:67], v102 offset:33792
    ds_read_b64_tr_b16 a[68:69], v102 offset:32776
    ds_read_b64_tr_b16 a[70:71], v102 offset:33800
    ds_read_b64_tr_b16 a[72:73], v102 offset:40960
    ds_read_b64_tr_b16 a[74:75], v102 offset:41984
    ds_read_b64_tr_b16 a[76:77], v102 offset:40968
    ds_read_b64_tr_b16 a[78:79], v102 offset:41992
    s_waitcnt lgkmcnt(0)
    ds_read_b64_tr_b16 a[80:81], v102 offset:49152
    ds_read_b64_tr_b16 a[82:83], v102 offset:50176
    ds_read_b64_tr_b16 a[84:85], v102 offset:49160
    ds_read_b64_tr_b16 a[86:87], v102 offset:50184
    ds_read_b64_tr_b16 a[88:89], v102 offset:57344
    ds_read_b64_tr_b16 a[90:91], v102 offset:58368
    ds_read_b64_tr_b16 a[92:93], v102 offset:57352
    ds_read_b64_tr_b16 a[94:95], v102 offset:58376
    s_branch L_w_89
L_w_89_2:
    s_cmp_eq_u32 s16, 2
    s_cbranch_scc0 L_w_89_3
    ds_read_b64_tr_b16 a[32:33], v102 offset:32768
    ds_read_b64_tr_b16 a[34:35], v102 offset:33792
    ds_read_b64_tr_b16 a[36:37], v102 offset:32776
    ds_read_b64_tr_b16 a[38:39], v102 offset:33800
    ds_read_b64_tr_b16 a[40:41], v102 offset:40960
    ds_read_b64_tr_b16 a[42:43], v102 offset:41984
    ds_read_b64_tr_b16 a[44:45], v102 offset:40968
    ds_read_b64_tr_b16 a[46:47], v102 offset:41992
    s_waitcnt lgkmcnt(0)
    ds_read_b64_tr_b16 a[48:49], v102 offset:49152
    ds_read_b64_tr_b16 a[50:51], v102 offset:50176
    ds_read_b64_tr_b16 a[52:53], v102 offset:49160
    ds_read_b64_tr_b16 a[54:55], v102 offset:50184
    ds_read_b64_tr_b16 a[56:57], v102 offset:57344
    ds_read_b64_tr_b16 a[58:59], v102 offset:58368
    ds_read_b64_tr_b16 a[60:61], v102 offset:57352
    ds_read_b64_tr_b16 a[62:63], v102 offset:58376
    s_branch L_w_89
L_w_89_3:
    ds_read_b64_tr_b16 a[0:1], v102 offset:32768
    ds_read_b64_tr_b16 a[2:3], v102 offset:33792
    ds_read_b64_tr_b16 a[4:5], v102 offset:32776
    ds_read_b64_tr_b16 a[6:7], v102 offset:33800
    ds_read_b64_tr_b16 a[8:9], v102 offset:40960
    ds_read_b64_tr_b16 a[10:11], v102 offset:41984
    ds_read_b64_tr_b16 a[12:13], v102 offset:40968
    ds_read_b64_tr_b16 a[14:15], v102 offset:41992
    s_waitcnt lgkmcnt(0)
    ds_read_b64_tr_b16 a[16:17], v102 offset:49152
    ds_read_b64_tr_b16 a[18:19], v102 offset:50176
    ds_read_b64_tr_b16 a[20:21], v102 offset:49160
    ds_read_b64_tr_b16 a[22:23], v102 offset:50184
    ds_read_b64_tr_b16 a[24:25], v102 offset:57344
    ds_read_b64_tr_b16 a[26:27], v102 offset:58368
    ds_read_b64_tr_b16 a[28:29], v102 offset:57352
    ds_read_b64_tr_b16 a[30:31], v102 offset:58376
L_w_89:
    s_waitcnt lgkmcnt(0)
    s_waitcnt vmcnt(16)
    s_barrier
    s_mul_i32 s22, s16, 114688
    s_add_u32 s22, s22, s72
    s_add_u32 m0, s26, 98304
    s_add_u32 s22, s22, 1376256
    buffer_load_dwordx4 v101, s[8:11], s22 offen lds
    s_add_u32 m0, m0, 1024
    s_add_u32 s22, s22, 14336
    buffer_load_dwordx4 v101, s[8:11], s22 offen lds
    s_add_u32 m0, m0, 1024
    s_add_u32 s22, s22, 14336
    buffer_load_dwordx4 v101, s[8:11], s22 offen lds
    s_add_u32 m0, m0, 1024
    s_add_u32 s22, s22, 14336
    buffer_load_dwordx4 v101, s[8:11], s22 offen lds
    s_add_u32 m0, m0, 1024
    s_add_u32 s22, s22, 14336
    buffer_load_dwordx4 v101, s[8:11], s22 offen lds
    s_add_u32 m0, m0, 1024
    s_add_u32 s22, s22, 14336
    buffer_load_dwordx4 v101, s[8:11], s22 offen lds
    s_add_u32 m0, m0, 1024
    s_add_u32 s22, s22, 14336
    buffer_load_dwordx4 v101, s[8:11], s22 offen lds
    s_add_u32 m0, m0, 1024
    s_add_u32 s22, s22, 14336
    buffer_load_dwordx4 v101, s[8:11], s22 offen lds
    v_xor_b32 v102, 0x10000, v102
    v_xor_b32 v103, 0x10000, v103
    v_xor_b32 v104, 0x10000, v104
    v_xor_b32 v105, 0x10000, v105
    v_xor_b32 v106, 0x10000, v106
    v_xor_b32 v107, 0x10000, v107
    v_xor_b32 v108, 0x10000, v108
    v_xor_b32 v109, 0x10000, v109
    s_cmp_eq_u32 s16, 0
    s_cbranch_scc0 L_w_90_1
    ds_read_b64_tr_b16 a[128:129], v102 offset:0
    ds_read_b64_tr_b16 a[130:131], v102 offset:1024
    ds_read_b64_tr_b16 a[132:133], v102 offset:8
    ds_read_b64_tr_b16 a[134:135], v102 offset:1032
    ds_read_b64_tr_b16 a[136:137], v102 offset:8192
    ds_read_b64_tr_b16 a[138:139], v102 offset:9216
    ds_read_b64_tr_b16 a[140:141], v102 offset:8200
    ds_read_b64_tr_b16 a[142:143], v102 offset:9224
    s_waitcnt lgkmcnt(0)
    ds_read_b64_tr_b16 a[144:145], v102 offset:16384
    ds_read_b64_tr_b16 a[146:147], v102 offset:17408
    ds_read_b64_tr_b16 a[148:149], v102 offset:16392
    ds_read_b64_tr_b16 a[150:151], v102 offset:17416
    ds_read_b64_tr_b16 a[152:153], v102 offset:24576
    ds_read_b64_tr_b16 a[154:155], v102 offset:25600
    ds_read_b64_tr_b16 a[156:157], v102 offset:24584
    ds_read_b64_tr_b16 a[158:159], v102 offset:25608
    s_branch L_w_90
L_w_90_1:
    s_cmp_eq_u32 s16, 1
    s_cbranch_scc0 L_w_90_2
    ds_read_b64_tr_b16 a[160:161], v102 offset:0
    ds_read_b64_tr_b16 a[162:163], v102 offset:1024
    ds_read_b64_tr_b16 a[164:165], v102 offset:8
    ds_read_b64_tr_b16 a[166:167], v102 offset:1032
    ds_read_b64_tr_b16 a[168:169], v102 offset:8192
    ds_read_b64_tr_b16 a[170:171], v102 offset:9216
    ds_read_b64_tr_b16 a[172:173], v102 offset:8200
    ds_read_b64_tr_b16 a[174:175], v102 offset:9224
    s_waitcnt lgkmcnt(0)
    ds_read_b64_tr_b16 a[176:177], v102 offset:16384
    ds_read_b64_tr_b16 a[178:179], v102 offset:17408
    ds_read_b64_tr_b16 a[180:181], v102 offset:16392
    ds_read_b64_tr_b16 a[182:183], v102 offset:17416
    ds_read_b64_tr_b16 a[184:185], v102 offset:24576
    ds_read_b64_tr_b16 a[186:187], v102 offset:25600
    ds_read_b64_tr_b16 a[188:189], v102 offset:24584
    ds_read_b64_tr_b16 a[190:191], v102 offset:25608
    s_branch L_w_90
L_w_90_2:
    s_cmp_eq_u32 s16, 2
    s_cbranch_scc0 L_w_90_3
    ds_read_b64_tr_b16 a[192:193], v102 offset:0
    ds_read_b64_tr_b16 a[194:195], v102 offset:1024
    ds_read_b64_tr_b16 a[196:197], v102 offset:8
    ds_read_b64_tr_b16 a[198:199], v102 offset:1032
    ds_read_b64_tr_b16 a[200:201], v102 offset:8192
    ds_read_b64_tr_b16 a[202:203], v102 offset:9216
    ds_read_b64_tr_b16 a[204:205], v102 offset:8200
    ds_read_b64_tr_b16 a[206:207], v102 offset:9224
    s_waitcnt lgkmcnt(0)
    ds_read_b64_tr_b16 a[208:209], v102 offset:16384
    ds_read_b64_tr_b16 a[210:211], v102 offset:17408
    ds_read_b64_tr_b16 a[212:213], v102 offset:16392
    ds_read_b64_tr_b16 a[214:215], v102 offset:17416
    ds_read_b64_tr_b16 a[216:217], v102 offset:24576
    ds_read_b64_tr_b16 a[218:219], v102 offset:25600
    ds_read_b64_tr_b16 a[220:221], v102 offset:24584
    ds_read_b64_tr_b16 a[222:223], v102 offset:25608
    s_branch L_w_90
L_w_90_3:
    ds_read_b64_tr_b16 a[224:225], v102 offset:0
    ds_read_b64_tr_b16 a[226:227], v102 offset:1024
    ds_read_b64_tr_b16 a[228:229], v102 offset:8
    ds_read_b64_tr_b16 a[230:231], v102 offset:1032
    ds_read_b64_tr_b16 a[232:233], v102 offset:8192
    ds_read_b64_tr_b16 a[234:235], v102 offset:9216
    ds_read_b64_tr_b16 a[236:237], v102 offset:8200
    ds_read_b64_tr_b16 a[238:239], v102 offset:9224
    s_waitcnt lgkmcnt(0)
    ds_read_b64_tr_b16 a[240:241], v102 offset:16384
    ds_read_b64_tr_b16 a[242:243], v102 offset:17408
    ds_read_b64_tr_b16 a[244:245], v102 offset:16392
    ds_read_b64_tr_b16 a[246:247], v102 offset:17416
    ds_read_b64_tr_b16 a[248:249], v102 offset:24576
    ds_read_b64_tr_b16 a[250:251], v102 offset:25600
    ds_read_b64_tr_b16 a[252:253], v102 offset:24584
    ds_read_b64_tr_b16 a[254:255], v102 offset:25608
L_w_90:
    s_waitcnt lgkmcnt(0)
    s_waitcnt vmcnt(16)
    s_barrier
    s_mov_b32 s8, s52
    s_and_b32 s9, s53, 0xffff
    s_mov_b32 s10, 1835008
    s_mov_b32 s11, 0x20000
    s_mul_i32 s22, s16, 8192
    s_add_u32 s22, s22, s73
    s_add_u32 m0, s26, 0
    s_add_u32 s22, s22, 0
    buffer_load_dwordx4 v100, s[8:11], s22 offen lds
    s_add_u32 m0, m0, 1024
    s_add_u32 s22, s22, 1024
    v_xor_b32 v114, 64, v100
    buffer_load_dwordx4 v114, s[8:11], s22 offen lds
    s_add_u32 m0, m0, 1024
    s_add_u32 s22, s22, 1024
    v_xor_b32 v114, 128, v100
    buffer_load_dwordx4 v114, s[8:11], s22 offen lds
    s_add_u32 m0, m0, 1024
    s_add_u32 s22, s22, 1024
    v_xor_b32 v114, 192, v100
    buffer_load_dwordx4 v114, s[8:11], s22 offen lds
    s_add_u32 m0, m0, 1024
    s_add_u32 s22, s22, 1024
    buffer_load_dwordx4 v100, s[8:11], s22 offen lds
    s_add_u32 m0, m0, 1024
    s_add_u32 s22, s22, 1024
    v_xor_b32 v114, 64, v100
    buffer_load_dwordx4 v114, s[8:11], s22 offen lds
    s_add_u32 m0, m0, 1024
    s_add_u32 s22, s22, 1024
    v_xor_b32 v114, 128, v100
    buffer_load_dwordx4 v114, s[8:11], s22 offen lds
    s_add_u32 m0, m0, 1024
    s_add_u32 s22, s22, 1024
    v_xor_b32 v114, 192, v100
    buffer_load_dwordx4 v114, s[8:11], s22 offen lds
    s_cmp_eq_u32 s16, 0
    s_cbranch_scc0 L_w_91_1
    ds_read_b64_tr_b16 a[160:161], v102 offset:32768
    ds_read_b64_tr_b16 a[162:163], v102 offset:33792
    ds_read_b64_tr_b16 a[164:165], v102 offset:32776
    ds_read_b64_tr_b16 a[166:167], v102 offset:33800
    ds_read_b64_tr_b16 a[168:169], v102 offset:40960
    ds_read_b64_tr_b16 a[170:171], v102 offset:41984
    ds_read_b64_tr_b16 a[172:173], v102 offset:40968
    ds_read_b64_tr_b16 a[174:175], v102 offset:41992
    s_waitcnt lgkmcnt(0)
    ds_read_b64_tr_b16 a[176:177], v102 offset:49152
    ds_read_b64_tr_b16 a[178:179], v102 offset:50176
    ds_read_b64_tr_b16 a[180:181], v102 offset:49160
    ds_read_b64_tr_b16 a[182:183], v102 offset:50184
    ds_read_b64_tr_b16 a[184:185], v102 offset:57344
    ds_read_b64_tr_b16 a[186:187], v102 offset:58368
    ds_read_b64_tr_b16 a[188:189], v102 offset:57352
    ds_read_b64_tr_b16 a[190:191], v102 offset:58376
    s_branch L_w_91
L_w_91_1:
    s_cmp_eq_u32 s16, 1
    s_cbranch_scc0 L_w_91_2
    ds_read_b64_tr_b16 a[128:129], v102 offset:32768
    ds_read_b64_tr_b16 a[130:131], v102 offset:33792
    ds_read_b64_tr_b16 a[132:133], v102 offset:32776
    ds_read_b64_tr_b16 a[134:135], v102 offset:33800
    ds_read_b64_tr_b16 a[136:137], v102 offset:40960
    ds_read_b64_tr_b16 a[138:139], v102 offset:41984
    ds_read_b64_tr_b16 a[140:141], v102 offset:40968
    ds_read_b64_tr_b16 a[142:143], v102 offset:41992
    s_waitcnt lgkmcnt(0)
    ds_read_b64_tr_b16 a[144:145], v102 offset:49152
    ds_read_b64_tr_b16 a[146:147], v102 offset:50176
    ds_read_b64_tr_b16 a[148:149], v102 offset:49160
    ds_read_b64_tr_b16 a[150:151], v102 offset:50184
    ds_read_b64_tr_b16 a[152:153], v102 offset:57344
    ds_read_b64_tr_b16 a[154:155], v102 offset:58368
    ds_read_b64_tr_b16 a[156:157], v102 offset:57352
    ds_read_b64_tr_b16 a[158:159], v102 offset:58376
    s_branch L_w_91
L_w_91_2:
    s_cmp_eq_u32 s16, 2
    s_cbranch_scc0 L_w_91_3
    ds_read_b64_tr_b16 a[224:225], v102 offset:32768
    ds_read_b64_tr_b16 a[226:227], v102 offset:33792
    ds_read_b64_tr_b16 a[228:229], v102 offset:32776
    ds_read_b64_tr_b16 a[230:231], v102 offset:33800
    ds_read_b64_tr_b16 a[232:233], v102 offset:40960
    ds_read_b64_tr_b16 a[234:235], v102 offset:41984
    ds_read_b64_tr_b16 a[236:237], v102 offset:40968
    ds_read_b64_tr_b16 a[238:239], v102 offset:41992
    s_waitcnt lgkmcnt(0)
    ds_read_b64_tr_b16 a[240:241], v102 offset:49152
    ds_read_b64_tr_b16 a[242:243], v102 offset:50176
    ds_read_b64_tr_b16 a[244:245], v102 offset:49160
    ds_read_b64_tr_b16 a[246:247], v102 offset:50184
    ds_read_b64_tr_b16 a[248:249], v102 offset:57344
    ds_read_b64_tr_b16 a[250:251], v102 offset:58368
    ds_read_b64_tr_b16 a[252:253], v102 offset:57352
    ds_read_b64_tr_b16 a[254:255], v102 offset:58376
    s_branch L_w_91
L_w_91_3:
    ds_read_b64_tr_b16 a[192:193], v102 offset:32768
    ds_read_b64_tr_b16 a[194:195], v102 offset:33792
    ds_read_b64_tr_b16 a[196:197], v102 offset:32776
    ds_read_b64_tr_b16 a[198:199], v102 offset:33800
    ds_read_b64_tr_b16 a[200:201], v102 offset:40960
    ds_read_b64_tr_b16 a[202:203], v102 offset:41984
    ds_read_b64_tr_b16 a[204:205], v102 offset:40968
    ds_read_b64_tr_b16 a[206:207], v102 offset:41992
    s_waitcnt lgkmcnt(0)
    ds_read_b64_tr_b16 a[208:209], v102 offset:49152
    ds_read_b64_tr_b16 a[210:211], v102 offset:50176
    ds_read_b64_tr_b16 a[212:213], v102 offset:49160
    ds_read_b64_tr_b16 a[214:215], v102 offset:50184
    ds_read_b64_tr_b16 a[216:217], v102 offset:57344
    ds_read_b64_tr_b16 a[218:219], v102 offset:58368
    ds_read_b64_tr_b16 a[220:221], v102 offset:57352
    ds_read_b64_tr_b16 a[222:223], v102 offset:58376
L_w_91:
    s_waitcnt lgkmcnt(0)
    s_waitcnt vmcnt(16)
    s_barrier
    s_mul_i32 s22, s16, 8192
    s_add_u32 s22, s22, s73
    s_add_u32 m0, s26, 32768
    s_add_u32 s22, s22, 32768
    buffer_load_dwordx4 v100, s[8:11], s22 offen lds
    s_add_u32 m0, m0, 1024
    s_add_u32 s22, s22, 1024
    v_xor_b32 v114, 64, v100
    buffer_load_dwordx4 v114, s[8:11], s22 offen lds
    s_add_u32 m0, m0, 1024
    s_add_u32 s22, s22, 1024
    v_xor_b32 v114, 128, v100
    buffer_load_dwordx4 v114, s[8:11], s22 offen lds
    s_add_u32 m0, m0, 1024
    s_add_u32 s22, s22, 1024
    v_xor_b32 v114, 192, v100
    buffer_load_dwordx4 v114, s[8:11], s22 offen lds
    s_add_u32 m0, m0, 1024
    s_add_u32 s22, s22, 1024
    buffer_load_dwordx4 v100, s[8:11], s22 offen lds
    s_add_u32 m0, m0, 1024
    s_add_u32 s22, s22, 1024
    v_xor_b32 v114, 64, v100
    buffer_load_dwordx4 v114, s[8:11], s22 offen lds
    s_add_u32 m0, m0, 1024
    s_add_u32 s22, s22, 1024
    v_xor_b32 v114, 128, v100
    buffer_load_dwordx4 v114, s[8:11], s22 offen lds
    s_add_u32 m0, m0, 1024
    s_add_u32 s22, s22, 1024
    v_xor_b32 v114, 192, v100
    buffer_load_dwordx4 v114, s[8:11], s22 offen lds
    v_xor_b32 v102, 0x10000, v102
    v_xor_b32 v103, 0x10000, v103
    v_xor_b32 v104, 0x10000, v104
    v_xor_b32 v105, 0x10000, v105
    v_xor_b32 v106, 0x10000, v106
    v_xor_b32 v107, 0x10000, v107
    v_xor_b32 v108, 0x10000, v108
    v_xor_b32 v109, 0x10000, v109
    s_cmp_eq_u32 s16, 0
    s_cbranch_scc0 L_w_92_1
    ds_read_b64_tr_b16 a[192:193], v102 offset:0
    ds_read_b64_tr_b16 a[194:195], v102 offset:1024
    ds_read_b64_tr_b16 a[196:197], v102 offset:8
    ds_read_b64_tr_b16 a[198:199], v102 offset:1032
    ds_read_b64_tr_b16 a[200:201], v102 offset:8192
    ds_read_b64_tr_b16 a[202:203], v102 offset:9216
    ds_read_b64_tr_b16 a[204:205], v102 offset:8200
    ds_read_b64_tr_b16 a[206:207], v102 offset:9224
    s_waitcnt lgkmcnt(0)
    ds_read_b64_tr_b16 a[208:209], v102 offset:16384
    ds_read_b64_tr_b16 a[210:211], v102 offset:17408
    ds_read_b64_tr_b16 a[212:213], v102 offset:16392
    ds_read_b64_tr_b16 a[214:215], v102 offset:17416
    ds_read_b64_tr_b16 a[216:217], v102 offset:24576
    ds_read_b64_tr_b16 a[218:219], v102 offset:25600
    ds_read_b64_tr_b16 a[220:221], v102 offset:24584
    ds_read_b64_tr_b16 a[222:223], v102 offset:25608
    s_branch L_w_92
L_w_92_1:
    s_cmp_eq_u32 s16, 1
    s_cbranch_scc0 L_w_92_2
    ds_read_b64_tr_b16 a[224:225], v102 offset:0
    ds_read_b64_tr_b16 a[226:227], v102 offset:1024
    ds_read_b64_tr_b16 a[228:229], v102 offset:8
    ds_read_b64_tr_b16 a[230:231], v102 offset:1032
    ds_read_b64_tr_b16 a[232:233], v102 offset:8192
    ds_read_b64_tr_b16 a[234:235], v102 offset:9216
    ds_read_b64_tr_b16 a[236:237], v102 offset:8200
    ds_read_b64_tr_b16 a[238:239], v102 offset:9224
    s_waitcnt lgkmcnt(0)
    ds_read_b64_tr_b16 a[240:241], v102 offset:16384
    ds_read_b64_tr_b16 a[242:243], v102 offset:17408
    ds_read_b64_tr_b16 a[244:245], v102 offset:16392
    ds_read_b64_tr_b16 a[246:247], v102 offset:17416
    ds_read_b64_tr_b16 a[248:249], v102 offset:24576
    ds_read_b64_tr_b16 a[250:251], v102 offset:25600
    ds_read_b64_tr_b16 a[252:253], v102 offset:24584
    ds_read_b64_tr_b16 a[254:255], v102 offset:25608
    s_branch L_w_92
L_w_92_2:
    s_cmp_eq_u32 s16, 2
    s_cbranch_scc0 L_w_92_3
    ds_read_b64_tr_b16 a[128:129], v102 offset:0
    ds_read_b64_tr_b16 a[130:131], v102 offset:1024
    ds_read_b64_tr_b16 a[132:133], v102 offset:8
    ds_read_b64_tr_b16 a[134:135], v102 offset:1032
    ds_read_b64_tr_b16 a[136:137], v102 offset:8192
    ds_read_b64_tr_b16 a[138:139], v102 offset:9216
    ds_read_b64_tr_b16 a[140:141], v102 offset:8200
    ds_read_b64_tr_b16 a[142:143], v102 offset:9224
    s_waitcnt lgkmcnt(0)
    ds_read_b64_tr_b16 a[144:145], v102 offset:16384
    ds_read_b64_tr_b16 a[146:147], v102 offset:17408
    ds_read_b64_tr_b16 a[148:149], v102 offset:16392
    ds_read_b64_tr_b16 a[150:151], v102 offset:17416
    ds_read_b64_tr_b16 a[152:153], v102 offset:24576
    ds_read_b64_tr_b16 a[154:155], v102 offset:25600
    ds_read_b64_tr_b16 a[156:157], v102 offset:24584
    ds_read_b64_tr_b16 a[158:159], v102 offset:25608
    s_branch L_w_92
L_w_92_3:
    ds_read_b64_tr_b16 a[160:161], v102 offset:0
    ds_read_b64_tr_b16 a[162:163], v102 offset:1024
    ds_read_b64_tr_b16 a[164:165], v102 offset:8
    ds_read_b64_tr_b16 a[166:167], v102 offset:1032
    ds_read_b64_tr_b16 a[168:169], v102 offset:8192
    ds_read_b64_tr_b16 a[170:171], v102 offset:9216
    ds_read_b64_tr_b16 a[172:173], v102 offset:8200
    ds_read_b64_tr_b16 a[174:175], v102 offset:9224
    s_waitcnt lgkmcnt(0)
    ds_read_b64_tr_b16 a[176:177], v102 offset:16384
    ds_read_b64_tr_b16 a[178:179], v102 offset:17408
    ds_read_b64_tr_b16 a[180:181], v102 offset:16392
    ds_read_b64_tr_b16 a[182:183], v102 offset:17416
    ds_read_b64_tr_b16 a[184:185], v102 offset:24576
    ds_read_b64_tr_b16 a[186:187], v102 offset:25600
    ds_read_b64_tr_b16 a[188:189], v102 offset:24584
    ds_read_b64_tr_b16 a[190:191], v102 offset:25608
L_w_92:
    s_waitcnt lgkmcnt(0)
    s_waitcnt vmcnt(16)
    s_barrier
    s_mul_i32 s22, s16, 8192
    s_add_u32 s22, s22, s73
    s_add_u32 m0, s26, 65536
    s_add_u32 s22, s22, 65536
    buffer_load_dwordx4 v100, s[8:11], s22 offen lds
    s_add_u32 m0, m0, 1024
    s_add_u32 s22, s22, 1024
    v_xor_b32 v114, 64, v100
    buffer_load_dwordx4 v114, s[8:11], s22 offen lds
    s_add_u32 m0, m0, 1024
    s_add_u32 s22, s22, 1024
    v_xor_b32 v114, 128, v100
    buffer_load_dwordx4 v114, s[8:11], s22 offen lds
    s_add_u32 m0, m0, 1024
    s_add_u32 s22, s22, 1024
    v_xor_b32 v114, 192, v100
    buffer_load_dwordx4 v114, s[8:11], s22 offen lds
    s_add_u32 m0, m0, 1024
    s_add_u32 s22, s22, 1024
    buffer_load_dwordx4 v100, s[8:11], s22 offen lds
    s_add_u32 m0, m0, 1024
    s_add_u32 s22, s22, 1024
    v_xor_b32 v114, 64, v100
    buffer_load_dwordx4 v114, s[8:11], s22 offen lds
    s_add_u32 m0, m0, 1024
    s_add_u32 s22, s22, 1024
    v_xor_b32 v114, 128, v100
    buffer_load_dwordx4 v114, s[8:11], s22 offen lds
    s_add_u32 m0, m0, 1024
    s_add_u32 s22, s22, 1024
    v_xor_b32 v114, 192, v100
    buffer_load_dwordx4 v114, s[8:11], s22 offen lds
    s_cmp_eq_u32 s16, 0
    s_cbranch_scc0 L_w_93_1
    ds_read_b64_tr_b16 a[224:225], v102 offset:32768
    ds_read_b64_tr_b16 a[226:227], v102 offset:33792
    ds_read_b64_tr_b16 a[228:229], v102 offset:32776
    ds_read_b64_tr_b16 a[230:231], v102 offset:33800
    ds_read_b64_tr_b16 a[232:233], v102 offset:40960
    ds_read_b64_tr_b16 a[234:235], v102 offset:41984
    ds_read_b64_tr_b16 a[236:237], v102 offset:40968
    ds_read_b64_tr_b16 a[238:239], v102 offset:41992
    s_waitcnt lgkmcnt(0)
    ds_read_b64_tr_b16 a[240:241], v102 offset:49152
    ds_read_b64_tr_b16 a[242:243], v102 offset:50176
    ds_read_b64_tr_b16 a[244:245], v102 offset:49160
    ds_read_b64_tr_b16 a[246:247], v102 offset:50184
    ds_read_b64_tr_b16 a[248:249], v102 offset:57344
    ds_read_b64_tr_b16 a[250:251], v102 offset:58368
    ds_read_b64_tr_b16 a[252:253], v102 offset:57352
    ds_read_b64_tr_b16 a[254:255], v102 offset:58376
    s_branch L_w_93
L_w_93_1:
    s_cmp_eq_u32 s16, 1
    s_cbranch_scc0 L_w_93_2
    ds_read_b64_tr_b16 a[192:193], v102 offset:32768
    ds_read_b64_tr_b16 a[194:195], v102 offset:33792
    ds_read_b64_tr_b16 a[196:197], v102 offset:32776
    ds_read_b64_tr_b16 a[198:199], v102 offset:33800
    ds_read_b64_tr_b16 a[200:201], v102 offset:40960
    ds_read_b64_tr_b16 a[202:203], v102 offset:41984
    ds_read_b64_tr_b16 a[204:205], v102 offset:40968
    ds_read_b64_tr_b16 a[206:207], v102 offset:41992
    s_waitcnt lgkmcnt(0)
    ds_read_b64_tr_b16 a[208:209], v102 offset:49152
    ds_read_b64_tr_b16 a[210:211], v102 offset:50176
    ds_read_b64_tr_b16 a[212:213], v102 offset:49160
    ds_read_b64_tr_b16 a[214:215], v102 offset:50184
    ds_read_b64_tr_b16 a[216:217], v102 offset:57344
    ds_read_b64_tr_b16 a[218:219], v102 offset:58368
    ds_read_b64_tr_b16 a[220:221], v102 offset:57352
    ds_read_b64_tr_b16 a[222:223], v102 offset:58376
    s_branch L_w_93
L_w_93_2:
    s_cmp_eq_u32 s16, 2
    s_cbranch_scc0 L_w_93_3
    ds_read_b64_tr_b16 a[160:161], v102 offset:32768
    ds_read_b64_tr_b16 a[162:163], v102 offset:33792
    ds_read_b64_tr_b16 a[164:165], v102 offset:32776
    ds_read_b64_tr_b16 a[166:167], v102 offset:33800
    ds_read_b64_tr_b16 a[168:169], v102 offset:40960
    ds_read_b64_tr_b16 a[170:171], v102 offset:41984
    ds_read_b64_tr_b16 a[172:173], v102 offset:40968
    ds_read_b64_tr_b16 a[174:175], v102 offset:41992
    s_waitcnt lgkmcnt(0)
    ds_read_b64_tr_b16 a[176:177], v102 offset:49152
    ds_read_b64_tr_b16 a[178:179], v102 offset:50176
    ds_read_b64_tr_b16 a[180:181], v102 offset:49160
    ds_read_b64_tr_b16 a[182:183], v102 offset:50184
    ds_read_b64_tr_b16 a[184:185], v102 offset:57344
    ds_read_b64_tr_b16 a[186:187], v102 offset:58368
    ds_read_b64_tr_b16 a[188:189], v102 offset:57352
    ds_read_b64_tr_b16 a[190:191], v102 offset:58376
    s_branch L_w_93
L_w_93_3:
    ds_read_b64_tr_b16 a[128:129], v102 offset:32768
    ds_read_b64_tr_b16 a[130:131], v102 offset:33792
    ds_read_b64_tr_b16 a[132:133], v102 offset:32776
    ds_read_b64_tr_b16 a[134:135], v102 offset:33800
    ds_read_b64_tr_b16 a[136:137], v102 offset:40960
    ds_read_b64_tr_b16 a[138:139], v102 offset:41984
    ds_read_b64_tr_b16 a[140:141], v102 offset:40968
    ds_read_b64_tr_b16 a[142:143], v102 offset:41992
    s_waitcnt lgkmcnt(0)
    ds_read_b64_tr_b16 a[144:145], v102 offset:49152
    ds_read_b64_tr_b16 a[146:147], v102 offset:50176
    ds_read_b64_tr_b16 a[148:149], v102 offset:49160
    ds_read_b64_tr_b16 a[150:151], v102 offset:50184
    ds_read_b64_tr_b16 a[152:153], v102 offset:57344
    ds_read_b64_tr_b16 a[154:155], v102 offset:58368
    ds_read_b64_tr_b16 a[156:157], v102 offset:57352
    ds_read_b64_tr_b16 a[158:159], v102 offset:58376
L_w_93:
    s_waitcnt lgkmcnt(0)
    s_waitcnt vmcnt(16)
    s_barrier
    s_mul_i32 s22, s16, 8192
    s_add_u32 s22, s22, s73
    s_add_u32 m0, s26, 98304
    s_add_u32 s22, s22, 98304
    buffer_load_dwordx4 v100, s[8:11], s22 offen lds
    s_add_u32 m0, m0, 1024
    s_add_u32 s22, s22, 1024
    v_xor_b32 v114, 64, v100
    buffer_load_dwordx4 v114, s[8:11], s22 offen lds
    s_add_u32 m0, m0, 1024
    s_add_u32 s22, s22, 1024
    v_xor_b32 v114, 128, v100
    buffer_load_dwordx4 v114, s[8:11], s22 offen lds
    s_add_u32 m0, m0, 1024
    s_add_u32 s22, s22, 1024
    v_xor_b32 v114, 192, v100
    buffer_load_dwordx4 v114, s[8:11], s22 offen lds
    s_add_u32 m0, m0, 1024
    s_add_u32 s22, s22, 1024
    buffer_load_dwordx4 v100, s[8:11], s22 offen lds
    s_add_u32 m0, m0, 1024
    s_add_u32 s22, s22, 1024
    v_xor_b32 v114, 64, v100
    buffer_load_dwordx4 v114, s[8:11], s22 offen lds
    s_add_u32 m0, m0, 1024
    s_add_u32 s22, s22, 1024
    v_xor_b32 v114, 128, v100
    buffer_load_dwordx4 v114, s[8:11], s22 offen lds
    s_add_u32 m0, m0, 1024
    s_add_u32 s22, s22, 1024
    v_xor_b32 v114, 192, v100
    buffer_load_dwordx4 v114, s[8:11], s22 offen lds
    v_xor_b32 v102, 0x10000, v102
    v_xor_b32 v103, 0x10000, v103
    v_xor_b32 v104, 0x10000, v104
    v_xor_b32 v105, 0x10000, v105
    v_xor_b32 v106, 0x10000, v106
    v_xor_b32 v107, 0x10000, v107
    v_xor_b32 v108, 0x10000, v108
    v_xor_b32 v109, 0x10000, v109
    s_cmp_eq_u32 s16, 0
    s_cbranch_scc0 L_w_94_1
    ds_read_b64_tr_b16 v[128:129], v106 offset:0
    ds_read_b64_tr_b16 v[130:131], v106 offset:4096
    ds_read_b64_tr_b16 v[132:133], v106 offset:8
    ds_read_b64_tr_b16 v[134:135], v106 offset:4104
    ds_read_b64_tr_b16 v[160:161], v107 offset:0
    ds_read_b64_tr_b16 v[162:163], v107 offset:4096
    ds_read_b64_tr_b16 v[164:165], v107 offset:8
    ds_read_b64_tr_b16 v[166:167], v107 offset:4104
    s_waitcnt lgkmcnt(0)
    ds_read_b64_tr_b16 v[192:193], v108 offset:0
    ds_read_b64_tr_b16 v[194:195], v108 offset:4096
    ds_read_b64_tr_b16 v[196:197], v108 offset:8
    ds_read_b64_tr_b16 v[198:199], v108 offset:4104
    ds_read_b64_tr_b16 v[224:225], v109 offset:0
    ds_read_b64_tr_b16 v[226:227], v109 offset:4096
    ds_read_b64_tr_b16 v[228:229], v109 offset:8
    ds_read_b64_tr_b16 v[230:231], v109 offset:4104
    s_branch L_w_94
L_w_94_1:
    s_cmp_eq_u32 s16, 1
    s_cbranch_scc0 L_w_94_2
    ds_read_b64_tr_b16 v[136:137], v106 offset:0
    ds_read_b64_tr_b16 v[138:139], v106 offset:4096
    ds_read_b64_tr_b16 v[140:141], v106 offset:8
    ds_read_b64_tr_b16 v[142:143], v106 offset:4104
    ds_read_b64_tr_b16 v[168:169], v107 offset:0
    ds_read_b64_tr_b16 v[170:171], v107 offset:4096
    ds_read_b64_tr_b16 v[172:173], v107 offset:8
    ds_read_b64_tr_b16 v[174:175], v107 offset:4104
    s_waitcnt lgkmcnt(0)
    ds_read_b64_tr_b16 v[200:201], v108 offset:0
    ds_read_b64_tr_b16 v[202:203], v108 offset:4096
    ds_read_b64_tr_b16 v[204:205], v108 offset:8
    ds_read_b64_tr_b16 v[206:207], v108 offset:4104
    ds_read_b64_tr_b16 v[232:233], v109 offset:0
    ds_read_b64_tr_b16 v[234:235], v109 offset:4096
    ds_read_b64_tr_b16 v[236:237], v109 offset:8
    ds_read_b64_tr_b16 v[238:239], v109 offset:4104
    s_branch L_w_94
L_w_94_2:
    s_cmp_eq_u32 s16, 2
    s_cbranch_scc0 L_w_94_3
    ds_read_b64_tr_b16 v[144:145], v106 offset:0
    ds_read_b64_tr_b16 v[146:147], v106 offset:4096
    ds_read_b64_tr_b16 v[148:149], v106 offset:8
    ds_read_b64_tr_b16 v[150:151], v106 offset:4104
    ds_read_b64_tr_b16 v[176:177], v107 offset:0
    ds_read_b64_tr_b16 v[178:179], v107 offset:4096
    ds_read_b64_tr_b16 v[180:181], v107 offset:8
    ds_read_b64_tr_b16 v[182:183], v107 offset:4104
    s_waitcnt lgkmcnt(0)
    ds_read_b64_tr_b16 v[208:209], v108 offset:0
    ds_read_b64_tr_b16 v[210:211], v108 offset:4096
    ds_read_b64_tr_b16 v[212:213], v108 offset:8
    ds_read_b64_tr_b16 v[214:215], v108 offset:4104
    ds_read_b64_tr_b16 v[240:241], v109 offset:0
    ds_read_b64_tr_b16 v[242:243], v109 offset:4096
    ds_read_b64_tr_b16 v[244:245], v109 offset:8
    ds_read_b64_tr_b16 v[246:247], v109 offset:4104
    s_branch L_w_94
L_w_94_3:
    ds_read_b64_tr_b16 v[152:153], v106 offset:0
    ds_read_b64_tr_b16 v[154:155], v106 offset:4096
    ds_read_b64_tr_b16 v[156:157], v106 offset:8
    ds_read_b64_tr_b16 v[158:159], v106 offset:4104
    ds_read_b64_tr_b16 v[184:185], v107 offset:0
    ds_read_b64_tr_b16 v[186:187], v107 offset:4096
    ds_read_b64_tr_b16 v[188:189], v107 offset:8
    ds_read_b64_tr_b16 v[190:191], v107 offset:4104
    s_waitcnt lgkmcnt(0)
    ds_read_b64_tr_b16 v[216:217], v108 offset:0
    ds_read_b64_tr_b16 v[218:219], v108 offset:4096
    ds_read_b64_tr_b16 v[220:221], v108 offset:8
    ds_read_b64_tr_b16 v[222:223], v108 offset:4104
    ds_read_b64_tr_b16 v[248:249], v109 offset:0
    ds_read_b64_tr_b16 v[250:251], v109 offset:4096
    ds_read_b64_tr_b16 v[252:253], v109 offset:8
    ds_read_b64_tr_b16 v[254:255], v109 offset:4104
L_w_94:
    s_waitcnt lgkmcnt(0)
    s_waitcnt vmcnt(16)
    s_barrier
    s_cmp_eq_u32 s16, 0
    s_cbranch_scc0 L_w_95_1
    ds_read_b64_tr_b16 v[136:137], v106 offset:32768
    ds_read_b64_tr_b16 v[138:139], v106 offset:36864
    ds_read_b64_tr_b16 v[140:141], v106 offset:32776
    ds_read_b64_tr_b16 v[142:143], v106 offset:36872
    ds_read_b64_tr_b16 v[168:169], v107 offset:32768
    ds_read_b64_tr_b16 v[170:171], v107 offset:36864
    ds_read_b64_tr_b16 v[172:173], v107 offset:32776
    ds_read_b64_tr_b16 v[174:175], v107 offset:36872
    s_waitcnt lgkmcnt(0)
    ds_read_b64_tr_b16 v[200:201], v108 offset:32768
    ds_read_b64_tr_b16 v[202:203], v108 offset:36864
    ds_read_b64_tr_b16 v[204:205], v108 offset:32776
    ds_read_b64_tr_b16 v[206:207], v108 offset:36872
    ds_read_b64_tr_b16 v[232:233], v109 offset:32768
    ds_read_b64_tr_b16 v[234:235], v109 offset:36864
    ds_read_b64_tr_b16 v[236:237], v109 offset:32776
    ds_read_b64_tr_b16 v[238:239], v109 offset:36872
    s_branch L_w_95
L_w_95_1:
    s_cmp_eq_u32 s16, 1
    s_cbranch_scc0 L_w_95_2
    ds_read_b64_tr_b16 v[128:129], v106 offset:32768
    ds_read_b64_tr_b16 v[130:131], v106 offset:36864
    ds_read_b64_tr_b16 v[132:133], v106 offset:32776
    ds_read_b64_tr_b16 v[134:135], v106 offset:36872
    ds_read_b64_tr_b16 v[160:161], v107 offset:32768
    ds_read_b64_tr_b16 v[162:163], v107 offset:36864
    ds_read_b64_tr_b16 v[164:165], v107 offset:32776
    ds_read_b64_tr_b16 v[166:167], v107 offset:36872
    s_waitcnt lgkmcnt(0)
    ds_read_b64_tr_b16 v[192:193], v108 offset:32768
    ds_read_b64_tr_b16 v[194:195], v108 offset:36864
    ds_read_b64_tr_b16 v[196:197], v108 offset:32776
    ds_read_b64_tr_b16 v[198:199], v108 offset:36872
    ds_read_b64_tr_b16 v[224:225], v109 offset:32768
    ds_read_b64_tr_b16 v[226:227], v109 offset:36864
    ds_read_b64_tr_b16 v[228:229], v109 offset:32776
    ds_read_b64_tr_b16 v[230:231], v109 offset:36872
    s_branch L_w_95
L_w_95_2:
    s_cmp_eq_u32 s16, 2
    s_cbranch_scc0 L_w_95_3
    ds_read_b64_tr_b16 v[152:153], v106 offset:32768
    ds_read_b64_tr_b16 v[154:155], v106 offset:36864
    ds_read_b64_tr_b16 v[156:157], v106 offset:32776
    ds_read_b64_tr_b16 v[158:159], v106 offset:36872
    ds_read_b64_tr_b16 v[184:185], v107 offset:32768
    ds_read_b64_tr_b16 v[186:187], v107 offset:36864
    ds_read_b64_tr_b16 v[188:189], v107 offset:32776
    ds_read_b64_tr_b16 v[190:191], v107 offset:36872
    s_waitcnt lgkmcnt(0)
    ds_read_b64_tr_b16 v[216:217], v108 offset:32768
    ds_read_b64_tr_b16 v[218:219], v108 offset:36864
    ds_read_b64_tr_b16 v[220:221], v108 offset:32776
    ds_read_b64_tr_b16 v[222:223], v108 offset:36872
    ds_read_b64_tr_b16 v[248:249], v109 offset:32768
    ds_read_b64_tr_b16 v[250:251], v109 offset:36864
    ds_read_b64_tr_b16 v[252:253], v109 offset:32776
    ds_read_b64_tr_b16 v[254:255], v109 offset:36872
    s_branch L_w_95
L_w_95_3:
    ds_read_b64_tr_b16 v[144:145], v106 offset:32768
    ds_read_b64_tr_b16 v[146:147], v106 offset:36864
    ds_read_b64_tr_b16 v[148:149], v106 offset:32776
    ds_read_b64_tr_b16 v[150:151], v106 offset:36872
    ds_read_b64_tr_b16 v[176:177], v107 offset:32768
    ds_read_b64_tr_b16 v[178:179], v107 offset:36864
    ds_read_b64_tr_b16 v[180:181], v107 offset:32776
    ds_read_b64_tr_b16 v[182:183], v107 offset:36872
    s_waitcnt lgkmcnt(0)
    ds_read_b64_tr_b16 v[208:209], v108 offset:32768
    ds_read_b64_tr_b16 v[210:211], v108 offset:36864
    ds_read_b64_tr_b16 v[212:213], v108 offset:32776
    ds_read_b64_tr_b16 v[214:215], v108 offset:36872
    ds_read_b64_tr_b16 v[240:241], v109 offset:32768
    ds_read_b64_tr_b16 v[242:243], v109 offset:36864
    ds_read_b64_tr_b16 v[244:245], v109 offset:32776
    ds_read_b64_tr_b16 v[246:247], v109 offset:36872
L_w_95:
    s_waitcnt lgkmcnt(0)
    s_waitcnt vmcnt(8)
    s_barrier
    v_xor_b32 v102, 0x10000, v102
    v_xor_b32 v103, 0x10000, v103
    v_xor_b32 v104, 0x10000, v104
    v_xor_b32 v105, 0x10000, v105
    v_xor_b32 v106, 0x10000, v106
    v_xor_b32 v107, 0x10000, v107
    v_xor_b32 v108, 0x10000, v108
    v_xor_b32 v109, 0x10000, v109
    s_cmp_eq_u32 s16, 0
    s_cbranch_scc0 L_w_96_1
    ds_read_b64_tr_b16 v[144:145], v106 offset:0
    ds_read_b64_tr_b16 v[146:147], v106 offset:4096
    ds_read_b64_tr_b16 v[148:149], v106 offset:8
    ds_read_b64_tr_b16 v[150:151], v106 offset:4104
    ds_read_b64_tr_b16 v[176:177], v107 offset:0
    ds_read_b64_tr_b16 v[178:179], v107 offset:4096
    ds_read_b64_tr_b16 v[180:181], v107 offset:8
    ds_read_b64_tr_b16 v[182:183], v107 offset:4104
    s_waitcnt lgkmcnt(0)
    ds_read_b64_tr_b16 v[208:209], v108 offset:0
    ds_read_b64_tr_b16 v[210:211], v108 offset:4096
    ds_read_b64_tr_b16 v[212:213], v108 offset:8
    ds_read_b64_tr_b16 v[214:215], v108 offset:4104
    ds_read_b64_tr_b16 v[240:241], v109 offset:0
    ds_read_b64_tr_b16 v[242:243], v109 offset:4096
    ds_read_b64_tr_b16 v[244:245], v109 offset:8
    ds_read_b64_tr_b16 v[246:247], v109 offset:4104
    s_branch L_w_96
L_w_96_1:
    s_cmp_eq_u32 s16, 1
    s_cbranch_scc0 L_w_96_2
    ds_read_b64_tr_b16 v[152:153], v106 offset:0
    ds_read_b64_tr_b16 v[154:155], v106 offset:4096
    ds_read_b64_tr_b16 v[156:157], v106 offset:8
    ds_read_b64_tr_b16 v[158:159], v106 offset:4104
    ds_read_b64_tr_b16 v[184:185], v107 offset:0
    ds_read_b64_tr_b16 v[186:187], v107 offset:4096
    ds_read_b64_tr_b16 v[188:189], v107 offset:8
    ds_read_b64_tr_b16 v[190:191], v107 offset:4104
    s_waitcnt lgkmcnt(0)
    ds_read_b64_tr_b16 v[216:217], v108 offset:0
    ds_read_b64_tr_b16 v[218:219], v108 offset:4096
    ds_read_b64_tr_b16 v[220:221], v108 offset:8
    ds_read_b64_tr_b16 v[222:223], v108 offset:4104
    ds_read_b64_tr_b16 v[248:249], v109 offset:0
    ds_read_b64_tr_b16 v[250:251], v109 offset:4096
    ds_read_b64_tr_b16 v[252:253], v109 offset:8
    ds_read_b64_tr_b16 v[254:255], v109 offset:4104
    s_branch L_w_96
L_w_96_2:
    s_cmp_eq_u32 s16, 2
    s_cbranch_scc0 L_w_96_3
    ds_read_b64_tr_b16 v[128:129], v106 offset:0
    ds_read_b64_tr_b16 v[130:131], v106 offset:4096
    ds_read_b64_tr_b16 v[132:133], v106 offset:8
    ds_read_b64_tr_b16 v[134:135], v106 offset:4104
    ds_read_b64_tr_b16 v[160:161], v107 offset:0
    ds_read_b64_tr_b16 v[162:163], v107 offset:4096
    ds_read_b64_tr_b16 v[164:165], v107 offset:8
    ds_read_b64_tr_b16 v[166:167], v107 offset:4104
    s_waitcnt lgkmcnt(0)
    ds_read_b64_tr_b16 v[192:193], v108 offset:0
    ds_read_b64_tr_b16 v[194:195], v108 offset:4096
    ds_read_b64_tr_b16 v[196:197], v108 offset:8
    ds_read_b64_tr_b16 v[198:199], v108 offset:4104
    ds_read_b64_tr_b16 v[224:225], v109 offset:0
    ds_read_b64_tr_b16 v[226:227], v109 offset:4096
    ds_read_b64_tr_b16 v[228:229], v109 offset:8
    ds_read_b64_tr_b16 v[230:231], v109 offset:4104
    s_branch L_w_96
L_w_96_3:
    ds_read_b64_tr_b16 v[136:137], v106 offset:0
    ds_read_b64_tr_b16 v[138:139], v106 offset:4096
    ds_read_b64_tr_b16 v[140:141], v106 offset:8
    ds_read_b64_tr_b16 v[142:143], v106 offset:4104
    ds_read_b64_tr_b16 v[168:169], v107 offset:0
    ds_read_b64_tr_b16 v[170:171], v107 offset:4096
    ds_read_b64_tr_b16 v[172:173], v107 offset:8
    ds_read_b64_tr_b16 v[174:175], v107 offset:4104
    s_waitcnt lgkmcnt(0)
    ds_read_b64_tr_b16 v[200:201], v108 offset:0
    ds_read_b64_tr_b16 v[202:203], v108 offset:4096
    ds_read_b64_tr_b16 v[204:205], v108 offset:8
    ds_read_b64_tr_b16 v[206:207], v108 offset:4104
    ds_read_b64_tr_b16 v[232:233], v109 offset:0
    ds_read_b64_tr_b16 v[234:235], v109 offset:4096
    ds_read_b64_tr_b16 v[236:237], v109 offset:8
    ds_read_b64_tr_b16 v[238:239], v109 offset:4104
L_w_96:
    s_waitcnt lgkmcnt(0)
    s_waitcnt vmcnt(0)
    s_barrier
    s_cmp_eq_u32 s16, 0
    s_cbranch_scc0 L_w_97_1
    ds_read_b64_tr_b16 v[152:153], v106 offset:32768
    ds_read_b64_tr_b16 v[154:155], v106 offset:36864
    ds_read_b64_tr_b16 v[156:157], v106 offset:32776
    ds_read_b64_tr_b16 v[158:159], v106 offset:36872
    ds_read_b64_tr_b16 v[184:185], v107 offset:32768
    ds_read_b64_tr_b16 v[186:187], v107 offset:36864
    ds_read_b64_tr_b16 v[188:189], v107 offset:32776
    ds_read_b64_tr_b16 v[190:191], v107 offset:36872
    s_waitcnt lgkmcnt(0)
    ds_read_b64_tr_b16 v[216:217], v108 offset:32768
    ds_read_b64_tr_b16 v[218:219], v108 offset:36864
    ds_read_b64_tr_b16 v[220:221], v108 offset:32776
    ds_read_b64_tr_b16 v[222:223], v108 offset:36872
    ds_read_b64_tr_b16 v[248:249], v109 offset:32768
    ds_read_b64_tr_b16 v[250:251], v109 offset:36864
    ds_read_b64_tr_b16 v[252:253], v109 offset:32776
    ds_read_b64_tr_b16 v[254:255], v109 offset:36872
    s_branch L_w_97
L_w_97_1:
    s_cmp_eq_u32 s16, 1
    s_cbranch_scc0 L_w_97_2
    ds_read_b64_tr_b16 v[144:145], v106 offset:32768
    ds_read_b64_tr_b16 v[146:147], v106 offset:36864
    ds_read_b64_tr_b16 v[148:149], v106 offset:32776
    ds_read_b64_tr_b16 v[150:151], v106 offset:36872
    ds_read_b64_tr_b16 v[176:177], v107 offset:32768
    ds_read_b64_tr_b16 v[178:179], v107 offset:36864
    ds_read_b64_tr_b16 v[180:181], v107 offset:32776
    ds_read_b64_tr_b16 v[182:183], v107 offset:36872
    s_waitcnt lgkmcnt(0)
    ds_read_b64_tr_b16 v[208:209], v108 offset:32768
    ds_read_b64_tr_b16 v[210:211], v108 offset:36864
    ds_read_b64_tr_b16 v[212:213], v108 offset:32776
    ds_read_b64_tr_b16 v[214:215], v108 offset:36872
    ds_read_b64_tr_b16 v[240:241], v109 offset:32768
    ds_read_b64_tr_b16 v[242:243], v109 offset:36864
    ds_read_b64_tr_b16 v[244:245], v109 offset:32776
    ds_read_b64_tr_b16 v[246:247], v109 offset:36872
    s_branch L_w_97
L_w_97_2:
    s_cmp_eq_u32 s16, 2
    s_cbranch_scc0 L_w_97_3
    ds_read_b64_tr_b16 v[136:137], v106 offset:32768
    ds_read_b64_tr_b16 v[138:139], v106 offset:36864
    ds_read_b64_tr_b16 v[140:141], v106 offset:32776
    ds_read_b64_tr_b16 v[142:143], v106 offset:36872
    ds_read_b64_tr_b16 v[168:169], v107 offset:32768
    ds_read_b64_tr_b16 v[170:171], v107 offset:36864
    ds_read_b64_tr_b16 v[172:173], v107 offset:32776
    ds_read_b64_tr_b16 v[174:175], v107 offset:36872
    s_waitcnt lgkmcnt(0)
    ds_read_b64_tr_b16 v[200:201], v108 offset:32768
    ds_read_b64_tr_b16 v[202:203], v108 offset:36864
    ds_read_b64_tr_b16 v[204:205], v108 offset:32776
    ds_read_b64_tr_b16 v[206:207], v108 offset:36872
    ds_read_b64_tr_b16 v[232:233], v109 offset:32768
    ds_read_b64_tr_b16 v[234:235], v109 offset:36864
    ds_read_b64_tr_b16 v[236:237], v109 offset:32776
    ds_read_b64_tr_b16 v[238:239], v109 offset:36872
    s_branch L_w_97
L_w_97_3:
    ds_read_b64_tr_b16 v[128:129], v106 offset:32768
    ds_read_b64_tr_b16 v[130:131], v106 offset:36864
    ds_read_b64_tr_b16 v[132:133], v106 offset:32776
    ds_read_b64_tr_b16 v[134:135], v106 offset:36872
    ds_read_b64_tr_b16 v[160:161], v107 offset:32768
    ds_read_b64_tr_b16 v[162:163], v107 offset:36864
    ds_read_b64_tr_b16 v[164:165], v107 offset:32776
    ds_read_b64_tr_b16 v[166:167], v107 offset:36872
    s_waitcnt lgkmcnt(0)
    ds_read_b64_tr_b16 v[192:193], v108 offset:32768
    ds_read_b64_tr_b16 v[194:195], v108 offset:36864
    ds_read_b64_tr_b16 v[196:197], v108 offset:32776
    ds_read_b64_tr_b16 v[198:199], v108 offset:36872
    ds_read_b64_tr_b16 v[224:225], v109 offset:32768
    ds_read_b64_tr_b16 v[226:227], v109 offset:36864
    ds_read_b64_tr_b16 v[228:229], v109 offset:32776
    ds_read_b64_tr_b16 v[230:231], v109 offset:36872
L_w_97:
    s_waitcnt lgkmcnt(0)
    s_cmp_eq_u32 s91, 0
    s_cbranch_scc0 L_arr_101
    s_mov_b32 s91, 1
    s_waitcnt vmcnt(0)
    s_barrier
    s_cmp_eq_u32 s16, 0
    s_cbranch_scc0 L_arr_101
    s_lshl_b32 s21, s17, 5
    s_add_u32 s21, s21, 4
    s_atomic_add s3, s[56:57], s21
L_arr_101:
    s_cmp_eq_u32 s20, 0
    s_cbranch_scc0 L_rdv_done_99
    s_mov_b32 s27, 0
    v_lshlrev_b32 v1, 2, v0
L_rdv_98:
    buffer_load_dword v2, v1, s[60:63], 0 offen sc1
    s_add_u32 s27, s27, 1
    s_cmp_gt_u32 s27, 262144
    s_cbranch_scc1 L_end
L_rdv_98_p:
    s_waitcnt vmcnt(0)
    s_mov_b32 s21, 0
    v_readlane_b32 s22, v2, 1
    s_nop 0
    s_add_u32 s21, s21, s22
    v_readlane_b32 s22, v2, 9
    s_nop 0
    s_add_u32 s21, s21, s22
    v_readlane_b32 s22, v2, 17
    s_nop 0
    s_add_u32 s21, s21, s22
    v_readlane_b32 s22, v2, 25
    s_nop 0
    s_add_u32 s21, s21, s22
    v_readlane_b32 s22, v2, 33
    s_nop 0
    s_add_u32 s21, s21, s22
    v_readlane_b32 s22, v2, 41
    s_nop 0
    s_add_u32 s21, s21, s22
    v_readlane_b32 s22, v2, 49
    s_nop 0
    s_add_u32 s21, s21, s22
    v_readlane_b32 s22, v2, 57
    s_nop 0
    s_add_u32 s21, s21, s22
    s_cmp_eq_u32 s21, 256
    s_cbranch_scc1 L_rdv_l_100
    s_sleep 4
    s_branch L_rdv_98
L_rdv_l_100:
    s_mov_b32 s21, 0
    s_mov_b32 s23, 0
    v_readlane_b32 s22, v2, 0
    s_cmp_gt_u32 s17, 0
    s_cselect_b32 s24, s22, 0
    s_add_u32 s23, s23, s24
    s_xor_b32 s22, s22, 32
    s_or_b32 s21, s21, s22
    v_readlane_b32 s22, v2, 8
    s_cmp_gt_u32 s17, 1
    s_cselect_b32 s24, s22, 0
    s_add_u32 s23, s23, s24
    s_xor_b32 s22, s22, 32
    s_or_b32 s21, s21, s22
    v_readlane_b32 s22, v2, 16
    s_cmp_gt_u32 s17, 2
    s_cselect_b32 s24, s22, 0
    s_add_u32 s23, s23, s24
    s_xor_b32 s22, s22, 32
    s_or_b32 s21, s21, s22
    v_readlane_b32 s22, v2, 24
    s_cmp_gt_u32 s17, 3
    s_cselect_b32 s24, s22, 0
    s_add_u32 s23, s23, s24
    s_xor_b32 s22, s22, 32
    s_or_b32 s21, s21, s22
    v_readlane_b32 s22, v2, 32
    s_cmp_gt_u32 s17, 4
    s_cselect_b32 s24, s22, 0
    s_add_u32 s23, s23, s24
    s_xor_b32 s22, s22, 32
    s_or_b32 s21, s21, s22
    v_readlane_b32 s22, v2, 40
    s_cmp_gt_u32 s17, 5
    s_cselect_b32 s24, s22, 0
    s_add_u32 s23, s23, s24
    s_xor_b32 s22, s22, 32
    s_or_b32 s21, s21, s22
    v_readlane_b32 s22, v2, 48
    s_cmp_gt_u32 s17, 6
    s_cselect_b32 s24, s22, 0
    s_add_u32 s23, s23, s24
    s_xor_b32 s22, s22, 32
    s_or_b32 s21, s21, s22
    v_readlane_b32 s22, v2, 56
    s_cmp_gt_u32 s17, 7
    s_cselect_b32 s24, s22, 0
    s_add_u32 s23, s23, s24
    s_xor_b32 s22, s22, 32
    s_or_b32 s21, s21, s22
    s_mov_b32 s20, 1
    s_cmp_eq_u32 s21, 0
    s_cbranch_scc1 L_rdv_done_99
    s_mov_b32 s20, 2
    s_add_u32 s19, s23, s18
    s_waitcnt vmcnt(0) lgkmcnt(0)
    s_barrier
    s_branch L_dispatch
L_rdv_done_99:
    v_bfe_u32 v9, v0, 2, 3
    v_lshlrev_b32 v2, 7, v9
    v_and_b32 v9, 3, v0
    v_lshl_add_u32 v2, v9, 5, v2
    v_lshrrev_b32 v9, 5, v0
    v_lshl_add_u32 v2, v9, 4, v2
    v_lshrrev_b32 v9, 5, v0
    v_bfe_u32 v10, v0, 2, 2
    v_xor_b32 v10, v10, v9
    v_lshlrev_b32 v1, 10, v9
    v_lshl_add_u32 v1, v10, 7, v1
    v_and_b32 v9, 3, v0
    v_lshl_add_u32 v1, v9, 5, v1
    v_bfe_u32 v9, v0, 4, 1
    v_lshl_add_u32 v1, v9, 4, v1
    v_lshrrev_b32 v9, 4, v0
    v_and_b32 v10, 15, v0
    v_lshlrev_b32 v9, 9, v9
    v_lshl_add_u32 v9, v10, 4, v9
    s_xor_b32 s21, s16, 0
    s_lshl_b32 s21, s21, 13
    s_add_u32 s21, s21, 0
    v_add_u32 v12, s21, v9
    s_xor_b32 s21, s16, 1
    s_lshl_b32 s21, s21, 13
    s_add_u32 s21, s21, 0
    v_add_u32 v13, s21, v9
    s_xor_b32 s21, s16, 2
    s_lshl_b32 s21, s21, 13
    s_add_u32 s21, s21, 0
    v_add_u32 v14, s21, v9
    s_xor_b32 s21, s16, 3
    s_lshl_b32 s21, s21, 13
    s_add_u32 s21, s21, 0
    v_add_u32 v15, s21, v9
    s_barrier
    v_mov_b32 v4, 1
    s_lshl_b32 s21, s16, 11
    s_add_u32 s21, s21, 0x10000
    v_add_u32 v5, s21, v9
    v_xor_b32 v6, 2048, v5
    v_xor_b32 v7, 4096, v5
    v_xor_b32 v8, 6144, v5
    s_lshl_b32 s77, s16, 13
    s_mov_b32 s69, 0
    s_mov_b32 s78, 3216550459
    s_lshl_b32 s80, s64, 15
    s_add_u32 s80, s80, s77
    s_add_u32 s80, s80, 69206016
    s_lshl_b32 s82, s16, 2
    s_lshl_b32 s81, s64, 7
    s_add_u32 s81, s81, s82
    s_add_u32 s82, s82, 1024
    v_and_b32 v9, 7, v0
    v_lshlrev_b32 v11, 7, v9
    s_add_u32 s81, s81, 4096
    s_mov_b32 s76, 0
    s_sub_u32 s21, s65, 17
    s_lshr_b32 s22, s21, 1
    s_add_u32 s23, s22, 64
    s_add_u32 s22, s22, 17
    s_bitcmp1_b32 s21, 0
    s_cselect_b32 s67, s23, s22
    s_cmp_lt_u32 s65, 17
    s_cselect_b32 s67, s65, s67
    s_cmp_ge_u32 s65, 111
    s_cselect_b32 s67, s65, s67
    s_lshl_b32 s74, s67, 14
    s_add_u32 s74, s74, s82
    s_cmp_lt_u32 s65, 128
    s_cselect_b32 s74, s74, 14336
    s_lshl_b32 s75, s67, 15
    s_add_u32 s75, s75, s77
    s_add_u32 s75, s75, 8388608
    s_xor_b32 s68, s69, 0x8000
    s_add_u32 s68, s68, s77
L_f_block:
    s_mov_b32 s27, 0
L_poll_102:
    buffer_load_dword v3, v11, s[4:7], s74 offen sc1
    s_add_u32 s27, s27, 1
    s_cmp_gt_u32 s27, 262144
    s_cbranch_scc1 L_end
    s_waitcnt vmcnt(0)
    v_cmp_gt_u32 vcc, 1, v3
    s_cbranch_vccz L_poll_102_ok
    s_sleep 4
    s_branch L_poll_102
L_poll_102_ok:
    v_xor_b32 v9, 0, v2
    s_mov_b32 m0, s68
    s_add_u32 s23, s75, 4096
    buffer_load_dwordx4 v9, s[4:7], s75 offen offset:0 sc1 lds
    v_xor_b32 v9, 128, v2
    buffer_load_dwordx4 v9, s[4:7], s75 offen offset:1024 sc1 lds
    v_xor_b32 v9, 256, v2
    buffer_load_dwordx4 v9, s[4:7], s75 offen offset:2048 sc1 lds
    v_xor_b32 v9, 384, v2
    buffer_load_dwordx4 v9, s[4:7], s75 offen offset:3072 sc1 lds
    v_xor_b32 v9, 512, v2
    s_add_u32 m0, m0, 4096
    s_nop 0
    buffer_load_dwordx4 v9, s[4:7], s23 offen offset:0 sc1 lds
    v_xor_b32 v9, 640, v2
    buffer_load_dwordx4 v9, s[4:7], s23 offen offset:1024 sc1 lds
    v_xor_b32 v9, 768, v2
    buffer_load_dwordx4 v9, s[4:7], s23 offen offset:2048 sc1 lds
    v_xor_b32 v9, 896, v2
    buffer_load_dwordx4 v9, s[4:7], s23 offen offset:3072 sc1 lds
    v_xor_b32 v12, 0x8000, v12
    v_xor_b32 v13, 0x8000, v13
    v_xor_b32 v14, 0x8000, v14
    v_xor_b32 v15, 0x8000, v15
    s_xor_b32 s69, s69, 0x8000
    s_mov_b32 s66, s67
    s_waitcnt vmcnt(6)
    ds_read_b128 v[64:67], v12 offset:0
    ds_read_b128 v[68:71], v12 offset:256
    s_waitcnt vmcnt(4)
    ds_read_b128 v[72:75], v12 offset:2048
    s_waitcnt lgkmcnt(2)
    v_mfma_f32_16x16x32_bf16 v[16:19], a[0:3], v[64:67], 0
    s_waitcnt vmcnt(4)
    ds_read_b128 v[76:79], v12 offset:2304
    v_mfma_f32_16x16x32_bf16 v[20:23], a[4:7], v[64:67], 0
    s_add_u32 s65, s65, 3
    v_mfma_f32_16x16x32_bf16 v[32:35], a[128:131], v[64:67], 0
    s_sub_u32 s21, s65, 17
    v_mfma_f32_16x16x32_bf16 v[36:39], a[132:135], v[64:67], 0
    s_lshr_b32 s22, s21, 1
    s_waitcnt lgkmcnt(2)
    v_mfma_f32_16x16x32_bf16 v[24:27], a[0:3], v[68:71], 0
    s_waitcnt vmcnt(2)
    ds_read_b128 v[64:67], v12 offset:4096
    v_mfma_f32_16x16x32_bf16 v[28:31], a[4:7], v[68:71], 0
    s_add_u32 s23, s22, 64
    v_mfma_f32_16x16x32_bf16 v[40:43], a[128:131], v[68:71], 0
    s_add_u32 s22, s22, 17
    v_mfma_f32_16x16x32_bf16 v[44:47], a[132:135], v[68:71], 0
    s_bitcmp1_b32 s21, 0
    s_waitcnt lgkmcnt(2)
    v_mfma_f32_16x16x32_bf16 v[16:19], a[8:11], v[72:75], v[16:19]
    ds_read_b128 v[68:71], v12 offset:4352
    v_mfma_f32_16x16x32_bf16 v[20:23], a[12:15], v[72:75], v[20:23]
    s_cselect_b32 s67, s23, s22
    v_mfma_f32_16x16x32_bf16 v[32:35], a[136:139], v[72:75], v[32:35]
    s_cmp_lt_u32 s65, 17
    v_mfma_f32_16x16x32_bf16 v[36:39], a[140:143], v[72:75], v[36:39]
    s_cselect_b32 s67, s65, s67
    s_waitcnt lgkmcnt(2)
    v_mfma_f32_16x16x32_bf16 v[24:27], a[8:11], v[76:79], v[24:27]
    s_waitcnt vmcnt(0)
    ds_read_b128 v[72:75], v12 offset:6144
    v_mfma_f32_16x16x32_bf16 v[28:31], a[12:15], v[76:79], v[28:31]
    s_cmp_ge_u32 s65, 111
    v_mfma_f32_16x16x32_bf16 v[40:43], a[136:139], v[76:79], v[40:43]
    s_cselect_b32 s67, s65, s67
    v_mfma_f32_16x16x32_bf16 v[44:47], a[140:143], v[76:79], v[44:47]
    s_lshl_b32 s74, s67, 14
    s_waitcnt lgkmcnt(2)
    v_mfma_f32_16x16x32_bf16 v[16:19], a[16:19], v[64:67], v[16:19]
    ds_read_b128 v[76:79], v12 offset:6400
    v_mfma_f32_16x16x32_bf16 v[20:23], a[20:23], v[64:67], v[20:23]
    s_add_u32 s74, s74, s82
    v_mfma_f32_16x16x32_bf16 v[32:35], a[144:147], v[64:67], v[32:35]
    s_cmp_lt_u32 s65, 128
    v_mfma_f32_16x16x32_bf16 v[36:39], a[148:151], v[64:67], v[36:39]
    s_cselect_b32 s74, s74, 14336
    s_waitcnt lgkmcnt(2)
    v_mfma_f32_16x16x32_bf16 v[24:27], a[16:19], v[68:71], v[24:27]
    s_barrier
    ds_read_b128 v[64:67], v13 offset:0
    v_mfma_f32_16x16x32_bf16 v[28:31], a[20:23], v[68:71], v[28:31]
    s_lshl_b32 s75, s67, 15
    v_mfma_f32_16x16x32_bf16 v[40:43], a[144:147], v[68:71], v[40:43]
    s_add_u32 s75, s75, s77
    v_mfma_f32_16x16x32_bf16 v[44:47], a[148:151], v[68:71], v[44:47]
    s_add_u32 s75, s75, 8388608
    s_waitcnt lgkmcnt(2)
    v_mfma_f32_16x16x32_bf16 v[16:19], a[24:27], v[72:75], v[16:19]
    ds_read_b128 v[68:71], v13 offset:2048
    v_mfma_f32_16x16x32_bf16 v[20:23], a[28:31], v[72:75], v[20:23]
    s_xor_b32 s68, s69, 0x8000
    v_mfma_f32_16x16x32_bf16 v[32:35], a[152:155], v[72:75], v[32:35]
    s_add_u32 s68, s68, s77
    v_mfma_f32_16x16x32_bf16 v[36:39], a[156:159], v[72:75], v[36:39]
    s_mul_i32 s70, s66, 458752
    s_waitcnt lgkmcnt(2)
    v_mfma_f32_16x16x32_bf16 v[24:27], a[24:27], v[76:79], v[24:27]
    ds_read_b128 v[72:75], v13 offset:4096
    v_mfma_f32_16x16x32_bf16 v[28:31], a[28:31], v[76:79], v[28:31]
    s_add_u32 s70, s70, s80
    v_mfma_f32_16x16x32_bf16 v[40:43], a[152:155], v[76:79], v[40:43]
    s_add_u32 s71, s70, 4096
    v_mfma_f32_16x16x32_bf16 v[44:47], a[156:159], v[76:79], v[44:47]
    s_branch L_f_up
L_f_loop1:
    v_xor_b32 v12, 0x8000, v12
    v_xor_b32 v13, 0x8000, v13
    v_xor_b32 v14, 0x8000, v14
    v_xor_b32 v15, 0x8000, v15
    s_xor_b32 s69, s69, 0x8000
    s_mov_b32 s66, s67
    ds_read_b128 v[64:67], v12 offset:0
    ds_read_b128 v[68:71], v12 offset:256
    ds_read_b128 v[72:75], v12 offset:2048
    s_waitcnt lgkmcnt(2)
    v_mfma_f32_16x16x32_bf16 v[16:19], a[0:3], v[64:67], 0
    ds_read_b128 v[76:79], v12 offset:2304
    v_mfma_f32_16x16x32_bf16 v[20:23], a[4:7], v[64:67], 0
    s_add_u32 s65, s65, 3
    v_mfma_f32_16x16x32_bf16 v[32:35], a[128:131], v[64:67], 0
    s_sub_u32 s21, s65, 17
    v_mfma_f32_16x16x32_bf16 v[36:39], a[132:135], v[64:67], 0
    s_lshr_b32 s22, s21, 1
    s_waitcnt lgkmcnt(2)
    v_mfma_f32_16x16x32_bf16 v[24:27], a[0:3], v[68:71], 0
    ds_read_b128 v[64:67], v12 offset:4096
    v_mfma_f32_16x16x32_bf16 v[28:31], a[4:7], v[68:71], 0
    s_add_u32 s23, s22, 64
    v_mfma_f32_16x16x32_bf16 v[40:43], a[128:131], v[68:71], 0
    s_add_u32 s22, s22, 17
    v_mfma_f32_16x16x32_bf16 v[44:47], a[132:135], v[68:71], 0
    s_bitcmp1_b32 s21, 0
    s_waitcnt lgkmcnt(2)
    v_mfma_f32_16x16x32_bf16 v[16:19], a[8:11], v[72:75], v[16:19]
    ds_read_b128 v[68:71], v12 offset:4352
    v_mfma_f32_16x16x32_bf16 v[20:23], a[12:15], v[72:75], v[20:23]
    s_cselect_b32 s67, s23, s22
    v_mfma_f32_16x16x32_bf16 v[32:35], a[136:139], v[72:75], v[32:35]
    s_cmp_lt_u32 s65, 17
    v_mfma_f32_16x16x32_bf16 v[36:39], a[140:143], v[72:75], v[36:39]
    s_cselect_b32 s67, s65, s67
    s_waitcnt lgkmcnt(2)
    v_mfma_f32_16x16x32_bf16 v[24:27], a[8:11], v[76:79], v[24:27]
    ds_read_b128 v[72:75], v12 offset:6144
    v_mfma_f32_16x16x32_bf16 v[28:31], a[12:15], v[76:79], v[28:31]
    s_cmp_ge_u32 s65, 111
    v_mfma_f32_16x16x32_bf16 v[40:43], a[136:139], v[76:79], v[40:43]
    s_cselect_b32 s67, s65, s67
    v_mfma_f32_16x16x32_bf16 v[44:47], a[140:143], v[76:79], v[44:47]
    s_lshl_b32 s74, s67, 14
    s_waitcnt lgkmcnt(2)
    v_mfma_f32_16x16x32_bf16 v[16:19], a[16:19], v[64:67], v[16:19]
    ds_read_b128 v[76:79], v12 offset:6400
    v_mfma_f32_16x16x32_bf16 v[20:23], a[20:23], v[64:67], v[20:23]
    s_add_u32 s74, s74, s82
    v_mfma_f32_16x16x32_bf16 v[32:35], a[144:147], v[64:67], v[32:35]
    s_cmp_lt_u32 s65, 128
    v_mfma_f32_16x16x32_bf16 v[36:39], a[148:151], v[64:67], v[36:39]
    s_cselect_b32 s74, s74, 14336
    s_waitcnt lgkmcnt(2)
    v_mfma_f32_16x16x32_bf16 v[24:27], a[16:19], v[68:71], v[24:27]
    s_barrier
    ds_read_b128 v[64:67], v13 offset:0
    v_mfma_f32_16x16x32_bf16 v[28:31], a[20:23], v[68:71], v[28:31]
    s_lshl_b32 s75, s67, 15
    v_mfma_f32_16x16x32_bf16 v[40:43], a[144:147], v[68:71], v[40:43]
    s_add_u32 s75, s75, s77
    v_mfma_f32_16x16x32_bf16 v[44:47], a[148:151], v[68:71], v[44:47]
    s_add_u32 s75, s75, 8388608
    s_waitcnt lgkmcnt(2)
    v_mfma_f32_16x16x32_bf16 v[16:19], a[24:27], v[72:75], v[16:19]
    ds_read_b128 v[68:71], v13 offset:2048
    v_mfma_f32_16x16x32_bf16 v[20:23], a[28:31], v[72:75], v[20:23]
    s_xor_b32 s68, s69, 0x8000
    v_mfma_f32_16x16x32_bf16 v[32:35], a[152:155], v[72:75], v[32:35]
    s_add_u32 s68, s68, s77
    v_mfma_f32_16x16x32_bf16 v[36:39], a[156:159], v[72:75], v[36:39]
    s_mul_i32 s70, s66, 458752
    s_waitcnt lgkmcnt(2)
    v_mfma_f32_16x16x32_bf16 v[24:27], a[24:27], v[76:79], v[24:27]
    ds_read_b128 v[72:75], v13 offset:4096
    v_mfma_f32_16x16x32_bf16 v[28:31], a[28:31], v[76:79], v[28:31]
    s_add_u32 s70, s70, s80
    v_mfma_f32_16x16x32_bf16 v[40:43], a[152:155], v[76:79], v[40:43]
    s_add_u32 s71, s70, 4096
    v_mfma_f32_16x16x32_bf16 v[44:47], a[156:159], v[76:79], v[44:47]
L_f_up:
    s_waitcnt lgkmcnt(2)
    v_mfma_f32_16x16x32_bf16 v[16:19], a[32:35], v[64:67], v[16:19]
    ds_read_b128 v[76:79], v13 offset:6144
    v_mfma_f32_16x16x32_bf16 v[20:23], a[36:39], v[64:67], v[20:23]
    v_mfma_f32_16x16x32_bf16 v[32:35], a[160:163], v[64:67], v[32:35]
    v_mfma_f32_16x16x32_bf16 v[36:39], a[164:167], v[64:67], v[36:39]
    s_waitcnt lgkmcnt(2)
    v_mfma_f32_16x16x32_bf16 v[16:19], a[40:43], v[68:71], v[16:19]
    ds_read_b128 v[64:67], v14 offset:0
    v_mfma_f32_16x16x32_bf16 v[20:23], a[44:47], v[68:71], v[20:23]
    v_mfma_f32_16x16x32_bf16 v[32:35], a[168:171], v[68:71], v[32:35]
    v_mfma_f32_16x16x32_bf16 v[36:39], a[172:175], v[68:71], v[36:39]
    s_waitcnt lgkmcnt(2)
    v_mfma_f32_16x16x32_bf16 v[16:19], a[48:51], v[72:75], v[16:19]
    ds_read_b128 v[68:71], v14 offset:2048
    v_mfma_f32_16x16x32_bf16 v[20:23], a[52:55], v[72:75], v[20:23]
    v_mfma_f32_16x16x32_bf16 v[32:35], a[176:179], v[72:75], v[32:35]
    v_mfma_f32_16x16x32_bf16 v[36:39], a[180:183], v[72:75], v[36:39]
    s_waitcnt lgkmcnt(2)
    v_mfma_f32_16x16x32_bf16 v[16:19], a[56:59], v[76:79], v[16:19]
    ds_read_b128 v[72:75], v14 offset:4096
    v_mfma_f32_16x16x32_bf16 v[20:23], a[60:63], v[76:79], v[20:23]
    s_cmp_eq_u32 s76, 0
    s_cbranch_scc1 L_df5
    s_waitcnt vmcnt(0)
    s_mov_b64 exec, 1
    buffer_store_dword v4, off, s[4:7], s76 sc1
    s_mov_b64 exec, -1
L_df5:
    v_mfma_f32_16x16x32_bf16 v[32:35], a[184:187], v[76:79], v[32:35]
    s_lshl_b32 s76, s66, 14
    v_mfma_f32_16x16x32_bf16 v[36:39], a[188:191], v[76:79], v[36:39]
    s_add_u32 s76, s76, s81
    s_waitcnt lgkmcnt(2)
    v_mfma_f32_16x16x32_bf16 v[16:19], a[64:67], v[64:67], v[16:19]
    ds_read_b128 v[76:79], v14 offset:6144
    v_mfma_f32_16x16x32_bf16 v[20:23], a[68:71], v[64:67], v[20:23]
    v_mfma_f32_16x16x32_bf16 v[32:35], a[192:195], v[64:67], v[32:35]
    v_mfma_f32_16x16x32_bf16 v[36:39], a[196:199], v[64:67], v[36:39]
    s_waitcnt lgkmcnt(2)
    v_mfma_f32_16x16x32_bf16 v[16:19], a[72:75], v[68:71], v[16:19]
    ds_read_b128 v[64:67], v15 offset:0
    v_mfma_f32_16x16x32_bf16 v[20:23], a[76:79], v[68:71], v[20:23]
    v_mfma_f32_16x16x32_bf16 v[32:35], a[200:203], v[68:71], v[32:35]
    v_mfma_f32_16x16x32_bf16 v[36:39], a[204:207], v[68:71], v[36:39]
    s_waitcnt lgkmcnt(2)
    v_mfma_f32_16x16x32_bf16 v[16:19], a[80:83], v[72:75], v[16:19]
    ds_read_b128 v[68:71], v15 offset:2048
    v_mfma_f32_16x16x32_bf16 v[20:23], a[84:87], v[72:75], v[20:23]
    v_mfma_f32_16x16x32_bf16 v[32:35], a[208:211], v[72:75], v[32:35]
    v_mfma_f32_16x16x32_bf16 v[36:39], a[212:215], v[72:75], v[36:39]
    s_waitcnt lgkmcnt(2)
    v_mfma_f32_16x16x32_bf16 v[16:19], a[88:91], v[76:79], v[16:19]
    ds_read_b128 v[72:75], v15 offset:4096
    v_mfma_f32_16x16x32_bf16 v[20:23], a[92:95], v[76:79], v[20:23]
    v_mfma_f32_16x16x32_bf16 v[32:35], a[216:219], v[76:79], v[32:35]
    v_mfma_f32_16x16x32_bf16 v[36:39], a[220:223], v[76:79], v[36:39]
    s_waitcnt lgkmcnt(2)
    v_mfma_f32_16x16x32_bf16 v[16:19], a[96:99], v[64:67], v[16:19]
    ds_read_b128 v[76:79], v15 offset:6144
    v_mfma_f32_16x16x32_bf16 v[20:23], a[100:103], v[64:67], v[20:23]
    v_mfma_f32_16x16x32_bf16 v[32:35], a[224:227], v[64:67], v[32:35]
    v_mfma_f32_16x16x32_bf16 v[36:39], a[228:231], v[64:67], v[36:39]
    s_waitcnt lgkmcnt(2)
    v_mfma_f32_16x16x32_bf16 v[16:19], a[104:107], v[68:71], v[16:19]
    ds_read_b128 v[64:67], v13 offset:256
    v_mfma_f32_16x16x32_bf16 v[20:23], a[108:111], v[68:71], v[20:23]
    v_mfma_f32_16x16x32_bf16 v[32:35], a[232:235], v[68:71], v[32:35]
    v_mfma_f32_16x16x32_bf16 v[36:39], a[236:239], v[68:71], v[36:39]
    s_waitcnt lgkmcnt(2)
    v_mfma_f32_16x16x32_bf16 v[16:19], a[112:115], v[72:75], v[16:19]
    ds_read_b128 v[68:71], v13 offset:2304
    v_mfma_f32_16x16x32_bf16 v[20:23], a[116:119], v[72:75], v[20:23]
    v_mfma_f32_16x16x32_bf16 v[32:35], a[240:243], v[72:75], v[32:35]
    v_mfma_f32_16x16x32_bf16 v[36:39], a[244:247], v[72:75], v[36:39]
    s_waitcnt lgkmcnt(2)
    v_mfma_f32_16x16x32_bf16 v[16:19], a[120:123], v[76:79], v[16:19]
    ds_read_b128 v[72:75], v13 offset:4352
    v_mfma_f32_16x16x32_bf16 v[20:23], a[124:127], v[76:79], v[20:23]
    v_mfma_f32_16x16x32_bf16 v[32:35], a[248:251], v[76:79], v[32:35]
    v_mfma_f32_16x16x32_bf16 v[36:39], a[252:255], v[76:79], v[36:39]
    s_waitcnt lgkmcnt(2)
    v_mfma_f32_16x16x32_bf16 v[24:27], a[32:35], v[64:67], v[24:27]
    ds_read_b128 v[76:79], v13 offset:6400
    v_mfma_f32_16x16x32_bf16 v[28:31], a[36:39], v[64:67], v[28:31]
    buffer_load_dword v3, v11, s[4:7], s74 offen sc1
    v_mfma_f32_16x16x32_bf16 v[40:43], a[160:163], v[64:67], v[40:43]
    v_mfma_f32_16x16x32_bf16 v[44:47], a[164:167], v[64:67], v[44:47]
    s_waitcnt lgkmcnt(2)
    v_mfma_f32_16x16x32_bf16 v[24:27], a[40:43], v[68:71], v[24:27]
    ds_read_b128 v[64:67], v14 offset:256
    v_mfma_f32_16x16x32_bf16 v[28:31], a[44:47], v[68:71], v[28:31]
    v_mfma_f32_16x16x32_bf16 v[40:43], a[168:171], v[68:71], v[40:43]
    v_mfma_f32_16x16x32_bf16 v[44:47], a[172:175], v[68:71], v[44:47]
    s_waitcnt lgkmcnt(2)
    v_mfma_f32_16x16x32_bf16 v[24:27], a[48:51], v[72:75], v[24:27]
    ds_read_b128 v[68:71], v14 offset:2304
    v_mfma_f32_16x16x32_bf16 v[28:31], a[52:55], v[72:75], v[28:31]
    v_mul_f32 v16, s78, v16
    v_mul_f32 v17, s78, v17
    v_mfma_f32_16x16x32_bf16 v[40:43], a[176:179], v[72:75], v[40:43]
    v_mul_f32 v18, s78, v18
    v_mul_f32 v19, s78, v19
    v_mfma_f32_16x16x32_bf16 v[44:47], a[180:183], v[72:75], v[44:47]
    v_mul_f32 v20, s78, v20
    s_waitcnt lgkmcnt(2)
    v_mfma_f32_16x16x32_bf16 v[24:27], a[56:59], v[76:79], v[24:27]
    ds_read_b128 v[72:75], v14 offset:4352
    v_mfma_f32_16x16x32_bf16 v[28:31], a[60:63], v[76:79], v[28:31]
    v_mul_f32 v21, s78, v21
    v_mul_f32 v22, s78, v22
    v_mfma_f32_16x16x32_bf16 v[40:43], a[184:187], v[76:79], v[40:43]
    v_mul_f32 v23, s78, v23
    v_exp_f32 v16, v16
    v_mfma_f32_16x16x32_bf16 v[44:47], a[188:191], v[76:79], v[44:47]
    v_exp_f32 v17, v17
    s_waitcnt lgkmcnt(2)
    v_mfma_f32_16x16x32_bf16 v[24:27], a[64:67], v[64:67], v[24:27]
    ds_read_b128 v[76:79], v14 offset:6400
    v_mfma_f32_16x16x32_bf16 v[28:31], a[68:71], v[64:67], v[28:31]
    v_exp_f32 v18, v18
    v_exp_f32 v19, v19
    v_mfma_f32_16x16x32_bf16 v[40:43], a[192:195], v[64:67], v[40:43]
    v_exp_f32 v20, v20
    v_exp_f32 v21, v21
    v_mfma_f32_16x16x32_bf16 v[44:47], a[196:199], v[64:67], v[44:47]
    v_exp_f32 v22, v22
    s_waitcnt lgkmcnt(2)
    v_mfma_f32_16x16x32_bf16 v[24:27], a[72:75], v[68:71], v[24:27]
    ds_read_b128 v[64:67], v15 offset:256
    v_mfma_f32_16x16x32_bf16 v[28:31], a[76:79], v[68:71], v[28:31]
    v_exp_f32 v23, v23
    v_add_f32 v16, 1.0, v16
    v_mfma_f32_16x16x32_bf16 v[40:43], a[200:203], v[68:71], v[40:43]
    v_add_f32 v17, 1.0, v17
    v_add_f32 v18, 1.0, v18
    v_mfma_f32_16x16x32_bf16 v[44:47], a[204:207], v[68:71], v[44:47]
    v_add_f32 v19, 1.0, v19
    s_waitcnt lgkmcnt(2)
    v_mfma_f32_16x16x32_bf16 v[24:27], a[80:83], v[72:75], v[24:27]
    ds_read_b128 v[68:71], v15 offset:2304
    v_mfma_f32_16x16x32_bf16 v[28:31], a[84:87], v[72:75], v[28:31]
    v_add_f32 v20, 1.0, v20
    v_add_f32 v21, 1.0, v21
    v_mfma_f32_16x16x32_bf16 v[40:43], a[208:211], v[72:75], v[40:43]
    v_add_f32 v22, 1.0, v22
    v_add_f32 v23, 1.0, v23
    v_mfma_f32_16x16x32_bf16 v[44:47], a[212:215], v[72:75], v[44:47]
    v_rcp_f32 v16, v16
    s_waitcnt lgkmcnt(2)
    v_mfma_f32_16x16x32_bf16 v[24:27], a[88:91], v[76:79], v[24:27]
    ds_read_b128 v[72:75], v15 offset:4352
    v_mfma_f32_16x16x32_bf16 v[28:31], a[92:95], v[76:79], v[28:31]
    v_rcp_f32 v17, v17
    v_rcp_f32 v18, v18
    v_mfma_f32_16x16x32_bf16 v[40:43], a[216:219], v[76:79], v[40:43]
    v_rcp_f32 v19, v19
    v_rcp_f32 v20, v20
    v_mfma_f32_16x16x32_bf16 v[44:47], a[220:223], v[76:79], v[44:47]
    v_rcp_f32 v21, v21
    s_waitcnt lgkmcnt(2)
    v_mfma_f32_16x16x32_bf16 v[24:27], a[96:99], v[64:67], v[24:27]
    ds_read_b128 v[76:79], v15 offset:6400
    v_mfma_f32_16x16x32_bf16 v[28:31], a[100:103], v[64:67], v[28:31]
    v_rcp_f32 v22, v22
    v_rcp_f32 v23, v23
    v_mfma_f32_16x16x32_bf16 v[40:43], a[224:227], v[64:67], v[40:43]
    v_mul_f32 v16, v16, v32
    v_mul_f32 v17, v17, v33
    v_mfma_f32_16x16x32_bf16 v[44:47], a[228:231], v[64:67], v[44:47]
    v_mul_f32 v18, v18, v34
    s_waitcnt lgkmcnt(2)
    v_mfma_f32_16x16x32_bf16 v[24:27], a[104:107], v[68:71], v[24:27]
    v_mul_f32 v19, v19, v35
    v_mul_f32 v20, v20, v36
    v_mfma_f32_16x16x32_bf16 v[28:31], a[108:111], v[68:71], v[28:31]
    v_mul_f32 v21, v21, v37
    v_mul_f32 v22, v22, v38
    v_mfma_f32_16x16x32_bf16 v[40:43], a[232:235], v[68:71], v[40:43]
    v_mul_f32 v23, v23, v39
    v_mfma_f32_16x16x32_bf16 v[44:47], a[236:239], v[68:71], v[44:47]
    s_waitcnt lgkmcnt(1)
    v_mfma_f32_16x16x32_bf16 v[24:27], a[112:115], v[72:75], v[24:27]
    v_cvt_pk_bf16_f32 v48, v16, v17
    v_cvt_pk_bf16_f32 v49, v18, v19
    v_mfma_f32_16x16x32_bf16 v[28:31], a[116:119], v[72:75], v[28:31]
    v_cvt_pk_bf16_f32 v50, v20, v21
    v_cvt_pk_bf16_f32 v51, v22, v23
    v_mfma_f32_16x16x32_bf16 v[40:43], a[240:243], v[72:75], v[40:43]
    v_mfma_f32_16x16x32_bf16 v[44:47], a[244:247], v[72:75], v[44:47]
    s_waitcnt lgkmcnt(0)
    v_mfma_f32_16x16x32_bf16 v[24:27], a[120:123], v[76:79], v[24:27]
    v_mfma_f32_16x16x32_bf16 v[28:31], a[124:127], v[76:79], v[28:31]
    v_mfma_f32_16x16x32_bf16 v[40:43], a[248:251], v[76:79], v[40:43]
    v_mfma_f32_16x16x32_bf16 v[44:47], a[252:255], v[76:79], v[44:47]
    v_mfma_f32_16x16x32_bf16 v[64:67], v[128:131], v[48:51], 0
    ds_write_b128 v5, v[48:51] offset:0
    v_mfma_f32_16x16x32_bf16 v[68:71], v[132:135], v[48:51], 0
    s_nop 1
    v_mfma_f32_16x16x32_bf16 v[80:83], v[160:163], v[48:51], 0
    s_nop 1
    v_mfma_f32_16x16x32_bf16 v[84:87], v[164:167], v[48:51], 0
    v_mul_f32 v24, s78, v24
    v_mul_f32 v25, s78, v25
    v_mfma_f32_16x16x32_bf16 v[96:99], v[192:195], v[48:51], 0
    v_mul_f32 v26, s78, v26
    v_mul_f32 v27, s78, v27
    v_mfma_f32_16x16x32_bf16 v[100:103], v[196:199], v[48:51], 0
    v_mul_f32 v28, s78, v28
    v_mul_f32 v29, s78, v29
    v_mfma_f32_16x16x32_bf16 v[112:115], v[224:227], v[48:51], 0
    v_mul_f32 v30, s78, v30
    v_mul_f32 v31, s78, v31
    v_mfma_f32_16x16x32_bf16 v[116:119], v[228:231], v[48:51], 0
    v_exp_f32 v24, v24
    v_exp_f32 v25, v25
    v_exp_f32 v26, v26
    v_exp_f32 v27, v27
    v_exp_f32 v28, v28
    v_exp_f32 v29, v29
    v_exp_f32 v30, v30
    v_exp_f32 v31, v31
    v_add_f32 v24, 1.0, v24
    v_add_f32 v25, 1.0, v25
    v_add_f32 v26, 1.0, v26
    v_add_f32 v27, 1.0, v27
    v_add_f32 v28, 1.0, v28
    v_add_f32 v29, 1.0, v29
    v_add_f32 v30, 1.0, v30
    v_add_f32 v31, 1.0, v31
    v_rcp_f32 v24, v24
    v_rcp_f32 v25, v25
    v_rcp_f32 v26, v26
    v_rcp_f32 v27, v27
    v_rcp_f32 v28, v28
    v_rcp_f32 v29, v29
    v_rcp_f32 v30, v30
    v_rcp_f32 v31, v31
    v_mul_f32 v24, v24, v40
    v_mul_f32 v25, v25, v41
    v_mul_f32 v26, v26, v42
    v_mul_f32 v27, v27, v43
    v_mul_f32 v28, v28, v44
    v_mul_f32 v29, v29, v45
    v_mul_f32 v30, v30, v46
    v_mul_f32 v31, v31, v47
    v_cvt_pk_bf16_f32 v52, v24, v25
    v_cvt_pk_bf16_f32 v53, v26, v27
    v_cvt_pk_bf16_f32 v54, v28, v29
    v_cvt_pk_bf16_f32 v55, v30, v31
    ds_write_b128 v5, v[52:55] offset:256
    s_nop 0
    v_mfma_f32_16x16x32_bf16 v[72:75], v[128:131], v[52:55], 0
    v_mfma_f32_16x16x32_bf16 v[76:79], v[132:135], v[52:55], 0
    v_mfma_f32_16x16x32_bf16 v[88:91], v[160:163], v[52:55], 0
    v_mfma_f32_16x16x32_bf16 v[92:95], v[164:167], v[52:55], 0
    s_waitcnt lgkmcnt(0)
    s_barrier
    ds_read_b128 v[16:19], v6 offset:0
    v_mfma_f32_16x16x32_bf16 v[104:107], v[192:195], v[52:55], 0
    ds_read_b128 v[20:23], v6 offset:256
    ds_read_b128 v[24:27], v7 offset:0
    v_mfma_f32_16x16x32_bf16 v[108:111], v[196:199], v[52:55], 0
    ds_read_b128 v[28:31], v7 offset:256
    v_mfma_f32_16x16x32_bf16 v[120:123], v[224:227], v[52:55], 0
    ds_read_b128 v[32:35], v8 offset:0
    v_mfma_f32_16x16x32_bf16 v[124:127], v[228:231], v[52:55], 0
    ds_read_b128 v[36:39], v8 offset:256
    s_waitcnt vmcnt(0)
    v_cmp_gt_u32 vcc, 1, v3
    s_cbranch_vccnz L_f_b0
    s_waitcnt lgkmcnt(5)
    v_mfma_f32_16x16x32_bf16 v[64:67], v[136:139], v[16:19], v[64:67]
    v_xor_b32 v9, 0, v2
    s_mov_b32 m0, s68
    s_add_u32 s23, s75, 4096
    buffer_load_dwordx4 v9, s[4:7], s75 offen offset:0 sc1 lds
    v_mfma_f32_16x16x32_bf16 v[68:71], v[140:143], v[16:19], v[68:71]
    v_xor_b32 v9, 128, v2
    buffer_load_dwordx4 v9, s[4:7], s75 offen offset:1024 sc1 lds
    s_waitcnt lgkmcnt(4)
    v_mfma_f32_16x16x32_bf16 v[72:75], v[136:139], v[20:23], v[72:75]
    v_xor_b32 v9, 256, v2
    buffer_load_dwordx4 v9, s[4:7], s75 offen offset:2048 sc1 lds
    v_mfma_f32_16x16x32_bf16 v[76:79], v[140:143], v[20:23], v[76:79]
    v_xor_b32 v9, 384, v2
    buffer_load_dwordx4 v9, s[4:7], s75 offen offset:3072 sc1 lds
    s_waitcnt lgkmcnt(3)
    v_mfma_f32_16x16x32_bf16 v[64:67], v[144:147], v[24:27], v[64:67]
    v_xor_b32 v9, 512, v2
    s_add_u32 m0, m0, 4096
    s_nop 0
    buffer_load_dwordx4 v9, s[4:7], s23 offen offset:0 sc1 lds
    v_mfma_f32_16x16x32_bf16 v[68:71], v[148:151], v[24:27], v[68:71]
    v_xor_b32 v9, 640, v2
    buffer_load_dwordx4 v9, s[4:7], s23 offen offset:1024 sc1 lds
    s_waitcnt lgkmcnt(2)
    v_mfma_f32_16x16x32_bf16 v[72:75], v[144:147], v[28:31], v[72:75]
    v_xor_b32 v9, 768, v2
    buffer_load_dwordx4 v9, s[4:7], s23 offen offset:2048 sc1 lds
    v_mfma_f32_16x16x32_bf16 v[76:79], v[148:151], v[28:31], v[76:79]
    v_xor_b32 v9, 896, v2
    buffer_load_dwordx4 v9, s[4:7], s23 offen offset:3072 sc1 lds
    s_waitcnt lgkmcnt(1)
    v_mfma_f32_16x16x32_bf16 v[64:67], v[152:155], v[32:35], v[64:67]
    v_mfma_f32_16x16x32_bf16 v[68:71], v[156:159], v[32:35], v[68:71]
    s_waitcnt lgkmcnt(0)
    v_mfma_f32_16x16x32_bf16 v[72:75], v[152:155], v[36:39], v[72:75]
    v_mfma_f32_16x16x32_bf16 v[76:79], v[156:159], v[36:39], v[76:79]
    v_mfma_f32_16x16x32_bf16 v[80:83], v[168:171], v[16:19], v[80:83]
    s_nop 1
    v_mfma_f32_16x16x32_bf16 v[84:87], v[172:175], v[16:19], v[84:87]
    s_nop 1
    v_mfma_f32_16x16x32_bf16 v[88:91], v[168:171], v[20:23], v[88:91]
    s_nop 0
    v_mfma_f32_16x16x32_bf16 v[92:95], v[172:175], v[20:23], v[92:95]
    v_cvt_pk_bf16_f32 v64, v64, v65
    v_cvt_pk_bf16_f32 v65, v66, v67
    v_mfma_f32_16x16x32_bf16 v[80:83], v[176:179], v[24:27], v[80:83]
    v_cvt_pk_bf16_f32 v66, v68, v69
    v_cvt_pk_bf16_f32 v67, v70, v71
    v_mfma_f32_16x16x32_bf16 v[84:87], v[180:183], v[24:27], v[84:87]
    v_cvt_pk_bf16_f32 v68, v72, v73
    v_cvt_pk_bf16_f32 v69, v74, v75
    v_mfma_f32_16x16x32_bf16 v[88:91], v[176:179], v[28:31], v[88:91]
    v_cvt_pk_bf16_f32 v70, v76, v77
    v_cvt_pk_bf16_f32 v71, v78, v79
    v_mfma_f32_16x16x32_bf16 v[92:95], v[180:183], v[28:31], v[92:95]
    v_mfma_f32_16x16x32_bf16 v[80:83], v[184:187], v[32:35], v[80:83]
    v_xor_b32 v9, 0, v1
    buffer_store_dwordx4 v[64:67], v9, s[4:7], s70 offen offset:0 sc1
    v_mfma_f32_16x16x32_bf16 v[84:87], v[188:191], v[32:35], v[84:87]
    v_mfma_f32_16x16x32_bf16 v[88:91], v[184:187], v[36:39], v[88:91]
    v_xor_b32 v9, 512, v1
    buffer_store_dwordx4 v[68:71], v9, s[4:7], s70 offen offset:0 sc1
    v_mfma_f32_16x16x32_bf16 v[92:95], v[188:191], v[36:39], v[92:95]
    v_mfma_f32_16x16x32_bf16 v[96:99], v[200:203], v[16:19], v[96:99]
    s_nop 1
    v_mfma_f32_16x16x32_bf16 v[100:103], v[204:207], v[16:19], v[100:103]
    s_nop 1
    v_mfma_f32_16x16x32_bf16 v[104:107], v[200:203], v[20:23], v[104:107]
    s_nop 0
    v_mfma_f32_16x16x32_bf16 v[108:111], v[204:207], v[20:23], v[108:111]
    v_cvt_pk_bf16_f32 v80, v80, v81
    v_cvt_pk_bf16_f32 v81, v82, v83
    v_mfma_f32_16x16x32_bf16 v[96:99], v[208:211], v[24:27], v[96:99]
    v_cvt_pk_bf16_f32 v82, v84, v85
    v_cvt_pk_bf16_f32 v83, v86, v87
    v_mfma_f32_16x16x32_bf16 v[100:103], v[212:215], v[24:27], v[100:103]
    v_cvt_pk_bf16_f32 v84, v88, v89
    v_cvt_pk_bf16_f32 v85, v90, v91
    v_mfma_f32_16x16x32_bf16 v[104:107], v[208:211], v[28:31], v[104:107]
    v_cvt_pk_bf16_f32 v86, v92, v93
    v_cvt_pk_bf16_f32 v87, v94, v95
    v_mfma_f32_16x16x32_bf16 v[108:111], v[212:215], v[28:31], v[108:111]
    v_mfma_f32_16x16x32_bf16 v[96:99], v[216:219], v[32:35], v[96:99]
    v_xor_b32 v9, 256, v1
    buffer_store_dwordx4 v[80:83], v9, s[4:7], s70 offen offset:2048 sc1
    v_mfma_f32_16x16x32_bf16 v[100:103], v[220:223], v[32:35], v[100:103]
    v_mfma_f32_16x16x32_bf16 v[104:107], v[216:219], v[36:39], v[104:107]
    v_xor_b32 v9, 768, v1
    buffer_store_dwordx4 v[84:87], v9, s[4:7], s70 offen offset:2048 sc1
    v_mfma_f32_16x16x32_bf16 v[108:111], v[220:223], v[36:39], v[108:111]
    v_mfma_f32_16x16x32_bf16 v[112:115], v[232:235], v[16:19], v[112:115]
    s_nop 1
    v_mfma_f32_16x16x32_bf16 v[116:119], v[236:239], v[16:19], v[116:119]
    s_nop 1
    v_mfma_f32_16x16x32_bf16 v[120:123], v[232:235], v[20:23], v[120:123]
    s_nop 0
    v_mfma_f32_16x16x32_bf16 v[124:127], v[236:239], v[20:23], v[124:127]
    v_cvt_pk_bf16_f32 v96, v96, v97
    v_cvt_pk_bf16_f32 v97, v98, v99
    v_mfma_f32_16x16x32_bf16 v[112:115], v[240:243], v[24:27], v[112:115]
    v_cvt_pk_bf16_f32 v98, v100, v101
    v_cvt_pk_bf16_f32 v99, v102, v103
    v_mfma_f32_16x16x32_bf16 v[116:119], v[244:247], v[24:27], v[116:119]
    v_cvt_pk_bf16_f32 v100, v104, v105
    v_cvt_pk_bf16_f32 v101, v106, v107
    v_mfma_f32_16x16x32_bf16 v[120:123], v[240:243], v[28:31], v[120:123]
    v_cvt_pk_bf16_f32 v102, v108, v109
    v_cvt_pk_bf16_f32 v103, v110, v111
    v_mfma_f32_16x16x32_bf16 v[124:127], v[244:247], v[28:31], v[124:127]
    v_mfma_f32_16x16x32_bf16 v[112:115], v[248:251], v[32:35], v[112:115]
    v_xor_b32 v9, 512, v1
    buffer_store_dwordx4 v[96:99], v9, s[4:7], s71 offen offset:0 sc1
    v_mfma_f32_16x16x32_bf16 v[116:119], v[252:255], v[32:35], v[116:119]
    v_mfma_f32_16x16x32_bf16 v[120:123], v[248:251], v[36:39], v[120:123]
    v_xor_b32 v9, 0, v1
    buffer_store_dwordx4 v[100:103], v9, s[4:7], s71 offen offset:0 sc1
    v_mfma_f32_16x16x32_bf16 v[124:127], v[252:255], v[36:39], v[124:127]
    s_nop 0
    v_cvt_pk_bf16_f32 v112, v112, v113
    v_cvt_pk_bf16_f32 v113, v114, v115
    s_nop 0
    v_cvt_pk_bf16_f32 v114, v116, v117
    v_cvt_pk_bf16_f32 v115, v118, v119
    v_cvt_pk_bf16_f32 v116, v120, v121
    v_cvt_pk_bf16_f32 v117, v122, v123
    v_cvt_pk_bf16_f32 v118, v124, v125
    v_cvt_pk_bf16_f32 v119, v126, v127
    v_xor_b32 v9, 768, v1
    buffer_store_dwordx4 v[112:115], v9, s[4:7], s71 offen offset:2048 sc1
    v_xor_b32 v9, 256, v1
    buffer_store_dwordx4 v[116:119], v9, s[4:7], s71 offen offset:2048 sc1
    s_cmp_lt_u32 s65, 128
    s_waitcnt vmcnt(8)
    s_cbranch_scc1 L_f_loop1
    s_branch L_f_done
L_f_b0:
    s_waitcnt lgkmcnt(5)
    v_mfma_f32_16x16x32_bf16 v[64:67], v[136:139], v[16:19], v[64:67]
    v_mfma_f32_16x16x32_bf16 v[68:71], v[140:143], v[16:19], v[68:71]
    s_waitcnt lgkmcnt(4)
    v_mfma_f32_16x16x32_bf16 v[72:75], v[136:139], v[20:23], v[72:75]
    v_mfma_f32_16x16x32_bf16 v[76:79], v[140:143], v[20:23], v[76:79]
    s_waitcnt lgkmcnt(3)
    v_mfma_f32_16x16x32_bf16 v[64:67], v[144:147], v[24:27], v[64:67]
    v_mfma_f32_16x16x32_bf16 v[68:71], v[148:151], v[24:27], v[68:71]
    s_waitcnt lgkmcnt(2)
    v_mfma_f32_16x16x32_bf16 v[72:75], v[144:147], v[28:31], v[72:75]
    v_mfma_f32_16x16x32_bf16 v[76:79], v[148:151], v[28:31], v[76:79]
    s_waitcnt lgkmcnt(1)
    v_mfma_f32_16x16x32_bf16 v[64:67], v[152:155], v[32:35], v[64:67]
    v_mfma_f32_16x16x32_bf16 v[68:71], v[156:159], v[32:35], v[68:71]
    s_waitcnt lgkmcnt(0)
    v_mfma_f32_16x16x32_bf16 v[72:75], v[152:155], v[36:39], v[72:75]
    v_mfma_f32_16x16x32_bf16 v[76:79], v[156:159], v[36:39], v[76:79]
    v_mfma_f32_16x16x32_bf16 v[80:83], v[168:171], v[16:19], v[80:83]
    s_nop 1
    v_mfma_f32_16x16x32_bf16 v[84:87], v[172:175], v[16:19], v[84:87]
    s_nop 1
    v_mfma_f32_16x16x32_bf16 v[88:91], v[168:171], v[20:23], v[88:91]
    s_nop 0
    v_mfma_f32_16x16x32_bf16 v[92:95], v[172:175], v[20:23], v[92:95]
    v_cvt_pk_bf16_f32 v64, v64, v65
    v_cvt_pk_bf16_f32 v65, v66, v67
    v_mfma_f32_16x16x32_bf16 v[80:83], v[176:179], v[24:27], v[80:83]
    v_cvt_pk_bf16_f32 v66, v68, v69
    v_cvt_pk_bf16_f32 v67, v70, v71
    v_mfma_f32_16x16x32_bf16 v[84:87], v[180:183], v[24:27], v[84:87]
    v_cvt_pk_bf16_f32 v68, v72, v73
    v_cvt_pk_bf16_f32 v69, v74, v75
    v_mfma_f32_16x16x32_bf16 v[88:91], v[176:179], v[28:31], v[88:91]
    v_cvt_pk_bf16_f32 v70, v76, v77
    v_cvt_pk_bf16_f32 v71, v78, v79
    v_mfma_f32_16x16x32_bf16 v[92:95], v[180:183], v[28:31], v[92:95]
    v_mfma_f32_16x16x32_bf16 v[80:83], v[184:187], v[32:35], v[80:83]
    v_xor_b32 v9, 0, v1
    buffer_store_dwordx4 v[64:67], v9, s[4:7], s70 offen offset:0 sc1
    v_mfma_f32_16x16x32_bf16 v[84:87], v[188:191], v[32:35], v[84:87]
    v_mfma_f32_16x16x32_bf16 v[88:91], v[184:187], v[36:39], v[88:91]
    v_xor_b32 v9, 512, v1
    buffer_store_dwordx4 v[68:71], v9, s[4:7], s70 offen offset:0 sc1
    v_mfma_f32_16x16x32_bf16 v[92:95], v[188:191], v[36:39], v[92:95]
    v_mfma_f32_16x16x32_bf16 v[96:99], v[200:203], v[16:19], v[96:99]
    s_nop 1
    v_mfma_f32_16x16x32_bf16 v[100:103], v[204:207], v[16:19], v[100:103]
    s_nop 1
    v_mfma_f32_16x16x32_bf16 v[104:107], v[200:203], v[20:23], v[104:107]
    s_nop 0
    v_mfma_f32_16x16x32_bf16 v[108:111], v[204:207], v[20:23], v[108:111]
    v_cvt_pk_bf16_f32 v80, v80, v81
    v_cvt_pk_bf16_f32 v81, v82, v83
    v_mfma_f32_16x16x32_bf16 v[96:99], v[208:211], v[24:27], v[96:99]
    v_cvt_pk_bf16_f32 v82, v84, v85
    v_cvt_pk_bf16_f32 v83, v86, v87
    v_mfma_f32_16x16x32_bf16 v[100:103], v[212:215], v[24:27], v[100:103]
    v_cvt_pk_bf16_f32 v84, v88, v89
    v_cvt_pk_bf16_f32 v85, v90, v91
    v_mfma_f32_16x16x32_bf16 v[104:107], v[208:211], v[28:31], v[104:107]
    v_cvt_pk_bf16_f32 v86, v92, v93
    v_cvt_pk_bf16_f32 v87, v94, v95
    v_mfma_f32_16x16x32_bf16 v[108:111], v[212:215], v[28:31], v[108:111]
    v_mfma_f32_16x16x32_bf16 v[96:99], v[216:219], v[32:35], v[96:99]
    v_xor_b32 v9, 256, v1
    buffer_store_dwordx4 v[80:83], v9, s[4:7], s70 offen offset:2048 sc1
    v_mfma_f32_16x16x32_bf16 v[100:103], v[220:223], v[32:35], v[100:103]
    v_mfma_f32_16x16x32_bf16 v[104:107], v[216:219], v[36:39], v[104:107]
    v_xor_b32 v9, 768, v1
    buffer_store_dwordx4 v[84:87], v9, s[4:7], s70 offen offset:2048 sc1
    v_mfma_f32_16x16x32_bf16 v[108:111], v[220:223], v[36:39], v[108:111]
    v_mfma_f32_16x16x32_bf16 v[112:115], v[232:235], v[16:19], v[112:115]
    s_nop 1
    v_mfma_f32_16x16x32_bf16 v[116:119], v[236:239], v[16:19], v[116:119]
    s_nop 1
    v_mfma_f32_16x16x32_bf16 v[120:123], v[232:235], v[20:23], v[120:123]
    s_nop 0
    v_mfma_f32_16x16x32_bf16 v[124:127], v[236:239], v[20:23], v[124:127]
    v_cvt_pk_bf16_f32 v96, v96, v97
    v_cvt_pk_bf16_f32 v97, v98, v99
    v_mfma_f32_16x16x32_bf16 v[112:115], v[240:243], v[24:27], v[112:115]
    v_cvt_pk_bf16_f32 v98, v100, v101
    v_cvt_pk_bf16_f32 v99, v102, v103
    v_mfma_f32_16x16x32_bf16 v[116:119], v[244:247], v[24:27], v[116:119]
    v_cvt_pk_bf16_f32 v100, v104, v105
    v_cvt_pk_bf16_f32 v101, v106, v107
    v_mfma_f32_16x16x32_bf16 v[120:123], v[240:243], v[28:31], v[120:123]
    v_cvt_pk_bf16_f32 v102, v108, v109
    v_cvt_pk_bf16_f32 v103, v110, v111
    v_mfma_f32_16x16x32_bf16 v[124:127], v[244:247], v[28:31], v[124:127]
    v_mfma_f32_16x16x32_bf16 v[112:115], v[248:251], v[32:35], v[112:115]
    v_xor_b32 v9, 512, v1
    buffer_store_dwordx4 v[96:99], v9, s[4:7], s71 offen offset:0 sc1
    v_mfma_f32_16x16x32_bf16 v[116:119], v[252:255], v[32:35], v[116:119]
    v_mfma_f32_16x16x32_bf16 v[120:123], v[248:251], v[36:39], v[120:123]
    v_xor_b32 v9, 0, v1
    buffer_store_dwordx4 v[100:103], v9, s[4:7], s71 offen offset:0 sc1
    v_mfma_f32_16x16x32_bf16 v[124:127], v[252:255], v[36:39], v[124:127]
    s_nop 0
    v_cvt_pk_bf16_f32 v112, v112, v113
    v_cvt_pk_bf16_f32 v113, v114, v115
    s_nop 0
    v_cvt_pk_bf16_f32 v114, v116, v117
    v_cvt_pk_bf16_f32 v115, v118, v119
    v_cvt_pk_bf16_f32 v116, v120, v121
    v_cvt_pk_bf16_f32 v117, v122, v123
    v_cvt_pk_bf16_f32 v118, v124, v125
    v_cvt_pk_bf16_f32 v119, v126, v127
    v_xor_b32 v9, 768, v1
    buffer_store_dwordx4 v[112:115], v9, s[4:7], s71 offen offset:2048 sc1
    v_xor_b32 v9, 256, v1
    buffer_store_dwordx4 v[116:119], v9, s[4:7], s71 offen offset:2048 sc1
    s_waitcnt vmcnt(0)
    s_mov_b64 exec, 1
    buffer_store_dword v4, off, s[4:7], s76 sc1
    s_mov_b64 exec, -1
    s_mov_b32 s76, 0
    s_cmp_lt_u32 s65, 128
    s_cbranch_scc1 L_f_block
    s_branch L_dump_role_f
L_f_done:
    s_waitcnt vmcnt(0)
    s_mov_b64 exec, 1
    buffer_store_dword v4, off, s[4:7], s76 sc1
    s_mov_b64 exec, -1
L_dump_role_f:
    s_branch L_end
L_end:
    s_endpgm
.section .rodata,"a"
.p2align 6
.amdhsa_kernel interleave_layers__memory_aug_recurrent_mem_tr__glu_gated_glu__prompt_kernel
  .amdhsa_next_free_vgpr 512
  .amdhsa_next_free_sgpr 102
  .amdhsa_accum_offset 256
  .amdhsa_group_segment_fixed_size 0
  .amdhsa_kernarg_size 112
  .amdhsa_user_sgpr_count 2
  .amdhsa_user_sgpr_kernarg_segment_ptr 1
  .amdhsa_system_sgpr_workgroup_id_x 1
.end_amdhsa_kernel
```
